```python
import torch

def _softmax(x, axis=-1):
    return torch.softmax(x, dim=axis)

def _gelu(x):
    return torch.nn.functional.gelu(x, approximate='tanh')

def _silu(x):
    return torch.nn.functional.silu(x)

def _sigmoid(x):
    return torch.sigmoid(x)

def _layernorm(x, axis=-1, eps=1e-05):
    m = x.mean(dim=axis, keepdim=True)
    v = x.var(dim=axis, keepdim=True, unbiased=False)
    return (x - m) / torch.sqrt(v + eps)

def _scatter_add(tgt, idx, src, axis=0):
    return tgt.clone().index_add_(axis, idx, src)

def _segment_sum(src, seg, n):
    out = torch.zeros((n,) + src.shape[1:], dtype=src.dtype)
    return out.index_add_(0, seg, src)

def _pad(x, pw):
    flat = tuple((v for pair in reversed(pw) for v in pair))
    return torch.nn.functional.pad(x, flat)
kernel_name = 'adaLN_cond__gqa_block_cached__glu_gated_swiglu__prompt'

def setup_inputs():

    _w = lambda a: (lambda t: t.to(torch.bfloat16) if t.is_floating_point() else t)(torch.as_tensor(a))

    def _A_setup():
        B, Sq, D = (1, 2048, 576)
        Hq, Hkv, Sk, Dh = (32, 16, 2048, 128)
        assert Hq % Hkv == 0, (Hq, Hkv)
        return {'x': _w((lambda *s: torch.randn(*s, dtype=torch.bfloat16) * 0.05)(B, Sq, D)), 'k_cache': _w((lambda *s: torch.randn(*s, dtype=torch.bfloat16) * 3.2)(B, Hkv, Sk, Dh)), 'v_cache': _w((lambda *s: torch.randn(*s, dtype=torch.bfloat16) * 1.6)(B, Hkv, Sk, Dh)), 'wq': _w((lambda *s: torch.randn(*s, dtype=torch.bfloat16) * 3.2)(D, Hq * Dh) * D ** (-0.5)), 'wo': _w((lambda *s: torch.randn(*s, dtype=torch.bfloat16) * 1.6)(Hq * Dh, D) * (Hq * Dh) ** (-0.5))}
    _A_in = _A_setup()

    def _B_setup():
        B, S, D, F = (1, 2048, 576, 4608)
        return {'x': _w((lambda *s: torch.randn(*s, dtype=torch.bfloat16) * 0.05)(B, S, D)), 'w1': _w((lambda *s: torch.randn(*s, dtype=torch.bfloat16) * 0.8)(D, F) * (2.0 / D) ** 0.5), 'w3': _w((lambda *s: torch.randn(*s, dtype=torch.bfloat16) * 0.8)(D, F) * (2.0 / D) ** 0.5), 'w2': _w((lambda *s: torch.randn(*s, dtype=torch.bfloat16) * 0.8)(F, D) * (2.0 / F) ** 0.5)}
    _B_in = _B_setup()
    return {'A_x': _A_in['x'], 'A_k_cache': _A_in['k_cache'], 'A_v_cache': _A_in['v_cache'], 'A_wq': _A_in['wq'], 'A_wo': _A_in['wo'], 'B_x': _B_in['x'], 'B_w1': _B_in['w1'], 'B_w3': _B_in['w3'], 'B_w2': _B_in['w2'], 'c': _w((lambda *s: torch.randn(*s, dtype=torch.bfloat16) * 0.2)(1, 576) * 8.0), 'w_mod': _w((lambda *s: torch.randn(*s, dtype=torch.bfloat16) * 0.2)(576, 6 * 576) * 576 ** (-0.5) * 8.0)}

def reference(A_x, A_k_cache, A_v_cache, A_wq, A_wo, B_x, B_w1, B_w3, B_w2, c, w_mod):

    def _A_ref(x, k_cache, v_cache, wq, wo):
        B, Sq, D = x.shape
        Hq, Dh = (32, 128)
        Hkv = k_cache.shape[1]
        rep = Hq // Hkv
        q = (lambda x, *d: x.permute(*d))((x @ wq).reshape(B, Sq, Hq, Dh), 0, 2, 1, 3)
        k = (lambda x, n, axis: torch.repeat_interleave(x, n, dim=axis))(k_cache, rep, axis=1)
        v = (lambda x, n, axis: torch.repeat_interleave(x, n, dim=axis))(v_cache, rep, axis=1)
        scores = torch.einsum('bhqd,bhkd->bhqk', q, k) * Dh ** (-0.5)
        p = _softmax(scores, axis=-1)
        o = torch.einsum('bhqk,bhkd->bhqd', p, v)
        return (lambda x, *d: x.permute(*d))(o, 0, 2, 1, 3).reshape(B, Sq, Hq * Dh) @ wo

    def _B_ref(x, w1, w3, w2):
        gate = torch.einsum('bsd,df->bsf', x, w1)
        up = torch.einsum('bsd,df->bsf', x, w3)
        h = _silu(gate) * up
        out = torch.einsum('bsf,fd->bsd', h, w2)
        return out
    x = A_x
    mod = (_silu(c) @ w_mod).reshape(c.shape[0], 6, 1, -1)
    sa, ca, ga, sb, cb, gb = (mod[:, 0].clone(), mod[:, 1].clone(), mod[:, 2].clone(), mod[:, 3].clone(), mod[:, 4].clone(), mod[:, 5].clone())
    h = _layernorm(x, axis=-1) * (1 + ca) + sa
    x = x + ga * _A_ref(h, A_k_cache, A_v_cache, A_wq, A_wo)
    h = _layernorm(x, axis=-1) * (1 + cb) + sb
    x = x + gb * _B_ref(h, B_w1, B_w3, B_w2)
    return x
```

```asm
; @launch kernel=attn_kernel grid=(256,1,1) block=(256,1,1) lds=161280
; @launch kernel=wo_kernel grid=(256,1,1) block=(256,1,1) lds=160000
.amdgcn_target "amdgcn-amd-amdhsa--gfx950"
.text
.globl attn_kernel
.p2align 8
.type attn_kernel,@function
attn_kernel:
  s_cmp_ge_u32 s2, 0x100
  s_cbranch_scc1 attn_end
  s_load_dwordx2 s[80:81], s[0:1], 0
  s_load_dwordx2 s[84:85], s[0:1], 96
  s_mov_b32 s82, 0x240000
  s_mov_b32 s83, 0x20000
  s_mov_b32 s86, 0x100
  s_mov_b32 s87, 0x20000
  v_lshrrev_b32 v21, 6, v0
  v_and_b32 v17, 31, v0
  v_readfirstlane_b32 s101, v21
  v_lshrrev_b32 v18, 5, v0
  s_lshl_b32 s37, s2, 3
  v_add_u32 v19, s37, v18
  v_mul_u32_u24 v19, 0x480, v19
  v_lshl_add_u32 v19, v17, 2, v19
  s_memrealtime s[88:89]
  s_waitcnt lgkmcnt(0)
  s_lshl_b32 s37, s2, 2
  s_or_b32 s37, s37, s101
  s_cmp_lg_u32 s37, 0
  s_cbranch_scc1 tag_done
  s_or_b32 s88, s88, 1
  s_mov_b64 exec, 1
  v_mov_b32 v21, s88
  buffer_store_dword v21, off, s[84:87], 0 sc1
  s_mov_b64 exec, -1
tag_done:
  buffer_load_dword v32, v19, s[80:83], 0 offen
  buffer_load_dword v33, v19, s[80:83], 0 offen offset:128
  buffer_load_dword v34, v19, s[80:83], 0 offen offset:256
  buffer_load_dword v35, v19, s[80:83], 0 offen offset:384
  buffer_load_dword v36, v19, s[80:83], 0 offen offset:512
  buffer_load_dword v37, v19, s[80:83], 0 offen offset:640
  buffer_load_dword v38, v19, s[80:83], 0 offen offset:768
  buffer_load_dword v39, v19, s[80:83], 0 offen offset:896
  buffer_load_dword v40, v19, s[80:83], 0 offen offset:1024
  s_cmp_ge_u32 s2, 0xa2
  s_cbranch_scc1 mod_pf
  s_load_dwordx2 s[4:5], s[0:1], 80
  s_load_dwordx2 s[6:7], s[0:1], 72
  s_load_dwordx2 s[24:25], s[0:1], 104
  s_mul_i32 s21, s2, 0x4be
  s_lshr_b32 s21, s21, 16
  s_mul_i32 s22, s21, 54
  s_sub_u32 s20, s2, s22
  s_mul_i32 s23, s21, 0x3600
  s_lshl_b32 s22, s20, 8
  s_add_u32 s23, s23, s22
  s_mul_i32 s34, s21, 18
  s_add_u32 s34, s34, s20
  s_lshl_b32 s34, s34, 7
  s_mul_i32 s21, s21, 0xc0
  v_lshrrev_b32 v121, 3, v0
  v_add_u32 v121, s21, v121
  v_lshlrev_b32 v123, 1, v121
  v_mul_u32_u24 v122, 0x1b00, v121
  v_and_b32 v124, 7, v0
  v_lshl_add_u32 v122, v124, 4, v122
  s_lshl_b32 s22, s20, 7
  v_add_u32 v122, s22, v122
  s_waitcnt lgkmcnt(0)
  s_mov_b32 s8, s4
  s_mov_b32 s9, s5
  s_mov_b32 s10, 0x3cc000
  s_mov_b32 s11, 0x20000
  s_mov_b32 s12, s6
  s_mov_b32 s13, s7
  s_mov_b32 s14, 0x480
  s_mov_b32 s15, 0x20000
  s_mov_b32 s16, s24
  s_mov_b32 s17, s25
  s_mov_b32 s18, 0xa200
  s_mov_b32 s19, 0x20000
  s_add_u32 s28, s24, 0x70000
  s_addc_u32 s29, s25, 0
  s_mov_b32 s30, 0x8000
  s_mov_b32 s31, 0x20000
  buffer_load_ushort v136, v123, s[12:15], 0 offen
  buffer_load_ushort v137, v123, s[12:15], 0 offen offset:64
  buffer_load_ushort v138, v123, s[12:15], 0 offen offset:128
  buffer_load_ushort v139, v123, s[12:15], 0 offen offset:192
  buffer_load_ushort v140, v123, s[12:15], 0 offen offset:256
  buffer_load_ushort v141, v123, s[12:15], 0 offen offset:320
  s_mov_b32 s26, 0
  buffer_load_dwordx4 v[168:171], v122, s[8:11], s26 offen
  s_mov_b32 s27, 0x36000
  buffer_load_dwordx4 v[172:175], v122, s[8:11], s27 offen
  s_mov_b32 s26, 0x6c000
  buffer_load_dwordx4 v[176:179], v122, s[8:11], s26 offen
  s_mov_b32 s27, 0xa2000
  buffer_load_dwordx4 v[180:183], v122, s[8:11], s27 offen
  s_mov_b32 s26, 0xd8000
  buffer_load_dwordx4 v[184:187], v122, s[8:11], s26 offen
  s_mov_b32 s27, 0x10e000
  buffer_load_dwordx4 v[188:191], v122, s[8:11], s27 offen
  s_waitcnt vmcnt(11)
  v_lshlrev_b32 v136, 16, v136
  v_mul_f32 v124, 0xbfb8aa3b, v136
  v_exp_f32 v124, v124
  s_nop 0
  v_add_f32 v124, 1.0, v124
  v_rcp_f32 v124, v124
  s_nop 0
  v_mul_f32 v136, v136, v124
  v_cvt_pk_bf16_f32 v136, v136, v136
  v_lshlrev_b32 v136, 16, v136
  s_waitcnt vmcnt(10)
  v_lshlrev_b32 v137, 16, v137
  v_mul_f32 v124, 0xbfb8aa3b, v137
  v_exp_f32 v124, v124
  s_nop 0
  v_add_f32 v124, 1.0, v124
  v_rcp_f32 v124, v124
  s_nop 0
  v_mul_f32 v137, v137, v124
  v_cvt_pk_bf16_f32 v137, v137, v137
  v_lshlrev_b32 v137, 16, v137
  s_waitcnt vmcnt(9)
  v_lshlrev_b32 v138, 16, v138
  v_mul_f32 v124, 0xbfb8aa3b, v138
  v_exp_f32 v124, v124
  s_nop 0
  v_add_f32 v124, 1.0, v124
  v_rcp_f32 v124, v124
  s_nop 0
  v_mul_f32 v138, v138, v124
  v_cvt_pk_bf16_f32 v138, v138, v138
  v_lshlrev_b32 v138, 16, v138
  s_waitcnt vmcnt(8)
  v_lshlrev_b32 v139, 16, v139
  v_mul_f32 v124, 0xbfb8aa3b, v139
  v_exp_f32 v124, v124
  s_nop 0
  v_add_f32 v124, 1.0, v124
  v_rcp_f32 v124, v124
  s_nop 0
  v_mul_f32 v139, v139, v124
  v_cvt_pk_bf16_f32 v139, v139, v139
  v_lshlrev_b32 v139, 16, v139
  s_waitcnt vmcnt(7)
  v_lshlrev_b32 v140, 16, v140
  v_mul_f32 v124, 0xbfb8aa3b, v140
  v_exp_f32 v124, v124
  s_nop 0
  v_add_f32 v124, 1.0, v124
  v_rcp_f32 v124, v124
  s_nop 0
  v_mul_f32 v140, v140, v124
  v_cvt_pk_bf16_f32 v140, v140, v140
  v_lshlrev_b32 v140, 16, v140
  s_waitcnt vmcnt(6)
  v_lshlrev_b32 v141, 16, v141
  v_mul_f32 v124, 0xbfb8aa3b, v141
  v_exp_f32 v124, v124
  s_nop 0
  v_add_f32 v124, 1.0, v124
  v_rcp_f32 v124, v124
  s_nop 0
  v_mul_f32 v141, v141, v124
  v_cvt_pk_bf16_f32 v141, v141, v141
  v_lshlrev_b32 v141, 16, v141
  s_waitcnt vmcnt(5)
  v_lshlrev_b32 v124, 16, v168
  v_and_b32 v125, 0xffff0000, v168
  v_mul_f32 v160, v136, v124
  v_mul_f32 v161, v136, v125
  v_lshlrev_b32 v124, 16, v169
  v_and_b32 v125, 0xffff0000, v169
  v_mul_f32 v162, v136, v124
  v_mul_f32 v163, v136, v125
  v_lshlrev_b32 v124, 16, v170
  v_and_b32 v125, 0xffff0000, v170
  v_mul_f32 v164, v136, v124
  v_mul_f32 v165, v136, v125
  v_lshlrev_b32 v124, 16, v171
  v_and_b32 v125, 0xffff0000, v171
  v_mul_f32 v166, v136, v124
  v_mul_f32 v167, v136, v125
  s_waitcnt vmcnt(4)
  v_lshlrev_b32 v124, 16, v172
  v_and_b32 v125, 0xffff0000, v172
  v_fmac_f32 v160, v137, v124
  v_fmac_f32 v161, v137, v125
  v_lshlrev_b32 v124, 16, v173
  v_and_b32 v125, 0xffff0000, v173
  v_fmac_f32 v162, v137, v124
  v_fmac_f32 v163, v137, v125
  v_lshlrev_b32 v124, 16, v174
  v_and_b32 v125, 0xffff0000, v174
  v_fmac_f32 v164, v137, v124
  v_fmac_f32 v165, v137, v125
  v_lshlrev_b32 v124, 16, v175
  v_and_b32 v125, 0xffff0000, v175
  v_fmac_f32 v166, v137, v124
  v_fmac_f32 v167, v137, v125
  s_waitcnt vmcnt(3)
  v_lshlrev_b32 v124, 16, v176
  v_and_b32 v125, 0xffff0000, v176
  v_fmac_f32 v160, v138, v124
  v_fmac_f32 v161, v138, v125
  v_lshlrev_b32 v124, 16, v177
  v_and_b32 v125, 0xffff0000, v177
  v_fmac_f32 v162, v138, v124
  v_fmac_f32 v163, v138, v125
  v_lshlrev_b32 v124, 16, v178
  v_and_b32 v125, 0xffff0000, v178
  v_fmac_f32 v164, v138, v124
  v_fmac_f32 v165, v138, v125
  v_lshlrev_b32 v124, 16, v179
  v_and_b32 v125, 0xffff0000, v179
  v_fmac_f32 v166, v138, v124
  v_fmac_f32 v167, v138, v125
  s_waitcnt vmcnt(2)
  v_lshlrev_b32 v124, 16, v180
  v_and_b32 v125, 0xffff0000, v180
  v_fmac_f32 v160, v139, v124
  v_fmac_f32 v161, v139, v125
  v_lshlrev_b32 v124, 16, v181
  v_and_b32 v125, 0xffff0000, v181
  v_fmac_f32 v162, v139, v124
  v_fmac_f32 v163, v139, v125
  v_lshlrev_b32 v124, 16, v182
  v_and_b32 v125, 0xffff0000, v182
  v_fmac_f32 v164, v139, v124
  v_fmac_f32 v165, v139, v125
  v_lshlrev_b32 v124, 16, v183
  v_and_b32 v125, 0xffff0000, v183
  v_fmac_f32 v166, v139, v124
  v_fmac_f32 v167, v139, v125
  s_waitcnt vmcnt(1)
  v_lshlrev_b32 v124, 16, v184
  v_and_b32 v125, 0xffff0000, v184
  v_fmac_f32 v160, v140, v124
  v_fmac_f32 v161, v140, v125
  v_lshlrev_b32 v124, 16, v185
  v_and_b32 v125, 0xffff0000, v185
  v_fmac_f32 v162, v140, v124
  v_fmac_f32 v163, v140, v125
  v_lshlrev_b32 v124, 16, v186
  v_and_b32 v125, 0xffff0000, v186
  v_fmac_f32 v164, v140, v124
  v_fmac_f32 v165, v140, v125
  v_lshlrev_b32 v124, 16, v187
  v_and_b32 v125, 0xffff0000, v187
  v_fmac_f32 v166, v140, v124
  v_fmac_f32 v167, v140, v125
  s_waitcnt vmcnt(0)
  v_lshlrev_b32 v124, 16, v188
  v_and_b32 v125, 0xffff0000, v188
  v_fmac_f32 v160, v141, v124
  v_fmac_f32 v161, v141, v125
  v_lshlrev_b32 v124, 16, v189
  v_and_b32 v125, 0xffff0000, v189
  v_fmac_f32 v162, v141, v124
  v_fmac_f32 v163, v141, v125
  v_lshlrev_b32 v124, 16, v190
  v_and_b32 v125, 0xffff0000, v190
  v_fmac_f32 v164, v141, v124
  v_fmac_f32 v165, v141, v125
  v_lshlrev_b32 v124, 16, v191
  v_and_b32 v125, 0xffff0000, v191
  v_fmac_f32 v166, v141, v124
  v_fmac_f32 v167, v141, v125
  v_mov_b32 v130, 0
  buffer_load_dword v131, v130, s[84:87], 0 offen sc1
  v_lshlrev_b32 v124, 5, v0
  v_add_u32 v124, 0x24000, v124
  ds_write_b128 v124, v[160:163]
  ds_write_b128 v124, v[164:167] offset:16
  v_lshlrev_b32 v125, 2, v0
  v_add_u32 v124, 0x24000, v125
  s_waitcnt lgkmcnt(0)
  s_barrier
  s_cmp_lg_u32 s101, 0
  s_cbranch_scc1 mod_done
mod_w0:
  ds_read_b32 v168, v124
  ds_read_b32 v169, v124 offset:256
  ds_read_b32 v170, v124 offset:512
  ds_read_b32 v171, v124 offset:768
  ds_read_b32 v172, v124 offset:1024
  ds_read_b32 v173, v124 offset:1280
  ds_read_b32 v174, v124 offset:1536
  ds_read_b32 v175, v124 offset:1792
  ds_read_b32 v176, v124 offset:2048
  ds_read_b32 v177, v124 offset:2304
  ds_read_b32 v178, v124 offset:2560
  ds_read_b32 v179, v124 offset:2816
  ds_read_b32 v180, v124 offset:3072
  ds_read_b32 v181, v124 offset:3328
  ds_read_b32 v182, v124 offset:3584
  ds_read_b32 v183, v124 offset:3840
  ds_read_b32 v184, v124 offset:4096
  ds_read_b32 v185, v124 offset:4352
  ds_read_b32 v186, v124 offset:4608
  ds_read_b32 v187, v124 offset:4864
  ds_read_b32 v188, v124 offset:5120
  ds_read_b32 v189, v124 offset:5376
  ds_read_b32 v190, v124 offset:5632
  ds_read_b32 v191, v124 offset:5888
  ds_read_b32 v192, v124 offset:6144
  ds_read_b32 v193, v124 offset:6400
  ds_read_b32 v194, v124 offset:6656
  ds_read_b32 v195, v124 offset:6912
  ds_read_b32 v196, v124 offset:7168
  ds_read_b32 v197, v124 offset:7424
  ds_read_b32 v198, v124 offset:7680
  ds_read_b32 v199, v124 offset:7936
  s_waitcnt lgkmcnt(15)
  v_add_f32 v168, v168, v184
  s_waitcnt lgkmcnt(14)
  v_add_f32 v169, v169, v185
  s_waitcnt lgkmcnt(13)
  v_add_f32 v170, v170, v186
  s_waitcnt lgkmcnt(12)
  v_add_f32 v171, v171, v187
  s_waitcnt lgkmcnt(11)
  v_add_f32 v172, v172, v188
  s_waitcnt lgkmcnt(10)
  v_add_f32 v173, v173, v189
  s_waitcnt lgkmcnt(9)
  v_add_f32 v174, v174, v190
  s_waitcnt lgkmcnt(8)
  v_add_f32 v175, v175, v191
  s_waitcnt lgkmcnt(7)
  v_add_f32 v176, v176, v192
  s_waitcnt lgkmcnt(6)
  v_add_f32 v177, v177, v193
  s_waitcnt lgkmcnt(5)
  v_add_f32 v178, v178, v194
  s_waitcnt lgkmcnt(4)
  v_add_f32 v179, v179, v195
  s_waitcnt lgkmcnt(3)
  v_add_f32 v180, v180, v196
  s_waitcnt lgkmcnt(2)
  v_add_f32 v181, v181, v197
  s_waitcnt lgkmcnt(1)
  v_add_f32 v182, v182, v198
  s_waitcnt lgkmcnt(0)
  v_add_f32 v183, v183, v199
  v_add_f32 v168, v168, v176
  v_add_f32 v169, v169, v177
  v_add_f32 v170, v170, v178
  v_add_f32 v171, v171, v179
  v_add_f32 v172, v172, v180
  v_add_f32 v173, v173, v181
  v_add_f32 v174, v174, v182
  v_add_f32 v175, v175, v183
  v_add_f32 v168, v168, v172
  v_add_f32 v169, v169, v173
  v_add_f32 v170, v170, v174
  v_add_f32 v171, v171, v175
  v_add_f32 v168, v168, v170
  v_add_f32 v169, v169, v171
  v_add_f32 v168, v168, v169
  buffer_store_dword v168, v125, s[16:19], s23 offen sc1
  s_cmp_ge_u32 s20, 18
  s_cbranch_scc1 mod_done
  s_waitcnt vmcnt(0)
  v_cmp_eq_u32 vcc, 0, v131
  s_nop 1
  s_cbranch_vccz mod_tag_ok
  s_mov_b32 s22, 0x40000
mod_tag:
  buffer_load_dword v131, v130, s[84:87], 0 offen sc1
  s_waitcnt vmcnt(0)
  v_cmp_eq_u32 vcc, 0, v131
  s_nop 1
  s_cbranch_vccz mod_tag_ok
  s_sleep 2
  s_sub_u32 s22, s22, 1
  s_cbranch_scc0 mod_tag
mod_tag_ok:
  s_mov_b64 exec, 1
  buffer_store_dword v131, off, s[28:31], s34 sc1
  s_mov_b64 exec, -1
  s_branch mod_done
mod_done:
  s_load_dwordx2 s[4:5], s[0:1], 104
  s_load_dwordx2 s[6:7], s[0:1], 24
  s_load_dwordx2 s[44:45], s[0:1], 8
  s_load_dwordx2 s[46:47], s[0:1], 16
  s_load_dwordx2 s[72:73], s[0:1], 32
  s_load_dwordx2 s[74:75], s[0:1], 48
  s_load_dwordx2 s[76:77], s[0:1], 56
  s_load_dwordx2 s[78:79], s[0:1], 64
  v_and_b32 v1, 63, v0
  v_lshrrev_b32 v2, 6, v0
  s_nop 0
  v_readfirstlane_b32 s32, v2
  s_and_b32 s33, s2, 7
  s_lshl_b32 s33, s33, 2
  s_lshr_b32 s34, s2, 3
  s_and_b32 s37, s34, 3
  s_add_u32 s33, s33, s37
  s_lshr_b32 s34, s34, 2
  s_lshl_b32 s34, s34, 4
  s_lshl_b32 s37, s32, 2
  s_add_u32 s34, s34, s37
  s_lshl_b32 s28, s32, 11
  s_lshl_b32 s29, s32, 12
  s_waitcnt lgkmcnt(0)
  s_add_u32 s8, s4, 0x100000
  s_addc_u32 s9, s5, 0
  s_mov_b32 s10, 0x240000
  s_mov_b32 s11, 0x20000
  s_add_u32 s24, s4, 0x400000
  s_addc_u32 s25, s5, 0
  s_mov_b32 s26, 0x1000000
  s_mov_b32 s27, 0x20000
  s_mov_b32 s12, s6
  s_mov_b32 s13, s7
  s_mov_b32 s14, 0x480000
  s_mov_b32 s15, 0x20000
  s_lshr_b32 s37, s33, 1
  s_lshl_b32 s37, s37, 19
  s_add_u32 s16, s44, s37
  s_addc_u32 s17, s45, 0
  s_mov_b32 s18, 0x80000
  s_mov_b32 s19, 0x20000
  s_add_u32 s20, s46, s37
  s_addc_u32 s21, s47, 0
  s_mov_b32 s22, 0x80000
  s_mov_b32 s23, 0x20000
  v_lshrrev_b32 v3, 4, v1
  v_and_b32 v4, 15, v1
  v_lshlrev_b32 v5, 2, v3
  v_xor_b32 v5, v5, v4
  v_lshlrev_b32 v5, 4, v5
  v_lshl_add_u32 v6, v2, 4, v3
  v_lshl_add_u32 v5, v6, 13, v5
  s_lshl_b32 s37, s33, 8
  v_add_u32 v244, s37, v5
  v_add_u32 v245, 0x7c00, v244
  v_add_u32 v246, 0xf800, v244
  v_add_u32 v247, 0x17400, v244
  s_mul_i32 s37, s34, 0x4800
  v_lshlrev_b32 v5, 4, v1
  v_add_u32 v248, s37, v5
  v_add_u32 v249, 0x4800, v248
  v_add_u32 v250, 0x9000, v248
  v_add_u32 v251, 0xd800, v248
  s_mul_i32 s37, s34, 0x20000
  s_lshl_b32 s38, s33, 12
  s_add_u32 s37, s37, s38
  v_add_u32 v252, s37, v5
  s_mov_b32 s35, 0
  s_mov_b32 s36, 0
  s_mov_b32 s48, 0
  s_mov_b32 s49, 0x20000
  s_mov_b32 s50, 0x40000
  s_mov_b32 s51, 0x60000
  s_mov_b32 s42, 0x3600
  s_mov_b32 s43, 0x6c00
  v_lshlrev_b32 v20, 4, v0
  v_lshlrev_b32 v106, 4, v0
  v_add_u32 v107, 0x1000, v106
  v_and_b32 v108, 63, v0
  v_min_u32 v108, 53, v108
  v_lshlrev_b32 v108, 7, v108
  s_mov_b32 s44, s4
  s_mov_b32 s45, s5
  s_mov_b32 s46, 0xa200
  s_mov_b32 s47, 0x20000
  v_cmp_gt_u32 vcc, 32, v0
  s_nop 0
  s_mov_b64 s[54:55], vcc
  v_cmp_gt_u32 vcc, 64, v0
  s_nop 0
  s_mov_b64 s[88:89], vcc
  v_add_u32 v20, 0x24000, v20
  v_lshlrev_b32 v23, 4, v18
  v_add_u32 v23, 0x24000, v23
  v_lshrrev_b32 v21, 4, v17
  v_lshl_add_u32 v23, v21, 9, v23
  v_bfe_u32 v21, v17, 1, 2
  v_lshl_add_u32 v23, v21, 7, v23
  v_bfe_u32 v21, v17, 3, 1
  v_lshl_add_u32 v23, v21, 3, v23
  v_and_b32 v21, 1, v17
  v_lshl_add_u32 v23, v21, 2, v23
  v_lshrrev_b32 v25, 3, v0
  v_lshlrev_b32 v25, 8, v25
  v_and_b32 v21, 7, v0
  v_lshl_add_u32 v25, v21, 4, v25
  v_lshlrev_b32 v22, 3, v17
  v_add_u32 v22, 0x24000, v22
  s_waitcnt vmcnt(0)
  s_add_u32 m0, s29, 0
  s_nop 0
  buffer_load_dwordx4 v244, s[12:15], s36 offen lds
  buffer_load_dwordx4 v245, s[12:15], s36 offen offset:1024 lds
  buffer_load_dwordx4 v246, s[12:15], s36 offen offset:2048 lds
  buffer_load_dwordx4 v247, s[12:15], s36 offen offset:3072 lds
  s_add_u32 s36, s36, 0x80000
  s_add_u32 m0, s29, 0x4000
  s_nop 0
  buffer_load_dwordx4 v244, s[12:15], s36 offen lds
  buffer_load_dwordx4 v245, s[12:15], s36 offen offset:1024 lds
  buffer_load_dwordx4 v246, s[12:15], s36 offen offset:2048 lds
  buffer_load_dwordx4 v247, s[12:15], s36 offen offset:3072 lds
  s_add_u32 s36, s36, 0x80000
  s_add_u32 m0, s29, 0x8000
  s_nop 0
  buffer_load_dwordx4 v244, s[12:15], s36 offen lds
  buffer_load_dwordx4 v245, s[12:15], s36 offen offset:1024 lds
  buffer_load_dwordx4 v246, s[12:15], s36 offen offset:2048 lds
  buffer_load_dwordx4 v247, s[12:15], s36 offen offset:3072 lds
  s_add_u32 s36, s36, 0x80000
  s_add_u32 m0, s29, 0xc000
  s_nop 0
  buffer_load_dwordx4 v244, s[12:15], s36 offen lds
  buffer_load_dwordx4 v245, s[12:15], s36 offen offset:1024 lds
  buffer_load_dwordx4 v246, s[12:15], s36 offen offset:2048 lds
  buffer_load_dwordx4 v247, s[12:15], s36 offen offset:3072 lds
  s_add_u32 s36, s36, 0x80000
  s_add_u32 m0, s29, 0x10000
  s_nop 0
  buffer_load_dwordx4 v244, s[12:15], s36 offen lds
  buffer_load_dwordx4 v245, s[12:15], s36 offen offset:1024 lds
  buffer_load_dwordx4 v246, s[12:15], s36 offen offset:2048 lds
  buffer_load_dwordx4 v247, s[12:15], s36 offen offset:3072 lds
  s_add_u32 s36, s36, 0x80000
  s_add_u32 m0, s29, 0x14000
  s_nop 0
  buffer_load_dwordx4 v244, s[12:15], s36 offen lds
  buffer_load_dwordx4 v245, s[12:15], s36 offen offset:1024 lds
  buffer_load_dwordx4 v246, s[12:15], s36 offen offset:2048 lds
  buffer_load_dwordx4 v247, s[12:15], s36 offen offset:3072 lds
  s_add_u32 s36, s36, 0x80000
  s_add_u32 m0, s29, 0x18000
  s_nop 0
  buffer_load_dwordx4 v244, s[12:15], s36 offen lds
  buffer_load_dwordx4 v245, s[12:15], s36 offen offset:1024 lds
  buffer_load_dwordx4 v246, s[12:15], s36 offen offset:2048 lds
  buffer_load_dwordx4 v247, s[12:15], s36 offen offset:3072 lds
  s_add_u32 s36, s36, 0x80000
  s_add_u32 m0, s29, 0x1c000
  s_nop 0
  buffer_load_dwordx4 v244, s[12:15], s36 offen lds
  buffer_load_dwordx4 v245, s[12:15], s36 offen offset:1024 lds
  buffer_load_dwordx4 v246, s[12:15], s36 offen offset:2048 lds
  buffer_load_dwordx4 v247, s[12:15], s36 offen offset:3072 lds
  s_add_u32 s36, s36, 0x80000
  s_add_u32 m0, s29, 0x20000
  s_nop 0
  buffer_load_dwordx4 v244, s[12:15], s36 offen lds
  buffer_load_dwordx4 v245, s[12:15], s36 offen offset:1024 lds
  buffer_load_dwordx4 v246, s[12:15], s36 offen offset:2048 lds
  buffer_load_dwordx4 v247, s[12:15], s36 offen offset:3072 lds
  s_add_u32 s36, s36, 0x80000
  v_lshl_add_u32 v6, v2, 3, v3
  v_add_u32 v5, 0, v6
  v_and_b32 v5, 15, v5
  v_xor_b32 v5, v5, v4
  v_lshlrev_b32 v5, 4, v5
  v_lshl_add_u32 v236, v6, 8, v5
  v_add_u32 v236, 0x2000, v236
  v_add_u32 v5, 0, v3
  v_lshlrev_b32 v5, 1, v5
  v_xor_b32 v5, v5, v4
  v_lshlrev_b32 v5, 4, v5
  v_lshl_add_u32 v238, v6, 8, v5
  v_add_u32 v5, 4, v6
  v_and_b32 v5, 15, v5
  v_xor_b32 v5, v5, v4
  v_lshlrev_b32 v5, 4, v5
  v_lshl_add_u32 v237, v6, 8, v5
  v_add_u32 v237, 0x2000, v237
  v_add_u32 v5, 4, v3
  v_lshlrev_b32 v5, 1, v5
  v_xor_b32 v5, v5, v4
  v_lshlrev_b32 v5, 4, v5
  v_lshl_add_u32 v239, v6, 8, v5
  v_add_u32 v5, 0, v3
  v_xor_b32 v5, v5, v4
  v_lshlrev_b32 v5, 4, v5
  v_lshl_add_u32 v212, v4, 8, v5
  v_add_u32 v216, 0x10000, v212
  v_add_u32 v5, 4, v3
  v_xor_b32 v5, v5, v4
  v_lshlrev_b32 v5, 4, v5
  v_lshl_add_u32 v213, v4, 8, v5
  v_add_u32 v217, 0x10000, v213
  v_add_u32 v5, 8, v3
  v_xor_b32 v5, v5, v4
  v_lshlrev_b32 v5, 4, v5
  v_lshl_add_u32 v214, v4, 8, v5
  v_add_u32 v218, 0x10000, v214
  v_add_u32 v5, 12, v3
  v_xor_b32 v5, v5, v4
  v_lshlrev_b32 v5, 4, v5
  v_lshl_add_u32 v215, v4, 8, v5
  v_add_u32 v219, 0x10000, v215
  v_lshrrev_b32 v6, 2, v1
  v_and_b32 v253, 3, v1
  v_and_b32 v0, 3, v6
  v_and_b32 v5, 7, v6
  v_xor_b32 v5, 0, v5
  v_lshlrev_b32 v5, 5, v5
  v_lshl_add_u32 v5, v253, 3, v5
  v_lshl_add_u32 v220, v6, 8, v5
  v_add_u32 v228, 0x10000, v220
  v_and_b32 v5, 7, v6
  v_xor_b32 v5, 1, v5
  v_lshlrev_b32 v5, 5, v5
  v_lshl_add_u32 v5, v253, 3, v5
  v_lshl_add_u32 v221, v6, 8, v5
  v_add_u32 v229, 0x10000, v221
  v_and_b32 v5, 7, v6
  v_xor_b32 v5, 2, v5
  v_lshlrev_b32 v5, 5, v5
  v_lshl_add_u32 v5, v253, 3, v5
  v_lshl_add_u32 v222, v6, 8, v5
  v_add_u32 v230, 0x10000, v222
  v_and_b32 v5, 7, v6
  v_xor_b32 v5, 3, v5
  v_lshlrev_b32 v5, 5, v5
  v_lshl_add_u32 v5, v253, 3, v5
  v_lshl_add_u32 v223, v6, 8, v5
  v_add_u32 v231, 0x10000, v223
  v_and_b32 v5, 7, v6
  v_xor_b32 v5, 4, v5
  v_lshlrev_b32 v5, 5, v5
  v_lshl_add_u32 v5, v253, 3, v5
  v_lshl_add_u32 v224, v6, 8, v5
  v_add_u32 v232, 0x10000, v224
  v_and_b32 v5, 7, v6
  v_xor_b32 v5, 5, v5
  v_lshlrev_b32 v5, 5, v5
  v_lshl_add_u32 v5, v253, 3, v5
  v_lshl_add_u32 v225, v6, 8, v5
  v_add_u32 v233, 0x10000, v225
  v_and_b32 v5, 7, v6
  v_xor_b32 v5, 6, v5
  v_lshlrev_b32 v5, 5, v5
  v_lshl_add_u32 v5, v253, 3, v5
  v_lshl_add_u32 v226, v6, 8, v5
  v_add_u32 v234, 0x10000, v226
  v_and_b32 v5, 7, v6
  v_xor_b32 v5, 7, v5
  v_lshlrev_b32 v5, 5, v5
  v_lshl_add_u32 v5, v253, 3, v5
  v_lshl_add_u32 v227, v6, 8, v5
  v_add_u32 v235, 0x10000, v227
  v_xor_b32 v5, 0, v0
  v_lshl_add_u32 v5, v5, 2, v253
  v_lshlrev_b32 v5, 4, v5
  v_lshl_add_u32 v240, v6, 8, v5
  v_xor_b32 v5, 1, v0
  v_lshl_add_u32 v5, v5, 2, v253
  v_lshlrev_b32 v5, 4, v5
  v_lshl_add_u32 v241, v6, 8, v5
  v_xor_b32 v5, 2, v0
  v_lshl_add_u32 v5, v5, 2, v253
  v_lshlrev_b32 v5, 4, v5
  v_lshl_add_u32 v242, v6, 8, v5
  v_xor_b32 v5, 3, v0
  v_lshl_add_u32 v5, v5, 2, v253
  v_lshlrev_b32 v5, 4, v5
  v_lshl_add_u32 v243, v6, 8, v5
  v_mov_b32 v144, 0x3f803f80
  v_mov_b32 v145, 0x3f803f80
  v_mov_b32 v146, 0x3f803f80
  v_mov_b32 v147, 0x3f803f80
  s_lshl_b32 s37, s2, 2
  s_add_u32 s37, s37, s32
  s_mul_i32 s37, s37, 0x1480
  v_lshl_add_u32 v7, v1, 7, s37
  v_cmp_gt_u32 vcc, 41, v1
  v_mov_b32 v5, 0x7fffffff
  s_nop 0
  v_cndmask_b32 v7, v5, v7, vcc
  s_mov_b32 s56, s72
  s_mov_b32 s57, s73
  s_mov_b32 s58, 0x480000
  s_mov_b32 s59, 0x20000
  s_getpc_b64 s[60:61]
attn_pc:
  s_add_u32 s60, s60, wo_kernel-attn_pc
  s_addc_u32 s61, s61, 0
  s_mov_b32 s62, wo_kernel_codeend-wo_kernel
  s_mov_b32 s63, 0x20000
  v_lshl_add_u32 v253, v2, 6, v1
  v_lshlrev_b32 v253, 7, v253
  s_mov_b32 s64, s72
  s_mov_b32 s65, s73
  s_mov_b32 s66, 0x480000
  s_mov_b32 s67, 0x20000
  v_lshlrev_b32 v44, 16, v32
  v_and_b32 v45, 0xffff0000, v32
  v_lshlrev_b32 v46, 16, v33
  v_and_b32 v47, 0xffff0000, v33
  v_lshlrev_b32 v48, 16, v34
  v_and_b32 v49, 0xffff0000, v34
  v_lshlrev_b32 v50, 16, v35
  v_and_b32 v51, 0xffff0000, v35
  v_lshlrev_b32 v52, 16, v36
  v_and_b32 v53, 0xffff0000, v36
  v_lshlrev_b32 v54, 16, v37
  v_and_b32 v55, 0xffff0000, v37
  v_lshlrev_b32 v56, 16, v38
  v_and_b32 v57, 0xffff0000, v38
  v_lshlrev_b32 v58, 16, v39
  v_and_b32 v59, 0xffff0000, v39
  v_lshlrev_b32 v60, 16, v40
  v_and_b32 v61, 0xffff0000, v40
  v_pk_add_f32 v[26:27], v[44:45], v[46:47]
  v_pk_add_f32 v[26:27], v[26:27], v[48:49]
  v_pk_add_f32 v[26:27], v[26:27], v[50:51]
  v_pk_add_f32 v[26:27], v[26:27], v[52:53]
  v_pk_add_f32 v[26:27], v[26:27], v[54:55]
  v_pk_add_f32 v[26:27], v[26:27], v[56:57]
  v_pk_add_f32 v[26:27], v[26:27], v[58:59]
  v_pk_add_f32 v[26:27], v[26:27], v[60:61]
  v_add_f32 v24, v26, v27
  s_nop 1
  v_add_f32_dpp v24, v24, v24 quad_perm:[1,0,3,2] row_mask:0xf bank_mask:0xf
  s_nop 1
  v_add_f32_dpp v24, v24, v24 quad_perm:[2,3,0,1] row_mask:0xf bank_mask:0xf
  s_nop 1
  v_add_f32_dpp v24, v24, v24 row_half_mirror row_mask:0xf bank_mask:0xf
  s_nop 1
  v_add_f32_dpp v24, v24, v24 row_mirror row_mask:0xf bank_mask:0xf
  v_mov_b32 v21, v24
  s_nop 1
  v_permlane16_swap_b32 v24, v21
  v_add_f32 v24, v24, v21
  v_mul_f32 v26, 0xbae38e39, v24
  v_mul_f32 v27, 0xbae38e39, v24
  v_pk_add_f32 v[44:45], v[44:45], v[26:27]
  v_pk_add_f32 v[46:47], v[46:47], v[26:27]
  v_pk_add_f32 v[48:49], v[48:49], v[26:27]
  v_pk_add_f32 v[50:51], v[50:51], v[26:27]
  v_pk_add_f32 v[52:53], v[52:53], v[26:27]
  v_pk_add_f32 v[54:55], v[54:55], v[26:27]
  v_pk_add_f32 v[56:57], v[56:57], v[26:27]
  v_pk_add_f32 v[58:59], v[58:59], v[26:27]
  v_pk_add_f32 v[60:61], v[60:61], v[26:27]
  v_pk_mul_f32 v[26:27], v[44:45], v[44:45]
  v_pk_fma_f32 v[26:27], v[46:47], v[46:47], v[26:27]
  v_pk_fma_f32 v[26:27], v[48:49], v[48:49], v[26:27]
  v_pk_fma_f32 v[26:27], v[50:51], v[50:51], v[26:27]
  v_pk_fma_f32 v[26:27], v[52:53], v[52:53], v[26:27]
  v_pk_fma_f32 v[26:27], v[54:55], v[54:55], v[26:27]
  v_pk_fma_f32 v[26:27], v[56:57], v[56:57], v[26:27]
  v_pk_fma_f32 v[26:27], v[58:59], v[58:59], v[26:27]
  v_pk_fma_f32 v[26:27], v[60:61], v[60:61], v[26:27]
  v_add_f32 v24, v26, v27
  s_nop 1
  v_add_f32_dpp v24, v24, v24 quad_perm:[1,0,3,2] row_mask:0xf bank_mask:0xf
  s_nop 1
  v_add_f32_dpp v24, v24, v24 quad_perm:[2,3,0,1] row_mask:0xf bank_mask:0xf
  s_nop 1
  v_add_f32_dpp v24, v24, v24 row_half_mirror row_mask:0xf bank_mask:0xf
  s_nop 1
  v_add_f32_dpp v24, v24, v24 row_mirror row_mask:0xf bank_mask:0xf
  v_mov_b32 v21, v24
  s_nop 1
  v_permlane16_swap_b32 v24, v21
  v_add_f32 v24, v24, v21
  v_mov_b32 v21, 0x3727c5ac
  v_fmac_f32 v21, 0x3ae38e39, v24
  v_rsq_f32 v24, v21
  s_nop 0
  v_mul_f32 v26, 0x3e0293ee, v24
  v_mul_f32 v27, 0x3e0293ee, v24
  v_mov_b32 v21, 0
  s_mov_b32 s37, 0x40000
tag_poll:
  buffer_load_dword v109, v21, s[84:87], 0 offen sc1
  s_waitcnt vmcnt(0)
  v_cmp_eq_u32 vcc, 0, v109
  s_nop 1
  s_cbranch_vccz tag_poll_ok
  s_sleep 2
  s_sub_u32 s37, s37, 1
  s_cbranch_scc0 tag_poll
tag_poll_ok:
  v_readfirstlane_b32 s100, v109
  s_add_u32 s84, s4, 0x70000
  s_addc_u32 s85, s5, 0
  s_mov_b32 s86, 0x8000
  s_mov_b32 s87, 0x20000
  s_cmp_lg_u32 s101, 0
  s_cbranch_scc1 mod_poll_ok
  s_mov_b32 s37, 0x40000
mod_poll:
  buffer_load_dword v109, v108, s[84:87], 0 offen sc1
  s_waitcnt vmcnt(0)
  v_cmp_ne_u32 vcc, s100, v109
  s_nop 1
  s_cbranch_vccz mod_poll_ok
  s_sleep 1
  s_sub_u32 s37, s37, 1
  s_cbranch_scc0 mod_poll
mod_poll_ok:
  s_barrier
  buffer_load_dwordx4 v[64:67], v106, s[44:47], 0 offen sc1
  buffer_load_dwordx4 v[68:71], v106, s[44:47], s42 offen sc1
  buffer_load_dwordx4 v[72:75], v106, s[44:47], s43 offen sc1
  buffer_load_dwordx4 v[76:79], v107, s[44:47], 0 offen sc1
  buffer_load_dwordx4 v[80:83], v107, s[44:47], s42 offen sc1
  buffer_load_dwordx4 v[84:87], v107, s[44:47], s43 offen sc1
  s_waitcnt vmcnt(4)
  v_pk_add_f32 v[64:65], v[64:65], v[68:69]
  s_waitcnt vmcnt(3)
  v_pk_add_f32 v[64:65], v[64:65], v[72:73]
  v_cvt_pk_bf16_f32 v65, v64, v65
  v_lshlrev_b32 v64, 16, v65
  v_and_b32 v65, 0xffff0000, v65
  v_pk_add_f32 v[66:67], v[66:67], v[70:71]
  v_pk_add_f32 v[66:67], v[66:67], v[74:75]
  v_cvt_pk_bf16_f32 v67, v66, v67
  v_lshlrev_b32 v66, 16, v67
  v_and_b32 v67, 0xffff0000, v67
  s_waitcnt vmcnt(1)
  v_pk_add_f32 v[76:77], v[76:77], v[80:81]
  s_waitcnt vmcnt(0)
  v_pk_add_f32 v[76:77], v[76:77], v[84:85]
  v_cvt_pk_bf16_f32 v77, v76, v77
  v_lshlrev_b32 v76, 16, v77
  v_and_b32 v77, 0xffff0000, v77
  v_pk_add_f32 v[78:79], v[78:79], v[82:83]
  v_pk_add_f32 v[78:79], v[78:79], v[86:87]
  v_cvt_pk_bf16_f32 v79, v78, v79
  v_lshlrev_b32 v78, 16, v79
  v_and_b32 v79, 0xffff0000, v79
  ds_write_b128 v20, v[64:67] offset:9216
  s_mov_b64 exec, s[54:55]
  ds_write_b128 v20, v[76:79] offset:13312
  s_mov_b64 exec, -1
  s_waitcnt lgkmcnt(0)
  s_barrier
  ds_read_b64 v[64:65], v22 offset:9216
  ds_read_b64 v[82:83], v22 offset:11520
  ds_read_b64 v[66:67], v22 offset:9472
  ds_read_b64 v[84:85], v22 offset:11776
  ds_read_b64 v[68:69], v22 offset:9728
  ds_read_b64 v[86:87], v22 offset:12032
  ds_read_b64 v[70:71], v22 offset:9984
  ds_read_b64 v[88:89], v22 offset:12288
  ds_read_b64 v[72:73], v22 offset:10240
  ds_read_b64 v[90:91], v22 offset:12544
  ds_read_b64 v[74:75], v22 offset:10496
  ds_read_b64 v[92:93], v22 offset:12800
  ds_read_b64 v[76:77], v22 offset:10752
  ds_read_b64 v[94:95], v22 offset:13056
  ds_read_b64 v[78:79], v22 offset:11008
  ds_read_b64 v[96:97], v22 offset:13312
  ds_read_b64 v[80:81], v22 offset:11264
  ds_read_b64 v[98:99], v22 offset:13568
  v_mov_b32 v28, 0x3e0293ee
  v_mov_b32 v29, 0x3e0293ee
  v_pk_mul_f32 v[44:45], v[44:45], v[26:27]
  s_waitcnt lgkmcnt(15)
  v_pk_fma_f32 v[64:65], v[64:65], v[28:29], v[44:45]
  s_waitcnt lgkmcnt(15)
  v_pk_fma_f32 v[44:45], v[44:45], v[82:83], v[64:65]
  v_cvt_pk_bf16_f32 v32, v44, v45
  ds_write_b32 v23, v32
  v_pk_mul_f32 v[46:47], v[46:47], v[26:27]
  s_waitcnt lgkmcnt(15)
  v_pk_fma_f32 v[66:67], v[66:67], v[28:29], v[46:47]
  s_waitcnt lgkmcnt(15)
  v_pk_fma_f32 v[46:47], v[46:47], v[84:85], v[66:67]
  v_cvt_pk_bf16_f32 v33, v46, v47
  ds_write_b32 v23, v33 offset:1024
  v_pk_mul_f32 v[48:49], v[48:49], v[26:27]
  s_waitcnt lgkmcnt(15)
  v_pk_fma_f32 v[68:69], v[68:69], v[28:29], v[48:49]
  s_waitcnt lgkmcnt(14)
  v_pk_fma_f32 v[48:49], v[48:49], v[86:87], v[68:69]
  v_cvt_pk_bf16_f32 v34, v48, v49
  ds_write_b32 v23, v34 offset:2048
  v_pk_mul_f32 v[50:51], v[50:51], v[26:27]
  s_waitcnt lgkmcnt(14)
  v_pk_fma_f32 v[70:71], v[70:71], v[28:29], v[50:51]
  s_waitcnt lgkmcnt(13)
  v_pk_fma_f32 v[50:51], v[50:51], v[88:89], v[70:71]
  v_cvt_pk_bf16_f32 v35, v50, v51
  ds_write_b32 v23, v35 offset:3072
  v_pk_mul_f32 v[52:53], v[52:53], v[26:27]
  s_waitcnt lgkmcnt(13)
  v_pk_fma_f32 v[72:73], v[72:73], v[28:29], v[52:53]
  s_waitcnt lgkmcnt(12)
  v_pk_fma_f32 v[52:53], v[52:53], v[90:91], v[72:73]
  v_cvt_pk_bf16_f32 v36, v52, v53
  ds_write_b32 v23, v36 offset:4096
  v_pk_mul_f32 v[54:55], v[54:55], v[26:27]
  s_waitcnt lgkmcnt(12)
  v_pk_fma_f32 v[74:75], v[74:75], v[28:29], v[54:55]
  s_waitcnt lgkmcnt(11)
  v_pk_fma_f32 v[54:55], v[54:55], v[92:93], v[74:75]
  v_cvt_pk_bf16_f32 v37, v54, v55
  ds_write_b32 v23, v37 offset:5120
  v_pk_mul_f32 v[56:57], v[56:57], v[26:27]
  s_waitcnt lgkmcnt(11)
  v_pk_fma_f32 v[76:77], v[76:77], v[28:29], v[56:57]
  s_waitcnt lgkmcnt(10)
  v_pk_fma_f32 v[56:57], v[56:57], v[94:95], v[76:77]
  v_cvt_pk_bf16_f32 v38, v56, v57
  ds_write_b32 v23, v38 offset:6144
  v_pk_mul_f32 v[58:59], v[58:59], v[26:27]
  s_waitcnt lgkmcnt(10)
  v_pk_fma_f32 v[78:79], v[78:79], v[28:29], v[58:59]
  s_waitcnt lgkmcnt(9)
  v_pk_fma_f32 v[58:59], v[58:59], v[96:97], v[78:79]
  v_cvt_pk_bf16_f32 v39, v58, v59
  ds_write_b32 v23, v39 offset:7168
  v_pk_mul_f32 v[60:61], v[60:61], v[26:27]
  s_waitcnt lgkmcnt(9)
  v_pk_fma_f32 v[80:81], v[80:81], v[28:29], v[60:61]
  s_waitcnt lgkmcnt(8)
  v_pk_fma_f32 v[60:61], v[60:61], v[98:99], v[80:81]
  v_cvt_pk_bf16_f32 v40, v60, v61
  ds_write_b32 v23, v40 offset:8192
  s_lshr_b32 s37, s2, 1
  s_mul_i32 s37, s37, 0x4800
  s_and_b32 s38, s2, 1
  s_lshl_b32 s38, s38, 7
  s_add_u32 s37, s37, s38
  s_add_u32 s38, s37, 0x2000
  s_add_u32 s39, s37, 0x4000
  s_waitcnt lgkmcnt(0)
  s_barrier
  ds_read_b128 v[32:35], v20
  ds_read_b128 v[36:39], v20 offset:4096
  ds_read_b128 v[40:43], v20 offset:8192
  s_waitcnt lgkmcnt(2)
  buffer_store_dwordx4 v[32:35], v25, s[8:11], s37 offen sc1
  s_waitcnt lgkmcnt(1)
  buffer_store_dwordx4 v[36:39], v25, s[8:11], s38 offen sc1
  s_mov_b64 exec, s[88:89]
  s_waitcnt lgkmcnt(0)
  buffer_store_dwordx4 v[40:43], v25, s[8:11], s39 offen sc1
  s_mov_b64 exec, -1
  s_add_u32 s84, s4, 0x60000
  s_addc_u32 s85, s5, 0
  s_mov_b32 s86, 0x8000
  s_mov_b32 s87, 0x20000
  s_lshl_b32 s37, s2, 7
  s_waitcnt vmcnt(0)
  s_barrier
  s_cmp_lg_u32 s101, 0
  s_cbranch_scc1 prep_pub
  s_mov_b64 exec, 1
  v_mov_b32 v21, s100
  buffer_store_dword v21, off, s[84:87], s37 sc1
  s_mov_b64 exec, -1
prep_pub:
  s_lshr_b32 s37, s2, 5
  s_lshl_b32 s37, s37, 12
  s_lshl_b32 s38, s101, 10
  s_add_u32 s37, s37, s38
  v_and_b32 v21, 7, v17
  v_lshl_add_u32 v21, v21, 7, s37
  s_mov_b32 s37, 0x40000
prep_poll:
  buffer_load_dword v22, v21, s[84:87], 0 offen sc1
  s_waitcnt vmcnt(0)
  v_cmp_ne_u32 vcc, s100, v22
  s_nop 1
  s_cbranch_vccz prep_poll_ok
  s_sleep 1
  s_sub_u32 s37, s37, 1
  s_cbranch_scc0 prep_poll
prep_poll_ok:
attn_qproj:
  buffer_load_dwordx4 a[0:3], v248, s[8:11], s35 offen sc1
  buffer_load_dwordx4 a[4:7], v249, s[8:11], s35 offen sc1
  buffer_load_dwordx4 a[8:11], v250, s[8:11], s35 offen sc1
  buffer_load_dwordx4 a[12:15], v251, s[8:11], s35 offen sc1
  buffer_load_dwordx4 a[16:19], v248, s[8:11], s35 offen offset:1024 sc1
  buffer_load_dwordx4 a[20:23], v249, s[8:11], s35 offen offset:1024 sc1
  buffer_load_dwordx4 a[24:27], v250, s[8:11], s35 offen offset:1024 sc1
  buffer_load_dwordx4 a[28:31], v251, s[8:11], s35 offen offset:1024 sc1
  s_add_u32 s35, s35, 0x800
  buffer_load_dwordx4 a[32:35], v248, s[8:11], s35 offen sc1
  buffer_load_dwordx4 a[36:39], v249, s[8:11], s35 offen sc1
  buffer_load_dwordx4 a[40:43], v250, s[8:11], s35 offen sc1
  buffer_load_dwordx4 a[44:47], v251, s[8:11], s35 offen sc1
  buffer_load_dwordx4 a[48:51], v248, s[8:11], s35 offen offset:1024 sc1
  buffer_load_dwordx4 a[52:55], v249, s[8:11], s35 offen offset:1024 sc1
  buffer_load_dwordx4 a[56:59], v250, s[8:11], s35 offen offset:1024 sc1
  buffer_load_dwordx4 a[60:63], v251, s[8:11], s35 offen offset:1024 sc1
  s_add_u32 s35, s35, 0x800
  ds_read_b64_tr_b16 a[192:193], v240
  ds_read_b64_tr_b16 a[194:195], v240 offset:4096
  ds_read_b64_tr_b16 a[196:197], v240 offset:8
  ds_read_b64_tr_b16 a[198:199], v240 offset:4104
  ds_read_b64_tr_b16 a[200:201], v241
  ds_read_b64_tr_b16 a[202:203], v241 offset:4096
  ds_read_b64_tr_b16 a[204:205], v241 offset:8
  ds_read_b64_tr_b16 a[206:207], v241 offset:4104
  ds_read_b64_tr_b16 a[208:209], v242
  ds_read_b64_tr_b16 a[210:211], v242 offset:4096
  ds_read_b64_tr_b16 a[212:213], v242 offset:8
  ds_read_b64_tr_b16 a[214:215], v242 offset:4104
  s_waitcnt vmcnt(15) lgkmcnt(10)
  v_mfma_f32_16x16x32_bf16 v[8:11], a[192:195], a[0:3], 0
  ds_read_b64_tr_b16 a[216:217], v243
  s_waitcnt vmcnt(14)
  v_mfma_f32_16x16x32_bf16 v[12:15], a[192:195], a[4:7], 0
  buffer_load_dwordx4 a[64:67], v248, s[8:11], s35 offen sc1
  s_waitcnt vmcnt(14)
  v_mfma_f32_16x16x32_bf16 v[16:19], a[192:195], a[8:11], 0
  ds_read_b64_tr_b16 a[218:219], v243 offset:4096
  s_waitcnt vmcnt(13)
  v_mfma_f32_16x16x32_bf16 v[20:23], a[192:195], a[12:15], 0
  s_waitcnt lgkmcnt(10)
  v_mfma_f32_16x16x32_bf16 v[24:27], a[196:199], a[0:3], 0
  ds_read_b64_tr_b16 a[220:221], v243 offset:8
  v_mfma_f32_16x16x32_bf16 v[28:31], a[196:199], a[4:7], 0
  buffer_load_dwordx4 a[68:71], v249, s[8:11], s35 offen sc1
  v_mfma_f32_16x16x32_bf16 v[32:35], a[196:199], a[8:11], 0
  ds_read_b64_tr_b16 a[222:223], v243 offset:4104
  v_mfma_f32_16x16x32_bf16 v[36:39], a[196:199], a[12:15], 0
  s_waitcnt lgkmcnt(10)
  v_mfma_f32_16x16x32_bf16 v[40:43], a[200:203], a[0:3], 0
  ds_read_b64_tr_b16 a[224:225], v240 offset:8192
  v_mfma_f32_16x16x32_bf16 v[44:47], a[200:203], a[4:7], 0
  buffer_load_dwordx4 a[72:75], v250, s[8:11], s35 offen sc1
  v_mfma_f32_16x16x32_bf16 v[48:51], a[200:203], a[8:11], 0
  ds_read_b64_tr_b16 a[226:227], v240 offset:12288
  v_mfma_f32_16x16x32_bf16 v[52:55], a[200:203], a[12:15], 0
  s_waitcnt lgkmcnt(10)
  v_mfma_f32_16x16x32_bf16 v[56:59], a[204:207], a[0:3], 0
  ds_read_b64_tr_b16 a[228:229], v240 offset:8200
  v_mfma_f32_16x16x32_bf16 v[60:63], a[204:207], a[4:7], 0
  buffer_load_dwordx4 a[76:79], v251, s[8:11], s35 offen sc1
  v_mfma_f32_16x16x32_bf16 v[64:67], a[204:207], a[8:11], 0
  ds_read_b64_tr_b16 a[230:231], v240 offset:12296
  v_mfma_f32_16x16x32_bf16 v[68:71], a[204:207], a[12:15], 0
  s_waitcnt lgkmcnt(10)
  v_mfma_f32_16x16x32_bf16 v[72:75], a[208:211], a[0:3], 0
  ds_read_b64_tr_b16 a[232:233], v241 offset:8192
  v_mfma_f32_16x16x32_bf16 v[76:79], a[208:211], a[4:7], 0
  buffer_load_dwordx4 a[80:83], v248, s[8:11], s35 offen offset:1024 sc1
  v_mfma_f32_16x16x32_bf16 v[80:83], a[208:211], a[8:11], 0
  ds_read_b64_tr_b16 a[234:235], v241 offset:12288
  v_mfma_f32_16x16x32_bf16 v[84:87], a[208:211], a[12:15], 0
  s_waitcnt lgkmcnt(10)
  v_mfma_f32_16x16x32_bf16 v[88:91], a[212:215], a[0:3], 0
  ds_read_b64_tr_b16 a[236:237], v241 offset:8200
  v_mfma_f32_16x16x32_bf16 v[92:95], a[212:215], a[4:7], 0
  buffer_load_dwordx4 a[84:87], v249, s[8:11], s35 offen offset:1024 sc1
  v_mfma_f32_16x16x32_bf16 v[96:99], a[212:215], a[8:11], 0
  ds_read_b64_tr_b16 a[238:239], v241 offset:12296
  v_mfma_f32_16x16x32_bf16 v[100:103], a[212:215], a[12:15], 0
  s_waitcnt lgkmcnt(10)
  v_mfma_f32_16x16x32_bf16 v[104:107], a[216:219], a[0:3], 0
  ds_read_b64_tr_b16 a[240:241], v242 offset:8192
  v_mfma_f32_16x16x32_bf16 v[108:111], a[216:219], a[4:7], 0
  buffer_load_dwordx4 a[88:91], v250, s[8:11], s35 offen offset:1024 sc1
  v_mfma_f32_16x16x32_bf16 v[112:115], a[216:219], a[8:11], 0
  ds_read_b64_tr_b16 a[242:243], v242 offset:12288
  v_mfma_f32_16x16x32_bf16 v[116:119], a[216:219], a[12:15], 0
  s_waitcnt lgkmcnt(10)
  v_mfma_f32_16x16x32_bf16 v[120:123], a[220:223], a[0:3], 0
  ds_read_b64_tr_b16 a[244:245], v242 offset:8200
  v_mfma_f32_16x16x32_bf16 v[124:127], a[220:223], a[4:7], 0
  buffer_load_dwordx4 a[92:95], v251, s[8:11], s35 offen offset:1024 sc1
  s_add_u32 s35, s35, 0x800
  v_mfma_f32_16x16x32_bf16 v[128:131], a[220:223], a[8:11], 0
  ds_read_b64_tr_b16 a[246:247], v242 offset:12296
  v_mfma_f32_16x16x32_bf16 v[132:135], a[220:223], a[12:15], 0
  s_waitcnt vmcnt(16) lgkmcnt(10)
  v_mfma_f32_16x16x32_bf16 v[8:11], a[224:227], a[16:19], v[8:11]
  ds_read_b64_tr_b16 a[248:249], v243 offset:8192
  v_mfma_f32_16x16x32_bf16 v[12:15], a[224:227], a[20:23], v[12:15]
  buffer_load_dwordx4 a[96:99], v248, s[8:11], s35 offen sc1
  v_mfma_f32_16x16x32_bf16 v[16:19], a[224:227], a[24:27], v[16:19]
  ds_read_b64_tr_b16 a[250:251], v243 offset:12288
  v_mfma_f32_16x16x32_bf16 v[20:23], a[224:227], a[28:31], v[20:23]
  s_waitcnt lgkmcnt(10)
  v_mfma_f32_16x16x32_bf16 v[24:27], a[228:231], a[16:19], v[24:27]
  ds_read_b64_tr_b16 a[252:253], v243 offset:8200
  v_mfma_f32_16x16x32_bf16 v[28:31], a[228:231], a[20:23], v[28:31]
  s_waitcnt vmcnt(63)
  s_barrier
  v_mfma_f32_16x16x32_bf16 v[32:35], a[228:231], a[24:27], v[32:35]
  ds_read_b64_tr_b16 a[254:255], v243 offset:12296
  v_mfma_f32_16x16x32_bf16 v[36:39], a[228:231], a[28:31], v[36:39]
  buffer_load_dwordx4 a[100:103], v249, s[8:11], s35 offen sc1
  s_waitcnt lgkmcnt(10)
  v_mfma_f32_16x16x32_bf16 v[40:43], a[232:235], a[16:19], v[40:43]
  ds_read_b64_tr_b16 a[192:193], v240 offset:16384
  v_mfma_f32_16x16x32_bf16 v[44:47], a[232:235], a[20:23], v[44:47]
  buffer_load_dwordx4 a[104:107], v250, s[8:11], s35 offen sc1
  v_mfma_f32_16x16x32_bf16 v[48:51], a[232:235], a[24:27], v[48:51]
  ds_read_b64_tr_b16 a[194:195], v240 offset:20480
  v_mfma_f32_16x16x32_bf16 v[52:55], a[232:235], a[28:31], v[52:55]
  s_waitcnt lgkmcnt(10)
  v_mfma_f32_16x16x32_bf16 v[56:59], a[236:239], a[16:19], v[56:59]
  ds_read_b64_tr_b16 a[196:197], v240 offset:16392
  v_mfma_f32_16x16x32_bf16 v[60:63], a[236:239], a[20:23], v[60:63]
  buffer_load_dwordx4 a[108:111], v251, s[8:11], s35 offen sc1
  v_mfma_f32_16x16x32_bf16 v[64:67], a[236:239], a[24:27], v[64:67]
  ds_read_b64_tr_b16 a[198:199], v240 offset:20488
  v_mfma_f32_16x16x32_bf16 v[68:71], a[236:239], a[28:31], v[68:71]
  s_waitcnt lgkmcnt(10)
  v_mfma_f32_16x16x32_bf16 v[72:75], a[240:243], a[16:19], v[72:75]
  ds_read_b64_tr_b16 a[200:201], v241 offset:16384
  v_mfma_f32_16x16x32_bf16 v[76:79], a[240:243], a[20:23], v[76:79]
  buffer_load_dwordx4 a[112:115], v248, s[8:11], s35 offen offset:1024 sc1
  v_mfma_f32_16x16x32_bf16 v[80:83], a[240:243], a[24:27], v[80:83]
  ds_read_b64_tr_b16 a[202:203], v241 offset:20480
  v_mfma_f32_16x16x32_bf16 v[84:87], a[240:243], a[28:31], v[84:87]
  s_waitcnt lgkmcnt(10)
  v_mfma_f32_16x16x32_bf16 v[88:91], a[244:247], a[16:19], v[88:91]
  ds_read_b64_tr_b16 a[204:205], v241 offset:16392
  v_mfma_f32_16x16x32_bf16 v[92:95], a[244:247], a[20:23], v[92:95]
  buffer_load_dwordx4 a[116:119], v249, s[8:11], s35 offen offset:1024 sc1
  v_mfma_f32_16x16x32_bf16 v[96:99], a[244:247], a[24:27], v[96:99]
  ds_read_b64_tr_b16 a[206:207], v241 offset:20488
  v_mfma_f32_16x16x32_bf16 v[100:103], a[244:247], a[28:31], v[100:103]
  s_waitcnt lgkmcnt(10)
  v_mfma_f32_16x16x32_bf16 v[104:107], a[248:251], a[16:19], v[104:107]
  ds_read_b64_tr_b16 a[208:209], v242 offset:16384
  v_mfma_f32_16x16x32_bf16 v[108:111], a[248:251], a[20:23], v[108:111]
  buffer_load_dwordx4 a[120:123], v250, s[8:11], s35 offen offset:1024 sc1
  v_mfma_f32_16x16x32_bf16 v[112:115], a[248:251], a[24:27], v[112:115]
  ds_read_b64_tr_b16 a[210:211], v242 offset:20480
  v_mfma_f32_16x16x32_bf16 v[116:119], a[248:251], a[28:31], v[116:119]
  s_waitcnt lgkmcnt(10)
  v_mfma_f32_16x16x32_bf16 v[120:123], a[252:255], a[16:19], v[120:123]
  ds_read_b64_tr_b16 a[212:213], v242 offset:16392
  v_mfma_f32_16x16x32_bf16 v[124:127], a[252:255], a[20:23], v[124:127]
  v_mfma_f32_16x16x32_bf16 v[128:131], a[252:255], a[24:27], v[128:131]
  ds_read_b64_tr_b16 a[214:215], v242 offset:20488
  v_mfma_f32_16x16x32_bf16 v[132:135], a[252:255], a[28:31], v[132:135]
  s_waitcnt vmcnt(19) lgkmcnt(10)
  v_mfma_f32_16x16x32_bf16 v[8:11], a[192:195], a[32:35], v[8:11]
  ds_read_b64_tr_b16 a[216:217], v243 offset:16384
  v_mfma_f32_16x16x32_bf16 v[12:15], a[192:195], a[36:39], v[12:15]
  buffer_load_dwordx4 a[124:127], v251, s[8:11], s35 offen offset:1024 sc1
  s_add_u32 s35, s35, 0x800
  v_mfma_f32_16x16x32_bf16 v[16:19], a[192:195], a[40:43], v[16:19]
  ds_read_b64_tr_b16 a[218:219], v243 offset:20480
  v_mfma_f32_16x16x32_bf16 v[20:23], a[192:195], a[44:47], v[20:23]
  s_waitcnt lgkmcnt(10)
  v_mfma_f32_16x16x32_bf16 v[24:27], a[196:199], a[32:35], v[24:27]
  ds_read_b64_tr_b16 a[220:221], v243 offset:16392
  v_mfma_f32_16x16x32_bf16 v[28:31], a[196:199], a[36:39], v[28:31]
  buffer_load_dwordx4 a[128:131], v248, s[8:11], s35 offen sc1
  v_mfma_f32_16x16x32_bf16 v[32:35], a[196:199], a[40:43], v[32:35]
  ds_read_b64_tr_b16 a[222:223], v243 offset:20488
  v_mfma_f32_16x16x32_bf16 v[36:39], a[196:199], a[44:47], v[36:39]
  s_waitcnt lgkmcnt(10)
  v_mfma_f32_16x16x32_bf16 v[40:43], a[200:203], a[32:35], v[40:43]
  ds_read_b64_tr_b16 a[224:225], v240 offset:24576
  v_mfma_f32_16x16x32_bf16 v[44:47], a[200:203], a[36:39], v[44:47]
  buffer_load_dwordx4 a[132:135], v249, s[8:11], s35 offen sc1
  v_mfma_f32_16x16x32_bf16 v[48:51], a[200:203], a[40:43], v[48:51]
  ds_read_b64_tr_b16 a[226:227], v240 offset:28672
  v_mfma_f32_16x16x32_bf16 v[52:55], a[200:203], a[44:47], v[52:55]
  s_waitcnt lgkmcnt(10)
  v_mfma_f32_16x16x32_bf16 v[56:59], a[204:207], a[32:35], v[56:59]
  ds_read_b64_tr_b16 a[228:229], v240 offset:24584
  v_mfma_f32_16x16x32_bf16 v[60:63], a[204:207], a[36:39], v[60:63]
  buffer_load_dwordx4 a[136:139], v250, s[8:11], s35 offen sc1
  v_mfma_f32_16x16x32_bf16 v[64:67], a[204:207], a[40:43], v[64:67]
  ds_read_b64_tr_b16 a[230:231], v240 offset:28680
  v_mfma_f32_16x16x32_bf16 v[68:71], a[204:207], a[44:47], v[68:71]
  s_waitcnt lgkmcnt(10)
  v_mfma_f32_16x16x32_bf16 v[72:75], a[208:211], a[32:35], v[72:75]
  ds_read_b64_tr_b16 a[232:233], v241 offset:24576
  v_mfma_f32_16x16x32_bf16 v[76:79], a[208:211], a[36:39], v[76:79]
  buffer_load_dwordx4 a[140:143], v251, s[8:11], s35 offen sc1
  v_mfma_f32_16x16x32_bf16 v[80:83], a[208:211], a[40:43], v[80:83]
  ds_read_b64_tr_b16 a[234:235], v241 offset:28672
  v_mfma_f32_16x16x32_bf16 v[84:87], a[208:211], a[44:47], v[84:87]
  s_waitcnt lgkmcnt(10)
  v_mfma_f32_16x16x32_bf16 v[88:91], a[212:215], a[32:35], v[88:91]
  ds_read_b64_tr_b16 a[236:237], v241 offset:24584
  v_mfma_f32_16x16x32_bf16 v[92:95], a[212:215], a[36:39], v[92:95]
  buffer_load_dwordx4 a[144:147], v248, s[8:11], s35 offen offset:1024 sc1
  v_mfma_f32_16x16x32_bf16 v[96:99], a[212:215], a[40:43], v[96:99]
  ds_read_b64_tr_b16 a[238:239], v241 offset:28680
  v_mfma_f32_16x16x32_bf16 v[100:103], a[212:215], a[44:47], v[100:103]
  s_waitcnt lgkmcnt(10)
  v_mfma_f32_16x16x32_bf16 v[104:107], a[216:219], a[32:35], v[104:107]
  ds_read_b64_tr_b16 a[240:241], v242 offset:24576
  v_mfma_f32_16x16x32_bf16 v[108:111], a[216:219], a[36:39], v[108:111]
  buffer_load_dwordx4 a[148:151], v249, s[8:11], s35 offen offset:1024 sc1
  v_mfma_f32_16x16x32_bf16 v[112:115], a[216:219], a[40:43], v[112:115]
  ds_read_b64_tr_b16 a[242:243], v242 offset:28672
  v_mfma_f32_16x16x32_bf16 v[116:119], a[216:219], a[44:47], v[116:119]
  s_waitcnt lgkmcnt(10)
  v_mfma_f32_16x16x32_bf16 v[120:123], a[220:223], a[32:35], v[120:123]
  ds_read_b64_tr_b16 a[244:245], v242 offset:24584
  v_mfma_f32_16x16x32_bf16 v[124:127], a[220:223], a[36:39], v[124:127]
  buffer_load_dwordx4 a[152:155], v250, s[8:11], s35 offen offset:1024 sc1
  v_mfma_f32_16x16x32_bf16 v[128:131], a[220:223], a[40:43], v[128:131]
  ds_read_b64_tr_b16 a[246:247], v242 offset:28680
  v_mfma_f32_16x16x32_bf16 v[132:135], a[220:223], a[44:47], v[132:135]
  s_waitcnt vmcnt(23) lgkmcnt(10)
  v_mfma_f32_16x16x32_bf16 v[8:11], a[224:227], a[48:51], v[8:11]
  ds_read_b64_tr_b16 a[248:249], v243 offset:24576
  v_mfma_f32_16x16x32_bf16 v[12:15], a[224:227], a[52:55], v[12:15]
  buffer_load_dwordx4 a[156:159], v251, s[8:11], s35 offen offset:1024 sc1
  s_add_u32 s35, s35, 0x800
  v_mfma_f32_16x16x32_bf16 v[16:19], a[224:227], a[56:59], v[16:19]
  ds_read_b64_tr_b16 a[250:251], v243 offset:28672
  v_mfma_f32_16x16x32_bf16 v[20:23], a[224:227], a[60:63], v[20:23]
  s_waitcnt lgkmcnt(10)
  v_mfma_f32_16x16x32_bf16 v[24:27], a[228:231], a[48:51], v[24:27]
  ds_read_b64_tr_b16 a[252:253], v243 offset:24584
  v_mfma_f32_16x16x32_bf16 v[28:31], a[228:231], a[52:55], v[28:31]
  s_waitcnt vmcnt(63)
  s_barrier
  v_mfma_f32_16x16x32_bf16 v[32:35], a[228:231], a[56:59], v[32:35]
  ds_read_b64_tr_b16 a[254:255], v243 offset:28680
  v_mfma_f32_16x16x32_bf16 v[36:39], a[228:231], a[60:63], v[36:39]
  buffer_load_dwordx4 a[160:163], v248, s[8:11], s35 offen sc1
  s_waitcnt lgkmcnt(10)
  v_mfma_f32_16x16x32_bf16 v[40:43], a[232:235], a[48:51], v[40:43]
  ds_read_b64_tr_b16 a[192:193], v240 offset:32768
  v_mfma_f32_16x16x32_bf16 v[44:47], a[232:235], a[52:55], v[44:47]
  buffer_load_dwordx4 a[164:167], v249, s[8:11], s35 offen sc1
  v_mfma_f32_16x16x32_bf16 v[48:51], a[232:235], a[56:59], v[48:51]
  ds_read_b64_tr_b16 a[194:195], v240 offset:36864
  v_mfma_f32_16x16x32_bf16 v[52:55], a[232:235], a[60:63], v[52:55]
  s_waitcnt lgkmcnt(10)
  v_mfma_f32_16x16x32_bf16 v[56:59], a[236:239], a[48:51], v[56:59]
  ds_read_b64_tr_b16 a[196:197], v240 offset:32776
  v_mfma_f32_16x16x32_bf16 v[60:63], a[236:239], a[52:55], v[60:63]
  buffer_load_dwordx4 a[168:171], v250, s[8:11], s35 offen sc1
  v_mfma_f32_16x16x32_bf16 v[64:67], a[236:239], a[56:59], v[64:67]
  ds_read_b64_tr_b16 a[198:199], v240 offset:36872
  v_mfma_f32_16x16x32_bf16 v[68:71], a[236:239], a[60:63], v[68:71]
  s_waitcnt lgkmcnt(10)
  v_mfma_f32_16x16x32_bf16 v[72:75], a[240:243], a[48:51], v[72:75]
  ds_read_b64_tr_b16 a[200:201], v241 offset:32768
  v_mfma_f32_16x16x32_bf16 v[76:79], a[240:243], a[52:55], v[76:79]
  buffer_load_dwordx4 a[172:175], v251, s[8:11], s35 offen sc1
  v_mfma_f32_16x16x32_bf16 v[80:83], a[240:243], a[56:59], v[80:83]
  ds_read_b64_tr_b16 a[202:203], v241 offset:36864
  v_mfma_f32_16x16x32_bf16 v[84:87], a[240:243], a[60:63], v[84:87]
  s_waitcnt lgkmcnt(10)
  v_mfma_f32_16x16x32_bf16 v[88:91], a[244:247], a[48:51], v[88:91]
  ds_read_b64_tr_b16 a[204:205], v241 offset:32776
  v_mfma_f32_16x16x32_bf16 v[92:95], a[244:247], a[52:55], v[92:95]
  buffer_load_dwordx4 a[176:179], v248, s[8:11], s35 offen offset:1024 sc1
  v_mfma_f32_16x16x32_bf16 v[96:99], a[244:247], a[56:59], v[96:99]
  ds_read_b64_tr_b16 a[206:207], v241 offset:36872
  v_mfma_f32_16x16x32_bf16 v[100:103], a[244:247], a[60:63], v[100:103]
  s_waitcnt lgkmcnt(10)
  v_mfma_f32_16x16x32_bf16 v[104:107], a[248:251], a[48:51], v[104:107]
  ds_read_b64_tr_b16 a[208:209], v242 offset:32768
  v_mfma_f32_16x16x32_bf16 v[108:111], a[248:251], a[52:55], v[108:111]
  buffer_load_dwordx4 a[180:183], v249, s[8:11], s35 offen offset:1024 sc1
  v_mfma_f32_16x16x32_bf16 v[112:115], a[248:251], a[56:59], v[112:115]
  ds_read_b64_tr_b16 a[210:211], v242 offset:36864
  v_mfma_f32_16x16x32_bf16 v[116:119], a[248:251], a[60:63], v[116:119]
  s_waitcnt lgkmcnt(10)
  v_mfma_f32_16x16x32_bf16 v[120:123], a[252:255], a[48:51], v[120:123]
  ds_read_b64_tr_b16 a[212:213], v242 offset:32776
  v_mfma_f32_16x16x32_bf16 v[124:127], a[252:255], a[52:55], v[124:127]
  v_mfma_f32_16x16x32_bf16 v[128:131], a[252:255], a[56:59], v[128:131]
  ds_read_b64_tr_b16 a[214:215], v242 offset:36872
  v_mfma_f32_16x16x32_bf16 v[132:135], a[252:255], a[60:63], v[132:135]
  s_waitcnt vmcnt(26) lgkmcnt(10)
  v_mfma_f32_16x16x32_bf16 v[8:11], a[192:195], a[64:67], v[8:11]
  ds_read_b64_tr_b16 a[216:217], v243 offset:32768
  v_mfma_f32_16x16x32_bf16 v[12:15], a[192:195], a[68:71], v[12:15]
  buffer_load_dwordx4 a[184:187], v250, s[8:11], s35 offen offset:1024 sc1
  v_mfma_f32_16x16x32_bf16 v[16:19], a[192:195], a[72:75], v[16:19]
  ds_read_b64_tr_b16 a[218:219], v243 offset:36864
  v_mfma_f32_16x16x32_bf16 v[20:23], a[192:195], a[76:79], v[20:23]
  s_waitcnt lgkmcnt(10)
  v_mfma_f32_16x16x32_bf16 v[24:27], a[196:199], a[64:67], v[24:27]
  ds_read_b64_tr_b16 a[220:221], v243 offset:32776
  v_mfma_f32_16x16x32_bf16 v[28:31], a[196:199], a[68:71], v[28:31]
  buffer_load_dwordx4 a[188:191], v251, s[8:11], s35 offen offset:1024 sc1
  s_add_u32 s35, s35, 0x800
  v_mfma_f32_16x16x32_bf16 v[32:35], a[196:199], a[72:75], v[32:35]
  ds_read_b64_tr_b16 a[222:223], v243 offset:36872
  v_mfma_f32_16x16x32_bf16 v[36:39], a[196:199], a[76:79], v[36:39]
  s_waitcnt lgkmcnt(10)
  v_mfma_f32_16x16x32_bf16 v[40:43], a[200:203], a[64:67], v[40:43]
  ds_read_b64_tr_b16 a[224:225], v240 offset:40960
  v_mfma_f32_16x16x32_bf16 v[44:47], a[200:203], a[68:71], v[44:47]
  buffer_load_dwordx4 a[0:3], v248, s[8:11], s35 offen sc1
  v_mfma_f32_16x16x32_bf16 v[48:51], a[200:203], a[72:75], v[48:51]
  ds_read_b64_tr_b16 a[226:227], v240 offset:45056
  v_mfma_f32_16x16x32_bf16 v[52:55], a[200:203], a[76:79], v[52:55]
  s_waitcnt lgkmcnt(10)
  v_mfma_f32_16x16x32_bf16 v[56:59], a[204:207], a[64:67], v[56:59]
  ds_read_b64_tr_b16 a[228:229], v240 offset:40968
  v_mfma_f32_16x16x32_bf16 v[60:63], a[204:207], a[68:71], v[60:63]
  buffer_load_dwordx4 a[4:7], v249, s[8:11], s35 offen sc1
  v_mfma_f32_16x16x32_bf16 v[64:67], a[204:207], a[72:75], v[64:67]
  ds_read_b64_tr_b16 a[230:231], v240 offset:45064
  v_mfma_f32_16x16x32_bf16 v[68:71], a[204:207], a[76:79], v[68:71]
  s_waitcnt lgkmcnt(10)
  v_mfma_f32_16x16x32_bf16 v[72:75], a[208:211], a[64:67], v[72:75]
  ds_read_b64_tr_b16 a[232:233], v241 offset:40960
  v_mfma_f32_16x16x32_bf16 v[76:79], a[208:211], a[68:71], v[76:79]
  buffer_load_dwordx4 a[8:11], v250, s[8:11], s35 offen sc1
  v_mfma_f32_16x16x32_bf16 v[80:83], a[208:211], a[72:75], v[80:83]
  ds_read_b64_tr_b16 a[234:235], v241 offset:45056
  v_mfma_f32_16x16x32_bf16 v[84:87], a[208:211], a[76:79], v[84:87]
  s_waitcnt lgkmcnt(10)
  v_mfma_f32_16x16x32_bf16 v[88:91], a[212:215], a[64:67], v[88:91]
  ds_read_b64_tr_b16 a[236:237], v241 offset:40968
  v_mfma_f32_16x16x32_bf16 v[92:95], a[212:215], a[68:71], v[92:95]
  buffer_load_dwordx4 a[12:15], v251, s[8:11], s35 offen sc1
  v_mfma_f32_16x16x32_bf16 v[96:99], a[212:215], a[72:75], v[96:99]
  ds_read_b64_tr_b16 a[238:239], v241 offset:45064
  v_mfma_f32_16x16x32_bf16 v[100:103], a[212:215], a[76:79], v[100:103]
  s_waitcnt lgkmcnt(10)
  v_mfma_f32_16x16x32_bf16 v[104:107], a[216:219], a[64:67], v[104:107]
  ds_read_b64_tr_b16 a[240:241], v242 offset:40960
  v_mfma_f32_16x16x32_bf16 v[108:111], a[216:219], a[68:71], v[108:111]
  buffer_load_dwordx4 a[16:19], v248, s[8:11], s35 offen offset:1024 sc1
  v_mfma_f32_16x16x32_bf16 v[112:115], a[216:219], a[72:75], v[112:115]
  ds_read_b64_tr_b16 a[242:243], v242 offset:45056
  v_mfma_f32_16x16x32_bf16 v[116:119], a[216:219], a[76:79], v[116:119]
  s_waitcnt lgkmcnt(10)
  v_mfma_f32_16x16x32_bf16 v[120:123], a[220:223], a[64:67], v[120:123]
  ds_read_b64_tr_b16 a[244:245], v242 offset:40968
  v_mfma_f32_16x16x32_bf16 v[124:127], a[220:223], a[68:71], v[124:127]
  buffer_load_dwordx4 a[20:23], v249, s[8:11], s35 offen offset:1024 sc1
  v_mfma_f32_16x16x32_bf16 v[128:131], a[220:223], a[72:75], v[128:131]
  ds_read_b64_tr_b16 a[246:247], v242 offset:45064
  v_mfma_f32_16x16x32_bf16 v[132:135], a[220:223], a[76:79], v[132:135]
  s_waitcnt vmcnt(30) lgkmcnt(10)
  v_mfma_f32_16x16x32_bf16 v[8:11], a[224:227], a[80:83], v[8:11]
  ds_read_b64_tr_b16 a[248:249], v243 offset:40960
  v_mfma_f32_16x16x32_bf16 v[12:15], a[224:227], a[84:87], v[12:15]
  buffer_load_dwordx4 a[24:27], v250, s[8:11], s35 offen offset:1024 sc1
  v_mfma_f32_16x16x32_bf16 v[16:19], a[224:227], a[88:91], v[16:19]
  ds_read_b64_tr_b16 a[250:251], v243 offset:45056
  v_mfma_f32_16x16x32_bf16 v[20:23], a[224:227], a[92:95], v[20:23]
  s_waitcnt lgkmcnt(10)
  v_mfma_f32_16x16x32_bf16 v[24:27], a[228:231], a[80:83], v[24:27]
  ds_read_b64_tr_b16 a[252:253], v243 offset:40968
  v_mfma_f32_16x16x32_bf16 v[28:31], a[228:231], a[84:87], v[28:31]
  s_waitcnt vmcnt(63)
  s_barrier
  v_mfma_f32_16x16x32_bf16 v[32:35], a[228:231], a[88:91], v[32:35]
  ds_read_b64_tr_b16 a[254:255], v243 offset:45064
  v_mfma_f32_16x16x32_bf16 v[36:39], a[228:231], a[92:95], v[36:39]
  buffer_load_dwordx4 a[28:31], v251, s[8:11], s35 offen offset:1024 sc1
  s_waitcnt lgkmcnt(10)
  v_mfma_f32_16x16x32_bf16 v[40:43], a[232:235], a[80:83], v[40:43]
  ds_read_b64_tr_b16 a[192:193], v240 offset:49152
  s_add_u32 s35, s35, 0x800
  v_mfma_f32_16x16x32_bf16 v[44:47], a[232:235], a[84:87], v[44:47]
  buffer_load_dwordx4 a[32:35], v248, s[8:11], s35 offen sc1
  v_mfma_f32_16x16x32_bf16 v[48:51], a[232:235], a[88:91], v[48:51]
  ds_read_b64_tr_b16 a[194:195], v240 offset:53248
  v_mfma_f32_16x16x32_bf16 v[52:55], a[232:235], a[92:95], v[52:55]
  s_waitcnt lgkmcnt(10)
  v_mfma_f32_16x16x32_bf16 v[56:59], a[236:239], a[80:83], v[56:59]
  ds_read_b64_tr_b16 a[196:197], v240 offset:49160
  v_mfma_f32_16x16x32_bf16 v[60:63], a[236:239], a[84:87], v[60:63]
  buffer_load_dwordx4 a[36:39], v249, s[8:11], s35 offen sc1
  v_mfma_f32_16x16x32_bf16 v[64:67], a[236:239], a[88:91], v[64:67]
  ds_read_b64_tr_b16 a[198:199], v240 offset:53256
  v_mfma_f32_16x16x32_bf16 v[68:71], a[236:239], a[92:95], v[68:71]
  s_waitcnt lgkmcnt(10)
  v_mfma_f32_16x16x32_bf16 v[72:75], a[240:243], a[80:83], v[72:75]
  ds_read_b64_tr_b16 a[200:201], v241 offset:49152
  v_mfma_f32_16x16x32_bf16 v[76:79], a[240:243], a[84:87], v[76:79]
  buffer_load_dwordx4 a[40:43], v250, s[8:11], s35 offen sc1
  v_mfma_f32_16x16x32_bf16 v[80:83], a[240:243], a[88:91], v[80:83]
  ds_read_b64_tr_b16 a[202:203], v241 offset:53248
  v_mfma_f32_16x16x32_bf16 v[84:87], a[240:243], a[92:95], v[84:87]
  s_waitcnt lgkmcnt(10)
  v_mfma_f32_16x16x32_bf16 v[88:91], a[244:247], a[80:83], v[88:91]
  ds_read_b64_tr_b16 a[204:205], v241 offset:49160
  v_mfma_f32_16x16x32_bf16 v[92:95], a[244:247], a[84:87], v[92:95]
  buffer_load_dwordx4 a[44:47], v251, s[8:11], s35 offen sc1
  v_mfma_f32_16x16x32_bf16 v[96:99], a[244:247], a[88:91], v[96:99]
  ds_read_b64_tr_b16 a[206:207], v241 offset:53256
  v_mfma_f32_16x16x32_bf16 v[100:103], a[244:247], a[92:95], v[100:103]
  s_waitcnt lgkmcnt(10)
  v_mfma_f32_16x16x32_bf16 v[104:107], a[248:251], a[80:83], v[104:107]
  ds_read_b64_tr_b16 a[208:209], v242 offset:49152
  v_mfma_f32_16x16x32_bf16 v[108:111], a[248:251], a[84:87], v[108:111]
  buffer_load_dwordx4 a[48:51], v248, s[8:11], s35 offen offset:1024 sc1
  v_mfma_f32_16x16x32_bf16 v[112:115], a[248:251], a[88:91], v[112:115]
  ds_read_b64_tr_b16 a[210:211], v242 offset:53248
  v_mfma_f32_16x16x32_bf16 v[116:119], a[248:251], a[92:95], v[116:119]
  s_waitcnt lgkmcnt(10)
  v_mfma_f32_16x16x32_bf16 v[120:123], a[252:255], a[80:83], v[120:123]
  ds_read_b64_tr_b16 a[212:213], v242 offset:49160
  v_mfma_f32_16x16x32_bf16 v[124:127], a[252:255], a[84:87], v[124:127]
  v_mfma_f32_16x16x32_bf16 v[128:131], a[252:255], a[88:91], v[128:131]
  ds_read_b64_tr_b16 a[214:215], v242 offset:53256
  v_mfma_f32_16x16x32_bf16 v[132:135], a[252:255], a[92:95], v[132:135]
  s_waitcnt vmcnt(33) lgkmcnt(10)
  v_mfma_f32_16x16x32_bf16 v[8:11], a[192:195], a[96:99], v[8:11]
  ds_read_b64_tr_b16 a[216:217], v243 offset:49152
  v_mfma_f32_16x16x32_bf16 v[12:15], a[192:195], a[100:103], v[12:15]
  buffer_load_dwordx4 a[52:55], v249, s[8:11], s35 offen offset:1024 sc1
  v_mfma_f32_16x16x32_bf16 v[16:19], a[192:195], a[104:107], v[16:19]
  ds_read_b64_tr_b16 a[218:219], v243 offset:53248
  v_mfma_f32_16x16x32_bf16 v[20:23], a[192:195], a[108:111], v[20:23]
  s_waitcnt lgkmcnt(10)
  v_mfma_f32_16x16x32_bf16 v[24:27], a[196:199], a[96:99], v[24:27]
  ds_read_b64_tr_b16 a[220:221], v243 offset:49160
  v_mfma_f32_16x16x32_bf16 v[28:31], a[196:199], a[100:103], v[28:31]
  buffer_load_dwordx4 a[56:59], v250, s[8:11], s35 offen offset:1024 sc1
  v_mfma_f32_16x16x32_bf16 v[32:35], a[196:199], a[104:107], v[32:35]
  ds_read_b64_tr_b16 a[222:223], v243 offset:53256
  v_mfma_f32_16x16x32_bf16 v[36:39], a[196:199], a[108:111], v[36:39]
  s_waitcnt lgkmcnt(10)
  v_mfma_f32_16x16x32_bf16 v[40:43], a[200:203], a[96:99], v[40:43]
  ds_read_b64_tr_b16 a[224:225], v240 offset:57344
  v_mfma_f32_16x16x32_bf16 v[44:47], a[200:203], a[100:103], v[44:47]
  buffer_load_dwordx4 a[60:63], v251, s[8:11], s35 offen offset:1024 sc1
  s_add_u32 s35, s35, 0x800
  v_mfma_f32_16x16x32_bf16 v[48:51], a[200:203], a[104:107], v[48:51]
  ds_read_b64_tr_b16 a[226:227], v240 offset:61440
  v_mfma_f32_16x16x32_bf16 v[52:55], a[200:203], a[108:111], v[52:55]
  s_waitcnt lgkmcnt(10)
  v_mfma_f32_16x16x32_bf16 v[56:59], a[204:207], a[96:99], v[56:59]
  ds_read_b64_tr_b16 a[228:229], v240 offset:57352
  v_mfma_f32_16x16x32_bf16 v[60:63], a[204:207], a[100:103], v[60:63]
  buffer_load_dwordx4 a[64:67], v248, s[8:11], s35 offen sc1
  v_mfma_f32_16x16x32_bf16 v[64:67], a[204:207], a[104:107], v[64:67]
  ds_read_b64_tr_b16 a[230:231], v240 offset:61448
  v_mfma_f32_16x16x32_bf16 v[68:71], a[204:207], a[108:111], v[68:71]
  s_waitcnt lgkmcnt(10)
  v_mfma_f32_16x16x32_bf16 v[72:75], a[208:211], a[96:99], v[72:75]
  ds_read_b64_tr_b16 a[232:233], v241 offset:57344
  v_mfma_f32_16x16x32_bf16 v[76:79], a[208:211], a[100:103], v[76:79]
  buffer_load_dwordx4 a[68:71], v249, s[8:11], s35 offen sc1
  v_mfma_f32_16x16x32_bf16 v[80:83], a[208:211], a[104:107], v[80:83]
  ds_read_b64_tr_b16 a[234:235], v241 offset:61440
  v_mfma_f32_16x16x32_bf16 v[84:87], a[208:211], a[108:111], v[84:87]
  s_waitcnt lgkmcnt(10)
  v_mfma_f32_16x16x32_bf16 v[88:91], a[212:215], a[96:99], v[88:91]
  ds_read_b64_tr_b16 a[236:237], v241 offset:57352
  v_mfma_f32_16x16x32_bf16 v[92:95], a[212:215], a[100:103], v[92:95]
  buffer_load_dwordx4 a[72:75], v250, s[8:11], s35 offen sc1
  v_mfma_f32_16x16x32_bf16 v[96:99], a[212:215], a[104:107], v[96:99]
  ds_read_b64_tr_b16 a[238:239], v241 offset:61448
  v_mfma_f32_16x16x32_bf16 v[100:103], a[212:215], a[108:111], v[100:103]
  s_waitcnt lgkmcnt(10)
  v_mfma_f32_16x16x32_bf16 v[104:107], a[216:219], a[96:99], v[104:107]
  ds_read_b64_tr_b16 a[240:241], v242 offset:57344
  v_mfma_f32_16x16x32_bf16 v[108:111], a[216:219], a[100:103], v[108:111]
  buffer_load_dwordx4 a[76:79], v251, s[8:11], s35 offen sc1
  v_mfma_f32_16x16x32_bf16 v[112:115], a[216:219], a[104:107], v[112:115]
  ds_read_b64_tr_b16 a[242:243], v242 offset:61440
  v_mfma_f32_16x16x32_bf16 v[116:119], a[216:219], a[108:111], v[116:119]
  s_waitcnt lgkmcnt(10)
  v_mfma_f32_16x16x32_bf16 v[120:123], a[220:223], a[96:99], v[120:123]
  ds_read_b64_tr_b16 a[244:245], v242 offset:57352
  v_mfma_f32_16x16x32_bf16 v[124:127], a[220:223], a[100:103], v[124:127]
  buffer_load_dwordx4 a[80:83], v248, s[8:11], s35 offen offset:1024 sc1
  v_mfma_f32_16x16x32_bf16 v[128:131], a[220:223], a[104:107], v[128:131]
  ds_read_b64_tr_b16 a[246:247], v242 offset:61448
  v_mfma_f32_16x16x32_bf16 v[132:135], a[220:223], a[108:111], v[132:135]
  s_waitcnt vmcnt(37) lgkmcnt(10)
  v_mfma_f32_16x16x32_bf16 v[8:11], a[224:227], a[112:115], v[8:11]
  ds_read_b64_tr_b16 a[248:249], v243 offset:57344
  v_mfma_f32_16x16x32_bf16 v[12:15], a[224:227], a[116:119], v[12:15]
  buffer_load_dwordx4 a[84:87], v249, s[8:11], s35 offen offset:1024 sc1
  v_mfma_f32_16x16x32_bf16 v[16:19], a[224:227], a[120:123], v[16:19]
  ds_read_b64_tr_b16 a[250:251], v243 offset:61440
  v_mfma_f32_16x16x32_bf16 v[20:23], a[224:227], a[124:127], v[20:23]
  s_waitcnt lgkmcnt(10)
  v_mfma_f32_16x16x32_bf16 v[24:27], a[228:231], a[112:115], v[24:27]
  ds_read_b64_tr_b16 a[252:253], v243 offset:57352
  v_add_u32 v240, 0x10000, v240
  v_mfma_f32_16x16x32_bf16 v[28:31], a[228:231], a[116:119], v[28:31]
  s_waitcnt vmcnt(63)
  s_barrier
  v_mfma_f32_16x16x32_bf16 v[32:35], a[228:231], a[120:123], v[32:35]
  ds_read_b64_tr_b16 a[254:255], v243 offset:61448
  v_add_u32 v241, 0x10000, v241
  v_mfma_f32_16x16x32_bf16 v[36:39], a[228:231], a[124:127], v[36:39]
  buffer_load_dwordx4 a[88:91], v250, s[8:11], s35 offen offset:1024 sc1
  s_waitcnt lgkmcnt(10)
  v_mfma_f32_16x16x32_bf16 v[40:43], a[232:235], a[112:115], v[40:43]
  ds_read_b64_tr_b16 a[192:193], v240
  v_add_u32 v242, 0x10000, v242
  v_mfma_f32_16x16x32_bf16 v[44:47], a[232:235], a[116:119], v[44:47]
  buffer_load_dwordx4 a[92:95], v251, s[8:11], s35 offen offset:1024 sc1
  s_add_u32 s35, s35, 0x800
  v_mfma_f32_16x16x32_bf16 v[48:51], a[232:235], a[120:123], v[48:51]
  ds_read_b64_tr_b16 a[194:195], v240 offset:4096
  v_add_u32 v243, 0x10000, v243
  v_mfma_f32_16x16x32_bf16 v[52:55], a[232:235], a[124:127], v[52:55]
  s_waitcnt lgkmcnt(10)
  v_mfma_f32_16x16x32_bf16 v[56:59], a[236:239], a[112:115], v[56:59]
  ds_read_b64_tr_b16 a[196:197], v240 offset:8
  s_add_u32 m0, s28, 0
  v_mfma_f32_16x16x32_bf16 v[60:63], a[236:239], a[116:119], v[60:63]
  s_mov_b32 s30, 0
  v_mfma_f32_16x16x32_bf16 v[64:67], a[236:239], a[120:123], v[64:67]
  ds_read_b64_tr_b16 a[198:199], v240 offset:4104
  v_subrev_u32 v254, 0x2000, v236
  v_mfma_f32_16x16x32_bf16 v[68:71], a[236:239], a[124:127], v[68:71]
  s_waitcnt lgkmcnt(10)
  v_mfma_f32_16x16x32_bf16 v[72:75], a[240:243], a[112:115], v[72:75]
  ds_read_b64_tr_b16 a[200:201], v241
  v_subrev_u32 v255, 0x2000, v237
  v_mfma_f32_16x16x32_bf16 v[76:79], a[240:243], a[116:119], v[76:79]
  buffer_load_dwordx4 v254, s[16:19], s30 offen lds
  v_mfma_f32_16x16x32_bf16 v[80:83], a[240:243], a[120:123], v[80:83]
  ds_read_b64_tr_b16 a[202:203], v241 offset:4096
  v_mfma_f32_16x16x32_bf16 v[84:87], a[240:243], a[124:127], v[84:87]
  buffer_load_dwordx4 v255, s[16:19], s30 offen offset:1024 lds
  s_waitcnt lgkmcnt(10)
  v_mfma_f32_16x16x32_bf16 v[88:91], a[244:247], a[112:115], v[88:91]
  ds_read_b64_tr_b16 a[204:205], v241 offset:8
  s_add_u32 m0, s28, 0x4000
  v_mfma_f32_16x16x32_bf16 v[92:95], a[244:247], a[116:119], v[92:95]
  buffer_load_dwordx4 v236, s[16:19], s30 offen lds
  v_mfma_f32_16x16x32_bf16 v[96:99], a[244:247], a[120:123], v[96:99]
  ds_read_b64_tr_b16 a[206:207], v241 offset:4104
  v_mfma_f32_16x16x32_bf16 v[100:103], a[244:247], a[124:127], v[100:103]
  s_waitcnt lgkmcnt(10)
  v_mfma_f32_16x16x32_bf16 v[104:107], a[248:251], a[112:115], v[104:107]
  ds_read_b64_tr_b16 a[208:209], v242
  v_mfma_f32_16x16x32_bf16 v[108:111], a[248:251], a[116:119], v[108:111]
  buffer_load_dwordx4 v237, s[16:19], s30 offen offset:1024 lds
  s_add_u32 m0, s28, 0x2000
  v_mfma_f32_16x16x32_bf16 v[112:115], a[248:251], a[120:123], v[112:115]
  ds_read_b64_tr_b16 a[210:211], v242 offset:4096
  v_mfma_f32_16x16x32_bf16 v[116:119], a[248:251], a[124:127], v[116:119]
  s_waitcnt lgkmcnt(10)
  v_mfma_f32_16x16x32_bf16 v[120:123], a[252:255], a[112:115], v[120:123]
  ds_read_b64_tr_b16 a[212:213], v242 offset:8
  v_mfma_f32_16x16x32_bf16 v[124:127], a[252:255], a[116:119], v[124:127]
  v_mfma_f32_16x16x32_bf16 v[128:131], a[252:255], a[120:123], v[128:131]
  ds_read_b64_tr_b16 a[214:215], v242 offset:4104
  v_mfma_f32_16x16x32_bf16 v[132:135], a[252:255], a[124:127], v[132:135]
  s_waitcnt vmcnt(40) lgkmcnt(10)
  v_mfma_f32_16x16x32_bf16 v[8:11], a[192:195], a[128:131], v[8:11]
  ds_read_b64_tr_b16 a[216:217], v243
  v_mfma_f32_16x16x32_bf16 v[12:15], a[192:195], a[132:135], v[12:15]
  buffer_load_dwordx4 v238, s[20:23], s30 offen lds
  v_mfma_f32_16x16x32_bf16 v[16:19], a[192:195], a[136:139], v[16:19]
  ds_read_b64_tr_b16 a[218:219], v243 offset:4096
  v_mfma_f32_16x16x32_bf16 v[20:23], a[192:195], a[140:143], v[20:23]
  s_waitcnt lgkmcnt(10)
  v_mfma_f32_16x16x32_bf16 v[24:27], a[196:199], a[128:131], v[24:27]
  ds_read_b64_tr_b16 a[220:221], v243 offset:8
  v_mfma_f32_16x16x32_bf16 v[28:31], a[196:199], a[132:135], v[28:31]
  buffer_load_dwordx4 v239, s[20:23], s30 offen offset:1024 lds
  s_add_u32 s30, s30, 0x2000
  v_mfma_f32_16x16x32_bf16 v[32:35], a[196:199], a[136:139], v[32:35]
  ds_read_b64_tr_b16 a[222:223], v243 offset:4104
  s_add_u32 m0, s28, 0x8000
  v_mfma_f32_16x16x32_bf16 v[36:39], a[196:199], a[140:143], v[36:39]
  s_waitcnt lgkmcnt(10)
  v_mfma_f32_16x16x32_bf16 v[40:43], a[200:203], a[128:131], v[40:43]
  ds_read_b64_tr_b16 a[224:225], v240 offset:8192
  v_mfma_f32_16x16x32_bf16 v[44:47], a[200:203], a[132:135], v[44:47]
  buffer_load_dwordx4 v236, s[16:19], s30 offen lds
  v_mfma_f32_16x16x32_bf16 v[48:51], a[200:203], a[136:139], v[48:51]
  ds_read_b64_tr_b16 a[226:227], v240 offset:12288
  v_mfma_f32_16x16x32_bf16 v[52:55], a[200:203], a[140:143], v[52:55]
  s_waitcnt lgkmcnt(10)
  v_mfma_f32_16x16x32_bf16 v[56:59], a[204:207], a[128:131], v[56:59]
  ds_read_b64_tr_b16 a[228:229], v240 offset:8200
  v_mfma_f32_16x16x32_bf16 v[60:63], a[204:207], a[132:135], v[60:63]
  buffer_load_dwordx4 v237, s[16:19], s30 offen offset:1024 lds
  s_add_u32 m0, s28, 0x6000
  v_mfma_f32_16x16x32_bf16 v[64:67], a[204:207], a[136:139], v[64:67]
  ds_read_b64_tr_b16 a[230:231], v240 offset:12296
  v_mfma_f32_16x16x32_bf16 v[68:71], a[204:207], a[140:143], v[68:71]
  s_waitcnt lgkmcnt(10)
  v_mfma_f32_16x16x32_bf16 v[72:75], a[208:211], a[128:131], v[72:75]
  ds_read_b64_tr_b16 a[232:233], v241 offset:8192
  v_mfma_f32_16x16x32_bf16 v[76:79], a[208:211], a[132:135], v[76:79]
  buffer_load_dwordx4 v238, s[20:23], s30 offen lds
  v_mfma_f32_16x16x32_bf16 v[80:83], a[208:211], a[136:139], v[80:83]
  ds_read_b64_tr_b16 a[234:235], v241 offset:12288
  v_mfma_f32_16x16x32_bf16 v[84:87], a[208:211], a[140:143], v[84:87]
  s_waitcnt lgkmcnt(10)
  v_mfma_f32_16x16x32_bf16 v[88:91], a[212:215], a[128:131], v[88:91]
  ds_read_b64_tr_b16 a[236:237], v241 offset:8200
  v_mfma_f32_16x16x32_bf16 v[92:95], a[212:215], a[132:135], v[92:95]
  buffer_load_dwordx4 v239, s[20:23], s30 offen offset:1024 lds
  s_add_u32 s30, s30, 0x2000
  v_mfma_f32_16x16x32_bf16 v[96:99], a[212:215], a[136:139], v[96:99]
  ds_read_b64_tr_b16 a[238:239], v241 offset:12296
  s_add_u32 m0, s28, 0xc000
  v_mfma_f32_16x16x32_bf16 v[100:103], a[212:215], a[140:143], v[100:103]
  s_waitcnt lgkmcnt(10)
  v_mfma_f32_16x16x32_bf16 v[104:107], a[216:219], a[128:131], v[104:107]
  ds_read_b64_tr_b16 a[240:241], v242 offset:8192
  v_mfma_f32_16x16x32_bf16 v[108:111], a[216:219], a[132:135], v[108:111]
  buffer_load_dwordx4 v236, s[16:19], s30 offen lds
  v_mfma_f32_16x16x32_bf16 v[112:115], a[216:219], a[136:139], v[112:115]
  ds_read_b64_tr_b16 a[242:243], v242 offset:12288
  v_mfma_f32_16x16x32_bf16 v[116:119], a[216:219], a[140:143], v[116:119]
  s_waitcnt lgkmcnt(10)
  v_mfma_f32_16x16x32_bf16 v[120:123], a[220:223], a[128:131], v[120:123]
  ds_read_b64_tr_b16 a[244:245], v242 offset:8200
  v_mfma_f32_16x16x32_bf16 v[124:127], a[220:223], a[132:135], v[124:127]
  buffer_load_dwordx4 v237, s[16:19], s30 offen offset:1024 lds
  s_add_u32 m0, s28, 0xa000
  v_mfma_f32_16x16x32_bf16 v[128:131], a[220:223], a[136:139], v[128:131]
  ds_read_b64_tr_b16 a[246:247], v242 offset:12296
  v_mfma_f32_16x16x32_bf16 v[132:135], a[220:223], a[140:143], v[132:135]
  s_waitcnt vmcnt(44) lgkmcnt(10)
  v_mfma_f32_16x16x32_bf16 v[8:11], a[224:227], a[144:147], v[8:11]
  ds_read_b64_tr_b16 a[248:249], v243 offset:8192
  v_mfma_f32_16x16x32_bf16 v[12:15], a[224:227], a[148:151], v[12:15]
  buffer_load_dwordx4 v238, s[20:23], s30 offen lds
  v_mfma_f32_16x16x32_bf16 v[16:19], a[224:227], a[152:155], v[16:19]
  ds_read_b64_tr_b16 a[250:251], v243 offset:12288
  v_mfma_f32_16x16x32_bf16 v[20:23], a[224:227], a[156:159], v[20:23]
  s_waitcnt lgkmcnt(10)
  v_mfma_f32_16x16x32_bf16 v[24:27], a[228:231], a[144:147], v[24:27]
  ds_read_b64_tr_b16 a[252:253], v243 offset:8200
  v_mfma_f32_16x16x32_bf16 v[28:31], a[228:231], a[148:151], v[28:31]
  s_waitcnt vmcnt(63)
  s_barrier
  v_mfma_f32_16x16x32_bf16 v[32:35], a[228:231], a[152:155], v[32:35]
  ds_read_b64_tr_b16 a[254:255], v243 offset:12296
  v_mfma_f32_16x16x32_bf16 v[36:39], a[228:231], a[156:159], v[36:39]
  buffer_load_dwordx4 v239, s[20:23], s30 offen offset:1024 lds
  s_waitcnt lgkmcnt(10)
  v_mfma_f32_16x16x32_bf16 v[40:43], a[232:235], a[144:147], v[40:43]
  ds_read_b64_tr_b16 a[192:193], v240 offset:16384
  s_add_u32 s30, s30, 0x2000
  v_mfma_f32_16x16x32_bf16 v[44:47], a[232:235], a[148:151], v[44:47]
  v_mfma_f32_16x16x32_bf16 v[48:51], a[232:235], a[152:155], v[48:51]
  ds_read_b64_tr_b16 a[194:195], v240 offset:20480
  v_mfma_f32_16x16x32_bf16 v[52:55], a[232:235], a[156:159], v[52:55]
  s_waitcnt lgkmcnt(10)
  v_mfma_f32_16x16x32_bf16 v[56:59], a[236:239], a[144:147], v[56:59]
  ds_read_b64_tr_b16 a[196:197], v240 offset:16392
  v_mfma_f32_16x16x32_bf16 v[60:63], a[236:239], a[148:151], v[60:63]
  v_mfma_f32_16x16x32_bf16 v[64:67], a[236:239], a[152:155], v[64:67]
  ds_read_b64_tr_b16 a[198:199], v240 offset:20488
  v_mfma_f32_16x16x32_bf16 v[68:71], a[236:239], a[156:159], v[68:71]
  s_waitcnt lgkmcnt(10)
  v_mfma_f32_16x16x32_bf16 v[72:75], a[240:243], a[144:147], v[72:75]
  ds_read_b64_tr_b16 a[200:201], v241 offset:16384
  v_mfma_f32_16x16x32_bf16 v[76:79], a[240:243], a[148:151], v[76:79]
  v_mfma_f32_16x16x32_bf16 v[80:83], a[240:243], a[152:155], v[80:83]
  ds_read_b64_tr_b16 a[202:203], v241 offset:20480
  v_mfma_f32_16x16x32_bf16 v[84:87], a[240:243], a[156:159], v[84:87]
  s_waitcnt lgkmcnt(10)
  v_mfma_f32_16x16x32_bf16 v[88:91], a[244:247], a[144:147], v[88:91]
  ds_read_b64_tr_b16 a[204:205], v241 offset:16392
  v_mfma_f32_16x16x32_bf16 v[92:95], a[244:247], a[148:151], v[92:95]
  v_mfma_f32_16x16x32_bf16 v[96:99], a[244:247], a[152:155], v[96:99]
  ds_read_b64_tr_b16 a[206:207], v241 offset:20488
  v_mfma_f32_16x16x32_bf16 v[100:103], a[244:247], a[156:159], v[100:103]
  s_waitcnt lgkmcnt(10)
  v_mfma_f32_16x16x32_bf16 v[104:107], a[248:251], a[144:147], v[104:107]
  ds_read_b64_tr_b16 a[208:209], v242 offset:16384
  v_mfma_f32_16x16x32_bf16 v[108:111], a[248:251], a[148:151], v[108:111]
  v_mfma_f32_16x16x32_bf16 v[112:115], a[248:251], a[152:155], v[112:115]
  ds_read_b64_tr_b16 a[210:211], v242 offset:20480
  v_mfma_f32_16x16x32_bf16 v[116:119], a[248:251], a[156:159], v[116:119]
  s_waitcnt lgkmcnt(10)
  v_mfma_f32_16x16x32_bf16 v[120:123], a[252:255], a[144:147], v[120:123]
  ds_read_b64_tr_b16 a[212:213], v242 offset:16392
  v_mfma_f32_16x16x32_bf16 v[124:127], a[252:255], a[148:151], v[124:127]
  v_mfma_f32_16x16x32_bf16 v[128:131], a[252:255], a[152:155], v[128:131]
  ds_read_b64_tr_b16 a[214:215], v242 offset:20488
  v_mfma_f32_16x16x32_bf16 v[132:135], a[252:255], a[156:159], v[132:135]
  s_waitcnt vmcnt(42) lgkmcnt(10)
  v_mfma_f32_16x16x32_bf16 v[8:11], a[192:195], a[160:163], v[8:11]
  ds_read_b64_tr_b16 a[216:217], v243 offset:16384
  s_add_u32 m0, s28, 0x10000
  v_mfma_f32_16x16x32_bf16 v[12:15], a[192:195], a[164:167], v[12:15]
  buffer_load_dwordx4 v236, s[16:19], s30 offen lds
  v_mfma_f32_16x16x32_bf16 v[16:19], a[192:195], a[168:171], v[16:19]
  ds_read_b64_tr_b16 a[218:219], v243 offset:20480
  v_mfma_f32_16x16x32_bf16 v[20:23], a[192:195], a[172:175], v[20:23]
  s_waitcnt lgkmcnt(10)
  v_mfma_f32_16x16x32_bf16 v[24:27], a[196:199], a[160:163], v[24:27]
  ds_read_b64_tr_b16 a[220:221], v243 offset:16392
  v_mfma_f32_16x16x32_bf16 v[28:31], a[196:199], a[164:167], v[28:31]
  buffer_load_dwordx4 v237, s[16:19], s30 offen offset:1024 lds
  s_add_u32 m0, s28, 0xe000
  v_mfma_f32_16x16x32_bf16 v[32:35], a[196:199], a[168:171], v[32:35]
  ds_read_b64_tr_b16 a[222:223], v243 offset:20488
  v_mfma_f32_16x16x32_bf16 v[36:39], a[196:199], a[172:175], v[36:39]
  s_waitcnt lgkmcnt(10)
  v_mfma_f32_16x16x32_bf16 v[40:43], a[200:203], a[160:163], v[40:43]
  ds_read_b64_tr_b16 a[224:225], v240 offset:24576
  v_mfma_f32_16x16x32_bf16 v[44:47], a[200:203], a[164:167], v[44:47]
  buffer_load_dwordx4 v238, s[20:23], s30 offen lds
  v_mfma_f32_16x16x32_bf16 v[48:51], a[200:203], a[168:171], v[48:51]
  ds_read_b64_tr_b16 a[226:227], v240 offset:28672
  v_mfma_f32_16x16x32_bf16 v[52:55], a[200:203], a[172:175], v[52:55]
  s_waitcnt lgkmcnt(10)
  v_mfma_f32_16x16x32_bf16 v[56:59], a[204:207], a[160:163], v[56:59]
  ds_read_b64_tr_b16 a[228:229], v240 offset:24584
  v_mfma_f32_16x16x32_bf16 v[60:63], a[204:207], a[164:167], v[60:63]
  buffer_load_dwordx4 v239, s[20:23], s30 offen offset:1024 lds
  s_add_u32 s30, s30, 0x2000
  v_mfma_f32_16x16x32_bf16 v[64:67], a[204:207], a[168:171], v[64:67]
  ds_read_b64_tr_b16 a[230:231], v240 offset:28680
  v_mfma_f32_16x16x32_bf16 v[68:71], a[204:207], a[172:175], v[68:71]
  s_waitcnt lgkmcnt(10)
  v_mfma_f32_16x16x32_bf16 v[72:75], a[208:211], a[160:163], v[72:75]
  ds_read_b64_tr_b16 a[232:233], v241 offset:24576
  v_mfma_f32_16x16x32_bf16 v[76:79], a[208:211], a[164:167], v[76:79]
  v_mfma_f32_16x16x32_bf16 v[80:83], a[208:211], a[168:171], v[80:83]
  ds_read_b64_tr_b16 a[234:235], v241 offset:28672
  v_mfma_f32_16x16x32_bf16 v[84:87], a[208:211], a[172:175], v[84:87]
  s_waitcnt lgkmcnt(10)
  v_mfma_f32_16x16x32_bf16 v[88:91], a[212:215], a[160:163], v[88:91]
  ds_read_b64_tr_b16 a[236:237], v241 offset:24584
  v_mfma_f32_16x16x32_bf16 v[92:95], a[212:215], a[164:167], v[92:95]
  v_mfma_f32_16x16x32_bf16 v[96:99], a[212:215], a[168:171], v[96:99]
  ds_read_b64_tr_b16 a[238:239], v241 offset:28680
  v_mfma_f32_16x16x32_bf16 v[100:103], a[212:215], a[172:175], v[100:103]
  s_waitcnt lgkmcnt(10)
  v_mfma_f32_16x16x32_bf16 v[104:107], a[216:219], a[160:163], v[104:107]
  ds_read_b64_tr_b16 a[240:241], v242 offset:24576
  v_mfma_f32_16x16x32_bf16 v[108:111], a[216:219], a[164:167], v[108:111]
  v_mfma_f32_16x16x32_bf16 v[112:115], a[216:219], a[168:171], v[112:115]
  ds_read_b64_tr_b16 a[242:243], v242 offset:28672
  v_mfma_f32_16x16x32_bf16 v[116:119], a[216:219], a[172:175], v[116:119]
  s_waitcnt lgkmcnt(10)
  v_mfma_f32_16x16x32_bf16 v[120:123], a[220:223], a[160:163], v[120:123]
  ds_read_b64_tr_b16 a[244:245], v242 offset:24584
  v_mfma_f32_16x16x32_bf16 v[124:127], a[220:223], a[164:167], v[124:127]
  v_mfma_f32_16x16x32_bf16 v[128:131], a[220:223], a[168:171], v[128:131]
  ds_read_b64_tr_b16 a[246:247], v242 offset:28680
  v_mfma_f32_16x16x32_bf16 v[132:135], a[220:223], a[172:175], v[132:135]
  s_waitcnt vmcnt(42) lgkmcnt(10)
  v_mfma_f32_16x16x32_bf16 v[8:11], a[224:227], a[176:179], v[8:11]
  ds_read_b64_tr_b16 a[248:249], v243 offset:24576
  v_mfma_f32_16x16x32_bf16 v[12:15], a[224:227], a[180:183], v[12:15]
  v_mfma_f32_16x16x32_bf16 v[16:19], a[224:227], a[184:187], v[16:19]
  ds_read_b64_tr_b16 a[250:251], v243 offset:28672
  v_mfma_f32_16x16x32_bf16 v[20:23], a[224:227], a[188:191], v[20:23]
  s_waitcnt lgkmcnt(10)
  v_mfma_f32_16x16x32_bf16 v[24:27], a[228:231], a[176:179], v[24:27]
  ds_read_b64_tr_b16 a[252:253], v243 offset:24584
  v_mfma_f32_16x16x32_bf16 v[28:31], a[228:231], a[180:183], v[28:31]
  s_waitcnt vmcnt(63)
  s_barrier
  v_mfma_f32_16x16x32_bf16 v[32:35], a[228:231], a[184:187], v[32:35]
  ds_read_b64_tr_b16 a[254:255], v243 offset:28680
  v_mfma_f32_16x16x32_bf16 v[36:39], a[228:231], a[188:191], v[36:39]
  s_waitcnt lgkmcnt(10)
  v_mfma_f32_16x16x32_bf16 v[40:43], a[232:235], a[176:179], v[40:43]
  ds_read_b64_tr_b16 a[192:193], v240 offset:32768
  v_mfma_f32_16x16x32_bf16 v[44:47], a[232:235], a[180:183], v[44:47]
  v_mfma_f32_16x16x32_bf16 v[48:51], a[232:235], a[184:187], v[48:51]
  ds_read_b64_tr_b16 a[194:195], v240 offset:36864
  v_mfma_f32_16x16x32_bf16 v[52:55], a[232:235], a[188:191], v[52:55]
  s_waitcnt lgkmcnt(10)
  v_mfma_f32_16x16x32_bf16 v[56:59], a[236:239], a[176:179], v[56:59]
  ds_read_b64_tr_b16 a[196:197], v240 offset:32776
  v_mfma_f32_16x16x32_bf16 v[60:63], a[236:239], a[180:183], v[60:63]
  v_mfma_f32_16x16x32_bf16 v[64:67], a[236:239], a[184:187], v[64:67]
  ds_read_b64_tr_b16 a[198:199], v240 offset:36872
  v_mfma_f32_16x16x32_bf16 v[68:71], a[236:239], a[188:191], v[68:71]
  s_waitcnt lgkmcnt(10)
  v_mfma_f32_16x16x32_bf16 v[72:75], a[240:243], a[176:179], v[72:75]
  ds_read_b64_tr_b16 a[200:201], v241 offset:32768
  v_mfma_f32_16x16x32_bf16 v[76:79], a[240:243], a[180:183], v[76:79]
  v_mfma_f32_16x16x32_bf16 v[80:83], a[240:243], a[184:187], v[80:83]
  ds_read_b64_tr_b16 a[202:203], v241 offset:36864
  v_mfma_f32_16x16x32_bf16 v[84:87], a[240:243], a[188:191], v[84:87]
  s_waitcnt lgkmcnt(10)
  v_mfma_f32_16x16x32_bf16 v[88:91], a[244:247], a[176:179], v[88:91]
  ds_read_b64_tr_b16 a[204:205], v241 offset:32776
  v_mfma_f32_16x16x32_bf16 v[92:95], a[244:247], a[180:183], v[92:95]
  v_mfma_f32_16x16x32_bf16 v[96:99], a[244:247], a[184:187], v[96:99]
  ds_read_b64_tr_b16 a[206:207], v241 offset:36872
  v_mfma_f32_16x16x32_bf16 v[100:103], a[244:247], a[188:191], v[100:103]
  s_waitcnt lgkmcnt(10)
  v_mfma_f32_16x16x32_bf16 v[104:107], a[248:251], a[176:179], v[104:107]
  ds_read_b64_tr_b16 a[208:209], v242 offset:32768
  v_mfma_f32_16x16x32_bf16 v[108:111], a[248:251], a[180:183], v[108:111]
  v_mfma_f32_16x16x32_bf16 v[112:115], a[248:251], a[184:187], v[112:115]
  ds_read_b64_tr_b16 a[210:211], v242 offset:36864
  v_mfma_f32_16x16x32_bf16 v[116:119], a[248:251], a[188:191], v[116:119]
  s_waitcnt lgkmcnt(10)
  v_mfma_f32_16x16x32_bf16 v[120:123], a[252:255], a[176:179], v[120:123]
  ds_read_b64_tr_b16 a[212:213], v242 offset:32776
  v_mfma_f32_16x16x32_bf16 v[124:127], a[252:255], a[180:183], v[124:127]
  v_mfma_f32_16x16x32_bf16 v[128:131], a[252:255], a[184:187], v[128:131]
  ds_read_b64_tr_b16 a[214:215], v242 offset:36872
  v_mfma_f32_16x16x32_bf16 v[132:135], a[252:255], a[188:191], v[132:135]
  s_waitcnt vmcnt(38) lgkmcnt(10)
  v_mfma_f32_16x16x32_bf16 v[8:11], a[192:195], a[0:3], v[8:11]
  ds_read_b64_tr_b16 a[216:217], v243 offset:32768
  s_add_u32 m0, s28, 0x14000
  v_mfma_f32_16x16x32_bf16 v[12:15], a[192:195], a[4:7], v[12:15]
  buffer_load_dwordx4 v236, s[16:19], s30 offen lds
  v_mfma_f32_16x16x32_bf16 v[16:19], a[192:195], a[8:11], v[16:19]
  ds_read_b64_tr_b16 a[218:219], v243 offset:36864
  v_mfma_f32_16x16x32_bf16 v[20:23], a[192:195], a[12:15], v[20:23]
  s_waitcnt lgkmcnt(10)
  v_mfma_f32_16x16x32_bf16 v[24:27], a[196:199], a[0:3], v[24:27]
  ds_read_b64_tr_b16 a[220:221], v243 offset:32776
  v_mfma_f32_16x16x32_bf16 v[28:31], a[196:199], a[4:7], v[28:31]
  buffer_load_dwordx4 v237, s[16:19], s30 offen offset:1024 lds
  s_add_u32 m0, s28, 0x12000
  v_mfma_f32_16x16x32_bf16 v[32:35], a[196:199], a[8:11], v[32:35]
  ds_read_b64_tr_b16 a[222:223], v243 offset:36872
  v_mfma_f32_16x16x32_bf16 v[36:39], a[196:199], a[12:15], v[36:39]
  s_waitcnt lgkmcnt(10)
  v_mfma_f32_16x16x32_bf16 v[40:43], a[200:203], a[0:3], v[40:43]
  ds_read_b64_tr_b16 a[224:225], v240 offset:40960
  v_mfma_f32_16x16x32_bf16 v[44:47], a[200:203], a[4:7], v[44:47]
  buffer_load_dwordx4 v238, s[20:23], s30 offen lds
  v_mfma_f32_16x16x32_bf16 v[48:51], a[200:203], a[8:11], v[48:51]
  ds_read_b64_tr_b16 a[226:227], v240 offset:45056
  v_mfma_f32_16x16x32_bf16 v[52:55], a[200:203], a[12:15], v[52:55]
  s_waitcnt lgkmcnt(10)
  v_mfma_f32_16x16x32_bf16 v[56:59], a[204:207], a[0:3], v[56:59]
  ds_read_b64_tr_b16 a[228:229], v240 offset:40968
  v_mfma_f32_16x16x32_bf16 v[60:63], a[204:207], a[4:7], v[60:63]
  buffer_load_dwordx4 v239, s[20:23], s30 offen offset:1024 lds
  s_add_u32 s30, s30, 0x2000
  v_mfma_f32_16x16x32_bf16 v[64:67], a[204:207], a[8:11], v[64:67]
  ds_read_b64_tr_b16 a[230:231], v240 offset:45064
  v_mfma_f32_16x16x32_bf16 v[68:71], a[204:207], a[12:15], v[68:71]
  s_waitcnt lgkmcnt(10)
  v_mfma_f32_16x16x32_bf16 v[72:75], a[208:211], a[0:3], v[72:75]
  ds_read_b64_tr_b16 a[232:233], v241 offset:40960
  v_mfma_f32_16x16x32_bf16 v[76:79], a[208:211], a[4:7], v[76:79]
  v_mfma_f32_16x16x32_bf16 v[80:83], a[208:211], a[8:11], v[80:83]
  ds_read_b64_tr_b16 a[234:235], v241 offset:45056
  v_mfma_f32_16x16x32_bf16 v[84:87], a[208:211], a[12:15], v[84:87]
  s_waitcnt lgkmcnt(10)
  v_mfma_f32_16x16x32_bf16 v[88:91], a[212:215], a[0:3], v[88:91]
  ds_read_b64_tr_b16 a[236:237], v241 offset:40968
  v_mfma_f32_16x16x32_bf16 v[92:95], a[212:215], a[4:7], v[92:95]
  v_mfma_f32_16x16x32_bf16 v[96:99], a[212:215], a[8:11], v[96:99]
  ds_read_b64_tr_b16 a[238:239], v241 offset:45064
  v_mfma_f32_16x16x32_bf16 v[100:103], a[212:215], a[12:15], v[100:103]
  s_waitcnt lgkmcnt(10)
  v_mfma_f32_16x16x32_bf16 v[104:107], a[216:219], a[0:3], v[104:107]
  ds_read_b64_tr_b16 a[240:241], v242 offset:40960
  v_mfma_f32_16x16x32_bf16 v[108:111], a[216:219], a[4:7], v[108:111]
  v_mfma_f32_16x16x32_bf16 v[112:115], a[216:219], a[8:11], v[112:115]
  ds_read_b64_tr_b16 a[242:243], v242 offset:45056
  v_mfma_f32_16x16x32_bf16 v[116:119], a[216:219], a[12:15], v[116:119]
  s_waitcnt lgkmcnt(10)
  v_mfma_f32_16x16x32_bf16 v[120:123], a[220:223], a[0:3], v[120:123]
  ds_read_b64_tr_b16 a[244:245], v242 offset:40968
  v_mfma_f32_16x16x32_bf16 v[124:127], a[220:223], a[4:7], v[124:127]
  v_mfma_f32_16x16x32_bf16 v[128:131], a[220:223], a[8:11], v[128:131]
  ds_read_b64_tr_b16 a[246:247], v242 offset:45064
  v_mfma_f32_16x16x32_bf16 v[132:135], a[220:223], a[12:15], v[132:135]
  s_waitcnt vmcnt(38) lgkmcnt(10)
  v_mfma_f32_16x16x32_bf16 v[8:11], a[224:227], a[16:19], v[8:11]
  ds_read_b64_tr_b16 a[248:249], v243 offset:40960
  v_mfma_f32_16x16x32_bf16 v[12:15], a[224:227], a[20:23], v[12:15]
  v_mfma_f32_16x16x32_bf16 v[16:19], a[224:227], a[24:27], v[16:19]
  ds_read_b64_tr_b16 a[250:251], v243 offset:45056
  v_mfma_f32_16x16x32_bf16 v[20:23], a[224:227], a[28:31], v[20:23]
  s_waitcnt lgkmcnt(10)
  v_mfma_f32_16x16x32_bf16 v[24:27], a[228:231], a[16:19], v[24:27]
  ds_read_b64_tr_b16 a[252:253], v243 offset:40968
  v_mfma_f32_16x16x32_bf16 v[28:31], a[228:231], a[20:23], v[28:31]
  s_waitcnt vmcnt(63)
  s_barrier
  v_mfma_f32_16x16x32_bf16 v[32:35], a[228:231], a[24:27], v[32:35]
  ds_read_b64_tr_b16 a[254:255], v243 offset:45064
  v_mfma_f32_16x16x32_bf16 v[36:39], a[228:231], a[28:31], v[36:39]
  s_waitcnt lgkmcnt(10)
  v_mfma_f32_16x16x32_bf16 v[40:43], a[232:235], a[16:19], v[40:43]
  ds_read_b64_tr_b16 a[192:193], v240 offset:49152
  v_mfma_f32_16x16x32_bf16 v[44:47], a[232:235], a[20:23], v[44:47]
  v_mfma_f32_16x16x32_bf16 v[48:51], a[232:235], a[24:27], v[48:51]
  ds_read_b64_tr_b16 a[194:195], v240 offset:53248
  v_mfma_f32_16x16x32_bf16 v[52:55], a[232:235], a[28:31], v[52:55]
  s_waitcnt lgkmcnt(10)
  v_mfma_f32_16x16x32_bf16 v[56:59], a[236:239], a[16:19], v[56:59]
  ds_read_b64_tr_b16 a[196:197], v240 offset:49160
  v_mfma_f32_16x16x32_bf16 v[60:63], a[236:239], a[20:23], v[60:63]
  v_mfma_f32_16x16x32_bf16 v[64:67], a[236:239], a[24:27], v[64:67]
  ds_read_b64_tr_b16 a[198:199], v240 offset:53256
  v_mfma_f32_16x16x32_bf16 v[68:71], a[236:239], a[28:31], v[68:71]
  s_waitcnt lgkmcnt(10)
  v_mfma_f32_16x16x32_bf16 v[72:75], a[240:243], a[16:19], v[72:75]
  ds_read_b64_tr_b16 a[200:201], v241 offset:49152
  v_mfma_f32_16x16x32_bf16 v[76:79], a[240:243], a[20:23], v[76:79]
  v_mfma_f32_16x16x32_bf16 v[80:83], a[240:243], a[24:27], v[80:83]
  ds_read_b64_tr_b16 a[202:203], v241 offset:53248
  v_mfma_f32_16x16x32_bf16 v[84:87], a[240:243], a[28:31], v[84:87]
  s_waitcnt lgkmcnt(10)
  v_mfma_f32_16x16x32_bf16 v[88:91], a[244:247], a[16:19], v[88:91]
  ds_read_b64_tr_b16 a[204:205], v241 offset:49160
  v_mfma_f32_16x16x32_bf16 v[92:95], a[244:247], a[20:23], v[92:95]
  v_mfma_f32_16x16x32_bf16 v[96:99], a[244:247], a[24:27], v[96:99]
  ds_read_b64_tr_b16 a[206:207], v241 offset:53256
  v_mfma_f32_16x16x32_bf16 v[100:103], a[244:247], a[28:31], v[100:103]
  s_waitcnt lgkmcnt(10)
  v_mfma_f32_16x16x32_bf16 v[104:107], a[248:251], a[16:19], v[104:107]
  ds_read_b64_tr_b16 a[208:209], v242 offset:49152
  v_mfma_f32_16x16x32_bf16 v[108:111], a[248:251], a[20:23], v[108:111]
  v_mfma_f32_16x16x32_bf16 v[112:115], a[248:251], a[24:27], v[112:115]
  ds_read_b64_tr_b16 a[210:211], v242 offset:53248
  v_mfma_f32_16x16x32_bf16 v[116:119], a[248:251], a[28:31], v[116:119]
  s_waitcnt lgkmcnt(10)
  v_mfma_f32_16x16x32_bf16 v[120:123], a[252:255], a[16:19], v[120:123]
  ds_read_b64_tr_b16 a[212:213], v242 offset:49160
  v_mfma_f32_16x16x32_bf16 v[124:127], a[252:255], a[20:23], v[124:127]
  v_mfma_f32_16x16x32_bf16 v[128:131], a[252:255], a[24:27], v[128:131]
  ds_read_b64_tr_b16 a[214:215], v242 offset:53256
  v_mfma_f32_16x16x32_bf16 v[132:135], a[252:255], a[28:31], v[132:135]
  s_waitcnt vmcnt(34) lgkmcnt(10)
  v_mfma_f32_16x16x32_bf16 v[8:11], a[192:195], a[32:35], v[8:11]
  ds_read_b64_tr_b16 a[216:217], v243 offset:49152
  s_add_u32 m0, s28, 0x18000
  v_mfma_f32_16x16x32_bf16 v[12:15], a[192:195], a[36:39], v[12:15]
  buffer_load_dwordx4 v236, s[16:19], s30 offen lds
  v_mfma_f32_16x16x32_bf16 v[16:19], a[192:195], a[40:43], v[16:19]
  ds_read_b64_tr_b16 a[218:219], v243 offset:53248
  v_mfma_f32_16x16x32_bf16 v[20:23], a[192:195], a[44:47], v[20:23]
  s_waitcnt lgkmcnt(10)
  v_mfma_f32_16x16x32_bf16 v[24:27], a[196:199], a[32:35], v[24:27]
  ds_read_b64_tr_b16 a[220:221], v243 offset:49160
  v_mfma_f32_16x16x32_bf16 v[28:31], a[196:199], a[36:39], v[28:31]
  buffer_load_dwordx4 v237, s[16:19], s30 offen offset:1024 lds
  s_add_u32 m0, s28, 0x16000
  v_mfma_f32_16x16x32_bf16 v[32:35], a[196:199], a[40:43], v[32:35]
  ds_read_b64_tr_b16 a[222:223], v243 offset:53256
  v_mfma_f32_16x16x32_bf16 v[36:39], a[196:199], a[44:47], v[36:39]
  s_waitcnt lgkmcnt(10)
  v_mfma_f32_16x16x32_bf16 v[40:43], a[200:203], a[32:35], v[40:43]
  ds_read_b64_tr_b16 a[224:225], v240 offset:57344
  v_mfma_f32_16x16x32_bf16 v[44:47], a[200:203], a[36:39], v[44:47]
  buffer_load_dwordx4 v238, s[20:23], s30 offen lds
  v_mfma_f32_16x16x32_bf16 v[48:51], a[200:203], a[40:43], v[48:51]
  ds_read_b64_tr_b16 a[226:227], v240 offset:61440
  v_mfma_f32_16x16x32_bf16 v[52:55], a[200:203], a[44:47], v[52:55]
  s_waitcnt lgkmcnt(10)
  v_mfma_f32_16x16x32_bf16 v[56:59], a[204:207], a[32:35], v[56:59]
  ds_read_b64_tr_b16 a[228:229], v240 offset:57352
  v_mfma_f32_16x16x32_bf16 v[60:63], a[204:207], a[36:39], v[60:63]
  buffer_load_dwordx4 v239, s[20:23], s30 offen offset:1024 lds
  s_add_u32 s30, s30, 0x2000
  v_mfma_f32_16x16x32_bf16 v[64:67], a[204:207], a[40:43], v[64:67]
  ds_read_b64_tr_b16 a[230:231], v240 offset:61448
  v_mfma_f32_16x16x32_bf16 v[68:71], a[204:207], a[44:47], v[68:71]
  s_waitcnt lgkmcnt(10)
  v_mfma_f32_16x16x32_bf16 v[72:75], a[208:211], a[32:35], v[72:75]
  ds_read_b64_tr_b16 a[232:233], v241 offset:57344
  v_mfma_f32_16x16x32_bf16 v[76:79], a[208:211], a[36:39], v[76:79]
  v_mfma_f32_16x16x32_bf16 v[80:83], a[208:211], a[40:43], v[80:83]
  ds_read_b64_tr_b16 a[234:235], v241 offset:61440
  v_mfma_f32_16x16x32_bf16 v[84:87], a[208:211], a[44:47], v[84:87]
  s_waitcnt lgkmcnt(10)
  v_mfma_f32_16x16x32_bf16 v[88:91], a[212:215], a[32:35], v[88:91]
  ds_read_b64_tr_b16 a[236:237], v241 offset:57352
  v_mfma_f32_16x16x32_bf16 v[92:95], a[212:215], a[36:39], v[92:95]
  v_mfma_f32_16x16x32_bf16 v[96:99], a[212:215], a[40:43], v[96:99]
  ds_read_b64_tr_b16 a[238:239], v241 offset:61448
  v_mfma_f32_16x16x32_bf16 v[100:103], a[212:215], a[44:47], v[100:103]
  s_waitcnt lgkmcnt(10)
  v_mfma_f32_16x16x32_bf16 v[104:107], a[216:219], a[32:35], v[104:107]
  ds_read_b64_tr_b16 a[240:241], v242 offset:57344
  v_mfma_f32_16x16x32_bf16 v[108:111], a[216:219], a[36:39], v[108:111]
  v_mfma_f32_16x16x32_bf16 v[112:115], a[216:219], a[40:43], v[112:115]
  ds_read_b64_tr_b16 a[242:243], v242 offset:61440
  v_mfma_f32_16x16x32_bf16 v[116:119], a[216:219], a[44:47], v[116:119]
  s_waitcnt lgkmcnt(10)
  v_mfma_f32_16x16x32_bf16 v[120:123], a[220:223], a[32:35], v[120:123]
  ds_read_b64_tr_b16 a[244:245], v242 offset:57352
  v_mfma_f32_16x16x32_bf16 v[124:127], a[220:223], a[36:39], v[124:127]
  v_mfma_f32_16x16x32_bf16 v[128:131], a[220:223], a[40:43], v[128:131]
  ds_read_b64_tr_b16 a[246:247], v242 offset:61448
  v_mfma_f32_16x16x32_bf16 v[132:135], a[220:223], a[44:47], v[132:135]
  s_waitcnt vmcnt(34) lgkmcnt(10)
  v_mfma_f32_16x16x32_bf16 v[8:11], a[224:227], a[48:51], v[8:11]
  ds_read_b64_tr_b16 a[248:249], v243 offset:57344
  v_mfma_f32_16x16x32_bf16 v[12:15], a[224:227], a[52:55], v[12:15]
  v_mfma_f32_16x16x32_bf16 v[16:19], a[224:227], a[56:59], v[16:19]
  ds_read_b64_tr_b16 a[250:251], v243 offset:61440
  v_mfma_f32_16x16x32_bf16 v[20:23], a[224:227], a[60:63], v[20:23]
  s_waitcnt lgkmcnt(10)
  v_mfma_f32_16x16x32_bf16 v[24:27], a[228:231], a[48:51], v[24:27]
  ds_read_b64_tr_b16 a[252:253], v243 offset:57352
  v_add_u32 v240, 0x10000, v240
  v_mfma_f32_16x16x32_bf16 v[28:31], a[228:231], a[52:55], v[28:31]
  s_waitcnt vmcnt(63)
  s_barrier
  v_mfma_f32_16x16x32_bf16 v[32:35], a[228:231], a[56:59], v[32:35]
  ds_read_b64_tr_b16 a[254:255], v243 offset:61448
  v_add_u32 v241, 0x10000, v241
  v_mfma_f32_16x16x32_bf16 v[36:39], a[228:231], a[60:63], v[36:39]
  s_waitcnt lgkmcnt(10)
  v_mfma_f32_16x16x32_bf16 v[40:43], a[232:235], a[48:51], v[40:43]
  ds_read_b64_tr_b16 a[192:193], v240
  v_add_u32 v242, 0x10000, v242
  v_mfma_f32_16x16x32_bf16 v[44:47], a[232:235], a[52:55], v[44:47]
  v_mfma_f32_16x16x32_bf16 v[48:51], a[232:235], a[56:59], v[48:51]
  ds_read_b64_tr_b16 a[194:195], v240 offset:4096
  v_add_u32 v243, 0x10000, v243
  v_mfma_f32_16x16x32_bf16 v[52:55], a[232:235], a[60:63], v[52:55]
  s_waitcnt lgkmcnt(10)
  v_mfma_f32_16x16x32_bf16 v[56:59], a[236:239], a[48:51], v[56:59]
  ds_read_b64_tr_b16 a[196:197], v240 offset:8
  v_mfma_f32_16x16x32_bf16 v[60:63], a[236:239], a[52:55], v[60:63]
  v_mfma_f32_16x16x32_bf16 v[64:67], a[236:239], a[56:59], v[64:67]
  ds_read_b64_tr_b16 a[198:199], v240 offset:4104
  v_mfma_f32_16x16x32_bf16 v[68:71], a[236:239], a[60:63], v[68:71]
  s_waitcnt lgkmcnt(10)
  v_mfma_f32_16x16x32_bf16 v[72:75], a[240:243], a[48:51], v[72:75]
  ds_read_b64_tr_b16 a[200:201], v241
  v_mfma_f32_16x16x32_bf16 v[76:79], a[240:243], a[52:55], v[76:79]
  v_mfma_f32_16x16x32_bf16 v[80:83], a[240:243], a[56:59], v[80:83]
  ds_read_b64_tr_b16 a[202:203], v241 offset:4096
  v_mfma_f32_16x16x32_bf16 v[84:87], a[240:243], a[60:63], v[84:87]
  s_waitcnt lgkmcnt(10)
  v_mfma_f32_16x16x32_bf16 v[88:91], a[244:247], a[48:51], v[88:91]
  ds_read_b64_tr_b16 a[204:205], v241 offset:8
  v_mfma_f32_16x16x32_bf16 v[92:95], a[244:247], a[52:55], v[92:95]
  v_mfma_f32_16x16x32_bf16 v[96:99], a[244:247], a[56:59], v[96:99]
  ds_read_b64_tr_b16 a[206:207], v241 offset:4104
  v_mfma_f32_16x16x32_bf16 v[100:103], a[244:247], a[60:63], v[100:103]
  s_waitcnt lgkmcnt(10)
  v_mfma_f32_16x16x32_bf16 v[104:107], a[248:251], a[48:51], v[104:107]
  ds_read_b64_tr_b16 a[208:209], v242
  v_mfma_f32_16x16x32_bf16 v[108:111], a[248:251], a[52:55], v[108:111]
  v_mfma_f32_16x16x32_bf16 v[112:115], a[248:251], a[56:59], v[112:115]
  ds_read_b64_tr_b16 a[210:211], v242 offset:4096
  v_mfma_f32_16x16x32_bf16 v[116:119], a[248:251], a[60:63], v[116:119]
  s_waitcnt lgkmcnt(10)
  v_mfma_f32_16x16x32_bf16 v[120:123], a[252:255], a[48:51], v[120:123]
  ds_read_b64_tr_b16 a[212:213], v242 offset:8
  v_mfma_f32_16x16x32_bf16 v[124:127], a[252:255], a[52:55], v[124:127]
  v_mfma_f32_16x16x32_bf16 v[128:131], a[252:255], a[56:59], v[128:131]
  ds_read_b64_tr_b16 a[214:215], v242 offset:4104
  v_mfma_f32_16x16x32_bf16 v[132:135], a[252:255], a[60:63], v[132:135]
  s_waitcnt vmcnt(30) lgkmcnt(10)
  v_mfma_f32_16x16x32_bf16 v[8:11], a[192:195], a[64:67], v[8:11]
  ds_read_b64_tr_b16 a[216:217], v243
  s_add_u32 m0, s28, 0x1c000
  v_mfma_f32_16x16x32_bf16 v[12:15], a[192:195], a[68:71], v[12:15]
  buffer_load_dwordx4 v236, s[16:19], s30 offen lds
  v_mfma_f32_16x16x32_bf16 v[16:19], a[192:195], a[72:75], v[16:19]
  ds_read_b64_tr_b16 a[218:219], v243 offset:4096
  v_mfma_f32_16x16x32_bf16 v[20:23], a[192:195], a[76:79], v[20:23]
  buffer_load_dwordx4 v237, s[16:19], s30 offen offset:1024 lds
  s_waitcnt lgkmcnt(10)
  v_mfma_f32_16x16x32_bf16 v[24:27], a[196:199], a[64:67], v[24:27]
  ds_read_b64_tr_b16 a[220:221], v243 offset:8
  s_add_u32 m0, s28, 0x1a000
  v_mfma_f32_16x16x32_bf16 v[28:31], a[196:199], a[68:71], v[28:31]
  buffer_load_dwordx4 v238, s[20:23], s30 offen lds
  v_mfma_f32_16x16x32_bf16 v[32:35], a[196:199], a[72:75], v[32:35]
  ds_read_b64_tr_b16 a[222:223], v243 offset:4104
  v_mfma_f32_16x16x32_bf16 v[36:39], a[196:199], a[76:79], v[36:39]
  buffer_load_dwordx4 v239, s[20:23], s30 offen offset:1024 lds
  s_waitcnt lgkmcnt(10)
  v_mfma_f32_16x16x32_bf16 v[40:43], a[200:203], a[64:67], v[40:43]
  ds_read_b64_tr_b16 a[224:225], v240 offset:8192
  s_add_u32 s30, s30, 0x2000
  v_mfma_f32_16x16x32_bf16 v[44:47], a[200:203], a[68:71], v[44:47]
  v_mfma_f32_16x16x32_bf16 v[48:51], a[200:203], a[72:75], v[48:51]
  ds_read_b64_tr_b16 a[226:227], v240 offset:12288
  v_mfma_f32_16x16x32_bf16 v[52:55], a[200:203], a[76:79], v[52:55]
  s_waitcnt lgkmcnt(10)
  v_mfma_f32_16x16x32_bf16 v[56:59], a[204:207], a[64:67], v[56:59]
  ds_read_b64_tr_b16 a[228:229], v240 offset:8200
  v_mfma_f32_16x16x32_bf16 v[60:63], a[204:207], a[68:71], v[60:63]
  v_mfma_f32_16x16x32_bf16 v[64:67], a[204:207], a[72:75], v[64:67]
  ds_read_b64_tr_b16 a[230:231], v240 offset:12296
  v_mfma_f32_16x16x32_bf16 v[68:71], a[204:207], a[76:79], v[68:71]
  s_waitcnt lgkmcnt(10)
  v_mfma_f32_16x16x32_bf16 v[72:75], a[208:211], a[64:67], v[72:75]
  ds_read_b64_tr_b16 a[232:233], v241 offset:8192
  v_mfma_f32_16x16x32_bf16 v[76:79], a[208:211], a[68:71], v[76:79]
  v_mfma_f32_16x16x32_bf16 v[80:83], a[208:211], a[72:75], v[80:83]
  ds_read_b64_tr_b16 a[234:235], v241 offset:12288
  v_mfma_f32_16x16x32_bf16 v[84:87], a[208:211], a[76:79], v[84:87]
  s_waitcnt lgkmcnt(10)
  v_mfma_f32_16x16x32_bf16 v[88:91], a[212:215], a[64:67], v[88:91]
  ds_read_b64_tr_b16 a[236:237], v241 offset:8200
  v_mfma_f32_16x16x32_bf16 v[92:95], a[212:215], a[68:71], v[92:95]
  v_mfma_f32_16x16x32_bf16 v[96:99], a[212:215], a[72:75], v[96:99]
  ds_read_b64_tr_b16 a[238:239], v241 offset:12296
  v_mfma_f32_16x16x32_bf16 v[100:103], a[212:215], a[76:79], v[100:103]
  s_waitcnt lgkmcnt(10)
  v_mfma_f32_16x16x32_bf16 v[104:107], a[216:219], a[64:67], v[104:107]
  ds_read_b64_tr_b16 a[240:241], v242 offset:8192
  v_mfma_f32_16x16x32_bf16 v[108:111], a[216:219], a[68:71], v[108:111]
  v_mfma_f32_16x16x32_bf16 v[112:115], a[216:219], a[72:75], v[112:115]
  ds_read_b64_tr_b16 a[242:243], v242 offset:12288
  v_mfma_f32_16x16x32_bf16 v[116:119], a[216:219], a[76:79], v[116:119]
  s_waitcnt lgkmcnt(10)
  v_mfma_f32_16x16x32_bf16 v[120:123], a[220:223], a[64:67], v[120:123]
  ds_read_b64_tr_b16 a[244:245], v242 offset:8200
  v_mfma_f32_16x16x32_bf16 v[124:127], a[220:223], a[68:71], v[124:127]
  v_mfma_f32_16x16x32_bf16 v[128:131], a[220:223], a[72:75], v[128:131]
  ds_read_b64_tr_b16 a[246:247], v242 offset:12296
  v_mfma_f32_16x16x32_bf16 v[132:135], a[220:223], a[76:79], v[132:135]
  s_waitcnt vmcnt(30) lgkmcnt(10)
  v_mfma_f32_16x16x32_bf16 v[8:11], a[224:227], a[80:83], v[8:11]
  ds_read_b64_tr_b16 a[248:249], v243 offset:8192
  v_mfma_f32_16x16x32_bf16 v[12:15], a[224:227], a[84:87], v[12:15]
  v_mfma_f32_16x16x32_bf16 v[16:19], a[224:227], a[88:91], v[16:19]
  ds_read_b64_tr_b16 a[250:251], v243 offset:12288
  v_mfma_f32_16x16x32_bf16 v[20:23], a[224:227], a[92:95], v[20:23]
  s_waitcnt lgkmcnt(10)
  v_mfma_f32_16x16x32_bf16 v[24:27], a[228:231], a[80:83], v[24:27]
  ds_read_b64_tr_b16 a[252:253], v243 offset:8200
  v_mfma_f32_16x16x32_bf16 v[28:31], a[228:231], a[84:87], v[28:31]
  v_mfma_f32_16x16x32_bf16 v[32:35], a[228:231], a[88:91], v[32:35]
  ds_read_b64_tr_b16 a[254:255], v243 offset:12296
  v_mfma_f32_16x16x32_bf16 v[36:39], a[228:231], a[92:95], v[36:39]
  s_waitcnt lgkmcnt(10)
  v_mfma_f32_16x16x32_bf16 v[40:43], a[232:235], a[80:83], v[40:43]
  v_mfma_f32_16x16x32_bf16 v[44:47], a[232:235], a[84:87], v[44:47]
  v_cvt_pk_bf16_f32 v148, v8, v9
  v_mfma_f32_16x16x32_bf16 v[48:51], a[232:235], a[88:91], v[48:51]
  v_cvt_pk_bf16_f32 v149, v10, v11
  v_mfma_f32_16x16x32_bf16 v[52:55], a[232:235], a[92:95], v[52:55]
  s_waitcnt lgkmcnt(8)
  v_mfma_f32_16x16x32_bf16 v[56:59], a[236:239], a[80:83], v[56:59]
  v_cvt_pk_bf16_f32 v164, v12, v13
  v_mfma_f32_16x16x32_bf16 v[60:63], a[236:239], a[84:87], v[60:63]
  v_cvt_pk_bf16_f32 v165, v14, v15
  v_mfma_f32_16x16x32_bf16 v[64:67], a[236:239], a[88:91], v[64:67]
  v_cvt_pk_bf16_f32 v180, v16, v17
  v_mfma_f32_16x16x32_bf16 v[68:71], a[236:239], a[92:95], v[68:71]
  s_waitcnt lgkmcnt(6)
  v_mfma_f32_16x16x32_bf16 v[72:75], a[240:243], a[80:83], v[72:75]
  v_cvt_pk_bf16_f32 v181, v18, v19
  v_mfma_f32_16x16x32_bf16 v[76:79], a[240:243], a[84:87], v[76:79]
  v_cvt_pk_bf16_f32 v196, v20, v21
  v_mfma_f32_16x16x32_bf16 v[80:83], a[240:243], a[88:91], v[80:83]
  v_cvt_pk_bf16_f32 v197, v22, v23
  v_mfma_f32_16x16x32_bf16 v[84:87], a[240:243], a[92:95], v[84:87]
  s_waitcnt lgkmcnt(4)
  v_mfma_f32_16x16x32_bf16 v[88:91], a[244:247], a[80:83], v[88:91]
  v_cvt_pk_bf16_f32 v150, v24, v25
  v_mfma_f32_16x16x32_bf16 v[92:95], a[244:247], a[84:87], v[92:95]
  v_cvt_pk_bf16_f32 v151, v26, v27
  v_mfma_f32_16x16x32_bf16 v[96:99], a[244:247], a[88:91], v[96:99]
  v_cvt_pk_bf16_f32 v166, v28, v29
  v_mfma_f32_16x16x32_bf16 v[100:103], a[244:247], a[92:95], v[100:103]
  s_waitcnt lgkmcnt(2)
  v_mfma_f32_16x16x32_bf16 v[104:107], a[248:251], a[80:83], v[104:107]
  v_cvt_pk_bf16_f32 v167, v30, v31
  v_mfma_f32_16x16x32_bf16 v[108:111], a[248:251], a[84:87], v[108:111]
  v_cvt_pk_bf16_f32 v182, v32, v33
  v_mfma_f32_16x16x32_bf16 v[112:115], a[248:251], a[88:91], v[112:115]
  v_cvt_pk_bf16_f32 v183, v34, v35
  v_mfma_f32_16x16x32_bf16 v[116:119], a[248:251], a[92:95], v[116:119]
  s_waitcnt lgkmcnt(0)
  v_mfma_f32_16x16x32_bf16 v[120:123], a[252:255], a[80:83], v[120:123]
  v_cvt_pk_bf16_f32 v198, v36, v37
  v_mfma_f32_16x16x32_bf16 v[124:127], a[252:255], a[84:87], v[124:127]
  v_cvt_pk_bf16_f32 v199, v38, v39
  v_mfma_f32_16x16x32_bf16 v[128:131], a[252:255], a[88:91], v[128:131]
  v_cvt_pk_bf16_f32 v152, v40, v41
  v_mfma_f32_16x16x32_bf16 v[132:135], a[252:255], a[92:95], v[132:135]
  s_nop 0
  s_waitcnt vmcnt(24)
  s_barrier
  ds_read_b128 a[192:195], v212
  ds_read_b128 a[196:199], v213
  ds_read_b128 a[200:203], v214
  ds_read_b128 a[204:207], v215
  ds_read_b128 a[208:211], v212 offset:4096
  ds_read_b128 a[212:215], v213 offset:4096
  ds_read_b128 a[216:219], v214 offset:4096
  ds_read_b128 a[220:223], v215 offset:4096
  v_cvt_pk_bf16_f32 v153, v42, v43
  v_cvt_pk_bf16_f32 v154, v56, v57
  v_cvt_pk_bf16_f32 v155, v58, v59
  v_cvt_pk_bf16_f32 v156, v72, v73
  v_cvt_pk_bf16_f32 v157, v74, v75
  v_cvt_pk_bf16_f32 v158, v88, v89
  v_cvt_pk_bf16_f32 v159, v90, v91
  v_cvt_pk_bf16_f32 v160, v104, v105
  v_cvt_pk_bf16_f32 v161, v106, v107
  v_cvt_pk_bf16_f32 v162, v120, v121
  v_cvt_pk_bf16_f32 v163, v122, v123
  v_cvt_pk_bf16_f32 v168, v44, v45
  v_cvt_pk_bf16_f32 v169, v46, v47
  v_cvt_pk_bf16_f32 v170, v60, v61
  v_cvt_pk_bf16_f32 v171, v62, v63
  v_cvt_pk_bf16_f32 v172, v76, v77
  v_cvt_pk_bf16_f32 v173, v78, v79
  v_cvt_pk_bf16_f32 v174, v92, v93
  v_cvt_pk_bf16_f32 v175, v94, v95
  v_cvt_pk_bf16_f32 v176, v108, v109
  v_cvt_pk_bf16_f32 v177, v110, v111
  v_cvt_pk_bf16_f32 v178, v124, v125
  v_cvt_pk_bf16_f32 v179, v126, v127
  v_cvt_pk_bf16_f32 v184, v48, v49
  v_cvt_pk_bf16_f32 v185, v50, v51
  v_cvt_pk_bf16_f32 v186, v64, v65
  v_cvt_pk_bf16_f32 v187, v66, v67
  v_cvt_pk_bf16_f32 v188, v80, v81
  v_cvt_pk_bf16_f32 v189, v82, v83
  v_cvt_pk_bf16_f32 v190, v96, v97
  v_cvt_pk_bf16_f32 v191, v98, v99
  v_cvt_pk_bf16_f32 v192, v112, v113
  v_cvt_pk_bf16_f32 v193, v114, v115
  v_cvt_pk_bf16_f32 v194, v128, v129
  v_cvt_pk_bf16_f32 v195, v130, v131
  v_cvt_pk_bf16_f32 v200, v52, v53
  v_cvt_pk_bf16_f32 v201, v54, v55
  v_cvt_pk_bf16_f32 v202, v68, v69
  v_cvt_pk_bf16_f32 v203, v70, v71
  v_cvt_pk_bf16_f32 v204, v84, v85
  v_cvt_pk_bf16_f32 v205, v86, v87
  v_cvt_pk_bf16_f32 v206, v100, v101
  v_cvt_pk_bf16_f32 v207, v102, v103
  v_cvt_pk_bf16_f32 v208, v116, v117
  v_cvt_pk_bf16_f32 v209, v118, v119
  v_cvt_pk_bf16_f32 v210, v132, v133
  v_cvt_pk_bf16_f32 v211, v134, v135
  s_waitcnt lgkmcnt(7)
  v_mfma_f32_16x16x32_bf16 v[8:11], a[192:195], v[148:151], 0
  s_waitcnt lgkmcnt(6)
  v_mfma_f32_16x16x32_bf16 v[8:11], a[196:199], v[152:155], v[8:11]
  s_waitcnt lgkmcnt(5)
  v_mfma_f32_16x16x32_bf16 v[8:11], a[200:203], v[156:159], v[8:11]
  s_waitcnt lgkmcnt(4)
  v_mfma_f32_16x16x32_bf16 v[8:11], a[204:207], v[160:163], v[8:11]
  s_waitcnt lgkmcnt(3)
  v_mfma_f32_16x16x32_bf16 v[40:43], a[208:211], v[148:151], 0
  s_waitcnt lgkmcnt(2)
  v_mfma_f32_16x16x32_bf16 v[40:43], a[212:215], v[152:155], v[40:43]
  s_waitcnt lgkmcnt(1)
  v_mfma_f32_16x16x32_bf16 v[40:43], a[216:219], v[156:159], v[40:43]
  s_waitcnt lgkmcnt(0)
  v_mfma_f32_16x16x32_bf16 v[40:43], a[220:223], v[160:163], v[40:43]
  v_mfma_f32_16x16x32_bf16 v[12:15], a[192:195], v[164:167], 0
  v_mfma_f32_16x16x32_bf16 v[12:15], a[196:199], v[168:171], v[12:15]
  v_mfma_f32_16x16x32_bf16 v[12:15], a[200:203], v[172:175], v[12:15]
  v_mfma_f32_16x16x32_bf16 v[12:15], a[204:207], v[176:179], v[12:15]
  v_mfma_f32_16x16x32_bf16 v[44:47], a[208:211], v[164:167], 0
  v_mfma_f32_16x16x32_bf16 v[44:47], a[212:215], v[168:171], v[44:47]
  v_mfma_f32_16x16x32_bf16 v[44:47], a[216:219], v[172:175], v[44:47]
  v_mfma_f32_16x16x32_bf16 v[44:47], a[220:223], v[176:179], v[44:47]
  v_mfma_f32_16x16x32_bf16 v[16:19], a[192:195], v[180:183], 0
  v_max3_f32 v2, v8, v9, v10
  v_max3_f32 v2, v2, v11, v40
  v_mfma_f32_16x16x32_bf16 v[16:19], a[196:199], v[184:187], v[16:19]
  v_max3_f32 v2, v2, v41, v42
  v_max_f32 v2, v2, v43
  v_mfma_f32_16x16x32_bf16 v[16:19], a[200:203], v[188:191], v[16:19]
  v_mov_b32 v3, v2
  s_nop 1
  v_permlane32_swap_b32 v2, v3
  v_mfma_f32_16x16x32_bf16 v[16:19], a[204:207], v[192:195], v[16:19]
  v_max_f32 v2, v2, v3
  v_mov_b32 v3, v2
  v_mfma_f32_16x16x32_bf16 v[48:51], a[208:211], v[180:183], 0
  s_nop 0
  v_permlane16_swap_b32 v2, v3
  v_max_f32 v2, v2, v3
  v_mfma_f32_16x16x32_bf16 v[48:51], a[212:215], v[184:187], v[48:51]
  v_add_f32 v2, 0x42c00000, v2
  v_sub_f32 v88, 0, v2
  v_mfma_f32_16x16x32_bf16 v[48:51], a[216:219], v[188:191], v[48:51]
  v_sub_f32 v89, 0, v2
  v_sub_f32 v90, 0, v2
  v_mfma_f32_16x16x32_bf16 v[48:51], a[220:223], v[192:195], v[48:51]
  v_sub_f32 v91, 0, v2
  v_sub_f32 v8, v8, v2
  v_mfma_f32_16x16x32_bf16 v[20:23], a[192:195], v[196:199], 0
  v_sub_f32 v9, v9, v2
  v_sub_f32 v10, v10, v2
  v_mfma_f32_16x16x32_bf16 v[20:23], a[196:199], v[200:203], v[20:23]
  v_sub_f32 v11, v11, v2
  v_sub_f32 v40, v40, v2
  v_mfma_f32_16x16x32_bf16 v[20:23], a[200:203], v[204:207], v[20:23]
  v_sub_f32 v41, v41, v2
  v_sub_f32 v42, v42, v2
  v_mfma_f32_16x16x32_bf16 v[20:23], a[204:207], v[208:211], v[20:23]
  v_sub_f32 v43, v43, v2
  v_exp_f32 v136, v8
  v_mfma_f32_16x16x32_bf16 v[52:55], a[208:211], v[196:199], 0
  v_exp_f32 v137, v9
  s_nop 0
  v_cvt_pk_bf16_f32 v56, v136, v137
  v_mfma_f32_16x16x32_bf16 v[52:55], a[212:215], v[200:203], v[52:55]
  v_exp_f32 v138, v10
  v_exp_f32 v139, v11
  v_mfma_f32_16x16x32_bf16 v[52:55], a[216:219], v[204:207], v[52:55]
  v_cvt_pk_bf16_f32 v57, v138, v139
  v_exp_f32 v136, v40
  v_mfma_f32_16x16x32_bf16 v[52:55], a[220:223], v[208:211], v[52:55]
  v_exp_f32 v137, v41
  s_nop 0
  v_cvt_pk_bf16_f32 v58, v136, v137
  v_exp_f32 v138, v42
  v_exp_f32 v139, v43
  s_nop 0
  v_cvt_pk_bf16_f32 v59, v138, v139
  ds_read_b128 a[192:195], v212 offset:16384
  ds_read_b128 a[196:199], v213 offset:16384
  ds_read_b128 a[200:203], v214 offset:16384
  ds_read_b128 a[204:207], v215 offset:16384
  ds_read_b128 a[208:211], v212 offset:20480
  ds_read_b128 a[212:215], v213 offset:20480
  ds_read_b128 a[216:219], v214 offset:20480
  ds_read_b128 a[220:223], v215 offset:20480
  ds_read_b64_tr_b16 a[224:225], v220 offset:8192
  ds_read_b64_tr_b16 a[226:227], v220 offset:12288
  ds_read_b64_tr_b16 a[228:229], v221 offset:8192
  ds_read_b64_tr_b16 a[230:231], v221 offset:12288
  ds_read_b64_tr_b16 a[232:233], v222 offset:8192
  ds_read_b64_tr_b16 a[234:235], v222 offset:12288
  ds_read_b64_tr_b16 a[236:237], v223 offset:8192
  ds_read_b64_tr_b16 a[238:239], v223 offset:12288
  ds_read_b64_tr_b16 a[240:241], v224 offset:8192
  ds_read_b64_tr_b16 a[242:243], v224 offset:12288
  ds_read_b64_tr_b16 a[244:245], v225 offset:8192
  ds_read_b64_tr_b16 a[246:247], v225 offset:12288
  ds_read_b64_tr_b16 a[248:249], v226 offset:8192
  ds_read_b64_tr_b16 a[250:251], v226 offset:12288
  ds_read_b64_tr_b16 a[252:253], v227 offset:8192
  ds_read_b64_tr_b16 a[254:255], v227 offset:12288
  v_max3_f32 v2, v12, v13, v14
  v_max3_f32 v2, v2, v15, v44
  v_max3_f32 v2, v2, v45, v46
  v_max_f32 v2, v2, v47
  v_mov_b32 v3, v2
  s_nop 1
  v_permlane32_swap_b32 v2, v3
  v_max_f32 v2, v2, v3
  v_mov_b32 v3, v2
  s_nop 1
  v_permlane16_swap_b32 v2, v3
  v_max_f32 v2, v2, v3
  v_add_f32 v2, 0x42c00000, v2
  v_sub_f32 v92, 0, v2
  v_sub_f32 v93, 0, v2
  v_sub_f32 v94, 0, v2
  v_sub_f32 v95, 0, v2
  v_sub_f32 v12, v12, v2
  v_sub_f32 v13, v13, v2
  v_sub_f32 v14, v14, v2
  v_sub_f32 v15, v15, v2
  v_sub_f32 v44, v44, v2
  v_sub_f32 v45, v45, v2
  v_sub_f32 v46, v46, v2
  v_sub_f32 v47, v47, v2
  v_exp_f32 v140, v12
  v_exp_f32 v141, v13
  s_nop 0
  v_cvt_pk_bf16_f32 v60, v140, v141
  v_exp_f32 v142, v14
  v_exp_f32 v143, v15
  s_nop 0
  v_cvt_pk_bf16_f32 v61, v142, v143
  v_exp_f32 v140, v44
  v_exp_f32 v141, v45
  s_nop 0
  v_cvt_pk_bf16_f32 v62, v140, v141
  v_exp_f32 v142, v46
  v_exp_f32 v143, v47
  s_nop 0
  v_cvt_pk_bf16_f32 v63, v142, v143
  s_waitcnt lgkmcnt(15)
  v_mfma_f32_16x16x32_bf16 v[24:27], a[192:195], v[148:151], v[88:91]
  v_max3_f32 v2, v16, v17, v18
  v_max3_f32 v2, v2, v19, v48
  v_max3_f32 v2, v2, v49, v50
  s_waitcnt lgkmcnt(15)
  v_mfma_f32_16x16x32_bf16 v[24:27], a[196:199], v[152:155], v[24:27]
  v_max_f32 v2, v2, v51
  v_mov_b32 v3, v2
  s_nop 1
  v_permlane32_swap_b32 v2, v3
  s_waitcnt lgkmcnt(15)
  v_mfma_f32_16x16x32_bf16 v[24:27], a[200:203], v[156:159], v[24:27]
  v_max_f32 v2, v2, v3
  v_mov_b32 v3, v2
  s_nop 1
  v_permlane16_swap_b32 v2, v3
  s_waitcnt lgkmcnt(15)
  v_mfma_f32_16x16x32_bf16 v[24:27], a[204:207], v[160:163], v[24:27]
  v_max_f32 v2, v2, v3
  v_add_f32 v2, 0x42c00000, v2
  v_sub_f32 v96, 0, v2
  v_mfma_f32_16x16x32_bf16 v[28:31], a[192:195], v[164:167], v[92:95]
  v_sub_f32 v97, 0, v2
  v_sub_f32 v98, 0, v2
  v_sub_f32 v99, 0, v2
  v_mfma_f32_16x16x32_bf16 v[28:31], a[196:199], v[168:171], v[28:31]
  v_sub_f32 v16, v16, v2
  v_sub_f32 v17, v17, v2
  v_sub_f32 v18, v18, v2
  v_mfma_f32_16x16x32_bf16 v[28:31], a[200:203], v[172:175], v[28:31]
  v_sub_f32 v19, v19, v2
  v_sub_f32 v48, v48, v2
  v_sub_f32 v49, v49, v2
  v_mfma_f32_16x16x32_bf16 v[28:31], a[204:207], v[176:179], v[28:31]
  v_sub_f32 v50, v50, v2
  v_sub_f32 v51, v51, v2
  v_exp_f32 v136, v16
  v_mfma_f32_16x16x32_bf16 v[104:107], v[144:147], v[56:59], 0
  v_exp_f32 v137, v17
  s_nop 0
  v_cvt_pk_bf16_f32 v64, v136, v137
  v_exp_f32 v138, v18
  v_mfma_f32_16x16x32_bf16 v[108:111], v[144:147], v[60:63], 0
  v_exp_f32 v139, v19
  s_nop 0
  v_cvt_pk_bf16_f32 v65, v138, v139
  v_exp_f32 v136, v48
  v_exp_f32 v137, v49
  s_nop 0
  v_cvt_pk_bf16_f32 v66, v136, v137
  v_exp_f32 v138, v50
  v_exp_f32 v139, v51
  s_nop 0
  v_cvt_pk_bf16_f32 v67, v138, v139
  v_mfma_f32_16x16x32_bf16 v[32:35], a[192:195], v[180:183], v[96:99]
  v_max3_f32 v2, v20, v21, v22
  v_max3_f32 v2, v2, v23, v52
  v_max3_f32 v2, v2, v53, v54
  v_max_f32 v2, v2, v55
  v_mov_b32 v3, v2
  v_mfma_f32_16x16x32_bf16 v[32:35], a[196:199], v[184:187], v[32:35]
  s_nop 0
  v_permlane32_swap_b32 v2, v3
  v_max_f32 v2, v2, v3
  v_mov_b32 v3, v2
  s_nop 1
  v_permlane16_swap_b32 v2, v3
  v_max_f32 v2, v2, v3
  v_mfma_f32_16x16x32_bf16 v[32:35], a[200:203], v[188:191], v[32:35]
  v_add_f32 v2, 0x42c00000, v2
  v_sub_f32 v100, 0, v2
  v_sub_f32 v101, 0, v2
  v_sub_f32 v102, 0, v2
  v_sub_f32 v103, 0, v2
  v_mfma_f32_16x16x32_bf16 v[32:35], a[204:207], v[192:195], v[32:35]
  v_sub_f32 v20, v20, v2
  v_sub_f32 v21, v21, v2
  v_sub_f32 v22, v22, v2
  v_sub_f32 v23, v23, v2
  v_sub_f32 v52, v52, v2
  v_mfma_f32_16x16x32_bf16 v[112:115], v[144:147], v[64:67], 0
  v_sub_f32 v53, v53, v2
  v_sub_f32 v54, v54, v2
  v_sub_f32 v55, v55, v2
  v_exp_f32 v140, v20
  v_exp_f32 v141, v21
  s_nop 0
  v_cvt_pk_bf16_f32 v68, v140, v141
  v_exp_f32 v142, v22
  v_exp_f32 v143, v23
  s_nop 0
  v_cvt_pk_bf16_f32 v69, v142, v143
  v_exp_f32 v140, v52
  v_exp_f32 v141, v53
  s_nop 0
  v_cvt_pk_bf16_f32 v70, v140, v141
  v_exp_f32 v142, v54
  v_exp_f32 v143, v55
  s_nop 0
  v_cvt_pk_bf16_f32 v71, v142, v143
  v_mfma_f32_16x16x32_bf16 v[36:39], a[192:195], v[196:199], v[100:103]
  v_mfma_f32_16x16x32_bf16 v[36:39], a[196:199], v[200:203], v[36:39]
  v_mfma_f32_16x16x32_bf16 v[36:39], a[200:203], v[204:207], v[36:39]
  v_mfma_f32_16x16x32_bf16 v[36:39], a[204:207], v[208:211], v[36:39]
  v_mfma_f32_16x16x32_bf16 v[116:119], v[144:147], v[68:71], 0
  s_lshr_b32 s37, s2, 3
  s_lshl_b32 s37, s37, 15
  s_bfe_u32 s38, s2, 0x20001
  s_mul_i32 s38, s38, 0x120000
  s_add_u32 s37, s37, s38
  v_add_u32 v254, s37, v253
  s_waitcnt vmcnt(20)
  s_barrier
  s_add_u32 m0, s28, 0
  s_nop 0
  buffer_load_dwordx4 v236, s[16:19], s30 offen lds
  buffer_load_dwordx4 v237, s[16:19], s30 offen offset:1024 lds
  s_add_u32 m0, s28, 0x1e000
  s_nop 0
  buffer_load_dwordx4 v238, s[20:23], s30 offen lds
  buffer_load_dwordx4 v239, s[20:23], s30 offen offset:1024 lds
  s_add_u32 s30, s30, 0x2000
  s_waitcnt lgkmcnt(0)
  v_mfma_f32_16x16x32_bf16 v[40:43], a[208:211], v[148:151], v[88:91]
  v_exp_f32 v136, v24
  v_mfma_f32_16x16x32_bf16 v[40:43], a[212:215], v[152:155], v[40:43]
  ds_read_b128 a[192:195], v212 offset:32768
  v_mfma_f32_16x16x32_bf16 v[40:43], a[216:219], v[156:159], v[40:43]
  v_exp_f32 v137, v25
  v_mfma_f32_16x16x32_bf16 v[40:43], a[220:223], v[160:163], v[40:43]
  ds_read_b128 a[196:199], v213 offset:32768
  v_cvt_pk_bf16_f32 v72, v136, v137
  v_mfma_f32_16x16x32_bf16 v[44:47], a[208:211], v[164:167], v[92:95]
  v_exp_f32 v138, v26
  v_mfma_f32_16x16x32_bf16 v[44:47], a[212:215], v[168:171], v[44:47]
  ds_read_b128 a[200:203], v214 offset:32768
  v_mfma_f32_16x16x32_bf16 v[44:47], a[216:219], v[172:175], v[44:47]
  v_exp_f32 v139, v27
  v_mfma_f32_16x16x32_bf16 v[44:47], a[220:223], v[176:179], v[44:47]
  ds_read_b128 a[204:207], v215 offset:32768
  v_cvt_pk_bf16_f32 v73, v138, v139
  v_mfma_f32_16x16x32_bf16 v[48:51], a[208:211], v[180:183], v[96:99]
  v_exp_f32 v140, v28
  v_mfma_f32_16x16x32_bf16 v[48:51], a[212:215], v[184:187], v[48:51]
  v_exp_f32 v141, v29
  v_mfma_f32_16x16x32_bf16 v[48:51], a[216:219], v[188:191], v[48:51]
  v_exp_f32 v142, v30
  v_mfma_f32_16x16x32_bf16 v[48:51], a[220:223], v[192:195], v[48:51]
  v_exp_f32 v143, v31
  v_mfma_f32_16x16x32_bf16 v[52:55], a[208:211], v[196:199], v[100:103]
  ds_read_b128 a[208:211], v212 offset:36864
  v_cvt_pk_bf16_f32 v76, v140, v141
  v_mfma_f32_16x16x32_bf16 v[52:55], a[212:215], v[200:203], v[52:55]
  v_exp_f32 v136, v32
  v_mfma_f32_16x16x32_bf16 v[52:55], a[216:219], v[204:207], v[52:55]
  ds_read_b128 a[212:215], v213 offset:36864
  v_cvt_pk_bf16_f32 v77, v142, v143
  v_mfma_f32_16x16x32_bf16 v[52:55], a[220:223], v[208:211], v[52:55]
  v_exp_f32 v137, v33
  v_mfma_f32_16x16x32_bf16 a[0:3], a[224:227], v[56:59], 0
  ds_read_b128 a[216:219], v214 offset:36864
  v_cvt_pk_bf16_f32 v80, v136, v137
  v_mfma_f32_16x16x32_bf16 a[4:7], a[224:227], v[60:63], 0
  v_exp_f32 v138, v34
  v_mfma_f32_16x16x32_bf16 a[8:11], a[224:227], v[64:67], 0
  ds_read_b128 a[220:223], v215 offset:36864
  v_mfma_f32_16x16x32_bf16 a[12:15], a[224:227], v[68:71], 0
  v_exp_f32 v139, v35
  v_mfma_f32_16x16x32_bf16 a[16:19], a[228:231], v[56:59], 0
  ds_read_b64_tr_b16 a[224:225], v220 offset:24576
  v_cvt_pk_bf16_f32 v81, v138, v139
  v_mfma_f32_16x16x32_bf16 a[20:23], a[228:231], v[60:63], 0
  v_exp_f32 v140, v36
  v_mfma_f32_16x16x32_bf16 a[24:27], a[228:231], v[64:67], 0
  ds_read_b64_tr_b16 a[226:227], v220 offset:28672
  v_mfma_f32_16x16x32_bf16 a[28:31], a[228:231], v[68:71], 0
  v_exp_f32 v141, v37
  v_mfma_f32_16x16x32_bf16 a[32:35], a[232:235], v[56:59], 0
  ds_read_b64_tr_b16 a[228:229], v221 offset:24576
  v_cvt_pk_bf16_f32 v84, v140, v141
  v_mfma_f32_16x16x32_bf16 a[36:39], a[232:235], v[60:63], 0
  v_exp_f32 v142, v38
  v_mfma_f32_16x16x32_bf16 a[40:43], a[232:235], v[64:67], 0
  ds_read_b64_tr_b16 a[230:231], v221 offset:28672
  s_waitcnt lgkmcnt(8)
  v_mfma_f32_16x16x32_bf16 a[44:47], a[232:235], v[68:71], 0
  v_exp_f32 v143, v39
  v_mfma_f32_16x16x32_bf16 a[48:51], a[236:239], v[56:59], 0
  ds_read_b64_tr_b16 a[232:233], v222 offset:24576
  v_cvt_pk_bf16_f32 v85, v142, v143
  v_mfma_f32_16x16x32_bf16 a[52:55], a[236:239], v[60:63], 0
  v_exp_f32 v136, v40
  v_mfma_f32_16x16x32_bf16 a[56:59], a[236:239], v[64:67], 0
  ds_read_b64_tr_b16 a[234:235], v222 offset:28672
  v_mfma_f32_16x16x32_bf16 a[60:63], a[236:239], v[68:71], 0
  v_exp_f32 v137, v41
  v_mfma_f32_16x16x32_bf16 a[64:67], a[240:243], v[56:59], 0
  ds_read_b64_tr_b16 a[236:237], v223 offset:24576
  v_cvt_pk_bf16_f32 v74, v136, v137
  v_mfma_f32_16x16x32_bf16 a[68:71], a[240:243], v[60:63], 0
  v_exp_f32 v138, v42
  v_mfma_f32_16x16x32_bf16 a[72:75], a[240:243], v[64:67], 0
  v_exp_f32 v139, v43
  v_mfma_f32_16x16x32_bf16 a[76:79], a[240:243], v[68:71], 0
  ds_read_b64_tr_b16 a[238:239], v223 offset:28672
  v_cvt_pk_bf16_f32 v75, v138, v139
  v_mfma_f32_16x16x32_bf16 a[80:83], a[244:247], v[56:59], 0
  v_exp_f32 v140, v44
  v_mfma_f32_16x16x32_bf16 a[84:87], a[244:247], v[60:63], 0
  v_exp_f32 v141, v45
  v_mfma_f32_16x16x32_bf16 a[88:91], a[244:247], v[64:67], 0
  ds_read_b64_tr_b16 a[240:241], v224 offset:24576
  v_cvt_pk_bf16_f32 v78, v140, v141
  v_mfma_f32_16x16x32_bf16 a[92:95], a[244:247], v[68:71], 0
  v_exp_f32 v142, v46
  v_mfma_f32_16x16x32_bf16 a[96:99], a[248:251], v[56:59], 0
  v_exp_f32 v143, v47
  v_mfma_f32_16x16x32_bf16 a[100:103], a[248:251], v[60:63], 0
  ds_read_b64_tr_b16 a[242:243], v224 offset:28672
  v_cvt_pk_bf16_f32 v79, v142, v143
  v_mfma_f32_16x16x32_bf16 a[104:107], a[248:251], v[64:67], 0
  v_exp_f32 v136, v48
  v_mfma_f32_16x16x32_bf16 a[108:111], a[248:251], v[68:71], 0
  v_exp_f32 v137, v49
  v_mfma_f32_16x16x32_bf16 a[112:115], a[252:255], v[56:59], 0
  ds_read_b64_tr_b16 a[244:245], v225 offset:24576
  v_cvt_pk_bf16_f32 v82, v136, v137
  v_mfma_f32_16x16x32_bf16 a[116:119], a[252:255], v[60:63], 0
  v_exp_f32 v138, v50
  v_mfma_f32_16x16x32_bf16 a[120:123], a[252:255], v[64:67], 0
  v_exp_f32 v139, v51
  v_mfma_f32_16x16x32_bf16 a[124:127], a[252:255], v[68:71], 0
  ds_read_b64_tr_b16 a[246:247], v225 offset:28672
  v_cvt_pk_bf16_f32 v83, v138, v139
  v_mfma_f32_16x16x32_bf16 v[8:11], a[192:195], v[148:151], v[88:91]
  v_exp_f32 v140, v52
  v_mfma_f32_16x16x32_bf16 v[8:11], a[196:199], v[152:155], v[8:11]
  v_exp_f32 v141, v53
  v_mfma_f32_16x16x32_bf16 v[8:11], a[200:203], v[156:159], v[8:11]
  ds_read_b64_tr_b16 a[248:249], v226 offset:24576
  v_cvt_pk_bf16_f32 v86, v140, v141
  v_mfma_f32_16x16x32_bf16 v[8:11], a[204:207], v[160:163], v[8:11]
  v_exp_f32 v142, v54
  v_mfma_f32_16x16x32_bf16 v[12:15], a[192:195], v[164:167], v[92:95]
  ds_read_b64_tr_b16 a[250:251], v226 offset:28672
  v_mfma_f32_16x16x32_bf16 v[12:15], a[196:199], v[168:171], v[12:15]
  v_exp_f32 v143, v55
  v_mfma_f32_16x16x32_bf16 v[12:15], a[200:203], v[172:175], v[12:15]
  ds_read_b64_tr_b16 a[252:253], v227 offset:24576
  v_cvt_pk_bf16_f32 v87, v142, v143
  v_mfma_f32_16x16x32_bf16 v[12:15], a[204:207], v[176:179], v[12:15]
  ds_read_b64_tr_b16 a[254:255], v227 offset:28672
  v_mfma_f32_16x16x32_bf16 v[120:123], v[144:147], v[72:75], v[104:107]
  s_waitcnt vmcnt(20)
  s_barrier
  v_mfma_f32_16x16x32_bf16 v[124:127], v[144:147], v[76:79], v[108:111]
  v_mfma_f32_16x16x32_bf16 v[128:131], v[144:147], v[80:83], v[112:115]
  v_mfma_f32_16x16x32_bf16 v[132:135], v[144:147], v[84:87], v[116:119]
  v_mfma_f32_16x16x32_bf16 v[16:19], a[192:195], v[180:183], v[96:99]
  v_mfma_f32_16x16x32_bf16 v[16:19], a[196:199], v[184:187], v[16:19]
  v_mfma_f32_16x16x32_bf16 v[16:19], a[200:203], v[188:191], v[16:19]
  s_nop 3
  v_max3_f32 v1, v120, v124, v128
  v_mfma_f32_16x16x32_bf16 v[16:19], a[204:207], v[192:195], v[16:19]
  v_mfma_f32_16x16x32_bf16 v[20:23], a[192:195], v[196:199], v[100:103]
  v_max_f32 v1, v1, v132
  v_mfma_f32_16x16x32_bf16 v[20:23], a[196:199], v[200:203], v[20:23]
  v_cmp_le_f32 vcc, 0x5d800000, v1
  v_mfma_f32_16x16x32_bf16 v[20:23], a[200:203], v[204:207], v[20:23]
  s_waitcnt lgkmcnt(10)
  v_mfma_f32_16x16x32_bf16 v[20:23], a[204:207], v[208:211], v[20:23]
  s_cbranch_vccnz attn_stubp1
attn_retp1:
  s_mov_b32 s31, 8
  s_branch attn_retl9
.p2align 6
attn_loop:
  v_mfma_f32_16x16x32_bf16 v[40:43], a[208:211], v[148:151], v[88:91]
  v_exp_f32 v136, v8
  v_mfma_f32_16x16x32_bf16 v[40:43], a[212:215], v[152:155], v[40:43]
  ds_read_b128 a[192:195], v212 offset:16384
  v_mfma_f32_16x16x32_bf16 v[40:43], a[216:219], v[156:159], v[40:43]
  v_exp_f32 v137, v9
  v_mfma_f32_16x16x32_bf16 v[40:43], a[220:223], v[160:163], v[40:43]
  ds_read_b128 a[196:199], v213 offset:16384
  v_cvt_pk_bf16_f32 v56, v136, v137
  v_mfma_f32_16x16x32_bf16 v[44:47], a[208:211], v[164:167], v[92:95]
  v_exp_f32 v138, v10
  v_mfma_f32_16x16x32_bf16 v[44:47], a[212:215], v[168:171], v[44:47]
  ds_read_b128 a[200:203], v214 offset:16384
  v_mfma_f32_16x16x32_bf16 v[44:47], a[216:219], v[172:175], v[44:47]
  v_exp_f32 v139, v11
  v_mfma_f32_16x16x32_bf16 v[44:47], a[220:223], v[176:179], v[44:47]
  ds_read_b128 a[204:207], v215 offset:16384
  v_cvt_pk_bf16_f32 v57, v138, v139
  v_mfma_f32_16x16x32_bf16 v[48:51], a[208:211], v[180:183], v[96:99]
  v_exp_f32 v140, v12
  v_mfma_f32_16x16x32_bf16 v[48:51], a[212:215], v[184:187], v[48:51]
  v_exp_f32 v141, v13
  v_mfma_f32_16x16x32_bf16 v[48:51], a[216:219], v[188:191], v[48:51]
  v_exp_f32 v142, v14
  v_mfma_f32_16x16x32_bf16 v[48:51], a[220:223], v[192:195], v[48:51]
  v_exp_f32 v143, v15
  v_mfma_f32_16x16x32_bf16 v[52:55], a[208:211], v[196:199], v[100:103]
  ds_read_b128 a[208:211], v212 offset:20480
  v_cvt_pk_bf16_f32 v60, v140, v141
  v_mfma_f32_16x16x32_bf16 v[52:55], a[212:215], v[200:203], v[52:55]
  v_exp_f32 v136, v16
  v_mfma_f32_16x16x32_bf16 v[52:55], a[216:219], v[204:207], v[52:55]
  ds_read_b128 a[212:215], v213 offset:20480
  v_cvt_pk_bf16_f32 v61, v142, v143
  v_mfma_f32_16x16x32_bf16 v[52:55], a[220:223], v[208:211], v[52:55]
  v_exp_f32 v137, v17
  v_mfma_f32_16x16x32_bf16 a[0:3], a[224:227], v[72:75], a[0:3]
  ds_read_b128 a[216:219], v214 offset:20480
  v_cvt_pk_bf16_f32 v64, v136, v137
  v_mfma_f32_16x16x32_bf16 a[4:7], a[224:227], v[76:79], a[4:7]
  v_exp_f32 v138, v18
  v_mfma_f32_16x16x32_bf16 a[8:11], a[224:227], v[80:83], a[8:11]
  ds_read_b128 a[220:223], v215 offset:20480
  v_mfma_f32_16x16x32_bf16 a[12:15], a[224:227], v[84:87], a[12:15]
  v_exp_f32 v139, v19
  v_mfma_f32_16x16x32_bf16 a[16:19], a[228:231], v[72:75], a[16:19]
  ds_read_b64_tr_b16 a[224:225], v220 offset:8192
  v_cvt_pk_bf16_f32 v65, v138, v139
  v_mfma_f32_16x16x32_bf16 a[20:23], a[228:231], v[76:79], a[20:23]
  v_exp_f32 v140, v20
  v_mfma_f32_16x16x32_bf16 a[24:27], a[228:231], v[80:83], a[24:27]
  ds_read_b64_tr_b16 a[226:227], v220 offset:12288
  v_mfma_f32_16x16x32_bf16 a[28:31], a[228:231], v[84:87], a[28:31]
  v_exp_f32 v141, v21
  v_mfma_f32_16x16x32_bf16 a[32:35], a[232:235], v[72:75], a[32:35]
  ds_read_b64_tr_b16 a[228:229], v221 offset:8192
  v_cvt_pk_bf16_f32 v68, v140, v141
  v_mfma_f32_16x16x32_bf16 a[36:39], a[232:235], v[76:79], a[36:39]
  v_exp_f32 v142, v22
  v_mfma_f32_16x16x32_bf16 a[40:43], a[232:235], v[80:83], a[40:43]
  ds_read_b64_tr_b16 a[230:231], v221 offset:12288
  s_waitcnt lgkmcnt(8)
  v_mfma_f32_16x16x32_bf16 a[44:47], a[232:235], v[84:87], a[44:47]
  v_exp_f32 v143, v23
  v_mfma_f32_16x16x32_bf16 a[48:51], a[236:239], v[72:75], a[48:51]
  ds_read_b64_tr_b16 a[232:233], v222 offset:8192
  v_cvt_pk_bf16_f32 v69, v142, v143
  v_mfma_f32_16x16x32_bf16 a[52:55], a[236:239], v[76:79], a[52:55]
  v_exp_f32 v136, v40
  v_mfma_f32_16x16x32_bf16 a[56:59], a[236:239], v[80:83], a[56:59]
  ds_read_b64_tr_b16 a[234:235], v222 offset:12288
  v_mfma_f32_16x16x32_bf16 a[60:63], a[236:239], v[84:87], a[60:63]
  v_exp_f32 v137, v41
  v_mfma_f32_16x16x32_bf16 a[64:67], a[240:243], v[72:75], a[64:67]
  ds_read_b64_tr_b16 a[236:237], v223 offset:8192
  v_cvt_pk_bf16_f32 v58, v136, v137
  v_mfma_f32_16x16x32_bf16 a[68:71], a[240:243], v[76:79], a[68:71]
  v_exp_f32 v138, v42
  v_mfma_f32_16x16x32_bf16 a[72:75], a[240:243], v[80:83], a[72:75]
  v_exp_f32 v139, v43
  v_mfma_f32_16x16x32_bf16 a[76:79], a[240:243], v[84:87], a[76:79]
  ds_read_b64_tr_b16 a[238:239], v223 offset:12288
  v_cvt_pk_bf16_f32 v59, v138, v139
  v_mfma_f32_16x16x32_bf16 a[80:83], a[244:247], v[72:75], a[80:83]
  v_exp_f32 v140, v44
  v_mfma_f32_16x16x32_bf16 a[84:87], a[244:247], v[76:79], a[84:87]
  v_exp_f32 v141, v45
  v_mfma_f32_16x16x32_bf16 a[88:91], a[244:247], v[80:83], a[88:91]
  ds_read_b64_tr_b16 a[240:241], v224 offset:8192
  v_cvt_pk_bf16_f32 v62, v140, v141
  v_mfma_f32_16x16x32_bf16 a[92:95], a[244:247], v[84:87], a[92:95]
  v_exp_f32 v142, v46
  v_mfma_f32_16x16x32_bf16 a[96:99], a[248:251], v[72:75], a[96:99]
  v_exp_f32 v143, v47
  v_mfma_f32_16x16x32_bf16 a[100:103], a[248:251], v[76:79], a[100:103]
  ds_read_b64_tr_b16 a[242:243], v224 offset:12288
  v_cvt_pk_bf16_f32 v63, v142, v143
  v_mfma_f32_16x16x32_bf16 a[104:107], a[248:251], v[80:83], a[104:107]
  v_exp_f32 v136, v48
  v_mfma_f32_16x16x32_bf16 a[108:111], a[248:251], v[84:87], a[108:111]
  v_exp_f32 v137, v49
  v_mfma_f32_16x16x32_bf16 a[112:115], a[252:255], v[72:75], a[112:115]
  ds_read_b64_tr_b16 a[244:245], v225 offset:8192
  v_cvt_pk_bf16_f32 v66, v136, v137
  v_mfma_f32_16x16x32_bf16 a[116:119], a[252:255], v[76:79], a[116:119]
  v_exp_f32 v138, v50
  v_mfma_f32_16x16x32_bf16 a[120:123], a[252:255], v[80:83], a[120:123]
  v_exp_f32 v139, v51
  v_mfma_f32_16x16x32_bf16 a[124:127], a[252:255], v[84:87], a[124:127]
  ds_read_b64_tr_b16 a[246:247], v225 offset:12288
  v_cvt_pk_bf16_f32 v67, v138, v139
  v_mfma_f32_16x16x32_bf16 v[24:27], a[192:195], v[148:151], v[88:91]
  v_exp_f32 v140, v52
  v_mfma_f32_16x16x32_bf16 v[24:27], a[196:199], v[152:155], v[24:27]
  v_exp_f32 v141, v53
  v_mfma_f32_16x16x32_bf16 v[24:27], a[200:203], v[156:159], v[24:27]
  ds_read_b64_tr_b16 a[248:249], v226 offset:8192
  v_cvt_pk_bf16_f32 v70, v140, v141
  v_mfma_f32_16x16x32_bf16 v[24:27], a[204:207], v[160:163], v[24:27]
  v_exp_f32 v142, v54
  v_mfma_f32_16x16x32_bf16 v[28:31], a[192:195], v[164:167], v[92:95]
  ds_read_b64_tr_b16 a[250:251], v226 offset:12288
  v_mfma_f32_16x16x32_bf16 v[28:31], a[196:199], v[168:171], v[28:31]
  v_exp_f32 v143, v55
  v_mfma_f32_16x16x32_bf16 v[28:31], a[200:203], v[172:175], v[28:31]
  ds_read_b64_tr_b16 a[252:253], v227 offset:8192
  v_cvt_pk_bf16_f32 v71, v142, v143
  v_mfma_f32_16x16x32_bf16 v[28:31], a[204:207], v[176:179], v[28:31]
  ds_read_b64_tr_b16 a[254:255], v227 offset:12288
  v_mfma_f32_16x16x32_bf16 v[104:107], v[144:147], v[56:59], v[120:123]
  s_waitcnt vmcnt(12)
  s_barrier
  v_mfma_f32_16x16x32_bf16 v[108:111], v[144:147], v[60:63], v[124:127]
  s_add_u32 m0, s28, 0x1c000
  v_mfma_f32_16x16x32_bf16 v[112:115], v[144:147], v[64:67], v[128:131]
  buffer_load_dwordx4 v236, s[16:19], s30 offen lds
  v_mfma_f32_16x16x32_bf16 v[116:119], v[144:147], v[68:71], v[132:135]
  buffer_load_dwordx4 v237, s[16:19], s30 offen offset:1024 lds
  s_add_u32 m0, s28, 0x1a000
  v_mfma_f32_16x16x32_bf16 v[32:35], a[192:195], v[180:183], v[96:99]
  buffer_load_dwordx4 v238, s[20:23], s30 offen lds
  v_mfma_f32_16x16x32_bf16 v[32:35], a[196:199], v[184:187], v[32:35]
  buffer_load_dwordx4 v239, s[20:23], s30 offen offset:1024 lds
  s_add_u32 s30, s30, 0x2000
  v_mfma_f32_16x16x32_bf16 v[32:35], a[200:203], v[188:191], v[32:35]
  v_max3_f32 v1, v104, v108, v112
  v_mfma_f32_16x16x32_bf16 v[32:35], a[204:207], v[192:195], v[32:35]
  v_mfma_f32_16x16x32_bf16 v[36:39], a[192:195], v[196:199], v[100:103]
  v_max_f32 v1, v1, v116
  v_mfma_f32_16x16x32_bf16 v[36:39], a[196:199], v[200:203], v[36:39]
  v_cmp_le_f32 vcc, 0x5d800000, v1
  v_mfma_f32_16x16x32_bf16 v[36:39], a[200:203], v[204:207], v[36:39]
  s_waitcnt lgkmcnt(10)
  v_mfma_f32_16x16x32_bf16 v[36:39], a[204:207], v[208:211], v[36:39]
  s_cbranch_vccnz attn_stubl8
attn_retl8:
  v_mfma_f32_16x16x32_bf16 v[40:43], a[208:211], v[148:151], v[88:91]
  v_exp_f32 v136, v24
  v_mfma_f32_16x16x32_bf16 v[40:43], a[212:215], v[152:155], v[40:43]
  ds_read_b128 a[192:195], v212 offset:32768
  v_mfma_f32_16x16x32_bf16 v[40:43], a[216:219], v[156:159], v[40:43]
  v_exp_f32 v137, v25
  v_mfma_f32_16x16x32_bf16 v[40:43], a[220:223], v[160:163], v[40:43]
  ds_read_b128 a[196:199], v213 offset:32768
  v_cvt_pk_bf16_f32 v72, v136, v137
  v_mfma_f32_16x16x32_bf16 v[44:47], a[208:211], v[164:167], v[92:95]
  v_exp_f32 v138, v26
  v_mfma_f32_16x16x32_bf16 v[44:47], a[212:215], v[168:171], v[44:47]
  ds_read_b128 a[200:203], v214 offset:32768
  v_mfma_f32_16x16x32_bf16 v[44:47], a[216:219], v[172:175], v[44:47]
  v_exp_f32 v139, v27
  v_mfma_f32_16x16x32_bf16 v[44:47], a[220:223], v[176:179], v[44:47]
  ds_read_b128 a[204:207], v215 offset:32768
  v_cvt_pk_bf16_f32 v73, v138, v139
  v_mfma_f32_16x16x32_bf16 v[48:51], a[208:211], v[180:183], v[96:99]
  v_exp_f32 v140, v28
  v_mfma_f32_16x16x32_bf16 v[48:51], a[212:215], v[184:187], v[48:51]
  v_exp_f32 v141, v29
  v_mfma_f32_16x16x32_bf16 v[48:51], a[216:219], v[188:191], v[48:51]
  v_exp_f32 v142, v30
  v_mfma_f32_16x16x32_bf16 v[48:51], a[220:223], v[192:195], v[48:51]
  v_exp_f32 v143, v31
  v_mfma_f32_16x16x32_bf16 v[52:55], a[208:211], v[196:199], v[100:103]
  ds_read_b128 a[208:211], v212 offset:36864
  v_cvt_pk_bf16_f32 v76, v140, v141
  v_mfma_f32_16x16x32_bf16 v[52:55], a[212:215], v[200:203], v[52:55]
  v_exp_f32 v136, v32
  v_mfma_f32_16x16x32_bf16 v[52:55], a[216:219], v[204:207], v[52:55]
  ds_read_b128 a[212:215], v213 offset:36864
  v_cvt_pk_bf16_f32 v77, v142, v143
  v_mfma_f32_16x16x32_bf16 v[52:55], a[220:223], v[208:211], v[52:55]
  v_exp_f32 v137, v33
  v_mfma_f32_16x16x32_bf16 a[0:3], a[224:227], v[56:59], a[0:3]
  ds_read_b128 a[216:219], v214 offset:36864
  v_cvt_pk_bf16_f32 v80, v136, v137
  v_mfma_f32_16x16x32_bf16 a[4:7], a[224:227], v[60:63], a[4:7]
  v_exp_f32 v138, v34
  v_mfma_f32_16x16x32_bf16 a[8:11], a[224:227], v[64:67], a[8:11]
  ds_read_b128 a[220:223], v215 offset:36864
  v_mfma_f32_16x16x32_bf16 a[12:15], a[224:227], v[68:71], a[12:15]
  v_exp_f32 v139, v35
  v_mfma_f32_16x16x32_bf16 a[16:19], a[228:231], v[56:59], a[16:19]
  ds_read_b64_tr_b16 a[224:225], v220 offset:24576
  v_cvt_pk_bf16_f32 v81, v138, v139
  v_mfma_f32_16x16x32_bf16 a[20:23], a[228:231], v[60:63], a[20:23]
  v_exp_f32 v140, v36
  v_mfma_f32_16x16x32_bf16 a[24:27], a[228:231], v[64:67], a[24:27]
  ds_read_b64_tr_b16 a[226:227], v220 offset:28672
  v_mfma_f32_16x16x32_bf16 a[28:31], a[228:231], v[68:71], a[28:31]
  v_exp_f32 v141, v37
  v_mfma_f32_16x16x32_bf16 a[32:35], a[232:235], v[56:59], a[32:35]
  ds_read_b64_tr_b16 a[228:229], v221 offset:24576
  v_cvt_pk_bf16_f32 v84, v140, v141
  v_mfma_f32_16x16x32_bf16 a[36:39], a[232:235], v[60:63], a[36:39]
  v_exp_f32 v142, v38
  v_mfma_f32_16x16x32_bf16 a[40:43], a[232:235], v[64:67], a[40:43]
  ds_read_b64_tr_b16 a[230:231], v221 offset:28672
  s_waitcnt lgkmcnt(8)
  v_mfma_f32_16x16x32_bf16 a[44:47], a[232:235], v[68:71], a[44:47]
  v_exp_f32 v143, v39
  v_mfma_f32_16x16x32_bf16 a[48:51], a[236:239], v[56:59], a[48:51]
  ds_read_b64_tr_b16 a[232:233], v222 offset:24576
  v_cvt_pk_bf16_f32 v85, v142, v143
  v_mfma_f32_16x16x32_bf16 a[52:55], a[236:239], v[60:63], a[52:55]
  v_exp_f32 v136, v40
  v_mfma_f32_16x16x32_bf16 a[56:59], a[236:239], v[64:67], a[56:59]
  ds_read_b64_tr_b16 a[234:235], v222 offset:28672
  v_mfma_f32_16x16x32_bf16 a[60:63], a[236:239], v[68:71], a[60:63]
  v_exp_f32 v137, v41
  v_mfma_f32_16x16x32_bf16 a[64:67], a[240:243], v[56:59], a[64:67]
  ds_read_b64_tr_b16 a[236:237], v223 offset:24576
  v_cvt_pk_bf16_f32 v74, v136, v137
  v_mfma_f32_16x16x32_bf16 a[68:71], a[240:243], v[60:63], a[68:71]
  v_exp_f32 v138, v42
  v_mfma_f32_16x16x32_bf16 a[72:75], a[240:243], v[64:67], a[72:75]
  v_exp_f32 v139, v43
  v_mfma_f32_16x16x32_bf16 a[76:79], a[240:243], v[68:71], a[76:79]
  ds_read_b64_tr_b16 a[238:239], v223 offset:28672
  v_cvt_pk_bf16_f32 v75, v138, v139
  v_mfma_f32_16x16x32_bf16 a[80:83], a[244:247], v[56:59], a[80:83]
  v_exp_f32 v140, v44
  v_mfma_f32_16x16x32_bf16 a[84:87], a[244:247], v[60:63], a[84:87]
  v_exp_f32 v141, v45
  v_mfma_f32_16x16x32_bf16 a[88:91], a[244:247], v[64:67], a[88:91]
  ds_read_b64_tr_b16 a[240:241], v224 offset:24576
  v_cvt_pk_bf16_f32 v78, v140, v141
  v_mfma_f32_16x16x32_bf16 a[92:95], a[244:247], v[68:71], a[92:95]
  v_exp_f32 v142, v46
  v_mfma_f32_16x16x32_bf16 a[96:99], a[248:251], v[56:59], a[96:99]
  v_exp_f32 v143, v47
  v_mfma_f32_16x16x32_bf16 a[100:103], a[248:251], v[60:63], a[100:103]
  ds_read_b64_tr_b16 a[242:243], v224 offset:28672
  v_cvt_pk_bf16_f32 v79, v142, v143
  v_mfma_f32_16x16x32_bf16 a[104:107], a[248:251], v[64:67], a[104:107]
  v_exp_f32 v136, v48
  v_mfma_f32_16x16x32_bf16 a[108:111], a[248:251], v[68:71], a[108:111]
  v_exp_f32 v137, v49
  v_mfma_f32_16x16x32_bf16 a[112:115], a[252:255], v[56:59], a[112:115]
  ds_read_b64_tr_b16 a[244:245], v225 offset:24576
  v_cvt_pk_bf16_f32 v82, v136, v137
  v_mfma_f32_16x16x32_bf16 a[116:119], a[252:255], v[60:63], a[116:119]
  v_exp_f32 v138, v50
  v_mfma_f32_16x16x32_bf16 a[120:123], a[252:255], v[64:67], a[120:123]
  v_exp_f32 v139, v51
  v_mfma_f32_16x16x32_bf16 a[124:127], a[252:255], v[68:71], a[124:127]
  ds_read_b64_tr_b16 a[246:247], v225 offset:28672
  v_cvt_pk_bf16_f32 v83, v138, v139
  v_mfma_f32_16x16x32_bf16 v[8:11], a[192:195], v[148:151], v[88:91]
  v_exp_f32 v140, v52
  v_mfma_f32_16x16x32_bf16 v[8:11], a[196:199], v[152:155], v[8:11]
  v_exp_f32 v141, v53
  v_mfma_f32_16x16x32_bf16 v[8:11], a[200:203], v[156:159], v[8:11]
  ds_read_b64_tr_b16 a[248:249], v226 offset:24576
  v_cvt_pk_bf16_f32 v86, v140, v141
  v_mfma_f32_16x16x32_bf16 v[8:11], a[204:207], v[160:163], v[8:11]
  v_exp_f32 v142, v54
  v_mfma_f32_16x16x32_bf16 v[12:15], a[192:195], v[164:167], v[92:95]
  ds_read_b64_tr_b16 a[250:251], v226 offset:28672
  v_mfma_f32_16x16x32_bf16 v[12:15], a[196:199], v[168:171], v[12:15]
  v_exp_f32 v143, v55
  v_mfma_f32_16x16x32_bf16 v[12:15], a[200:203], v[172:175], v[12:15]
  ds_read_b64_tr_b16 a[252:253], v227 offset:24576
  v_cvt_pk_bf16_f32 v87, v142, v143
  v_mfma_f32_16x16x32_bf16 v[12:15], a[204:207], v[176:179], v[12:15]
  ds_read_b64_tr_b16 a[254:255], v227 offset:28672
  v_mfma_f32_16x16x32_bf16 v[120:123], v[144:147], v[72:75], v[104:107]
  v_mfma_f32_16x16x32_bf16 v[124:127], v[144:147], v[76:79], v[108:111]
  s_add_u32 m0, s28, 0
  v_mfma_f32_16x16x32_bf16 v[128:131], v[144:147], v[80:83], v[112:115]
  buffer_load_dwordx4 v236, s[16:19], s30 offen lds
  v_mfma_f32_16x16x32_bf16 v[132:135], v[144:147], v[84:87], v[116:119]
  buffer_load_dwordx4 v237, s[16:19], s30 offen offset:1024 lds
  s_add_u32 m0, s28, 0x1e000
  v_mfma_f32_16x16x32_bf16 v[16:19], a[192:195], v[180:183], v[96:99]
  buffer_load_dwordx4 v238, s[20:23], s30 offen lds
  v_mfma_f32_16x16x32_bf16 v[16:19], a[196:199], v[184:187], v[16:19]
  buffer_load_dwordx4 v239, s[20:23], s30 offen offset:1024 lds
  s_add_u32 s30, s30, 0x2000
  v_mfma_f32_16x16x32_bf16 v[16:19], a[200:203], v[188:191], v[16:19]
  v_max3_f32 v1, v120, v124, v128
  v_mfma_f32_16x16x32_bf16 v[16:19], a[204:207], v[192:195], v[16:19]
  v_mfma_f32_16x16x32_bf16 v[20:23], a[192:195], v[196:199], v[100:103]
  v_max_f32 v1, v1, v132
  v_mfma_f32_16x16x32_bf16 v[20:23], a[196:199], v[200:203], v[20:23]
  v_cmp_le_f32 vcc, 0x5d800000, v1
  v_mfma_f32_16x16x32_bf16 v[20:23], a[200:203], v[204:207], v[20:23]
  s_waitcnt lgkmcnt(10)
  v_mfma_f32_16x16x32_bf16 v[20:23], a[204:207], v[208:211], v[20:23]
  s_cbranch_vccnz attn_stubl9
attn_retl9:
  v_mfma_f32_16x16x32_bf16 v[40:43], a[208:211], v[148:151], v[88:91]
  v_exp_f32 v136, v8
  v_mfma_f32_16x16x32_bf16 v[40:43], a[212:215], v[152:155], v[40:43]
  ds_read_b128 a[192:195], v212 offset:49152
  v_mfma_f32_16x16x32_bf16 v[40:43], a[216:219], v[156:159], v[40:43]
  v_exp_f32 v137, v9
  v_mfma_f32_16x16x32_bf16 v[40:43], a[220:223], v[160:163], v[40:43]
  ds_read_b128 a[196:199], v213 offset:49152
  v_cvt_pk_bf16_f32 v56, v136, v137
  v_mfma_f32_16x16x32_bf16 v[44:47], a[208:211], v[164:167], v[92:95]
  v_exp_f32 v138, v10
  v_mfma_f32_16x16x32_bf16 v[44:47], a[212:215], v[168:171], v[44:47]
  ds_read_b128 a[200:203], v214 offset:49152
  v_mfma_f32_16x16x32_bf16 v[44:47], a[216:219], v[172:175], v[44:47]
  v_exp_f32 v139, v11
  v_mfma_f32_16x16x32_bf16 v[44:47], a[220:223], v[176:179], v[44:47]
  ds_read_b128 a[204:207], v215 offset:49152
  v_cvt_pk_bf16_f32 v57, v138, v139
  v_mfma_f32_16x16x32_bf16 v[48:51], a[208:211], v[180:183], v[96:99]
  v_exp_f32 v140, v12
  v_mfma_f32_16x16x32_bf16 v[48:51], a[212:215], v[184:187], v[48:51]
  v_exp_f32 v141, v13
  v_mfma_f32_16x16x32_bf16 v[48:51], a[216:219], v[188:191], v[48:51]
  v_exp_f32 v142, v14
  v_mfma_f32_16x16x32_bf16 v[48:51], a[220:223], v[192:195], v[48:51]
  v_exp_f32 v143, v15
  v_mfma_f32_16x16x32_bf16 v[52:55], a[208:211], v[196:199], v[100:103]
  ds_read_b128 a[208:211], v212 offset:53248
  v_cvt_pk_bf16_f32 v60, v140, v141
  v_mfma_f32_16x16x32_bf16 v[52:55], a[212:215], v[200:203], v[52:55]
  v_exp_f32 v136, v16
  v_mfma_f32_16x16x32_bf16 v[52:55], a[216:219], v[204:207], v[52:55]
  ds_read_b128 a[212:215], v213 offset:53248
  v_cvt_pk_bf16_f32 v61, v142, v143
  v_mfma_f32_16x16x32_bf16 v[52:55], a[220:223], v[208:211], v[52:55]
  v_exp_f32 v137, v17
  v_mfma_f32_16x16x32_bf16 a[0:3], a[224:227], v[72:75], a[0:3]
  ds_read_b128 a[216:219], v214 offset:53248
  v_cvt_pk_bf16_f32 v64, v136, v137
  v_mfma_f32_16x16x32_bf16 a[4:7], a[224:227], v[76:79], a[4:7]
  v_exp_f32 v138, v18
  v_mfma_f32_16x16x32_bf16 a[8:11], a[224:227], v[80:83], a[8:11]
  ds_read_b128 a[220:223], v215 offset:53248
  v_mfma_f32_16x16x32_bf16 a[12:15], a[224:227], v[84:87], a[12:15]
  v_exp_f32 v139, v19
  v_mfma_f32_16x16x32_bf16 a[16:19], a[228:231], v[72:75], a[16:19]
  ds_read_b64_tr_b16 a[224:225], v220 offset:40960
  v_cvt_pk_bf16_f32 v65, v138, v139
  v_mfma_f32_16x16x32_bf16 a[20:23], a[228:231], v[76:79], a[20:23]
  v_exp_f32 v140, v20
  v_mfma_f32_16x16x32_bf16 a[24:27], a[228:231], v[80:83], a[24:27]
  ds_read_b64_tr_b16 a[226:227], v220 offset:45056
  v_mfma_f32_16x16x32_bf16 a[28:31], a[228:231], v[84:87], a[28:31]
  v_exp_f32 v141, v21
  v_mfma_f32_16x16x32_bf16 a[32:35], a[232:235], v[72:75], a[32:35]
  ds_read_b64_tr_b16 a[228:229], v221 offset:40960
  v_cvt_pk_bf16_f32 v68, v140, v141
  v_mfma_f32_16x16x32_bf16 a[36:39], a[232:235], v[76:79], a[36:39]
  v_exp_f32 v142, v22
  v_mfma_f32_16x16x32_bf16 a[40:43], a[232:235], v[80:83], a[40:43]
  ds_read_b64_tr_b16 a[230:231], v221 offset:45056
  s_waitcnt lgkmcnt(8)
  v_mfma_f32_16x16x32_bf16 a[44:47], a[232:235], v[84:87], a[44:47]
  v_exp_f32 v143, v23
  v_mfma_f32_16x16x32_bf16 a[48:51], a[236:239], v[72:75], a[48:51]
  ds_read_b64_tr_b16 a[232:233], v222 offset:40960
  v_cvt_pk_bf16_f32 v69, v142, v143
  v_mfma_f32_16x16x32_bf16 a[52:55], a[236:239], v[76:79], a[52:55]
  v_exp_f32 v136, v40
  v_mfma_f32_16x16x32_bf16 a[56:59], a[236:239], v[80:83], a[56:59]
  ds_read_b64_tr_b16 a[234:235], v222 offset:45056
  v_mfma_f32_16x16x32_bf16 a[60:63], a[236:239], v[84:87], a[60:63]
  v_exp_f32 v137, v41
  v_mfma_f32_16x16x32_bf16 a[64:67], a[240:243], v[72:75], a[64:67]
  ds_read_b64_tr_b16 a[236:237], v223 offset:40960
  v_cvt_pk_bf16_f32 v58, v136, v137
  v_mfma_f32_16x16x32_bf16 a[68:71], a[240:243], v[76:79], a[68:71]
  v_exp_f32 v138, v42
  v_mfma_f32_16x16x32_bf16 a[72:75], a[240:243], v[80:83], a[72:75]
  v_exp_f32 v139, v43
  v_mfma_f32_16x16x32_bf16 a[76:79], a[240:243], v[84:87], a[76:79]
  ds_read_b64_tr_b16 a[238:239], v223 offset:45056
  v_cvt_pk_bf16_f32 v59, v138, v139
  v_mfma_f32_16x16x32_bf16 a[80:83], a[244:247], v[72:75], a[80:83]
  v_exp_f32 v140, v44
  v_mfma_f32_16x16x32_bf16 a[84:87], a[244:247], v[76:79], a[84:87]
  v_exp_f32 v141, v45
  v_mfma_f32_16x16x32_bf16 a[88:91], a[244:247], v[80:83], a[88:91]
  ds_read_b64_tr_b16 a[240:241], v224 offset:40960
  v_cvt_pk_bf16_f32 v62, v140, v141
  v_mfma_f32_16x16x32_bf16 a[92:95], a[244:247], v[84:87], a[92:95]
  v_exp_f32 v142, v46
  v_mfma_f32_16x16x32_bf16 a[96:99], a[248:251], v[72:75], a[96:99]
  v_exp_f32 v143, v47
  v_mfma_f32_16x16x32_bf16 a[100:103], a[248:251], v[76:79], a[100:103]
  ds_read_b64_tr_b16 a[242:243], v224 offset:45056
  v_cvt_pk_bf16_f32 v63, v142, v143
  v_mfma_f32_16x16x32_bf16 a[104:107], a[248:251], v[80:83], a[104:107]
  v_exp_f32 v136, v48
  v_mfma_f32_16x16x32_bf16 a[108:111], a[248:251], v[84:87], a[108:111]
  v_exp_f32 v137, v49
  v_mfma_f32_16x16x32_bf16 a[112:115], a[252:255], v[72:75], a[112:115]
  ds_read_b64_tr_b16 a[244:245], v225 offset:40960
  v_cvt_pk_bf16_f32 v66, v136, v137
  v_mfma_f32_16x16x32_bf16 a[116:119], a[252:255], v[76:79], a[116:119]
  v_exp_f32 v138, v50
  v_mfma_f32_16x16x32_bf16 a[120:123], a[252:255], v[80:83], a[120:123]
  v_exp_f32 v139, v51
  v_mfma_f32_16x16x32_bf16 a[124:127], a[252:255], v[84:87], a[124:127]
  ds_read_b64_tr_b16 a[246:247], v225 offset:45056
  v_cvt_pk_bf16_f32 v67, v138, v139
  v_mfma_f32_16x16x32_bf16 v[24:27], a[192:195], v[148:151], v[88:91]
  v_exp_f32 v140, v52
  v_mfma_f32_16x16x32_bf16 v[24:27], a[196:199], v[152:155], v[24:27]
  v_exp_f32 v141, v53
  v_mfma_f32_16x16x32_bf16 v[24:27], a[200:203], v[156:159], v[24:27]
  ds_read_b64_tr_b16 a[248:249], v226 offset:40960
  v_cvt_pk_bf16_f32 v70, v140, v141
  v_mfma_f32_16x16x32_bf16 v[24:27], a[204:207], v[160:163], v[24:27]
  v_exp_f32 v142, v54
  v_mfma_f32_16x16x32_bf16 v[28:31], a[192:195], v[164:167], v[92:95]
  ds_read_b64_tr_b16 a[250:251], v226 offset:45056
  v_mfma_f32_16x16x32_bf16 v[28:31], a[196:199], v[168:171], v[28:31]
  v_exp_f32 v143, v55
  v_mfma_f32_16x16x32_bf16 v[28:31], a[200:203], v[172:175], v[28:31]
  ds_read_b64_tr_b16 a[252:253], v227 offset:40960
  v_cvt_pk_bf16_f32 v71, v142, v143
  v_mfma_f32_16x16x32_bf16 v[28:31], a[204:207], v[176:179], v[28:31]
  ds_read_b64_tr_b16 a[254:255], v227 offset:45056
  v_mfma_f32_16x16x32_bf16 v[104:107], v[144:147], v[56:59], v[120:123]
  s_waitcnt vmcnt(12)
  s_barrier
  v_mfma_f32_16x16x32_bf16 v[108:111], v[144:147], v[60:63], v[124:127]
  s_add_u32 m0, s28, 0x4000
  v_mfma_f32_16x16x32_bf16 v[112:115], v[144:147], v[64:67], v[128:131]
  buffer_load_dwordx4 v236, s[16:19], s30 offen lds
  v_mfma_f32_16x16x32_bf16 v[116:119], v[144:147], v[68:71], v[132:135]
  buffer_load_dwordx4 v237, s[16:19], s30 offen offset:1024 lds
  s_add_u32 m0, s28, 0x2000
  v_mfma_f32_16x16x32_bf16 v[32:35], a[192:195], v[180:183], v[96:99]
  buffer_load_dwordx4 v238, s[20:23], s30 offen lds
  v_mfma_f32_16x16x32_bf16 v[32:35], a[196:199], v[184:187], v[32:35]
  buffer_load_dwordx4 v239, s[20:23], s30 offen offset:1024 lds
  s_add_u32 s30, s30, 0x2000
  v_mfma_f32_16x16x32_bf16 v[32:35], a[200:203], v[188:191], v[32:35]
  v_max3_f32 v1, v104, v108, v112
  v_mfma_f32_16x16x32_bf16 v[32:35], a[204:207], v[192:195], v[32:35]
  v_mfma_f32_16x16x32_bf16 v[36:39], a[192:195], v[196:199], v[100:103]
  v_max_f32 v1, v1, v116
  v_mfma_f32_16x16x32_bf16 v[36:39], a[196:199], v[200:203], v[36:39]
  v_cmp_le_f32 vcc, 0x5d800000, v1
  v_mfma_f32_16x16x32_bf16 v[36:39], a[200:203], v[204:207], v[36:39]
  s_waitcnt lgkmcnt(10)
  v_mfma_f32_16x16x32_bf16 v[36:39], a[204:207], v[208:211], v[36:39]
  s_cbranch_vccnz attn_stubl10
attn_retl10:
  v_mfma_f32_16x16x32_bf16 v[40:43], a[208:211], v[148:151], v[88:91]
  v_exp_f32 v136, v24
  v_mfma_f32_16x16x32_bf16 v[40:43], a[212:215], v[152:155], v[40:43]
  ds_read_b128 a[192:195], v216
  v_mfma_f32_16x16x32_bf16 v[40:43], a[216:219], v[156:159], v[40:43]
  v_exp_f32 v137, v25
  v_mfma_f32_16x16x32_bf16 v[40:43], a[220:223], v[160:163], v[40:43]
  ds_read_b128 a[196:199], v217
  v_cvt_pk_bf16_f32 v72, v136, v137
  v_mfma_f32_16x16x32_bf16 v[44:47], a[208:211], v[164:167], v[92:95]
  v_exp_f32 v138, v26
  v_mfma_f32_16x16x32_bf16 v[44:47], a[212:215], v[168:171], v[44:47]
  ds_read_b128 a[200:203], v218
  v_mfma_f32_16x16x32_bf16 v[44:47], a[216:219], v[172:175], v[44:47]
  v_exp_f32 v139, v27
  v_mfma_f32_16x16x32_bf16 v[44:47], a[220:223], v[176:179], v[44:47]
  ds_read_b128 a[204:207], v219
  v_cvt_pk_bf16_f32 v73, v138, v139
  v_mfma_f32_16x16x32_bf16 v[48:51], a[208:211], v[180:183], v[96:99]
  v_exp_f32 v140, v28
  v_mfma_f32_16x16x32_bf16 v[48:51], a[212:215], v[184:187], v[48:51]
  v_exp_f32 v141, v29
  v_mfma_f32_16x16x32_bf16 v[48:51], a[216:219], v[188:191], v[48:51]
  v_exp_f32 v142, v30
  v_mfma_f32_16x16x32_bf16 v[48:51], a[220:223], v[192:195], v[48:51]
  v_exp_f32 v143, v31
  v_mfma_f32_16x16x32_bf16 v[52:55], a[208:211], v[196:199], v[100:103]
  ds_read_b128 a[208:211], v216 offset:4096
  v_cvt_pk_bf16_f32 v76, v140, v141
  v_mfma_f32_16x16x32_bf16 v[52:55], a[212:215], v[200:203], v[52:55]
  v_exp_f32 v136, v32
  v_mfma_f32_16x16x32_bf16 v[52:55], a[216:219], v[204:207], v[52:55]
  ds_read_b128 a[212:215], v217 offset:4096
  v_cvt_pk_bf16_f32 v77, v142, v143
  v_mfma_f32_16x16x32_bf16 v[52:55], a[220:223], v[208:211], v[52:55]
  v_exp_f32 v137, v33
  v_mfma_f32_16x16x32_bf16 a[0:3], a[224:227], v[56:59], a[0:3]
  ds_read_b128 a[216:219], v218 offset:4096
  v_cvt_pk_bf16_f32 v80, v136, v137
  v_mfma_f32_16x16x32_bf16 a[4:7], a[224:227], v[60:63], a[4:7]
  v_exp_f32 v138, v34
  v_mfma_f32_16x16x32_bf16 a[8:11], a[224:227], v[64:67], a[8:11]
  ds_read_b128 a[220:223], v219 offset:4096
  v_mfma_f32_16x16x32_bf16 a[12:15], a[224:227], v[68:71], a[12:15]
  v_exp_f32 v139, v35
  v_mfma_f32_16x16x32_bf16 a[16:19], a[228:231], v[56:59], a[16:19]
  ds_read_b64_tr_b16 a[224:225], v220 offset:57344
  v_cvt_pk_bf16_f32 v81, v138, v139
  v_mfma_f32_16x16x32_bf16 a[20:23], a[228:231], v[60:63], a[20:23]
  v_exp_f32 v140, v36
  v_mfma_f32_16x16x32_bf16 a[24:27], a[228:231], v[64:67], a[24:27]
  ds_read_b64_tr_b16 a[226:227], v220 offset:61440
  v_mfma_f32_16x16x32_bf16 a[28:31], a[228:231], v[68:71], a[28:31]
  v_exp_f32 v141, v37
  v_mfma_f32_16x16x32_bf16 a[32:35], a[232:235], v[56:59], a[32:35]
  ds_read_b64_tr_b16 a[228:229], v221 offset:57344
  v_cvt_pk_bf16_f32 v84, v140, v141
  v_mfma_f32_16x16x32_bf16 a[36:39], a[232:235], v[60:63], a[36:39]
  v_exp_f32 v142, v38
  v_mfma_f32_16x16x32_bf16 a[40:43], a[232:235], v[64:67], a[40:43]
  ds_read_b64_tr_b16 a[230:231], v221 offset:61440
  s_waitcnt lgkmcnt(8)
  v_mfma_f32_16x16x32_bf16 a[44:47], a[232:235], v[68:71], a[44:47]
  v_exp_f32 v143, v39
  v_mfma_f32_16x16x32_bf16 a[48:51], a[236:239], v[56:59], a[48:51]
  ds_read_b64_tr_b16 a[232:233], v222 offset:57344
  v_cvt_pk_bf16_f32 v85, v142, v143
  v_mfma_f32_16x16x32_bf16 a[52:55], a[236:239], v[60:63], a[52:55]
  v_exp_f32 v136, v40
  v_mfma_f32_16x16x32_bf16 a[56:59], a[236:239], v[64:67], a[56:59]
  ds_read_b64_tr_b16 a[234:235], v222 offset:61440
  v_mfma_f32_16x16x32_bf16 a[60:63], a[236:239], v[68:71], a[60:63]
  v_exp_f32 v137, v41
  v_mfma_f32_16x16x32_bf16 a[64:67], a[240:243], v[56:59], a[64:67]
  ds_read_b64_tr_b16 a[236:237], v223 offset:57344
  v_cvt_pk_bf16_f32 v74, v136, v137
  v_mfma_f32_16x16x32_bf16 a[68:71], a[240:243], v[60:63], a[68:71]
  v_exp_f32 v138, v42
  v_mfma_f32_16x16x32_bf16 a[72:75], a[240:243], v[64:67], a[72:75]
  v_exp_f32 v139, v43
  v_mfma_f32_16x16x32_bf16 a[76:79], a[240:243], v[68:71], a[76:79]
  ds_read_b64_tr_b16 a[238:239], v223 offset:61440
  v_cvt_pk_bf16_f32 v75, v138, v139
  v_mfma_f32_16x16x32_bf16 a[80:83], a[244:247], v[56:59], a[80:83]
  v_exp_f32 v140, v44
  v_mfma_f32_16x16x32_bf16 a[84:87], a[244:247], v[60:63], a[84:87]
  v_exp_f32 v141, v45
  v_mfma_f32_16x16x32_bf16 a[88:91], a[244:247], v[64:67], a[88:91]
  ds_read_b64_tr_b16 a[240:241], v224 offset:57344
  v_cvt_pk_bf16_f32 v78, v140, v141
  v_mfma_f32_16x16x32_bf16 a[92:95], a[244:247], v[68:71], a[92:95]
  v_exp_f32 v142, v46
  v_mfma_f32_16x16x32_bf16 a[96:99], a[248:251], v[56:59], a[96:99]
  v_exp_f32 v143, v47
  v_mfma_f32_16x16x32_bf16 a[100:103], a[248:251], v[60:63], a[100:103]
  ds_read_b64_tr_b16 a[242:243], v224 offset:61440
  v_cvt_pk_bf16_f32 v79, v142, v143
  v_mfma_f32_16x16x32_bf16 a[104:107], a[248:251], v[64:67], a[104:107]
  v_exp_f32 v136, v48
  v_mfma_f32_16x16x32_bf16 a[108:111], a[248:251], v[68:71], a[108:111]
  v_exp_f32 v137, v49
  v_mfma_f32_16x16x32_bf16 a[112:115], a[252:255], v[56:59], a[112:115]
  ds_read_b64_tr_b16 a[244:245], v225 offset:57344
  v_cvt_pk_bf16_f32 v82, v136, v137
  v_mfma_f32_16x16x32_bf16 a[116:119], a[252:255], v[60:63], a[116:119]
  v_exp_f32 v138, v50
  v_mfma_f32_16x16x32_bf16 a[120:123], a[252:255], v[64:67], a[120:123]
  v_exp_f32 v139, v51
  v_mfma_f32_16x16x32_bf16 a[124:127], a[252:255], v[68:71], a[124:127]
  ds_read_b64_tr_b16 a[246:247], v225 offset:61440
  v_cvt_pk_bf16_f32 v83, v138, v139
  v_mfma_f32_16x16x32_bf16 v[8:11], a[192:195], v[148:151], v[88:91]
  v_exp_f32 v140, v52
  v_mfma_f32_16x16x32_bf16 v[8:11], a[196:199], v[152:155], v[8:11]
  v_exp_f32 v141, v53
  v_mfma_f32_16x16x32_bf16 v[8:11], a[200:203], v[156:159], v[8:11]
  ds_read_b64_tr_b16 a[248:249], v226 offset:57344
  v_cvt_pk_bf16_f32 v86, v140, v141
  v_mfma_f32_16x16x32_bf16 v[8:11], a[204:207], v[160:163], v[8:11]
  v_exp_f32 v142, v54
  v_mfma_f32_16x16x32_bf16 v[12:15], a[192:195], v[164:167], v[92:95]
  ds_read_b64_tr_b16 a[250:251], v226 offset:61440
  v_mfma_f32_16x16x32_bf16 v[12:15], a[196:199], v[168:171], v[12:15]
  v_exp_f32 v143, v55
  v_mfma_f32_16x16x32_bf16 v[12:15], a[200:203], v[172:175], v[12:15]
  ds_read_b64_tr_b16 a[252:253], v227 offset:57344
  v_cvt_pk_bf16_f32 v87, v142, v143
  v_mfma_f32_16x16x32_bf16 v[12:15], a[204:207], v[176:179], v[12:15]
  ds_read_b64_tr_b16 a[254:255], v227 offset:61440
  v_mfma_f32_16x16x32_bf16 v[120:123], v[144:147], v[72:75], v[104:107]
  v_mfma_f32_16x16x32_bf16 v[124:127], v[144:147], v[76:79], v[108:111]
  s_add_u32 m0, s28, 0x8000
  v_mfma_f32_16x16x32_bf16 v[128:131], v[144:147], v[80:83], v[112:115]
  buffer_load_dwordx4 v236, s[16:19], s30 offen lds
  v_mfma_f32_16x16x32_bf16 v[132:135], v[144:147], v[84:87], v[116:119]
  buffer_load_dwordx4 v237, s[16:19], s30 offen offset:1024 lds
  s_add_u32 m0, s28, 0x6000
  v_mfma_f32_16x16x32_bf16 v[16:19], a[192:195], v[180:183], v[96:99]
  buffer_load_dwordx4 v238, s[20:23], s30 offen lds
  v_mfma_f32_16x16x32_bf16 v[16:19], a[196:199], v[184:187], v[16:19]
  buffer_load_dwordx4 v239, s[20:23], s30 offen offset:1024 lds
  s_add_u32 s30, s30, 0x2000
  v_mfma_f32_16x16x32_bf16 v[16:19], a[200:203], v[188:191], v[16:19]
  s_cmp_eq_u32 s31, 1
  v_max3_f32 v1, v120, v124, v128
  v_mfma_f32_16x16x32_bf16 v[16:19], a[204:207], v[192:195], v[16:19]
  s_cbranch_scc1 attn_cpf
attn_cpf_ret:
  v_mfma_f32_16x16x32_bf16 v[20:23], a[192:195], v[196:199], v[100:103]
  v_max_f32 v1, v1, v132
  v_mfma_f32_16x16x32_bf16 v[20:23], a[196:199], v[200:203], v[20:23]
  v_cmp_le_f32 vcc, 0x5d800000, v1
  v_mfma_f32_16x16x32_bf16 v[20:23], a[200:203], v[204:207], v[20:23]
  s_waitcnt lgkmcnt(10)
  v_mfma_f32_16x16x32_bf16 v[20:23], a[204:207], v[208:211], v[20:23]
  s_cbranch_vccnz attn_stubl11
attn_retl11:
  v_mfma_f32_16x16x32_bf16 v[40:43], a[208:211], v[148:151], v[88:91]
  v_exp_f32 v136, v8
  v_mfma_f32_16x16x32_bf16 v[40:43], a[212:215], v[152:155], v[40:43]
  ds_read_b128 a[192:195], v216 offset:16384
  v_mfma_f32_16x16x32_bf16 v[40:43], a[216:219], v[156:159], v[40:43]
  v_exp_f32 v137, v9
  v_mfma_f32_16x16x32_bf16 v[40:43], a[220:223], v[160:163], v[40:43]
  ds_read_b128 a[196:199], v217 offset:16384
  v_cvt_pk_bf16_f32 v56, v136, v137
  v_mfma_f32_16x16x32_bf16 v[44:47], a[208:211], v[164:167], v[92:95]
  v_exp_f32 v138, v10
  v_mfma_f32_16x16x32_bf16 v[44:47], a[212:215], v[168:171], v[44:47]
  ds_read_b128 a[200:203], v218 offset:16384
  v_mfma_f32_16x16x32_bf16 v[44:47], a[216:219], v[172:175], v[44:47]
  v_exp_f32 v139, v11
  v_mfma_f32_16x16x32_bf16 v[44:47], a[220:223], v[176:179], v[44:47]
  ds_read_b128 a[204:207], v219 offset:16384
  v_cvt_pk_bf16_f32 v57, v138, v139
  v_mfma_f32_16x16x32_bf16 v[48:51], a[208:211], v[180:183], v[96:99]
  v_exp_f32 v140, v12
  v_mfma_f32_16x16x32_bf16 v[48:51], a[212:215], v[184:187], v[48:51]
  v_exp_f32 v141, v13
  v_mfma_f32_16x16x32_bf16 v[48:51], a[216:219], v[188:191], v[48:51]
  v_exp_f32 v142, v14
  v_mfma_f32_16x16x32_bf16 v[48:51], a[220:223], v[192:195], v[48:51]
  v_exp_f32 v143, v15
  v_mfma_f32_16x16x32_bf16 v[52:55], a[208:211], v[196:199], v[100:103]
  ds_read_b128 a[208:211], v216 offset:20480
  v_cvt_pk_bf16_f32 v60, v140, v141
  v_mfma_f32_16x16x32_bf16 v[52:55], a[212:215], v[200:203], v[52:55]
  v_exp_f32 v136, v16
  v_mfma_f32_16x16x32_bf16 v[52:55], a[216:219], v[204:207], v[52:55]
  ds_read_b128 a[212:215], v217 offset:20480
  v_cvt_pk_bf16_f32 v61, v142, v143
  v_mfma_f32_16x16x32_bf16 v[52:55], a[220:223], v[208:211], v[52:55]
  v_exp_f32 v137, v17
  v_mfma_f32_16x16x32_bf16 a[0:3], a[224:227], v[72:75], a[0:3]
  ds_read_b128 a[216:219], v218 offset:20480
  v_cvt_pk_bf16_f32 v64, v136, v137
  v_mfma_f32_16x16x32_bf16 a[4:7], a[224:227], v[76:79], a[4:7]
  v_exp_f32 v138, v18
  v_mfma_f32_16x16x32_bf16 a[8:11], a[224:227], v[80:83], a[8:11]
  ds_read_b128 a[220:223], v219 offset:20480
  v_mfma_f32_16x16x32_bf16 a[12:15], a[224:227], v[84:87], a[12:15]
  v_exp_f32 v139, v19
  v_mfma_f32_16x16x32_bf16 a[16:19], a[228:231], v[72:75], a[16:19]
  ds_read_b64_tr_b16 a[224:225], v228 offset:8192
  v_cvt_pk_bf16_f32 v65, v138, v139
  v_mfma_f32_16x16x32_bf16 a[20:23], a[228:231], v[76:79], a[20:23]
  v_exp_f32 v140, v20
  v_mfma_f32_16x16x32_bf16 a[24:27], a[228:231], v[80:83], a[24:27]
  ds_read_b64_tr_b16 a[226:227], v228 offset:12288
  v_mfma_f32_16x16x32_bf16 a[28:31], a[228:231], v[84:87], a[28:31]
  v_exp_f32 v141, v21
  v_mfma_f32_16x16x32_bf16 a[32:35], a[232:235], v[72:75], a[32:35]
  ds_read_b64_tr_b16 a[228:229], v229 offset:8192
  v_cvt_pk_bf16_f32 v68, v140, v141
  v_mfma_f32_16x16x32_bf16 a[36:39], a[232:235], v[76:79], a[36:39]
  v_exp_f32 v142, v22
  v_mfma_f32_16x16x32_bf16 a[40:43], a[232:235], v[80:83], a[40:43]
  ds_read_b64_tr_b16 a[230:231], v229 offset:12288
  s_waitcnt lgkmcnt(8)
  v_mfma_f32_16x16x32_bf16 a[44:47], a[232:235], v[84:87], a[44:47]
  v_exp_f32 v143, v23
  v_mfma_f32_16x16x32_bf16 a[48:51], a[236:239], v[72:75], a[48:51]
  ds_read_b64_tr_b16 a[232:233], v230 offset:8192
  v_cvt_pk_bf16_f32 v69, v142, v143
  v_mfma_f32_16x16x32_bf16 a[52:55], a[236:239], v[76:79], a[52:55]
  v_exp_f32 v136, v40
  v_mfma_f32_16x16x32_bf16 a[56:59], a[236:239], v[80:83], a[56:59]
  ds_read_b64_tr_b16 a[234:235], v230 offset:12288
  v_mfma_f32_16x16x32_bf16 a[60:63], a[236:239], v[84:87], a[60:63]
  v_exp_f32 v137, v41
  v_mfma_f32_16x16x32_bf16 a[64:67], a[240:243], v[72:75], a[64:67]
  ds_read_b64_tr_b16 a[236:237], v231 offset:8192
  v_cvt_pk_bf16_f32 v58, v136, v137
  v_mfma_f32_16x16x32_bf16 a[68:71], a[240:243], v[76:79], a[68:71]
  v_exp_f32 v138, v42
  v_mfma_f32_16x16x32_bf16 a[72:75], a[240:243], v[80:83], a[72:75]
  v_exp_f32 v139, v43
  v_mfma_f32_16x16x32_bf16 a[76:79], a[240:243], v[84:87], a[76:79]
  ds_read_b64_tr_b16 a[238:239], v231 offset:12288
  v_cvt_pk_bf16_f32 v59, v138, v139
  v_mfma_f32_16x16x32_bf16 a[80:83], a[244:247], v[72:75], a[80:83]
  v_exp_f32 v140, v44
  v_mfma_f32_16x16x32_bf16 a[84:87], a[244:247], v[76:79], a[84:87]
  v_exp_f32 v141, v45
  v_mfma_f32_16x16x32_bf16 a[88:91], a[244:247], v[80:83], a[88:91]
  ds_read_b64_tr_b16 a[240:241], v232 offset:8192
  v_cvt_pk_bf16_f32 v62, v140, v141
  v_mfma_f32_16x16x32_bf16 a[92:95], a[244:247], v[84:87], a[92:95]
  v_exp_f32 v142, v46
  v_mfma_f32_16x16x32_bf16 a[96:99], a[248:251], v[72:75], a[96:99]
  v_exp_f32 v143, v47
  v_mfma_f32_16x16x32_bf16 a[100:103], a[248:251], v[76:79], a[100:103]
  ds_read_b64_tr_b16 a[242:243], v232 offset:12288
  v_cvt_pk_bf16_f32 v63, v142, v143
  v_mfma_f32_16x16x32_bf16 a[104:107], a[248:251], v[80:83], a[104:107]
  v_exp_f32 v136, v48
  v_mfma_f32_16x16x32_bf16 a[108:111], a[248:251], v[84:87], a[108:111]
  v_exp_f32 v137, v49
  v_mfma_f32_16x16x32_bf16 a[112:115], a[252:255], v[72:75], a[112:115]
  ds_read_b64_tr_b16 a[244:245], v233 offset:8192
  v_cvt_pk_bf16_f32 v66, v136, v137
  v_mfma_f32_16x16x32_bf16 a[116:119], a[252:255], v[76:79], a[116:119]
  v_exp_f32 v138, v50
  v_mfma_f32_16x16x32_bf16 a[120:123], a[252:255], v[80:83], a[120:123]
  v_exp_f32 v139, v51
  v_mfma_f32_16x16x32_bf16 a[124:127], a[252:255], v[84:87], a[124:127]
  ds_read_b64_tr_b16 a[246:247], v233 offset:12288
  v_cvt_pk_bf16_f32 v67, v138, v139
  v_mfma_f32_16x16x32_bf16 v[24:27], a[192:195], v[148:151], v[88:91]
  v_exp_f32 v140, v52
  v_mfma_f32_16x16x32_bf16 v[24:27], a[196:199], v[152:155], v[24:27]
  v_exp_f32 v141, v53
  v_mfma_f32_16x16x32_bf16 v[24:27], a[200:203], v[156:159], v[24:27]
  ds_read_b64_tr_b16 a[248:249], v234 offset:8192
  v_cvt_pk_bf16_f32 v70, v140, v141
  v_mfma_f32_16x16x32_bf16 v[24:27], a[204:207], v[160:163], v[24:27]
  v_exp_f32 v142, v54
  v_mfma_f32_16x16x32_bf16 v[28:31], a[192:195], v[164:167], v[92:95]
  ds_read_b64_tr_b16 a[250:251], v234 offset:12288
  v_mfma_f32_16x16x32_bf16 v[28:31], a[196:199], v[168:171], v[28:31]
  v_exp_f32 v143, v55
  v_mfma_f32_16x16x32_bf16 v[28:31], a[200:203], v[172:175], v[28:31]
  ds_read_b64_tr_b16 a[252:253], v235 offset:8192
  v_cvt_pk_bf16_f32 v71, v142, v143
  v_mfma_f32_16x16x32_bf16 v[28:31], a[204:207], v[176:179], v[28:31]
  ds_read_b64_tr_b16 a[254:255], v235 offset:12288
  v_mfma_f32_16x16x32_bf16 v[104:107], v[144:147], v[56:59], v[120:123]
  s_waitcnt vmcnt(12)
  s_barrier
  v_mfma_f32_16x16x32_bf16 v[108:111], v[144:147], v[60:63], v[124:127]
  s_add_u32 m0, s28, 0xc000
  v_mfma_f32_16x16x32_bf16 v[112:115], v[144:147], v[64:67], v[128:131]
  buffer_load_dwordx4 v236, s[16:19], s30 offen lds
  v_mfma_f32_16x16x32_bf16 v[116:119], v[144:147], v[68:71], v[132:135]
  buffer_load_dwordx4 v237, s[16:19], s30 offen offset:1024 lds
  s_add_u32 m0, s28, 0xa000
  v_mfma_f32_16x16x32_bf16 v[32:35], a[192:195], v[180:183], v[96:99]
  buffer_load_dwordx4 v238, s[20:23], s30 offen lds
  v_mfma_f32_16x16x32_bf16 v[32:35], a[196:199], v[184:187], v[32:35]
  buffer_load_dwordx4 v239, s[20:23], s30 offen offset:1024 lds
  s_add_u32 s30, s30, 0x2000
  v_mfma_f32_16x16x32_bf16 v[32:35], a[200:203], v[188:191], v[32:35]
  v_max3_f32 v1, v104, v108, v112
  v_mfma_f32_16x16x32_bf16 v[32:35], a[204:207], v[192:195], v[32:35]
  v_mfma_f32_16x16x32_bf16 v[36:39], a[192:195], v[196:199], v[100:103]
  v_max_f32 v1, v1, v116
  v_mfma_f32_16x16x32_bf16 v[36:39], a[196:199], v[200:203], v[36:39]
  v_cmp_le_f32 vcc, 0x5d800000, v1
  v_mfma_f32_16x16x32_bf16 v[36:39], a[200:203], v[204:207], v[36:39]
  s_waitcnt lgkmcnt(10)
  v_mfma_f32_16x16x32_bf16 v[36:39], a[204:207], v[208:211], v[36:39]
  s_cbranch_vccnz attn_stubl12
attn_retl12:
  v_mfma_f32_16x16x32_bf16 v[40:43], a[208:211], v[148:151], v[88:91]
  v_exp_f32 v136, v24
  v_mfma_f32_16x16x32_bf16 v[40:43], a[212:215], v[152:155], v[40:43]
  ds_read_b128 a[192:195], v216 offset:32768
  v_mfma_f32_16x16x32_bf16 v[40:43], a[216:219], v[156:159], v[40:43]
  v_exp_f32 v137, v25
  v_mfma_f32_16x16x32_bf16 v[40:43], a[220:223], v[160:163], v[40:43]
  ds_read_b128 a[196:199], v217 offset:32768
  v_cvt_pk_bf16_f32 v72, v136, v137
  v_mfma_f32_16x16x32_bf16 v[44:47], a[208:211], v[164:167], v[92:95]
  v_exp_f32 v138, v26
  v_mfma_f32_16x16x32_bf16 v[44:47], a[212:215], v[168:171], v[44:47]
  ds_read_b128 a[200:203], v218 offset:32768
  v_mfma_f32_16x16x32_bf16 v[44:47], a[216:219], v[172:175], v[44:47]
  v_exp_f32 v139, v27
  v_mfma_f32_16x16x32_bf16 v[44:47], a[220:223], v[176:179], v[44:47]
  ds_read_b128 a[204:207], v219 offset:32768
  v_cvt_pk_bf16_f32 v73, v138, v139
  v_mfma_f32_16x16x32_bf16 v[48:51], a[208:211], v[180:183], v[96:99]
  v_exp_f32 v140, v28
  v_mfma_f32_16x16x32_bf16 v[48:51], a[212:215], v[184:187], v[48:51]
  v_exp_f32 v141, v29
  v_mfma_f32_16x16x32_bf16 v[48:51], a[216:219], v[188:191], v[48:51]
  v_exp_f32 v142, v30
  v_mfma_f32_16x16x32_bf16 v[48:51], a[220:223], v[192:195], v[48:51]
  v_exp_f32 v143, v31
  v_mfma_f32_16x16x32_bf16 v[52:55], a[208:211], v[196:199], v[100:103]
  ds_read_b128 a[208:211], v216 offset:36864
  v_cvt_pk_bf16_f32 v76, v140, v141
  v_mfma_f32_16x16x32_bf16 v[52:55], a[212:215], v[200:203], v[52:55]
  v_exp_f32 v136, v32
  v_mfma_f32_16x16x32_bf16 v[52:55], a[216:219], v[204:207], v[52:55]
  ds_read_b128 a[212:215], v217 offset:36864
  v_cvt_pk_bf16_f32 v77, v142, v143
  v_mfma_f32_16x16x32_bf16 v[52:55], a[220:223], v[208:211], v[52:55]
  v_exp_f32 v137, v33
  v_mfma_f32_16x16x32_bf16 a[0:3], a[224:227], v[56:59], a[0:3]
  ds_read_b128 a[216:219], v218 offset:36864
  v_cvt_pk_bf16_f32 v80, v136, v137
  v_mfma_f32_16x16x32_bf16 a[4:7], a[224:227], v[60:63], a[4:7]
  v_exp_f32 v138, v34
  v_mfma_f32_16x16x32_bf16 a[8:11], a[224:227], v[64:67], a[8:11]
  ds_read_b128 a[220:223], v219 offset:36864
  v_mfma_f32_16x16x32_bf16 a[12:15], a[224:227], v[68:71], a[12:15]
  v_exp_f32 v139, v35
  v_mfma_f32_16x16x32_bf16 a[16:19], a[228:231], v[56:59], a[16:19]
  ds_read_b64_tr_b16 a[224:225], v228 offset:24576
  v_cvt_pk_bf16_f32 v81, v138, v139
  v_mfma_f32_16x16x32_bf16 a[20:23], a[228:231], v[60:63], a[20:23]
  v_exp_f32 v140, v36
  v_mfma_f32_16x16x32_bf16 a[24:27], a[228:231], v[64:67], a[24:27]
  ds_read_b64_tr_b16 a[226:227], v228 offset:28672
  v_mfma_f32_16x16x32_bf16 a[28:31], a[228:231], v[68:71], a[28:31]
  v_exp_f32 v141, v37
  v_mfma_f32_16x16x32_bf16 a[32:35], a[232:235], v[56:59], a[32:35]
  ds_read_b64_tr_b16 a[228:229], v229 offset:24576
  v_cvt_pk_bf16_f32 v84, v140, v141
  v_mfma_f32_16x16x32_bf16 a[36:39], a[232:235], v[60:63], a[36:39]
  v_exp_f32 v142, v38
  v_mfma_f32_16x16x32_bf16 a[40:43], a[232:235], v[64:67], a[40:43]
  ds_read_b64_tr_b16 a[230:231], v229 offset:28672
  s_waitcnt lgkmcnt(8)
  v_mfma_f32_16x16x32_bf16 a[44:47], a[232:235], v[68:71], a[44:47]
  v_exp_f32 v143, v39
  v_mfma_f32_16x16x32_bf16 a[48:51], a[236:239], v[56:59], a[48:51]
  ds_read_b64_tr_b16 a[232:233], v230 offset:24576
  v_cvt_pk_bf16_f32 v85, v142, v143
  v_mfma_f32_16x16x32_bf16 a[52:55], a[236:239], v[60:63], a[52:55]
  v_exp_f32 v136, v40
  v_mfma_f32_16x16x32_bf16 a[56:59], a[236:239], v[64:67], a[56:59]
  ds_read_b64_tr_b16 a[234:235], v230 offset:28672
  v_mfma_f32_16x16x32_bf16 a[60:63], a[236:239], v[68:71], a[60:63]
  v_exp_f32 v137, v41
  v_mfma_f32_16x16x32_bf16 a[64:67], a[240:243], v[56:59], a[64:67]
  ds_read_b64_tr_b16 a[236:237], v231 offset:24576
  v_cvt_pk_bf16_f32 v74, v136, v137
  v_mfma_f32_16x16x32_bf16 a[68:71], a[240:243], v[60:63], a[68:71]
  v_exp_f32 v138, v42
  v_mfma_f32_16x16x32_bf16 a[72:75], a[240:243], v[64:67], a[72:75]
  v_exp_f32 v139, v43
  v_mfma_f32_16x16x32_bf16 a[76:79], a[240:243], v[68:71], a[76:79]
  ds_read_b64_tr_b16 a[238:239], v231 offset:28672
  v_cvt_pk_bf16_f32 v75, v138, v139
  v_mfma_f32_16x16x32_bf16 a[80:83], a[244:247], v[56:59], a[80:83]
  v_exp_f32 v140, v44
  v_mfma_f32_16x16x32_bf16 a[84:87], a[244:247], v[60:63], a[84:87]
  v_exp_f32 v141, v45
  v_mfma_f32_16x16x32_bf16 a[88:91], a[244:247], v[64:67], a[88:91]
  ds_read_b64_tr_b16 a[240:241], v232 offset:24576
  v_cvt_pk_bf16_f32 v78, v140, v141
  v_mfma_f32_16x16x32_bf16 a[92:95], a[244:247], v[68:71], a[92:95]
  v_exp_f32 v142, v46
  v_mfma_f32_16x16x32_bf16 a[96:99], a[248:251], v[56:59], a[96:99]
  v_exp_f32 v143, v47
  v_mfma_f32_16x16x32_bf16 a[100:103], a[248:251], v[60:63], a[100:103]
  ds_read_b64_tr_b16 a[242:243], v232 offset:28672
  v_cvt_pk_bf16_f32 v79, v142, v143
  v_mfma_f32_16x16x32_bf16 a[104:107], a[248:251], v[64:67], a[104:107]
  v_exp_f32 v136, v48
  v_mfma_f32_16x16x32_bf16 a[108:111], a[248:251], v[68:71], a[108:111]
  v_exp_f32 v137, v49
  v_mfma_f32_16x16x32_bf16 a[112:115], a[252:255], v[56:59], a[112:115]
  ds_read_b64_tr_b16 a[244:245], v233 offset:24576
  v_cvt_pk_bf16_f32 v82, v136, v137
  v_mfma_f32_16x16x32_bf16 a[116:119], a[252:255], v[60:63], a[116:119]
  v_exp_f32 v138, v50
  v_mfma_f32_16x16x32_bf16 a[120:123], a[252:255], v[64:67], a[120:123]
  v_exp_f32 v139, v51
  v_mfma_f32_16x16x32_bf16 a[124:127], a[252:255], v[68:71], a[124:127]
  ds_read_b64_tr_b16 a[246:247], v233 offset:28672
  v_cvt_pk_bf16_f32 v83, v138, v139
  v_mfma_f32_16x16x32_bf16 v[8:11], a[192:195], v[148:151], v[88:91]
  v_exp_f32 v140, v52
  v_mfma_f32_16x16x32_bf16 v[8:11], a[196:199], v[152:155], v[8:11]
  v_exp_f32 v141, v53
  v_mfma_f32_16x16x32_bf16 v[8:11], a[200:203], v[156:159], v[8:11]
  ds_read_b64_tr_b16 a[248:249], v234 offset:24576
  v_cvt_pk_bf16_f32 v86, v140, v141
  v_mfma_f32_16x16x32_bf16 v[8:11], a[204:207], v[160:163], v[8:11]
  v_exp_f32 v142, v54
  v_mfma_f32_16x16x32_bf16 v[12:15], a[192:195], v[164:167], v[92:95]
  ds_read_b64_tr_b16 a[250:251], v234 offset:28672
  v_mfma_f32_16x16x32_bf16 v[12:15], a[196:199], v[168:171], v[12:15]
  v_exp_f32 v143, v55
  v_mfma_f32_16x16x32_bf16 v[12:15], a[200:203], v[172:175], v[12:15]
  ds_read_b64_tr_b16 a[252:253], v235 offset:24576
  v_cvt_pk_bf16_f32 v87, v142, v143
  v_mfma_f32_16x16x32_bf16 v[12:15], a[204:207], v[176:179], v[12:15]
  ds_read_b64_tr_b16 a[254:255], v235 offset:28672
  v_mfma_f32_16x16x32_bf16 v[120:123], v[144:147], v[72:75], v[104:107]
  v_mfma_f32_16x16x32_bf16 v[124:127], v[144:147], v[76:79], v[108:111]
  s_add_u32 m0, s28, 0x10000
  v_mfma_f32_16x16x32_bf16 v[128:131], v[144:147], v[80:83], v[112:115]
  buffer_load_dwordx4 v236, s[16:19], s30 offen lds
  v_mfma_f32_16x16x32_bf16 v[132:135], v[144:147], v[84:87], v[116:119]
  buffer_load_dwordx4 v237, s[16:19], s30 offen offset:1024 lds
  s_add_u32 m0, s28, 0xe000
  v_mfma_f32_16x16x32_bf16 v[16:19], a[192:195], v[180:183], v[96:99]
  buffer_load_dwordx4 v238, s[20:23], s30 offen lds
  v_mfma_f32_16x16x32_bf16 v[16:19], a[196:199], v[184:187], v[16:19]
  buffer_load_dwordx4 v239, s[20:23], s30 offen offset:1024 lds
  s_add_u32 s30, s30, 0x2000
  v_mfma_f32_16x16x32_bf16 v[16:19], a[200:203], v[188:191], v[16:19]
  s_cmp_gt_u32 s31, 4
  v_max3_f32 v1, v120, v124, v128
  v_mfma_f32_16x16x32_bf16 v[16:19], a[204:207], v[192:195], v[16:19]
  s_cbranch_scc1 attn_pf
attn_pf_ret:
  v_mfma_f32_16x16x32_bf16 v[20:23], a[192:195], v[196:199], v[100:103]
  v_max_f32 v1, v1, v132
  v_mfma_f32_16x16x32_bf16 v[20:23], a[196:199], v[200:203], v[20:23]
  v_cmp_le_f32 vcc, 0x5d800000, v1
  v_mfma_f32_16x16x32_bf16 v[20:23], a[200:203], v[204:207], v[20:23]
  s_waitcnt lgkmcnt(10)
  v_mfma_f32_16x16x32_bf16 v[20:23], a[204:207], v[208:211], v[20:23]
  s_cbranch_vccnz attn_stubl13
attn_retl13:
  v_mfma_f32_16x16x32_bf16 v[40:43], a[208:211], v[148:151], v[88:91]
  v_exp_f32 v136, v8
  v_mfma_f32_16x16x32_bf16 v[40:43], a[212:215], v[152:155], v[40:43]
  ds_read_b128 a[192:195], v216 offset:49152
  v_mfma_f32_16x16x32_bf16 v[40:43], a[216:219], v[156:159], v[40:43]
  v_exp_f32 v137, v9
  v_mfma_f32_16x16x32_bf16 v[40:43], a[220:223], v[160:163], v[40:43]
  ds_read_b128 a[196:199], v217 offset:49152
  v_cvt_pk_bf16_f32 v56, v136, v137
  v_mfma_f32_16x16x32_bf16 v[44:47], a[208:211], v[164:167], v[92:95]
  v_exp_f32 v138, v10
  v_mfma_f32_16x16x32_bf16 v[44:47], a[212:215], v[168:171], v[44:47]
  ds_read_b128 a[200:203], v218 offset:49152
  v_mfma_f32_16x16x32_bf16 v[44:47], a[216:219], v[172:175], v[44:47]
  v_exp_f32 v139, v11
  v_mfma_f32_16x16x32_bf16 v[44:47], a[220:223], v[176:179], v[44:47]
  ds_read_b128 a[204:207], v219 offset:49152
  v_cvt_pk_bf16_f32 v57, v138, v139
  v_mfma_f32_16x16x32_bf16 v[48:51], a[208:211], v[180:183], v[96:99]
  v_exp_f32 v140, v12
  v_mfma_f32_16x16x32_bf16 v[48:51], a[212:215], v[184:187], v[48:51]
  v_exp_f32 v141, v13
  v_mfma_f32_16x16x32_bf16 v[48:51], a[216:219], v[188:191], v[48:51]
  v_exp_f32 v142, v14
  v_mfma_f32_16x16x32_bf16 v[48:51], a[220:223], v[192:195], v[48:51]
  v_exp_f32 v143, v15
  v_mfma_f32_16x16x32_bf16 v[52:55], a[208:211], v[196:199], v[100:103]
  ds_read_b128 a[208:211], v216 offset:53248
  v_cvt_pk_bf16_f32 v60, v140, v141
  v_mfma_f32_16x16x32_bf16 v[52:55], a[212:215], v[200:203], v[52:55]
  v_exp_f32 v136, v16
  v_mfma_f32_16x16x32_bf16 v[52:55], a[216:219], v[204:207], v[52:55]
  ds_read_b128 a[212:215], v217 offset:53248
  v_cvt_pk_bf16_f32 v61, v142, v143
  v_mfma_f32_16x16x32_bf16 v[52:55], a[220:223], v[208:211], v[52:55]
  v_exp_f32 v137, v17
  v_mfma_f32_16x16x32_bf16 a[0:3], a[224:227], v[72:75], a[0:3]
  ds_read_b128 a[216:219], v218 offset:53248
  v_cvt_pk_bf16_f32 v64, v136, v137
  v_mfma_f32_16x16x32_bf16 a[4:7], a[224:227], v[76:79], a[4:7]
  v_exp_f32 v138, v18
  v_mfma_f32_16x16x32_bf16 a[8:11], a[224:227], v[80:83], a[8:11]
  ds_read_b128 a[220:223], v219 offset:53248
  v_mfma_f32_16x16x32_bf16 a[12:15], a[224:227], v[84:87], a[12:15]
  v_exp_f32 v139, v19
  v_mfma_f32_16x16x32_bf16 a[16:19], a[228:231], v[72:75], a[16:19]
  ds_read_b64_tr_b16 a[224:225], v228 offset:40960
  v_cvt_pk_bf16_f32 v65, v138, v139
  v_mfma_f32_16x16x32_bf16 a[20:23], a[228:231], v[76:79], a[20:23]
  v_exp_f32 v140, v20
  v_mfma_f32_16x16x32_bf16 a[24:27], a[228:231], v[80:83], a[24:27]
  ds_read_b64_tr_b16 a[226:227], v228 offset:45056
  v_mfma_f32_16x16x32_bf16 a[28:31], a[228:231], v[84:87], a[28:31]
  v_exp_f32 v141, v21
  v_mfma_f32_16x16x32_bf16 a[32:35], a[232:235], v[72:75], a[32:35]
  ds_read_b64_tr_b16 a[228:229], v229 offset:40960
  v_cvt_pk_bf16_f32 v68, v140, v141
  v_mfma_f32_16x16x32_bf16 a[36:39], a[232:235], v[76:79], a[36:39]
  v_exp_f32 v142, v22
  v_mfma_f32_16x16x32_bf16 a[40:43], a[232:235], v[80:83], a[40:43]
  ds_read_b64_tr_b16 a[230:231], v229 offset:45056
  s_waitcnt lgkmcnt(8)
  v_mfma_f32_16x16x32_bf16 a[44:47], a[232:235], v[84:87], a[44:47]
  v_exp_f32 v143, v23
  v_mfma_f32_16x16x32_bf16 a[48:51], a[236:239], v[72:75], a[48:51]
  ds_read_b64_tr_b16 a[232:233], v230 offset:40960
  v_cvt_pk_bf16_f32 v69, v142, v143
  v_mfma_f32_16x16x32_bf16 a[52:55], a[236:239], v[76:79], a[52:55]
  v_exp_f32 v136, v40
  v_mfma_f32_16x16x32_bf16 a[56:59], a[236:239], v[80:83], a[56:59]
  ds_read_b64_tr_b16 a[234:235], v230 offset:45056
  v_mfma_f32_16x16x32_bf16 a[60:63], a[236:239], v[84:87], a[60:63]
  v_exp_f32 v137, v41
  v_mfma_f32_16x16x32_bf16 a[64:67], a[240:243], v[72:75], a[64:67]
  ds_read_b64_tr_b16 a[236:237], v231 offset:40960
  v_cvt_pk_bf16_f32 v58, v136, v137
  v_mfma_f32_16x16x32_bf16 a[68:71], a[240:243], v[76:79], a[68:71]
  v_exp_f32 v138, v42
  v_mfma_f32_16x16x32_bf16 a[72:75], a[240:243], v[80:83], a[72:75]
  v_exp_f32 v139, v43
  v_mfma_f32_16x16x32_bf16 a[76:79], a[240:243], v[84:87], a[76:79]
  ds_read_b64_tr_b16 a[238:239], v231 offset:45056
  v_cvt_pk_bf16_f32 v59, v138, v139
  v_mfma_f32_16x16x32_bf16 a[80:83], a[244:247], v[72:75], a[80:83]
  v_exp_f32 v140, v44
  v_mfma_f32_16x16x32_bf16 a[84:87], a[244:247], v[76:79], a[84:87]
  v_exp_f32 v141, v45
  v_mfma_f32_16x16x32_bf16 a[88:91], a[244:247], v[80:83], a[88:91]
  ds_read_b64_tr_b16 a[240:241], v232 offset:40960
  v_cvt_pk_bf16_f32 v62, v140, v141
  v_mfma_f32_16x16x32_bf16 a[92:95], a[244:247], v[84:87], a[92:95]
  v_exp_f32 v142, v46
  v_mfma_f32_16x16x32_bf16 a[96:99], a[248:251], v[72:75], a[96:99]
  v_exp_f32 v143, v47
  v_mfma_f32_16x16x32_bf16 a[100:103], a[248:251], v[76:79], a[100:103]
  ds_read_b64_tr_b16 a[242:243], v232 offset:45056
  v_cvt_pk_bf16_f32 v63, v142, v143
  v_mfma_f32_16x16x32_bf16 a[104:107], a[248:251], v[80:83], a[104:107]
  v_exp_f32 v136, v48
  v_mfma_f32_16x16x32_bf16 a[108:111], a[248:251], v[84:87], a[108:111]
  v_exp_f32 v137, v49
  v_mfma_f32_16x16x32_bf16 a[112:115], a[252:255], v[72:75], a[112:115]
  ds_read_b64_tr_b16 a[244:245], v233 offset:40960
  v_cvt_pk_bf16_f32 v66, v136, v137
  v_mfma_f32_16x16x32_bf16 a[116:119], a[252:255], v[76:79], a[116:119]
  v_exp_f32 v138, v50
  v_mfma_f32_16x16x32_bf16 a[120:123], a[252:255], v[80:83], a[120:123]
  v_exp_f32 v139, v51
  v_mfma_f32_16x16x32_bf16 a[124:127], a[252:255], v[84:87], a[124:127]
  ds_read_b64_tr_b16 a[246:247], v233 offset:45056
  v_cvt_pk_bf16_f32 v67, v138, v139
  v_mfma_f32_16x16x32_bf16 v[24:27], a[192:195], v[148:151], v[88:91]
  v_exp_f32 v140, v52
  v_mfma_f32_16x16x32_bf16 v[24:27], a[196:199], v[152:155], v[24:27]
  v_exp_f32 v141, v53
  v_mfma_f32_16x16x32_bf16 v[24:27], a[200:203], v[156:159], v[24:27]
  ds_read_b64_tr_b16 a[248:249], v234 offset:40960
  v_cvt_pk_bf16_f32 v70, v140, v141
  v_mfma_f32_16x16x32_bf16 v[24:27], a[204:207], v[160:163], v[24:27]
  v_exp_f32 v142, v54
  v_mfma_f32_16x16x32_bf16 v[28:31], a[192:195], v[164:167], v[92:95]
  ds_read_b64_tr_b16 a[250:251], v234 offset:45056
  v_mfma_f32_16x16x32_bf16 v[28:31], a[196:199], v[168:171], v[28:31]
  v_exp_f32 v143, v55
  v_mfma_f32_16x16x32_bf16 v[28:31], a[200:203], v[172:175], v[28:31]
  ds_read_b64_tr_b16 a[252:253], v235 offset:40960
  v_cvt_pk_bf16_f32 v71, v142, v143
  v_mfma_f32_16x16x32_bf16 v[28:31], a[204:207], v[176:179], v[28:31]
  ds_read_b64_tr_b16 a[254:255], v235 offset:45056
  v_mfma_f32_16x16x32_bf16 v[104:107], v[144:147], v[56:59], v[120:123]
  s_waitcnt vmcnt(12)
  s_barrier
  v_mfma_f32_16x16x32_bf16 v[108:111], v[144:147], v[60:63], v[124:127]
  s_add_u32 m0, s28, 0x14000
  v_mfma_f32_16x16x32_bf16 v[112:115], v[144:147], v[64:67], v[128:131]
  buffer_load_dwordx4 v236, s[16:19], s30 offen lds
  v_mfma_f32_16x16x32_bf16 v[116:119], v[144:147], v[68:71], v[132:135]
  buffer_load_dwordx4 v237, s[16:19], s30 offen offset:1024 lds
  s_add_u32 m0, s28, 0x12000
  v_mfma_f32_16x16x32_bf16 v[32:35], a[192:195], v[180:183], v[96:99]
  buffer_load_dwordx4 v238, s[20:23], s30 offen lds
  v_mfma_f32_16x16x32_bf16 v[32:35], a[196:199], v[184:187], v[32:35]
  buffer_load_dwordx4 v239, s[20:23], s30 offen offset:1024 lds
  s_add_u32 s30, s30, 0x2000
  v_mfma_f32_16x16x32_bf16 v[32:35], a[200:203], v[188:191], v[32:35]
  v_max3_f32 v1, v104, v108, v112
  v_mfma_f32_16x16x32_bf16 v[32:35], a[204:207], v[192:195], v[32:35]
  v_mfma_f32_16x16x32_bf16 v[36:39], a[192:195], v[196:199], v[100:103]
  v_max_f32 v1, v1, v116
  v_mfma_f32_16x16x32_bf16 v[36:39], a[196:199], v[200:203], v[36:39]
  v_cmp_le_f32 vcc, 0x5d800000, v1
  v_mfma_f32_16x16x32_bf16 v[36:39], a[200:203], v[204:207], v[36:39]
  s_waitcnt lgkmcnt(10)
  v_mfma_f32_16x16x32_bf16 v[36:39], a[204:207], v[208:211], v[36:39]
  s_cbranch_vccnz attn_stubl14
attn_retl14:
  v_mfma_f32_16x16x32_bf16 v[40:43], a[208:211], v[148:151], v[88:91]
  v_exp_f32 v136, v24
  v_mfma_f32_16x16x32_bf16 v[40:43], a[212:215], v[152:155], v[40:43]
  ds_read_b128 a[192:195], v212
  v_mfma_f32_16x16x32_bf16 v[40:43], a[216:219], v[156:159], v[40:43]
  v_exp_f32 v137, v25
  v_mfma_f32_16x16x32_bf16 v[40:43], a[220:223], v[160:163], v[40:43]
  ds_read_b128 a[196:199], v213
  v_cvt_pk_bf16_f32 v72, v136, v137
  v_mfma_f32_16x16x32_bf16 v[44:47], a[208:211], v[164:167], v[92:95]
  v_exp_f32 v138, v26
  v_mfma_f32_16x16x32_bf16 v[44:47], a[212:215], v[168:171], v[44:47]
  ds_read_b128 a[200:203], v214
  v_mfma_f32_16x16x32_bf16 v[44:47], a[216:219], v[172:175], v[44:47]
  v_exp_f32 v139, v27
  v_mfma_f32_16x16x32_bf16 v[44:47], a[220:223], v[176:179], v[44:47]
  ds_read_b128 a[204:207], v215
  v_cvt_pk_bf16_f32 v73, v138, v139
  v_mfma_f32_16x16x32_bf16 v[48:51], a[208:211], v[180:183], v[96:99]
  v_exp_f32 v140, v28
  v_mfma_f32_16x16x32_bf16 v[48:51], a[212:215], v[184:187], v[48:51]
  v_exp_f32 v141, v29
  v_mfma_f32_16x16x32_bf16 v[48:51], a[216:219], v[188:191], v[48:51]
  v_exp_f32 v142, v30
  v_mfma_f32_16x16x32_bf16 v[48:51], a[220:223], v[192:195], v[48:51]
  v_exp_f32 v143, v31
  v_mfma_f32_16x16x32_bf16 v[52:55], a[208:211], v[196:199], v[100:103]
  ds_read_b128 a[208:211], v212 offset:4096
  v_cvt_pk_bf16_f32 v76, v140, v141
  v_mfma_f32_16x16x32_bf16 v[52:55], a[212:215], v[200:203], v[52:55]
  v_exp_f32 v136, v32
  v_mfma_f32_16x16x32_bf16 v[52:55], a[216:219], v[204:207], v[52:55]
  ds_read_b128 a[212:215], v213 offset:4096
  v_cvt_pk_bf16_f32 v77, v142, v143
  v_mfma_f32_16x16x32_bf16 v[52:55], a[220:223], v[208:211], v[52:55]
  v_exp_f32 v137, v33
  v_mfma_f32_16x16x32_bf16 a[0:3], a[224:227], v[56:59], a[0:3]
  ds_read_b128 a[216:219], v214 offset:4096
  v_cvt_pk_bf16_f32 v80, v136, v137
  v_mfma_f32_16x16x32_bf16 a[4:7], a[224:227], v[60:63], a[4:7]
  v_exp_f32 v138, v34
  v_mfma_f32_16x16x32_bf16 a[8:11], a[224:227], v[64:67], a[8:11]
  ds_read_b128 a[220:223], v215 offset:4096
  v_mfma_f32_16x16x32_bf16 a[12:15], a[224:227], v[68:71], a[12:15]
  v_exp_f32 v139, v35
  v_mfma_f32_16x16x32_bf16 a[16:19], a[228:231], v[56:59], a[16:19]
  ds_read_b64_tr_b16 a[224:225], v228 offset:57344
  v_cvt_pk_bf16_f32 v81, v138, v139
  v_mfma_f32_16x16x32_bf16 a[20:23], a[228:231], v[60:63], a[20:23]
  v_exp_f32 v140, v36
  v_mfma_f32_16x16x32_bf16 a[24:27], a[228:231], v[64:67], a[24:27]
  ds_read_b64_tr_b16 a[226:227], v228 offset:61440
  v_mfma_f32_16x16x32_bf16 a[28:31], a[228:231], v[68:71], a[28:31]
  v_exp_f32 v141, v37
  v_mfma_f32_16x16x32_bf16 a[32:35], a[232:235], v[56:59], a[32:35]
  ds_read_b64_tr_b16 a[228:229], v229 offset:57344
  v_cvt_pk_bf16_f32 v84, v140, v141
  v_mfma_f32_16x16x32_bf16 a[36:39], a[232:235], v[60:63], a[36:39]
  v_exp_f32 v142, v38
  v_mfma_f32_16x16x32_bf16 a[40:43], a[232:235], v[64:67], a[40:43]
  ds_read_b64_tr_b16 a[230:231], v229 offset:61440
  s_waitcnt lgkmcnt(8)
  v_mfma_f32_16x16x32_bf16 a[44:47], a[232:235], v[68:71], a[44:47]
  v_exp_f32 v143, v39
  v_mfma_f32_16x16x32_bf16 a[48:51], a[236:239], v[56:59], a[48:51]
  ds_read_b64_tr_b16 a[232:233], v230 offset:57344
  v_cvt_pk_bf16_f32 v85, v142, v143
  v_mfma_f32_16x16x32_bf16 a[52:55], a[236:239], v[60:63], a[52:55]
  v_exp_f32 v136, v40
  v_mfma_f32_16x16x32_bf16 a[56:59], a[236:239], v[64:67], a[56:59]
  ds_read_b64_tr_b16 a[234:235], v230 offset:61440
  v_mfma_f32_16x16x32_bf16 a[60:63], a[236:239], v[68:71], a[60:63]
  v_exp_f32 v137, v41
  v_mfma_f32_16x16x32_bf16 a[64:67], a[240:243], v[56:59], a[64:67]
  ds_read_b64_tr_b16 a[236:237], v231 offset:57344
  v_cvt_pk_bf16_f32 v74, v136, v137
  v_mfma_f32_16x16x32_bf16 a[68:71], a[240:243], v[60:63], a[68:71]
  v_exp_f32 v138, v42
  v_mfma_f32_16x16x32_bf16 a[72:75], a[240:243], v[64:67], a[72:75]
  v_exp_f32 v139, v43
  v_mfma_f32_16x16x32_bf16 a[76:79], a[240:243], v[68:71], a[76:79]
  ds_read_b64_tr_b16 a[238:239], v231 offset:61440
  v_cvt_pk_bf16_f32 v75, v138, v139
  v_mfma_f32_16x16x32_bf16 a[80:83], a[244:247], v[56:59], a[80:83]
  v_exp_f32 v140, v44
  v_mfma_f32_16x16x32_bf16 a[84:87], a[244:247], v[60:63], a[84:87]
  v_exp_f32 v141, v45
  v_mfma_f32_16x16x32_bf16 a[88:91], a[244:247], v[64:67], a[88:91]
  ds_read_b64_tr_b16 a[240:241], v232 offset:57344
  v_cvt_pk_bf16_f32 v78, v140, v141
  v_mfma_f32_16x16x32_bf16 a[92:95], a[244:247], v[68:71], a[92:95]
  v_exp_f32 v142, v46
  v_mfma_f32_16x16x32_bf16 a[96:99], a[248:251], v[56:59], a[96:99]
  v_exp_f32 v143, v47
  v_mfma_f32_16x16x32_bf16 a[100:103], a[248:251], v[60:63], a[100:103]
  ds_read_b64_tr_b16 a[242:243], v232 offset:61440
  v_cvt_pk_bf16_f32 v79, v142, v143
  v_mfma_f32_16x16x32_bf16 a[104:107], a[248:251], v[64:67], a[104:107]
  v_exp_f32 v136, v48
  v_mfma_f32_16x16x32_bf16 a[108:111], a[248:251], v[68:71], a[108:111]
  v_exp_f32 v137, v49
  v_mfma_f32_16x16x32_bf16 a[112:115], a[252:255], v[56:59], a[112:115]
  ds_read_b64_tr_b16 a[244:245], v233 offset:57344
  v_cvt_pk_bf16_f32 v82, v136, v137
  v_mfma_f32_16x16x32_bf16 a[116:119], a[252:255], v[60:63], a[116:119]
  v_exp_f32 v138, v50
  v_mfma_f32_16x16x32_bf16 a[120:123], a[252:255], v[64:67], a[120:123]
  v_exp_f32 v139, v51
  v_mfma_f32_16x16x32_bf16 a[124:127], a[252:255], v[68:71], a[124:127]
  ds_read_b64_tr_b16 a[246:247], v233 offset:61440
  v_cvt_pk_bf16_f32 v83, v138, v139
  v_mfma_f32_16x16x32_bf16 v[8:11], a[192:195], v[148:151], v[88:91]
  v_exp_f32 v140, v52
  v_mfma_f32_16x16x32_bf16 v[8:11], a[196:199], v[152:155], v[8:11]
  v_exp_f32 v141, v53
  v_mfma_f32_16x16x32_bf16 v[8:11], a[200:203], v[156:159], v[8:11]
  ds_read_b64_tr_b16 a[248:249], v234 offset:57344
  v_cvt_pk_bf16_f32 v86, v140, v141
  v_mfma_f32_16x16x32_bf16 v[8:11], a[204:207], v[160:163], v[8:11]
  v_exp_f32 v142, v54
  v_mfma_f32_16x16x32_bf16 v[12:15], a[192:195], v[164:167], v[92:95]
  ds_read_b64_tr_b16 a[250:251], v234 offset:61440
  v_mfma_f32_16x16x32_bf16 v[12:15], a[196:199], v[168:171], v[12:15]
  v_exp_f32 v143, v55
  v_mfma_f32_16x16x32_bf16 v[12:15], a[200:203], v[172:175], v[12:15]
  ds_read_b64_tr_b16 a[252:253], v235 offset:57344
  v_cvt_pk_bf16_f32 v87, v142, v143
  v_mfma_f32_16x16x32_bf16 v[12:15], a[204:207], v[176:179], v[12:15]
  ds_read_b64_tr_b16 a[254:255], v235 offset:61440
  v_mfma_f32_16x16x32_bf16 v[120:123], v[144:147], v[72:75], v[104:107]
  v_mfma_f32_16x16x32_bf16 v[124:127], v[144:147], v[76:79], v[108:111]
  s_add_u32 m0, s28, 0x18000
  v_mfma_f32_16x16x32_bf16 v[128:131], v[144:147], v[80:83], v[112:115]
  buffer_load_dwordx4 v236, s[16:19], s30 offen lds
  v_mfma_f32_16x16x32_bf16 v[132:135], v[144:147], v[84:87], v[116:119]
  buffer_load_dwordx4 v237, s[16:19], s30 offen offset:1024 lds
  s_add_u32 m0, s28, 0x16000
  v_mfma_f32_16x16x32_bf16 v[16:19], a[192:195], v[180:183], v[96:99]
  buffer_load_dwordx4 v238, s[20:23], s30 offen lds
  v_mfma_f32_16x16x32_bf16 v[16:19], a[196:199], v[184:187], v[16:19]
  buffer_load_dwordx4 v239, s[20:23], s30 offen offset:1024 lds
  s_add_u32 s30, s30, 0x2000
  v_mfma_f32_16x16x32_bf16 v[16:19], a[200:203], v[188:191], v[16:19]
  v_max3_f32 v1, v120, v124, v128
  v_mfma_f32_16x16x32_bf16 v[16:19], a[204:207], v[192:195], v[16:19]
  v_mfma_f32_16x16x32_bf16 v[20:23], a[192:195], v[196:199], v[100:103]
  v_max_f32 v1, v1, v132
  v_mfma_f32_16x16x32_bf16 v[20:23], a[196:199], v[200:203], v[20:23]
  v_cmp_le_f32 vcc, 0x5d800000, v1
  v_mfma_f32_16x16x32_bf16 v[20:23], a[200:203], v[204:207], v[20:23]
  s_waitcnt lgkmcnt(0)
  v_mfma_f32_16x16x32_bf16 v[20:23], a[204:207], v[208:211], v[20:23]
  s_cbranch_vccnz attn_stubl15
attn_retl15:
  s_sub_u32 s31, s31, 1
  s_cmp_lg_u32 s31, 0
  s_cbranch_scc1 attn_loop
  v_mfma_f32_16x16x32_bf16 a[0:3], a[224:227], v[72:75], a[0:3]
  v_rcp_f32 v88, v120
  v_mfma_f32_16x16x32_bf16 a[16:19], a[228:231], v[72:75], a[16:19]
  v_rcp_f32 v89, v120
  v_mfma_f32_16x16x32_bf16 a[32:35], a[232:235], v[72:75], a[32:35]
  v_rcp_f32 v90, v124
  v_mfma_f32_16x16x32_bf16 a[48:51], a[236:239], v[72:75], a[48:51]
  v_rcp_f32 v91, v124
  v_mfma_f32_16x16x32_bf16 a[64:67], a[240:243], v[72:75], a[64:67]
  v_rcp_f32 v92, v128
  v_mfma_f32_16x16x32_bf16 a[80:83], a[244:247], v[72:75], a[80:83]
  v_rcp_f32 v93, v128
  v_mfma_f32_16x16x32_bf16 a[96:99], a[248:251], v[72:75], a[96:99]
  v_rcp_f32 v94, v132
  v_mfma_f32_16x16x32_bf16 a[112:115], a[252:255], v[72:75], a[112:115]
  v_rcp_f32 v95, v132
  v_mfma_f32_16x16x32_bf16 a[4:7], a[224:227], v[76:79], a[4:7]
  v_mfma_f32_16x16x32_bf16 a[20:23], a[228:231], v[76:79], a[20:23]
  v_mfma_f32_16x16x32_bf16 a[36:39], a[232:235], v[76:79], a[36:39]
  v_mfma_f32_16x16x32_bf16 a[52:55], a[236:239], v[76:79], a[52:55]
  v_mfma_f32_16x16x32_bf16 a[68:71], a[240:243], v[76:79], a[68:71]
  v_mfma_f32_16x16x32_bf16 a[84:87], a[244:247], v[76:79], a[84:87]
  v_mfma_f32_16x16x32_bf16 a[100:103], a[248:251], v[76:79], a[100:103]
  v_mfma_f32_16x16x32_bf16 a[116:119], a[252:255], v[76:79], a[116:119]
  v_mfma_f32_16x16x32_bf16 a[8:11], a[224:227], v[80:83], a[8:11]
  v_accvgpr_read_b32 v8, a0
  v_accvgpr_read_b32 v9, a1
  v_mfma_f32_16x16x32_bf16 a[24:27], a[228:231], v[80:83], a[24:27]
  v_accvgpr_read_b32 v10, a2
  v_accvgpr_read_b32 v11, a3
  v_mfma_f32_16x16x32_bf16 a[40:43], a[232:235], v[80:83], a[40:43]
  v_accvgpr_read_b32 v12, a16
  v_accvgpr_read_b32 v13, a17
  v_mfma_f32_16x16x32_bf16 a[56:59], a[236:239], v[80:83], a[56:59]
  v_accvgpr_read_b32 v14, a18
  v_accvgpr_read_b32 v15, a19
  v_mfma_f32_16x16x32_bf16 a[72:75], a[240:243], v[80:83], a[72:75]
  v_mul_f32 v8, v8, v88
  v_mul_f32 v9, v9, v88
  v_mfma_f32_16x16x32_bf16 a[88:91], a[244:247], v[80:83], a[88:91]
  v_mul_f32 v10, v10, v88
  v_mul_f32 v11, v11, v88
  v_mfma_f32_16x16x32_bf16 a[104:107], a[248:251], v[80:83], a[104:107]
  v_mul_f32 v12, v12, v88
  v_mul_f32 v13, v13, v88
  v_mfma_f32_16x16x32_bf16 a[120:123], a[252:255], v[80:83], a[120:123]
  v_mul_f32 v14, v14, v88
  v_mul_f32 v15, v15, v88
  v_mfma_f32_16x16x32_bf16 a[12:15], a[224:227], v[84:87], a[12:15]
  v_cvt_pk_bf16_f32 v96, v8, v9
  v_cvt_pk_bf16_f32 v97, v10, v11
  v_mfma_f32_16x16x32_bf16 a[28:31], a[228:231], v[84:87], a[28:31]
  v_cvt_pk_bf16_f32 v98, v12, v13
  v_cvt_pk_bf16_f32 v99, v14, v15
  v_mfma_f32_16x16x32_bf16 a[44:47], a[232:235], v[84:87], a[44:47]
  buffer_store_dwordx4 v[96:99], v252, s[24:27], s48 offen sc1
  v_accvgpr_read_b32 v16, a32
  v_mfma_f32_16x16x32_bf16 a[60:63], a[236:239], v[84:87], a[60:63]
  v_accvgpr_read_b32 v17, a33
  v_accvgpr_read_b32 v18, a34
  v_mfma_f32_16x16x32_bf16 a[76:79], a[240:243], v[84:87], a[76:79]
  v_accvgpr_read_b32 v19, a35
  v_accvgpr_read_b32 v20, a48
  v_mfma_f32_16x16x32_bf16 a[92:95], a[244:247], v[84:87], a[92:95]
  v_accvgpr_read_b32 v21, a49
  v_accvgpr_read_b32 v22, a50
  v_mfma_f32_16x16x32_bf16 a[108:111], a[248:251], v[84:87], a[108:111]
  v_accvgpr_read_b32 v23, a51
  v_mul_f32 v16, v16, v88
  v_mfma_f32_16x16x32_bf16 a[124:127], a[252:255], v[84:87], a[124:127]
  v_mul_f32 v17, v17, v88
  v_mul_f32 v18, v18, v88
  v_mul_f32 v19, v19, v88
  v_mul_f32 v20, v20, v88
  v_mul_f32 v21, v21, v88
  v_mul_f32 v22, v22, v88
  v_mul_f32 v23, v23, v88
  v_cvt_pk_bf16_f32 v100, v16, v17
  v_cvt_pk_bf16_f32 v101, v18, v19
  v_cvt_pk_bf16_f32 v102, v20, v21
  v_cvt_pk_bf16_f32 v103, v22, v23
  buffer_store_dwordx4 v[100:103], v252, s[24:27], s48 offen offset:1024 sc1
  v_accvgpr_read_b32 v24, a64
  v_accvgpr_read_b32 v25, a65
  v_accvgpr_read_b32 v26, a66
  v_accvgpr_read_b32 v27, a67
  v_accvgpr_read_b32 v28, a80
  v_accvgpr_read_b32 v29, a81
  v_accvgpr_read_b32 v30, a82
  v_accvgpr_read_b32 v31, a83
  v_mul_f32 v24, v24, v88
  v_mul_f32 v25, v25, v88
  v_mul_f32 v26, v26, v88
  v_mul_f32 v27, v27, v88
  v_mul_f32 v28, v28, v88
  v_mul_f32 v29, v29, v88
  v_mul_f32 v30, v30, v88
  v_mul_f32 v31, v31, v88
  v_cvt_pk_bf16_f32 v104, v24, v25
  v_cvt_pk_bf16_f32 v105, v26, v27
  v_cvt_pk_bf16_f32 v106, v28, v29
  v_cvt_pk_bf16_f32 v107, v30, v31
  buffer_store_dwordx4 v[104:107], v252, s[24:27], s48 offen offset:2048 sc1
  v_accvgpr_read_b32 v32, a96
  v_accvgpr_read_b32 v33, a97
  v_accvgpr_read_b32 v34, a98
  v_accvgpr_read_b32 v35, a99
  v_accvgpr_read_b32 v36, a112
  v_accvgpr_read_b32 v37, a113
  v_accvgpr_read_b32 v38, a114
  v_accvgpr_read_b32 v39, a115
  v_mul_f32 v32, v32, v88
  v_mul_f32 v33, v33, v88
  v_mul_f32 v34, v34, v88
  v_mul_f32 v35, v35, v88
  v_mul_f32 v36, v36, v88
  v_mul_f32 v37, v37, v88
  v_mul_f32 v38, v38, v88
  v_mul_f32 v39, v39, v88
  v_cvt_pk_bf16_f32 v108, v32, v33
  v_cvt_pk_bf16_f32 v109, v34, v35
  v_cvt_pk_bf16_f32 v110, v36, v37
  v_cvt_pk_bf16_f32 v111, v38, v39
  buffer_store_dwordx4 v[108:111], v252, s[24:27], s48 offen offset:3072 sc1
  v_accvgpr_read_b32 v8, a4
  v_accvgpr_read_b32 v9, a5
  v_accvgpr_read_b32 v10, a6
  v_accvgpr_read_b32 v11, a7
  v_accvgpr_read_b32 v12, a20
  v_accvgpr_read_b32 v13, a21
  v_accvgpr_read_b32 v14, a22
  v_accvgpr_read_b32 v15, a23
  v_pk_mul_f32 v[8:9], v[8:9], v[90:91]
  v_pk_mul_f32 v[10:11], v[10:11], v[90:91]
  v_pk_mul_f32 v[12:13], v[12:13], v[90:91]
  v_pk_mul_f32 v[14:15], v[14:15], v[90:91]
  v_cvt_pk_bf16_f32 v112, v8, v9
  v_cvt_pk_bf16_f32 v113, v10, v11
  v_cvt_pk_bf16_f32 v114, v12, v13
  v_cvt_pk_bf16_f32 v115, v14, v15
  buffer_store_dwordx4 v[112:115], v252, s[24:27], s49 offen sc1
  v_accvgpr_read_b32 v16, a36
  v_accvgpr_read_b32 v17, a37
  v_accvgpr_read_b32 v18, a38
  v_accvgpr_read_b32 v19, a39
  v_accvgpr_read_b32 v20, a52
  v_accvgpr_read_b32 v21, a53
  v_accvgpr_read_b32 v22, a54
  v_accvgpr_read_b32 v23, a55
  v_pk_mul_f32 v[16:17], v[16:17], v[90:91]
  v_pk_mul_f32 v[18:19], v[18:19], v[90:91]
  v_pk_mul_f32 v[20:21], v[20:21], v[90:91]
  v_pk_mul_f32 v[22:23], v[22:23], v[90:91]
  v_cvt_pk_bf16_f32 v116, v16, v17
  v_cvt_pk_bf16_f32 v117, v18, v19
  v_cvt_pk_bf16_f32 v118, v20, v21
  v_cvt_pk_bf16_f32 v119, v22, v23
  buffer_store_dwordx4 v[116:119], v252, s[24:27], s49 offen offset:1024 sc1
  v_accvgpr_read_b32 v24, a68
  v_accvgpr_read_b32 v25, a69
  v_accvgpr_read_b32 v26, a70
  v_accvgpr_read_b32 v27, a71
  v_accvgpr_read_b32 v28, a84
  v_accvgpr_read_b32 v29, a85
  v_accvgpr_read_b32 v30, a86
  v_accvgpr_read_b32 v31, a87
  v_pk_mul_f32 v[24:25], v[24:25], v[90:91]
  v_pk_mul_f32 v[26:27], v[26:27], v[90:91]
  v_pk_mul_f32 v[28:29], v[28:29], v[90:91]
  v_pk_mul_f32 v[30:31], v[30:31], v[90:91]
  v_cvt_pk_bf16_f32 v120, v24, v25
  v_cvt_pk_bf16_f32 v121, v26, v27
  v_cvt_pk_bf16_f32 v122, v28, v29
  v_cvt_pk_bf16_f32 v123, v30, v31
  buffer_store_dwordx4 v[120:123], v252, s[24:27], s49 offen offset:2048 sc1
  v_accvgpr_read_b32 v32, a100
  v_accvgpr_read_b32 v33, a101
  v_accvgpr_read_b32 v34, a102
  v_accvgpr_read_b32 v35, a103
  v_accvgpr_read_b32 v36, a116
  v_accvgpr_read_b32 v37, a117
  v_accvgpr_read_b32 v38, a118
  v_accvgpr_read_b32 v39, a119
  v_pk_mul_f32 v[32:33], v[32:33], v[90:91]
  v_pk_mul_f32 v[34:35], v[34:35], v[90:91]
  v_pk_mul_f32 v[36:37], v[36:37], v[90:91]
  v_pk_mul_f32 v[38:39], v[38:39], v[90:91]
  v_cvt_pk_bf16_f32 v124, v32, v33
  v_cvt_pk_bf16_f32 v125, v34, v35
  v_cvt_pk_bf16_f32 v126, v36, v37
  v_cvt_pk_bf16_f32 v127, v38, v39
  buffer_store_dwordx4 v[124:127], v252, s[24:27], s49 offen offset:3072 sc1
  v_accvgpr_read_b32 v8, a8
  v_accvgpr_read_b32 v9, a9
  v_accvgpr_read_b32 v10, a10
  v_accvgpr_read_b32 v11, a11
  v_accvgpr_read_b32 v12, a24
  v_accvgpr_read_b32 v13, a25
  v_accvgpr_read_b32 v14, a26
  v_accvgpr_read_b32 v15, a27
  v_pk_mul_f32 v[8:9], v[8:9], v[92:93]
  v_pk_mul_f32 v[10:11], v[10:11], v[92:93]
  v_pk_mul_f32 v[12:13], v[12:13], v[92:93]
  v_pk_mul_f32 v[14:15], v[14:15], v[92:93]
  v_cvt_pk_bf16_f32 v96, v8, v9
  v_cvt_pk_bf16_f32 v97, v10, v11
  v_cvt_pk_bf16_f32 v98, v12, v13
  v_cvt_pk_bf16_f32 v99, v14, v15
  buffer_store_dwordx4 v[96:99], v252, s[24:27], s50 offen sc1
  v_accvgpr_read_b32 v16, a40
  v_accvgpr_read_b32 v17, a41
  v_accvgpr_read_b32 v18, a42
  v_accvgpr_read_b32 v19, a43
  v_accvgpr_read_b32 v20, a56
  v_accvgpr_read_b32 v21, a57
  v_accvgpr_read_b32 v22, a58
  v_accvgpr_read_b32 v23, a59
  v_pk_mul_f32 v[16:17], v[16:17], v[92:93]
  v_pk_mul_f32 v[18:19], v[18:19], v[92:93]
  v_pk_mul_f32 v[20:21], v[20:21], v[92:93]
  v_pk_mul_f32 v[22:23], v[22:23], v[92:93]
  v_cvt_pk_bf16_f32 v100, v16, v17
  v_cvt_pk_bf16_f32 v101, v18, v19
  v_cvt_pk_bf16_f32 v102, v20, v21
  v_cvt_pk_bf16_f32 v103, v22, v23
  buffer_store_dwordx4 v[100:103], v252, s[24:27], s50 offen offset:1024 sc1
  v_accvgpr_read_b32 v24, a72
  v_accvgpr_read_b32 v25, a73
  v_accvgpr_read_b32 v26, a74
  v_accvgpr_read_b32 v27, a75
  v_accvgpr_read_b32 v28, a88
  v_accvgpr_read_b32 v29, a89
  v_accvgpr_read_b32 v30, a90
  v_accvgpr_read_b32 v31, a91
  v_pk_mul_f32 v[24:25], v[24:25], v[92:93]
  v_pk_mul_f32 v[26:27], v[26:27], v[92:93]
  v_pk_mul_f32 v[28:29], v[28:29], v[92:93]
  v_pk_mul_f32 v[30:31], v[30:31], v[92:93]
  v_cvt_pk_bf16_f32 v104, v24, v25
  v_cvt_pk_bf16_f32 v105, v26, v27
  v_cvt_pk_bf16_f32 v106, v28, v29
  v_cvt_pk_bf16_f32 v107, v30, v31
  buffer_store_dwordx4 v[104:107], v252, s[24:27], s50 offen offset:2048 sc1
  v_accvgpr_read_b32 v32, a104
  v_accvgpr_read_b32 v33, a105
  v_accvgpr_read_b32 v34, a106
  v_accvgpr_read_b32 v35, a107
  v_accvgpr_read_b32 v36, a120
  v_accvgpr_read_b32 v37, a121
  v_accvgpr_read_b32 v38, a122
  v_accvgpr_read_b32 v39, a123
  v_pk_mul_f32 v[32:33], v[32:33], v[92:93]
  v_pk_mul_f32 v[34:35], v[34:35], v[92:93]
  v_pk_mul_f32 v[36:37], v[36:37], v[92:93]
  v_pk_mul_f32 v[38:39], v[38:39], v[92:93]
  v_cvt_pk_bf16_f32 v108, v32, v33
  v_cvt_pk_bf16_f32 v109, v34, v35
  v_cvt_pk_bf16_f32 v110, v36, v37
  v_cvt_pk_bf16_f32 v111, v38, v39
  buffer_store_dwordx4 v[108:111], v252, s[24:27], s50 offen offset:3072 sc1
  v_accvgpr_read_b32 v8, a12
  v_accvgpr_read_b32 v9, a13
  v_accvgpr_read_b32 v10, a14
  v_accvgpr_read_b32 v11, a15
  v_accvgpr_read_b32 v12, a28
  v_accvgpr_read_b32 v13, a29
  v_accvgpr_read_b32 v14, a30
  v_accvgpr_read_b32 v15, a31
  v_pk_mul_f32 v[8:9], v[8:9], v[94:95]
  v_pk_mul_f32 v[10:11], v[10:11], v[94:95]
  v_pk_mul_f32 v[12:13], v[12:13], v[94:95]
  v_pk_mul_f32 v[14:15], v[14:15], v[94:95]
  v_cvt_pk_bf16_f32 v112, v8, v9
  v_cvt_pk_bf16_f32 v113, v10, v11
  v_cvt_pk_bf16_f32 v114, v12, v13
  v_cvt_pk_bf16_f32 v115, v14, v15
  buffer_store_dwordx4 v[112:115], v252, s[24:27], s51 offen sc1
  v_accvgpr_read_b32 v16, a44
  v_accvgpr_read_b32 v17, a45
  v_accvgpr_read_b32 v18, a46
  v_accvgpr_read_b32 v19, a47
  v_accvgpr_read_b32 v20, a60
  v_accvgpr_read_b32 v21, a61
  v_accvgpr_read_b32 v22, a62
  v_accvgpr_read_b32 v23, a63
  v_pk_mul_f32 v[16:17], v[16:17], v[94:95]
  v_pk_mul_f32 v[18:19], v[18:19], v[94:95]
  v_pk_mul_f32 v[20:21], v[20:21], v[94:95]
  v_pk_mul_f32 v[22:23], v[22:23], v[94:95]
  v_cvt_pk_bf16_f32 v116, v16, v17
  v_cvt_pk_bf16_f32 v117, v18, v19
  v_cvt_pk_bf16_f32 v118, v20, v21
  v_cvt_pk_bf16_f32 v119, v22, v23
  buffer_store_dwordx4 v[116:119], v252, s[24:27], s51 offen offset:1024 sc1
  v_accvgpr_read_b32 v24, a76
  v_accvgpr_read_b32 v25, a77
  v_accvgpr_read_b32 v26, a78
  v_accvgpr_read_b32 v27, a79
  v_accvgpr_read_b32 v28, a92
  v_accvgpr_read_b32 v29, a93
  v_accvgpr_read_b32 v30, a94
  v_accvgpr_read_b32 v31, a95
  v_pk_mul_f32 v[24:25], v[24:25], v[94:95]
  v_pk_mul_f32 v[26:27], v[26:27], v[94:95]
  v_pk_mul_f32 v[28:29], v[28:29], v[94:95]
  v_pk_mul_f32 v[30:31], v[30:31], v[94:95]
  v_cvt_pk_bf16_f32 v120, v24, v25
  v_cvt_pk_bf16_f32 v121, v26, v27
  v_cvt_pk_bf16_f32 v122, v28, v29
  v_cvt_pk_bf16_f32 v123, v30, v31
  buffer_store_dwordx4 v[120:123], v252, s[24:27], s51 offen offset:2048 sc1
  v_accvgpr_read_b32 v32, a108
  v_accvgpr_read_b32 v33, a109
  v_accvgpr_read_b32 v34, a110
  v_accvgpr_read_b32 v35, a111
  v_accvgpr_read_b32 v36, a124
  v_accvgpr_read_b32 v37, a125
  v_accvgpr_read_b32 v38, a126
  v_accvgpr_read_b32 v39, a127
  v_pk_mul_f32 v[32:33], v[32:33], v[94:95]
  v_pk_mul_f32 v[34:35], v[34:35], v[94:95]
  v_pk_mul_f32 v[36:37], v[36:37], v[94:95]
  v_pk_mul_f32 v[38:39], v[38:39], v[94:95]
  v_cvt_pk_bf16_f32 v124, v32, v33
  v_cvt_pk_bf16_f32 v125, v34, v35
  v_cvt_pk_bf16_f32 v126, v36, v37
  v_cvt_pk_bf16_f32 v127, v38, v39
  buffer_store_dwordx4 v[124:127], v252, s[24:27], s51 offen offset:3072 sc1
attn_end:
  s_endpgm
mod_pf:
  s_cmp_lt_u32 s2, 0xa8
  s_cbranch_scc1 mod_done
  s_load_dwordx2 s[4:5], s[0:1], 24
  s_load_dwordx2 s[24:25], s[0:1], 104
  s_lshr_b32 s23, s2, 3
  s_sub_u32 s23, s23, 21
  s_and_b32 s22, s2, 7
  v_lshrrev_b32 v121, 3, v0
  v_lshlrev_b32 v121, 13, v121
  v_and_b32 v122, 7, v0
  v_lshl_add_u32 v121, v122, 7, v121
  v_cmp_gt_u32 vcc, 0, v0
  v_mov_b32 v122, 0x7fffffff
  s_nop 0
  v_cndmask_b32 v121, v122, v121, vcc
  v_lshlrev_b32 v123, 7, v0
  s_lshl_b32 s20, s22, 10
  s_mul_i32 s21, s23, 0
  s_add_u32 s20, s20, s21
  s_add_u32 s20, s20, 0x100000
  s_waitcnt lgkmcnt(0)
  s_mov_b32 s8, s4
  s_mov_b32 s9, s5
  s_mov_b32 s10, 0x480000
  s_mov_b32 s11, 0x20000
  s_add_u32 s28, s24, 0x40000
  s_addc_u32 s29, s25, 0
  s_mov_b32 s30, 0x20000
  s_mov_b32 s31, 0x20000
  s_getpc_b64 s[16:17]
mod_pc:
  s_add_u32 s16, s16, attn_qproj-mod_pc
  s_addc_u32 s17, s17, -1
  s_mov_b32 s18, attn_kernel_codeend-attn_qproj
  s_mov_b32 s19, 0x20000
  s_sub_u32 s26, s2, 0xa8
  s_lshl_b32 s26, s26, 15
  v_lshl_add_u32 v128, v0, 7, s26
  v_mov_b32 v129, 0
  buffer_store_dword v129, v128, s[28:31], 0 offen
  s_lshl_b32 s23, s23, 15
  buffer_load_dword v127, v123, s[16:19], s23 offen
  buffer_load_dword v126, v121, s[8:11], s20 offen
  s_branch mod_done
attn_stubp1:
  s_call_b64 s[40:41], attn_slow1
  s_branch attn_retp1
attn_stubl8:
  s_call_b64 s[40:41], attn_slow0
  s_branch attn_retl8
attn_stubl9:
  s_call_b64 s[40:41], attn_slow1
  s_branch attn_retl9
attn_stubl10:
  s_call_b64 s[40:41], attn_slow0
  s_branch attn_retl10
attn_stubl11:
  s_call_b64 s[40:41], attn_slow1
  s_branch attn_retl11
attn_cpf:
  buffer_load_dword v6, v253, s[60:63], 0 offen
  buffer_load_dword v6, v254, s[64:67], 0 offen
  s_branch attn_cpf_ret
attn_stubl12:
  s_call_b64 s[40:41], attn_slow0
  s_branch attn_retl12
attn_stubl13:
  s_call_b64 s[40:41], attn_slow1
  s_branch attn_retl13
attn_pf:
  buffer_load_dword v6, v7, s[56:59], 0 offen
  s_mov_b32 s58, 0x510000
  s_mov_b64 s[56:57], s[74:75]
  s_mov_b64 s[74:75], s[76:77]
  s_mov_b64 s[76:77], s[78:79]
  s_branch attn_pf_ret
attn_stubl14:
  s_call_b64 s[40:41], attn_slow0
  s_branch attn_retl14
attn_stubl15:
  s_call_b64 s[40:41], attn_slow1
  s_branch attn_retl15
attn_slow0:
  s_nop 15
  s_nop 3
  v_max3_f32 v2, v8, v9, v10
  v_max3_f32 v2, v2, v11, v40
  v_max3_f32 v2, v2, v41, v42
  v_max_f32 v2, v2, v43
  v_mov_b32 v4, v2
  s_nop 1
  v_permlane32_swap_b32 v2, v4
  v_max_f32 v2, v2, v4
  v_mov_b32 v4, v2
  s_nop 1
  v_permlane16_swap_b32 v2, v4
  v_max_f32 v2, v2, v4
  v_log_f32 v4, v120
  s_nop 0
  v_max_f32 v2, v2, v4
  v_add_f32 v2, 0x42c00000, v2
  v_max_f32 v2, 0, v2
  v_ceil_f32 v2, v2
  v_cvt_i32_f32 v3, -v2
  v_sub_f32 v88, v88, v2
  v_sub_f32 v89, v89, v2
  v_sub_f32 v90, v90, v2
  v_sub_f32 v91, v91, v2
  v_sub_f32 v8, v8, v2
  v_sub_f32 v9, v9, v2
  v_sub_f32 v10, v10, v2
  v_sub_f32 v11, v11, v2
  v_sub_f32 v40, v40, v2
  v_sub_f32 v41, v41, v2
  v_sub_f32 v42, v42, v2
  v_sub_f32 v43, v43, v2
  v_sub_f32 v24, v24, v2
  v_sub_f32 v25, v25, v2
  v_sub_f32 v26, v26, v2
  v_sub_f32 v27, v27, v2
  v_ldexp_f32 v120, v120, v3
  v_ldexp_f32 v121, v121, v3
  v_ldexp_f32 v122, v122, v3
  v_ldexp_f32 v123, v123, v3
  v_accvgpr_read_b32 v136, a0
  v_accvgpr_read_b32 v137, a1
  v_accvgpr_read_b32 v138, a2
  v_accvgpr_read_b32 v139, a3
  v_ldexp_f32 v136, v136, v3
  v_ldexp_f32 v137, v137, v3
  v_ldexp_f32 v138, v138, v3
  v_ldexp_f32 v139, v139, v3
  v_accvgpr_write_b32 a0, v136
  v_accvgpr_write_b32 a1, v137
  v_accvgpr_write_b32 a2, v138
  v_accvgpr_write_b32 a3, v139
  v_accvgpr_read_b32 v136, a16
  v_accvgpr_read_b32 v137, a17
  v_accvgpr_read_b32 v138, a18
  v_accvgpr_read_b32 v139, a19
  v_ldexp_f32 v136, v136, v3
  v_ldexp_f32 v137, v137, v3
  v_ldexp_f32 v138, v138, v3
  v_ldexp_f32 v139, v139, v3
  v_accvgpr_write_b32 a16, v136
  v_accvgpr_write_b32 a17, v137
  v_accvgpr_write_b32 a18, v138
  v_accvgpr_write_b32 a19, v139
  v_accvgpr_read_b32 v136, a32
  v_accvgpr_read_b32 v137, a33
  v_accvgpr_read_b32 v138, a34
  v_accvgpr_read_b32 v139, a35
  v_ldexp_f32 v136, v136, v3
  v_ldexp_f32 v137, v137, v3
  v_ldexp_f32 v138, v138, v3
  v_ldexp_f32 v139, v139, v3
  v_accvgpr_write_b32 a32, v136
  v_accvgpr_write_b32 a33, v137
  v_accvgpr_write_b32 a34, v138
  v_accvgpr_write_b32 a35, v139
  v_accvgpr_read_b32 v136, a48
  v_accvgpr_read_b32 v137, a49
  v_accvgpr_read_b32 v138, a50
  v_accvgpr_read_b32 v139, a51
  v_ldexp_f32 v136, v136, v3
  v_ldexp_f32 v137, v137, v3
  v_ldexp_f32 v138, v138, v3
  v_ldexp_f32 v139, v139, v3
  v_accvgpr_write_b32 a48, v136
  v_accvgpr_write_b32 a49, v137
  v_accvgpr_write_b32 a50, v138
  v_accvgpr_write_b32 a51, v139
  v_accvgpr_read_b32 v136, a64
  v_accvgpr_read_b32 v137, a65
  v_accvgpr_read_b32 v138, a66
  v_accvgpr_read_b32 v139, a67
  v_ldexp_f32 v136, v136, v3
  v_ldexp_f32 v137, v137, v3
  v_ldexp_f32 v138, v138, v3
  v_ldexp_f32 v139, v139, v3
  v_accvgpr_write_b32 a64, v136
  v_accvgpr_write_b32 a65, v137
  v_accvgpr_write_b32 a66, v138
  v_accvgpr_write_b32 a67, v139
  v_accvgpr_read_b32 v136, a80
  v_accvgpr_read_b32 v137, a81
  v_accvgpr_read_b32 v138, a82
  v_accvgpr_read_b32 v139, a83
  v_ldexp_f32 v136, v136, v3
  v_ldexp_f32 v137, v137, v3
  v_ldexp_f32 v138, v138, v3
  v_ldexp_f32 v139, v139, v3
  v_accvgpr_write_b32 a80, v136
  v_accvgpr_write_b32 a81, v137
  v_accvgpr_write_b32 a82, v138
  v_accvgpr_write_b32 a83, v139
  v_accvgpr_read_b32 v136, a96
  v_accvgpr_read_b32 v137, a97
  v_accvgpr_read_b32 v138, a98
  v_accvgpr_read_b32 v139, a99
  v_ldexp_f32 v136, v136, v3
  v_ldexp_f32 v137, v137, v3
  v_ldexp_f32 v138, v138, v3
  v_ldexp_f32 v139, v139, v3
  v_accvgpr_write_b32 a96, v136
  v_accvgpr_write_b32 a97, v137
  v_accvgpr_write_b32 a98, v138
  v_accvgpr_write_b32 a99, v139
  v_accvgpr_read_b32 v136, a112
  v_accvgpr_read_b32 v137, a113
  v_accvgpr_read_b32 v138, a114
  v_accvgpr_read_b32 v139, a115
  v_ldexp_f32 v136, v136, v3
  v_ldexp_f32 v137, v137, v3
  v_ldexp_f32 v138, v138, v3
  v_ldexp_f32 v139, v139, v3
  v_accvgpr_write_b32 a112, v136
  v_accvgpr_write_b32 a113, v137
  v_accvgpr_write_b32 a114, v138
  v_accvgpr_write_b32 a115, v139
  v_max3_f32 v2, v12, v13, v14
  v_max3_f32 v2, v2, v15, v44
  v_max3_f32 v2, v2, v45, v46
  v_max_f32 v2, v2, v47
  v_mov_b32 v4, v2
  s_nop 1
  v_permlane32_swap_b32 v2, v4
  v_max_f32 v2, v2, v4
  v_mov_b32 v4, v2
  s_nop 1
  v_permlane16_swap_b32 v2, v4
  v_max_f32 v2, v2, v4
  v_log_f32 v4, v124
  s_nop 0
  v_max_f32 v2, v2, v4
  v_add_f32 v2, 0x42c00000, v2
  v_max_f32 v2, 0, v2
  v_ceil_f32 v2, v2
  v_cvt_i32_f32 v3, -v2
  v_sub_f32 v92, v92, v2
  v_sub_f32 v93, v93, v2
  v_sub_f32 v94, v94, v2
  v_sub_f32 v95, v95, v2
  v_sub_f32 v12, v12, v2
  v_sub_f32 v13, v13, v2
  v_sub_f32 v14, v14, v2
  v_sub_f32 v15, v15, v2
  v_sub_f32 v44, v44, v2
  v_sub_f32 v45, v45, v2
  v_sub_f32 v46, v46, v2
  v_sub_f32 v47, v47, v2
  v_sub_f32 v28, v28, v2
  v_sub_f32 v29, v29, v2
  v_sub_f32 v30, v30, v2
  v_sub_f32 v31, v31, v2
  v_ldexp_f32 v124, v124, v3
  v_ldexp_f32 v125, v125, v3
  v_ldexp_f32 v126, v126, v3
  v_ldexp_f32 v127, v127, v3
  v_accvgpr_read_b32 v136, a4
  v_accvgpr_read_b32 v137, a5
  v_accvgpr_read_b32 v138, a6
  v_accvgpr_read_b32 v139, a7
  v_ldexp_f32 v136, v136, v3
  v_ldexp_f32 v137, v137, v3
  v_ldexp_f32 v138, v138, v3
  v_ldexp_f32 v139, v139, v3
  v_accvgpr_write_b32 a4, v136
  v_accvgpr_write_b32 a5, v137
  v_accvgpr_write_b32 a6, v138
  v_accvgpr_write_b32 a7, v139
  v_accvgpr_read_b32 v136, a20
  v_accvgpr_read_b32 v137, a21
  v_accvgpr_read_b32 v138, a22
  v_accvgpr_read_b32 v139, a23
  v_ldexp_f32 v136, v136, v3
  v_ldexp_f32 v137, v137, v3
  v_ldexp_f32 v138, v138, v3
  v_ldexp_f32 v139, v139, v3
  v_accvgpr_write_b32 a20, v136
  v_accvgpr_write_b32 a21, v137
  v_accvgpr_write_b32 a22, v138
  v_accvgpr_write_b32 a23, v139
  v_accvgpr_read_b32 v136, a36
  v_accvgpr_read_b32 v137, a37
  v_accvgpr_read_b32 v138, a38
  v_accvgpr_read_b32 v139, a39
  v_ldexp_f32 v136, v136, v3
  v_ldexp_f32 v137, v137, v3
  v_ldexp_f32 v138, v138, v3
  v_ldexp_f32 v139, v139, v3
  v_accvgpr_write_b32 a36, v136
  v_accvgpr_write_b32 a37, v137
  v_accvgpr_write_b32 a38, v138
  v_accvgpr_write_b32 a39, v139
  v_accvgpr_read_b32 v136, a52
  v_accvgpr_read_b32 v137, a53
  v_accvgpr_read_b32 v138, a54
  v_accvgpr_read_b32 v139, a55
  v_ldexp_f32 v136, v136, v3
  v_ldexp_f32 v137, v137, v3
  v_ldexp_f32 v138, v138, v3
  v_ldexp_f32 v139, v139, v3
  v_accvgpr_write_b32 a52, v136
  v_accvgpr_write_b32 a53, v137
  v_accvgpr_write_b32 a54, v138
  v_accvgpr_write_b32 a55, v139
  v_accvgpr_read_b32 v136, a68
  v_accvgpr_read_b32 v137, a69
  v_accvgpr_read_b32 v138, a70
  v_accvgpr_read_b32 v139, a71
  v_ldexp_f32 v136, v136, v3
  v_ldexp_f32 v137, v137, v3
  v_ldexp_f32 v138, v138, v3
  v_ldexp_f32 v139, v139, v3
  v_accvgpr_write_b32 a68, v136
  v_accvgpr_write_b32 a69, v137
  v_accvgpr_write_b32 a70, v138
  v_accvgpr_write_b32 a71, v139
  v_accvgpr_read_b32 v136, a84
  v_accvgpr_read_b32 v137, a85
  v_accvgpr_read_b32 v138, a86
  v_accvgpr_read_b32 v139, a87
  v_ldexp_f32 v136, v136, v3
  v_ldexp_f32 v137, v137, v3
  v_ldexp_f32 v138, v138, v3
  v_ldexp_f32 v139, v139, v3
  v_accvgpr_write_b32 a84, v136
  v_accvgpr_write_b32 a85, v137
  v_accvgpr_write_b32 a86, v138
  v_accvgpr_write_b32 a87, v139
  v_accvgpr_read_b32 v136, a100
  v_accvgpr_read_b32 v137, a101
  v_accvgpr_read_b32 v138, a102
  v_accvgpr_read_b32 v139, a103
  v_ldexp_f32 v136, v136, v3
  v_ldexp_f32 v137, v137, v3
  v_ldexp_f32 v138, v138, v3
  v_ldexp_f32 v139, v139, v3
  v_accvgpr_write_b32 a100, v136
  v_accvgpr_write_b32 a101, v137
  v_accvgpr_write_b32 a102, v138
  v_accvgpr_write_b32 a103, v139
  v_accvgpr_read_b32 v136, a116
  v_accvgpr_read_b32 v137, a117
  v_accvgpr_read_b32 v138, a118
  v_accvgpr_read_b32 v139, a119
  v_ldexp_f32 v136, v136, v3
  v_ldexp_f32 v137, v137, v3
  v_ldexp_f32 v138, v138, v3
  v_ldexp_f32 v139, v139, v3
  v_accvgpr_write_b32 a116, v136
  v_accvgpr_write_b32 a117, v137
  v_accvgpr_write_b32 a118, v138
  v_accvgpr_write_b32 a119, v139
  v_max3_f32 v2, v16, v17, v18
  v_max3_f32 v2, v2, v19, v48
  v_max3_f32 v2, v2, v49, v50
  v_max_f32 v2, v2, v51
  v_mov_b32 v4, v2
  s_nop 1
  v_permlane32_swap_b32 v2, v4
  v_max_f32 v2, v2, v4
  v_mov_b32 v4, v2
  s_nop 1
  v_permlane16_swap_b32 v2, v4
  v_max_f32 v2, v2, v4
  v_log_f32 v4, v128
  s_nop 0
  v_max_f32 v2, v2, v4
  v_add_f32 v2, 0x42c00000, v2
  v_max_f32 v2, 0, v2
  v_ceil_f32 v2, v2
  v_cvt_i32_f32 v3, -v2
  v_sub_f32 v96, v96, v2
  v_sub_f32 v97, v97, v2
  v_sub_f32 v98, v98, v2
  v_sub_f32 v99, v99, v2
  v_sub_f32 v16, v16, v2
  v_sub_f32 v17, v17, v2
  v_sub_f32 v18, v18, v2
  v_sub_f32 v19, v19, v2
  v_sub_f32 v48, v48, v2
  v_sub_f32 v49, v49, v2
  v_sub_f32 v50, v50, v2
  v_sub_f32 v51, v51, v2
  v_sub_f32 v32, v32, v2
  v_sub_f32 v33, v33, v2
  v_sub_f32 v34, v34, v2
  v_sub_f32 v35, v35, v2
  v_ldexp_f32 v128, v128, v3
  v_ldexp_f32 v129, v129, v3
  v_ldexp_f32 v130, v130, v3
  v_ldexp_f32 v131, v131, v3
  v_accvgpr_read_b32 v136, a8
  v_accvgpr_read_b32 v137, a9
  v_accvgpr_read_b32 v138, a10
  v_accvgpr_read_b32 v139, a11
  v_ldexp_f32 v136, v136, v3
  v_ldexp_f32 v137, v137, v3
  v_ldexp_f32 v138, v138, v3
  v_ldexp_f32 v139, v139, v3
  v_accvgpr_write_b32 a8, v136
  v_accvgpr_write_b32 a9, v137
  v_accvgpr_write_b32 a10, v138
  v_accvgpr_write_b32 a11, v139
  v_accvgpr_read_b32 v136, a24
  v_accvgpr_read_b32 v137, a25
  v_accvgpr_read_b32 v138, a26
  v_accvgpr_read_b32 v139, a27
  v_ldexp_f32 v136, v136, v3
  v_ldexp_f32 v137, v137, v3
  v_ldexp_f32 v138, v138, v3
  v_ldexp_f32 v139, v139, v3
  v_accvgpr_write_b32 a24, v136
  v_accvgpr_write_b32 a25, v137
  v_accvgpr_write_b32 a26, v138
  v_accvgpr_write_b32 a27, v139
  v_accvgpr_read_b32 v136, a40
  v_accvgpr_read_b32 v137, a41
  v_accvgpr_read_b32 v138, a42
  v_accvgpr_read_b32 v139, a43
  v_ldexp_f32 v136, v136, v3
  v_ldexp_f32 v137, v137, v3
  v_ldexp_f32 v138, v138, v3
  v_ldexp_f32 v139, v139, v3
  v_accvgpr_write_b32 a40, v136
  v_accvgpr_write_b32 a41, v137
  v_accvgpr_write_b32 a42, v138
  v_accvgpr_write_b32 a43, v139
  v_accvgpr_read_b32 v136, a56
  v_accvgpr_read_b32 v137, a57
  v_accvgpr_read_b32 v138, a58
  v_accvgpr_read_b32 v139, a59
  v_ldexp_f32 v136, v136, v3
  v_ldexp_f32 v137, v137, v3
  v_ldexp_f32 v138, v138, v3
  v_ldexp_f32 v139, v139, v3
  v_accvgpr_write_b32 a56, v136
  v_accvgpr_write_b32 a57, v137
  v_accvgpr_write_b32 a58, v138
  v_accvgpr_write_b32 a59, v139
  v_accvgpr_read_b32 v136, a72
  v_accvgpr_read_b32 v137, a73
  v_accvgpr_read_b32 v138, a74
  v_accvgpr_read_b32 v139, a75
  v_ldexp_f32 v136, v136, v3
  v_ldexp_f32 v137, v137, v3
  v_ldexp_f32 v138, v138, v3
  v_ldexp_f32 v139, v139, v3
  v_accvgpr_write_b32 a72, v136
  v_accvgpr_write_b32 a73, v137
  v_accvgpr_write_b32 a74, v138
  v_accvgpr_write_b32 a75, v139
  v_accvgpr_read_b32 v136, a88
  v_accvgpr_read_b32 v137, a89
  v_accvgpr_read_b32 v138, a90
  v_accvgpr_read_b32 v139, a91
  v_ldexp_f32 v136, v136, v3
  v_ldexp_f32 v137, v137, v3
  v_ldexp_f32 v138, v138, v3
  v_ldexp_f32 v139, v139, v3
  v_accvgpr_write_b32 a88, v136
  v_accvgpr_write_b32 a89, v137
  v_accvgpr_write_b32 a90, v138
  v_accvgpr_write_b32 a91, v139
  v_accvgpr_read_b32 v136, a104
  v_accvgpr_read_b32 v137, a105
  v_accvgpr_read_b32 v138, a106
  v_accvgpr_read_b32 v139, a107
  v_ldexp_f32 v136, v136, v3
  v_ldexp_f32 v137, v137, v3
  v_ldexp_f32 v138, v138, v3
  v_ldexp_f32 v139, v139, v3
  v_accvgpr_write_b32 a104, v136
  v_accvgpr_write_b32 a105, v137
  v_accvgpr_write_b32 a106, v138
  v_accvgpr_write_b32 a107, v139
  v_accvgpr_read_b32 v136, a120
  v_accvgpr_read_b32 v137, a121
  v_accvgpr_read_b32 v138, a122
  v_accvgpr_read_b32 v139, a123
  v_ldexp_f32 v136, v136, v3
  v_ldexp_f32 v137, v137, v3
  v_ldexp_f32 v138, v138, v3
  v_ldexp_f32 v139, v139, v3
  v_accvgpr_write_b32 a120, v136
  v_accvgpr_write_b32 a121, v137
  v_accvgpr_write_b32 a122, v138
  v_accvgpr_write_b32 a123, v139
  v_max3_f32 v2, v20, v21, v22
  v_max3_f32 v2, v2, v23, v52
  v_max3_f32 v2, v2, v53, v54
  v_max_f32 v2, v2, v55
  v_mov_b32 v4, v2
  s_nop 1
  v_permlane32_swap_b32 v2, v4
  v_max_f32 v2, v2, v4
  v_mov_b32 v4, v2
  s_nop 1
  v_permlane16_swap_b32 v2, v4
  v_max_f32 v2, v2, v4
  v_log_f32 v4, v132
  s_nop 0
  v_max_f32 v2, v2, v4
  v_add_f32 v2, 0x42c00000, v2
  v_max_f32 v2, 0, v2
  v_ceil_f32 v2, v2
  v_cvt_i32_f32 v3, -v2
  v_sub_f32 v100, v100, v2
  v_sub_f32 v101, v101, v2
  v_sub_f32 v102, v102, v2
  v_sub_f32 v103, v103, v2
  v_sub_f32 v20, v20, v2
  v_sub_f32 v21, v21, v2
  v_sub_f32 v22, v22, v2
  v_sub_f32 v23, v23, v2
  v_sub_f32 v52, v52, v2
  v_sub_f32 v53, v53, v2
  v_sub_f32 v54, v54, v2
  v_sub_f32 v55, v55, v2
  v_sub_f32 v36, v36, v2
  v_sub_f32 v37, v37, v2
  v_sub_f32 v38, v38, v2
  v_sub_f32 v39, v39, v2
  v_ldexp_f32 v132, v132, v3
  v_ldexp_f32 v133, v133, v3
  v_ldexp_f32 v134, v134, v3
  v_ldexp_f32 v135, v135, v3
  v_accvgpr_read_b32 v136, a12
  v_accvgpr_read_b32 v137, a13
  v_accvgpr_read_b32 v138, a14
  v_accvgpr_read_b32 v139, a15
  v_ldexp_f32 v136, v136, v3
  v_ldexp_f32 v137, v137, v3
  v_ldexp_f32 v138, v138, v3
  v_ldexp_f32 v139, v139, v3
  v_accvgpr_write_b32 a12, v136
  v_accvgpr_write_b32 a13, v137
  v_accvgpr_write_b32 a14, v138
  v_accvgpr_write_b32 a15, v139
  v_accvgpr_read_b32 v136, a28
  v_accvgpr_read_b32 v137, a29
  v_accvgpr_read_b32 v138, a30
  v_accvgpr_read_b32 v139, a31
  v_ldexp_f32 v136, v136, v3
  v_ldexp_f32 v137, v137, v3
  v_ldexp_f32 v138, v138, v3
  v_ldexp_f32 v139, v139, v3
  v_accvgpr_write_b32 a28, v136
  v_accvgpr_write_b32 a29, v137
  v_accvgpr_write_b32 a30, v138
  v_accvgpr_write_b32 a31, v139
  v_accvgpr_read_b32 v136, a44
  v_accvgpr_read_b32 v137, a45
  v_accvgpr_read_b32 v138, a46
  v_accvgpr_read_b32 v139, a47
  v_ldexp_f32 v136, v136, v3
  v_ldexp_f32 v137, v137, v3
  v_ldexp_f32 v138, v138, v3
  v_ldexp_f32 v139, v139, v3
  v_accvgpr_write_b32 a44, v136
  v_accvgpr_write_b32 a45, v137
  v_accvgpr_write_b32 a46, v138
  v_accvgpr_write_b32 a47, v139
  v_accvgpr_read_b32 v136, a60
  v_accvgpr_read_b32 v137, a61
  v_accvgpr_read_b32 v138, a62
  v_accvgpr_read_b32 v139, a63
  v_ldexp_f32 v136, v136, v3
  v_ldexp_f32 v137, v137, v3
  v_ldexp_f32 v138, v138, v3
  v_ldexp_f32 v139, v139, v3
  v_accvgpr_write_b32 a60, v136
  v_accvgpr_write_b32 a61, v137
  v_accvgpr_write_b32 a62, v138
  v_accvgpr_write_b32 a63, v139
  v_accvgpr_read_b32 v136, a76
  v_accvgpr_read_b32 v137, a77
  v_accvgpr_read_b32 v138, a78
  v_accvgpr_read_b32 v139, a79
  v_ldexp_f32 v136, v136, v3
  v_ldexp_f32 v137, v137, v3
  v_ldexp_f32 v138, v138, v3
  v_ldexp_f32 v139, v139, v3
  v_accvgpr_write_b32 a76, v136
  v_accvgpr_write_b32 a77, v137
  v_accvgpr_write_b32 a78, v138
  v_accvgpr_write_b32 a79, v139
  v_accvgpr_read_b32 v136, a92
  v_accvgpr_read_b32 v137, a93
  v_accvgpr_read_b32 v138, a94
  v_accvgpr_read_b32 v139, a95
  v_ldexp_f32 v136, v136, v3
  v_ldexp_f32 v137, v137, v3
  v_ldexp_f32 v138, v138, v3
  v_ldexp_f32 v139, v139, v3
  v_accvgpr_write_b32 a92, v136
  v_accvgpr_write_b32 a93, v137
  v_accvgpr_write_b32 a94, v138
  v_accvgpr_write_b32 a95, v139
  v_accvgpr_read_b32 v136, a108
  v_accvgpr_read_b32 v137, a109
  v_accvgpr_read_b32 v138, a110
  v_accvgpr_read_b32 v139, a111
  v_ldexp_f32 v136, v136, v3
  v_ldexp_f32 v137, v137, v3
  v_ldexp_f32 v138, v138, v3
  v_ldexp_f32 v139, v139, v3
  v_accvgpr_write_b32 a108, v136
  v_accvgpr_write_b32 a109, v137
  v_accvgpr_write_b32 a110, v138
  v_accvgpr_write_b32 a111, v139
  v_accvgpr_read_b32 v136, a124
  v_accvgpr_read_b32 v137, a125
  v_accvgpr_read_b32 v138, a126
  v_accvgpr_read_b32 v139, a127
  v_ldexp_f32 v136, v136, v3
  v_ldexp_f32 v137, v137, v3
  v_ldexp_f32 v138, v138, v3
  v_ldexp_f32 v139, v139, v3
  v_accvgpr_write_b32 a124, v136
  v_accvgpr_write_b32 a125, v137
  v_accvgpr_write_b32 a126, v138
  v_accvgpr_write_b32 a127, v139
  v_exp_f32 v136, v8
  v_exp_f32 v137, v9
  s_nop 0
  v_cvt_pk_bf16_f32 v56, v136, v137
  v_exp_f32 v138, v10
  v_exp_f32 v139, v11
  s_nop 0
  v_cvt_pk_bf16_f32 v57, v138, v139
  v_exp_f32 v140, v12
  v_exp_f32 v141, v13
  s_nop 0
  v_cvt_pk_bf16_f32 v60, v140, v141
  v_exp_f32 v142, v14
  v_exp_f32 v143, v15
  s_nop 0
  v_cvt_pk_bf16_f32 v61, v142, v143
  v_exp_f32 v136, v16
  v_exp_f32 v137, v17
  s_nop 0
  v_cvt_pk_bf16_f32 v64, v136, v137
  v_exp_f32 v138, v18
  v_exp_f32 v139, v19
  s_nop 0
  v_cvt_pk_bf16_f32 v65, v138, v139
  v_exp_f32 v140, v20
  v_exp_f32 v141, v21
  s_nop 0
  v_cvt_pk_bf16_f32 v68, v140, v141
  v_exp_f32 v142, v22
  v_exp_f32 v143, v23
  s_nop 0
  v_cvt_pk_bf16_f32 v69, v142, v143
  v_exp_f32 v136, v40
  v_exp_f32 v137, v41
  s_nop 0
  v_cvt_pk_bf16_f32 v58, v136, v137
  v_exp_f32 v138, v42
  v_exp_f32 v139, v43
  s_nop 0
  v_cvt_pk_bf16_f32 v59, v138, v139
  v_exp_f32 v140, v44
  v_exp_f32 v141, v45
  s_nop 0
  v_cvt_pk_bf16_f32 v62, v140, v141
  v_exp_f32 v142, v46
  v_exp_f32 v143, v47
  s_nop 0
  v_cvt_pk_bf16_f32 v63, v142, v143
  v_exp_f32 v136, v48
  v_exp_f32 v137, v49
  s_nop 0
  v_cvt_pk_bf16_f32 v66, v136, v137
  v_exp_f32 v138, v50
  v_exp_f32 v139, v51
  s_nop 0
  v_cvt_pk_bf16_f32 v67, v138, v139
  v_exp_f32 v140, v52
  v_exp_f32 v141, v53
  s_nop 0
  v_cvt_pk_bf16_f32 v70, v140, v141
  v_exp_f32 v142, v54
  v_exp_f32 v143, v55
  s_nop 0
  v_cvt_pk_bf16_f32 v71, v142, v143
  v_mfma_f32_16x16x32_bf16 v[104:107], v[144:147], v[56:59], v[120:123]
  v_mfma_f32_16x16x32_bf16 v[108:111], v[144:147], v[60:63], v[124:127]
  v_mfma_f32_16x16x32_bf16 v[112:115], v[144:147], v[64:67], v[128:131]
  v_mfma_f32_16x16x32_bf16 v[116:119], v[144:147], v[68:71], v[132:135]
  s_nop 7
  s_setpc_b64 s[40:41]
attn_slow1:
  s_nop 15
  s_nop 3
  v_max3_f32 v2, v24, v25, v26
  v_max3_f32 v2, v2, v27, v40
  v_max3_f32 v2, v2, v41, v42
  v_max_f32 v2, v2, v43
  v_mov_b32 v4, v2
  s_nop 1
  v_permlane32_swap_b32 v2, v4
  v_max_f32 v2, v2, v4
  v_mov_b32 v4, v2
  s_nop 1
  v_permlane16_swap_b32 v2, v4
  v_max_f32 v2, v2, v4
  v_log_f32 v4, v104
  s_nop 0
  v_max_f32 v2, v2, v4
  v_add_f32 v2, 0x42c00000, v2
  v_max_f32 v2, 0, v2
  v_ceil_f32 v2, v2
  v_cvt_i32_f32 v3, -v2
  v_sub_f32 v88, v88, v2
  v_sub_f32 v89, v89, v2
  v_sub_f32 v90, v90, v2
  v_sub_f32 v91, v91, v2
  v_sub_f32 v24, v24, v2
  v_sub_f32 v25, v25, v2
  v_sub_f32 v26, v26, v2
  v_sub_f32 v27, v27, v2
  v_sub_f32 v40, v40, v2
  v_sub_f32 v41, v41, v2
  v_sub_f32 v42, v42, v2
  v_sub_f32 v43, v43, v2
  v_sub_f32 v8, v8, v2
  v_sub_f32 v9, v9, v2
  v_sub_f32 v10, v10, v2
  v_sub_f32 v11, v11, v2
  v_ldexp_f32 v104, v104, v3
  v_ldexp_f32 v105, v105, v3
  v_ldexp_f32 v106, v106, v3
  v_ldexp_f32 v107, v107, v3
  v_accvgpr_read_b32 v136, a0
  v_accvgpr_read_b32 v137, a1
  v_accvgpr_read_b32 v138, a2
  v_accvgpr_read_b32 v139, a3
  v_ldexp_f32 v136, v136, v3
  v_ldexp_f32 v137, v137, v3
  v_ldexp_f32 v138, v138, v3
  v_ldexp_f32 v139, v139, v3
  v_accvgpr_write_b32 a0, v136
  v_accvgpr_write_b32 a1, v137
  v_accvgpr_write_b32 a2, v138
  v_accvgpr_write_b32 a3, v139
  v_accvgpr_read_b32 v136, a16
  v_accvgpr_read_b32 v137, a17
  v_accvgpr_read_b32 v138, a18
  v_accvgpr_read_b32 v139, a19
  v_ldexp_f32 v136, v136, v3
  v_ldexp_f32 v137, v137, v3
  v_ldexp_f32 v138, v138, v3
  v_ldexp_f32 v139, v139, v3
  v_accvgpr_write_b32 a16, v136
  v_accvgpr_write_b32 a17, v137
  v_accvgpr_write_b32 a18, v138
  v_accvgpr_write_b32 a19, v139
  v_accvgpr_read_b32 v136, a32
  v_accvgpr_read_b32 v137, a33
  v_accvgpr_read_b32 v138, a34
  v_accvgpr_read_b32 v139, a35
  v_ldexp_f32 v136, v136, v3
  v_ldexp_f32 v137, v137, v3
  v_ldexp_f32 v138, v138, v3
  v_ldexp_f32 v139, v139, v3
  v_accvgpr_write_b32 a32, v136
  v_accvgpr_write_b32 a33, v137
  v_accvgpr_write_b32 a34, v138
  v_accvgpr_write_b32 a35, v139
  v_accvgpr_read_b32 v136, a48
  v_accvgpr_read_b32 v137, a49
  v_accvgpr_read_b32 v138, a50
  v_accvgpr_read_b32 v139, a51
  v_ldexp_f32 v136, v136, v3
  v_ldexp_f32 v137, v137, v3
  v_ldexp_f32 v138, v138, v3
  v_ldexp_f32 v139, v139, v3
  v_accvgpr_write_b32 a48, v136
  v_accvgpr_write_b32 a49, v137
  v_accvgpr_write_b32 a50, v138
  v_accvgpr_write_b32 a51, v139
  v_accvgpr_read_b32 v136, a64
  v_accvgpr_read_b32 v137, a65
  v_accvgpr_read_b32 v138, a66
  v_accvgpr_read_b32 v139, a67
  v_ldexp_f32 v136, v136, v3
  v_ldexp_f32 v137, v137, v3
  v_ldexp_f32 v138, v138, v3
  v_ldexp_f32 v139, v139, v3
  v_accvgpr_write_b32 a64, v136
  v_accvgpr_write_b32 a65, v137
  v_accvgpr_write_b32 a66, v138
  v_accvgpr_write_b32 a67, v139
  v_accvgpr_read_b32 v136, a80
  v_accvgpr_read_b32 v137, a81
  v_accvgpr_read_b32 v138, a82
  v_accvgpr_read_b32 v139, a83
  v_ldexp_f32 v136, v136, v3
  v_ldexp_f32 v137, v137, v3
  v_ldexp_f32 v138, v138, v3
  v_ldexp_f32 v139, v139, v3
  v_accvgpr_write_b32 a80, v136
  v_accvgpr_write_b32 a81, v137
  v_accvgpr_write_b32 a82, v138
  v_accvgpr_write_b32 a83, v139
  v_accvgpr_read_b32 v136, a96
  v_accvgpr_read_b32 v137, a97
  v_accvgpr_read_b32 v138, a98
  v_accvgpr_read_b32 v139, a99
  v_ldexp_f32 v136, v136, v3
  v_ldexp_f32 v137, v137, v3
  v_ldexp_f32 v138, v138, v3
  v_ldexp_f32 v139, v139, v3
  v_accvgpr_write_b32 a96, v136
  v_accvgpr_write_b32 a97, v137
  v_accvgpr_write_b32 a98, v138
  v_accvgpr_write_b32 a99, v139
  v_accvgpr_read_b32 v136, a112
  v_accvgpr_read_b32 v137, a113
  v_accvgpr_read_b32 v138, a114
  v_accvgpr_read_b32 v139, a115
  v_ldexp_f32 v136, v136, v3
  v_ldexp_f32 v137, v137, v3
  v_ldexp_f32 v138, v138, v3
  v_ldexp_f32 v139, v139, v3
  v_accvgpr_write_b32 a112, v136
  v_accvgpr_write_b32 a113, v137
  v_accvgpr_write_b32 a114, v138
  v_accvgpr_write_b32 a115, v139
  v_max3_f32 v2, v28, v29, v30
  v_max3_f32 v2, v2, v31, v44
  v_max3_f32 v2, v2, v45, v46
  v_max_f32 v2, v2, v47
  v_mov_b32 v4, v2
  s_nop 1
  v_permlane32_swap_b32 v2, v4
  v_max_f32 v2, v2, v4
  v_mov_b32 v4, v2
  s_nop 1
  v_permlane16_swap_b32 v2, v4
  v_max_f32 v2, v2, v4
  v_log_f32 v4, v108
  s_nop 0
  v_max_f32 v2, v2, v4
  v_add_f32 v2, 0x42c00000, v2
  v_max_f32 v2, 0, v2
  v_ceil_f32 v2, v2
  v_cvt_i32_f32 v3, -v2
  v_sub_f32 v92, v92, v2
  v_sub_f32 v93, v93, v2
  v_sub_f32 v94, v94, v2
  v_sub_f32 v95, v95, v2
  v_sub_f32 v28, v28, v2
  v_sub_f32 v29, v29, v2
  v_sub_f32 v30, v30, v2
  v_sub_f32 v31, v31, v2
  v_sub_f32 v44, v44, v2
  v_sub_f32 v45, v45, v2
  v_sub_f32 v46, v46, v2
  v_sub_f32 v47, v47, v2
  v_sub_f32 v12, v12, v2
  v_sub_f32 v13, v13, v2
  v_sub_f32 v14, v14, v2
  v_sub_f32 v15, v15, v2
  v_ldexp_f32 v108, v108, v3
  v_ldexp_f32 v109, v109, v3
  v_ldexp_f32 v110, v110, v3
  v_ldexp_f32 v111, v111, v3
  v_accvgpr_read_b32 v136, a4
  v_accvgpr_read_b32 v137, a5
  v_accvgpr_read_b32 v138, a6
  v_accvgpr_read_b32 v139, a7
  v_ldexp_f32 v136, v136, v3
  v_ldexp_f32 v137, v137, v3
  v_ldexp_f32 v138, v138, v3
  v_ldexp_f32 v139, v139, v3
  v_accvgpr_write_b32 a4, v136
  v_accvgpr_write_b32 a5, v137
  v_accvgpr_write_b32 a6, v138
  v_accvgpr_write_b32 a7, v139
  v_accvgpr_read_b32 v136, a20
  v_accvgpr_read_b32 v137, a21
  v_accvgpr_read_b32 v138, a22
  v_accvgpr_read_b32 v139, a23
  v_ldexp_f32 v136, v136, v3
  v_ldexp_f32 v137, v137, v3
  v_ldexp_f32 v138, v138, v3
  v_ldexp_f32 v139, v139, v3
  v_accvgpr_write_b32 a20, v136
  v_accvgpr_write_b32 a21, v137
  v_accvgpr_write_b32 a22, v138
  v_accvgpr_write_b32 a23, v139
  v_accvgpr_read_b32 v136, a36
  v_accvgpr_read_b32 v137, a37
  v_accvgpr_read_b32 v138, a38
  v_accvgpr_read_b32 v139, a39
  v_ldexp_f32 v136, v136, v3
  v_ldexp_f32 v137, v137, v3
  v_ldexp_f32 v138, v138, v3
  v_ldexp_f32 v139, v139, v3
  v_accvgpr_write_b32 a36, v136
  v_accvgpr_write_b32 a37, v137
  v_accvgpr_write_b32 a38, v138
  v_accvgpr_write_b32 a39, v139
  v_accvgpr_read_b32 v136, a52
  v_accvgpr_read_b32 v137, a53
  v_accvgpr_read_b32 v138, a54
  v_accvgpr_read_b32 v139, a55
  v_ldexp_f32 v136, v136, v3
  v_ldexp_f32 v137, v137, v3
  v_ldexp_f32 v138, v138, v3
  v_ldexp_f32 v139, v139, v3
  v_accvgpr_write_b32 a52, v136
  v_accvgpr_write_b32 a53, v137
  v_accvgpr_write_b32 a54, v138
  v_accvgpr_write_b32 a55, v139
  v_accvgpr_read_b32 v136, a68
  v_accvgpr_read_b32 v137, a69
  v_accvgpr_read_b32 v138, a70
  v_accvgpr_read_b32 v139, a71
  v_ldexp_f32 v136, v136, v3
  v_ldexp_f32 v137, v137, v3
  v_ldexp_f32 v138, v138, v3
  v_ldexp_f32 v139, v139, v3
  v_accvgpr_write_b32 a68, v136
  v_accvgpr_write_b32 a69, v137
  v_accvgpr_write_b32 a70, v138
  v_accvgpr_write_b32 a71, v139
  v_accvgpr_read_b32 v136, a84
  v_accvgpr_read_b32 v137, a85
  v_accvgpr_read_b32 v138, a86
  v_accvgpr_read_b32 v139, a87
  v_ldexp_f32 v136, v136, v3
  v_ldexp_f32 v137, v137, v3
  v_ldexp_f32 v138, v138, v3
  v_ldexp_f32 v139, v139, v3
  v_accvgpr_write_b32 a84, v136
  v_accvgpr_write_b32 a85, v137
  v_accvgpr_write_b32 a86, v138
  v_accvgpr_write_b32 a87, v139
  v_accvgpr_read_b32 v136, a100
  v_accvgpr_read_b32 v137, a101
  v_accvgpr_read_b32 v138, a102
  v_accvgpr_read_b32 v139, a103
  v_ldexp_f32 v136, v136, v3
  v_ldexp_f32 v137, v137, v3
  v_ldexp_f32 v138, v138, v3
  v_ldexp_f32 v139, v139, v3
  v_accvgpr_write_b32 a100, v136
  v_accvgpr_write_b32 a101, v137
  v_accvgpr_write_b32 a102, v138
  v_accvgpr_write_b32 a103, v139
  v_accvgpr_read_b32 v136, a116
  v_accvgpr_read_b32 v137, a117
  v_accvgpr_read_b32 v138, a118
  v_accvgpr_read_b32 v139, a119
  v_ldexp_f32 v136, v136, v3
  v_ldexp_f32 v137, v137, v3
  v_ldexp_f32 v138, v138, v3
  v_ldexp_f32 v139, v139, v3
  v_accvgpr_write_b32 a116, v136
  v_accvgpr_write_b32 a117, v137
  v_accvgpr_write_b32 a118, v138
  v_accvgpr_write_b32 a119, v139
  v_max3_f32 v2, v32, v33, v34
  v_max3_f32 v2, v2, v35, v48
  v_max3_f32 v2, v2, v49, v50
  v_max_f32 v2, v2, v51
  v_mov_b32 v4, v2
  s_nop 1
  v_permlane32_swap_b32 v2, v4
  v_max_f32 v2, v2, v4
  v_mov_b32 v4, v2
  s_nop 1
  v_permlane16_swap_b32 v2, v4
  v_max_f32 v2, v2, v4
  v_log_f32 v4, v112
  s_nop 0
  v_max_f32 v2, v2, v4
  v_add_f32 v2, 0x42c00000, v2
  v_max_f32 v2, 0, v2
  v_ceil_f32 v2, v2
  v_cvt_i32_f32 v3, -v2
  v_sub_f32 v96, v96, v2
  v_sub_f32 v97, v97, v2
  v_sub_f32 v98, v98, v2
  v_sub_f32 v99, v99, v2
  v_sub_f32 v32, v32, v2
  v_sub_f32 v33, v33, v2
  v_sub_f32 v34, v34, v2
  v_sub_f32 v35, v35, v2
  v_sub_f32 v48, v48, v2
  v_sub_f32 v49, v49, v2
  v_sub_f32 v50, v50, v2
  v_sub_f32 v51, v51, v2
  v_sub_f32 v16, v16, v2
  v_sub_f32 v17, v17, v2
  v_sub_f32 v18, v18, v2
  v_sub_f32 v19, v19, v2
  v_ldexp_f32 v112, v112, v3
  v_ldexp_f32 v113, v113, v3
  v_ldexp_f32 v114, v114, v3
  v_ldexp_f32 v115, v115, v3
  v_accvgpr_read_b32 v136, a8
  v_accvgpr_read_b32 v137, a9
  v_accvgpr_read_b32 v138, a10
  v_accvgpr_read_b32 v139, a11
  v_ldexp_f32 v136, v136, v3
  v_ldexp_f32 v137, v137, v3
  v_ldexp_f32 v138, v138, v3
  v_ldexp_f32 v139, v139, v3
  v_accvgpr_write_b32 a8, v136
  v_accvgpr_write_b32 a9, v137
  v_accvgpr_write_b32 a10, v138
  v_accvgpr_write_b32 a11, v139
  v_accvgpr_read_b32 v136, a24
  v_accvgpr_read_b32 v137, a25
  v_accvgpr_read_b32 v138, a26
  v_accvgpr_read_b32 v139, a27
  v_ldexp_f32 v136, v136, v3
  v_ldexp_f32 v137, v137, v3
  v_ldexp_f32 v138, v138, v3
  v_ldexp_f32 v139, v139, v3
  v_accvgpr_write_b32 a24, v136
  v_accvgpr_write_b32 a25, v137
  v_accvgpr_write_b32 a26, v138
  v_accvgpr_write_b32 a27, v139
  v_accvgpr_read_b32 v136, a40
  v_accvgpr_read_b32 v137, a41
  v_accvgpr_read_b32 v138, a42
  v_accvgpr_read_b32 v139, a43
  v_ldexp_f32 v136, v136, v3
  v_ldexp_f32 v137, v137, v3
  v_ldexp_f32 v138, v138, v3
  v_ldexp_f32 v139, v139, v3
  v_accvgpr_write_b32 a40, v136
  v_accvgpr_write_b32 a41, v137
  v_accvgpr_write_b32 a42, v138
  v_accvgpr_write_b32 a43, v139
  v_accvgpr_read_b32 v136, a56
  v_accvgpr_read_b32 v137, a57
  v_accvgpr_read_b32 v138, a58
  v_accvgpr_read_b32 v139, a59
  v_ldexp_f32 v136, v136, v3
  v_ldexp_f32 v137, v137, v3
  v_ldexp_f32 v138, v138, v3
  v_ldexp_f32 v139, v139, v3
  v_accvgpr_write_b32 a56, v136
  v_accvgpr_write_b32 a57, v137
  v_accvgpr_write_b32 a58, v138
  v_accvgpr_write_b32 a59, v139
  v_accvgpr_read_b32 v136, a72
  v_accvgpr_read_b32 v137, a73
  v_accvgpr_read_b32 v138, a74
  v_accvgpr_read_b32 v139, a75
  v_ldexp_f32 v136, v136, v3
  v_ldexp_f32 v137, v137, v3
  v_ldexp_f32 v138, v138, v3
  v_ldexp_f32 v139, v139, v3
  v_accvgpr_write_b32 a72, v136
  v_accvgpr_write_b32 a73, v137
  v_accvgpr_write_b32 a74, v138
  v_accvgpr_write_b32 a75, v139
  v_accvgpr_read_b32 v136, a88
  v_accvgpr_read_b32 v137, a89
  v_accvgpr_read_b32 v138, a90
  v_accvgpr_read_b32 v139, a91
  v_ldexp_f32 v136, v136, v3
  v_ldexp_f32 v137, v137, v3
  v_ldexp_f32 v138, v138, v3
  v_ldexp_f32 v139, v139, v3
  v_accvgpr_write_b32 a88, v136
  v_accvgpr_write_b32 a89, v137
  v_accvgpr_write_b32 a90, v138
  v_accvgpr_write_b32 a91, v139
  v_accvgpr_read_b32 v136, a104
  v_accvgpr_read_b32 v137, a105
  v_accvgpr_read_b32 v138, a106
  v_accvgpr_read_b32 v139, a107
  v_ldexp_f32 v136, v136, v3
  v_ldexp_f32 v137, v137, v3
  v_ldexp_f32 v138, v138, v3
  v_ldexp_f32 v139, v139, v3
  v_accvgpr_write_b32 a104, v136
  v_accvgpr_write_b32 a105, v137
  v_accvgpr_write_b32 a106, v138
  v_accvgpr_write_b32 a107, v139
  v_accvgpr_read_b32 v136, a120
  v_accvgpr_read_b32 v137, a121
  v_accvgpr_read_b32 v138, a122
  v_accvgpr_read_b32 v139, a123
  v_ldexp_f32 v136, v136, v3
  v_ldexp_f32 v137, v137, v3
  v_ldexp_f32 v138, v138, v3
  v_ldexp_f32 v139, v139, v3
  v_accvgpr_write_b32 a120, v136
  v_accvgpr_write_b32 a121, v137
  v_accvgpr_write_b32 a122, v138
  v_accvgpr_write_b32 a123, v139
  v_max3_f32 v2, v36, v37, v38
  v_max3_f32 v2, v2, v39, v52
  v_max3_f32 v2, v2, v53, v54
  v_max_f32 v2, v2, v55
  v_mov_b32 v4, v2
  s_nop 1
  v_permlane32_swap_b32 v2, v4
  v_max_f32 v2, v2, v4
  v_mov_b32 v4, v2
  s_nop 1
  v_permlane16_swap_b32 v2, v4
  v_max_f32 v2, v2, v4
  v_log_f32 v4, v116
  s_nop 0
  v_max_f32 v2, v2, v4
  v_add_f32 v2, 0x42c00000, v2
  v_max_f32 v2, 0, v2
  v_ceil_f32 v2, v2
  v_cvt_i32_f32 v3, -v2
  v_sub_f32 v100, v100, v2
  v_sub_f32 v101, v101, v2
  v_sub_f32 v102, v102, v2
  v_sub_f32 v103, v103, v2
  v_sub_f32 v36, v36, v2
  v_sub_f32 v37, v37, v2
  v_sub_f32 v38, v38, v2
  v_sub_f32 v39, v39, v2
  v_sub_f32 v52, v52, v2
  v_sub_f32 v53, v53, v2
  v_sub_f32 v54, v54, v2
  v_sub_f32 v55, v55, v2
  v_sub_f32 v20, v20, v2
  v_sub_f32 v21, v21, v2
  v_sub_f32 v22, v22, v2
  v_sub_f32 v23, v23, v2
  v_ldexp_f32 v116, v116, v3
  v_ldexp_f32 v117, v117, v3
  v_ldexp_f32 v118, v118, v3
  v_ldexp_f32 v119, v119, v3
  v_accvgpr_read_b32 v136, a12
  v_accvgpr_read_b32 v137, a13
  v_accvgpr_read_b32 v138, a14
  v_accvgpr_read_b32 v139, a15
  v_ldexp_f32 v136, v136, v3
  v_ldexp_f32 v137, v137, v3
  v_ldexp_f32 v138, v138, v3
  v_ldexp_f32 v139, v139, v3
  v_accvgpr_write_b32 a12, v136
  v_accvgpr_write_b32 a13, v137
  v_accvgpr_write_b32 a14, v138
  v_accvgpr_write_b32 a15, v139
  v_accvgpr_read_b32 v136, a28
  v_accvgpr_read_b32 v137, a29
  v_accvgpr_read_b32 v138, a30
  v_accvgpr_read_b32 v139, a31
  v_ldexp_f32 v136, v136, v3
  v_ldexp_f32 v137, v137, v3
  v_ldexp_f32 v138, v138, v3
  v_ldexp_f32 v139, v139, v3
  v_accvgpr_write_b32 a28, v136
  v_accvgpr_write_b32 a29, v137
  v_accvgpr_write_b32 a30, v138
  v_accvgpr_write_b32 a31, v139
  v_accvgpr_read_b32 v136, a44
  v_accvgpr_read_b32 v137, a45
  v_accvgpr_read_b32 v138, a46
  v_accvgpr_read_b32 v139, a47
  v_ldexp_f32 v136, v136, v3
  v_ldexp_f32 v137, v137, v3
  v_ldexp_f32 v138, v138, v3
  v_ldexp_f32 v139, v139, v3
  v_accvgpr_write_b32 a44, v136
  v_accvgpr_write_b32 a45, v137
  v_accvgpr_write_b32 a46, v138
  v_accvgpr_write_b32 a47, v139
  v_accvgpr_read_b32 v136, a60
  v_accvgpr_read_b32 v137, a61
  v_accvgpr_read_b32 v138, a62
  v_accvgpr_read_b32 v139, a63
  v_ldexp_f32 v136, v136, v3
  v_ldexp_f32 v137, v137, v3
  v_ldexp_f32 v138, v138, v3
  v_ldexp_f32 v139, v139, v3
  v_accvgpr_write_b32 a60, v136
  v_accvgpr_write_b32 a61, v137
  v_accvgpr_write_b32 a62, v138
  v_accvgpr_write_b32 a63, v139
  v_accvgpr_read_b32 v136, a76
  v_accvgpr_read_b32 v137, a77
  v_accvgpr_read_b32 v138, a78
  v_accvgpr_read_b32 v139, a79
  v_ldexp_f32 v136, v136, v3
  v_ldexp_f32 v137, v137, v3
  v_ldexp_f32 v138, v138, v3
  v_ldexp_f32 v139, v139, v3
  v_accvgpr_write_b32 a76, v136
  v_accvgpr_write_b32 a77, v137
  v_accvgpr_write_b32 a78, v138
  v_accvgpr_write_b32 a79, v139
  v_accvgpr_read_b32 v136, a92
  v_accvgpr_read_b32 v137, a93
  v_accvgpr_read_b32 v138, a94
  v_accvgpr_read_b32 v139, a95
  v_ldexp_f32 v136, v136, v3
  v_ldexp_f32 v137, v137, v3
  v_ldexp_f32 v138, v138, v3
  v_ldexp_f32 v139, v139, v3
  v_accvgpr_write_b32 a92, v136
  v_accvgpr_write_b32 a93, v137
  v_accvgpr_write_b32 a94, v138
  v_accvgpr_write_b32 a95, v139
  v_accvgpr_read_b32 v136, a108
  v_accvgpr_read_b32 v137, a109
  v_accvgpr_read_b32 v138, a110
  v_accvgpr_read_b32 v139, a111
  v_ldexp_f32 v136, v136, v3
  v_ldexp_f32 v137, v137, v3
  v_ldexp_f32 v138, v138, v3
  v_ldexp_f32 v139, v139, v3
  v_accvgpr_write_b32 a108, v136
  v_accvgpr_write_b32 a109, v137
  v_accvgpr_write_b32 a110, v138
  v_accvgpr_write_b32 a111, v139
  v_accvgpr_read_b32 v136, a124
  v_accvgpr_read_b32 v137, a125
  v_accvgpr_read_b32 v138, a126
  v_accvgpr_read_b32 v139, a127
  v_ldexp_f32 v136, v136, v3
  v_ldexp_f32 v137, v137, v3
  v_ldexp_f32 v138, v138, v3
  v_ldexp_f32 v139, v139, v3
  v_accvgpr_write_b32 a124, v136
  v_accvgpr_write_b32 a125, v137
  v_accvgpr_write_b32 a126, v138
  v_accvgpr_write_b32 a127, v139
  v_exp_f32 v136, v24
  v_exp_f32 v137, v25
  s_nop 0
  v_cvt_pk_bf16_f32 v72, v136, v137
  v_exp_f32 v138, v26
  v_exp_f32 v139, v27
  s_nop 0
  v_cvt_pk_bf16_f32 v73, v138, v139
  v_exp_f32 v140, v28
  v_exp_f32 v141, v29
  s_nop 0
  v_cvt_pk_bf16_f32 v76, v140, v141
  v_exp_f32 v142, v30
  v_exp_f32 v143, v31
  s_nop 0
  v_cvt_pk_bf16_f32 v77, v142, v143
  v_exp_f32 v136, v32
  v_exp_f32 v137, v33
  s_nop 0
  v_cvt_pk_bf16_f32 v80, v136, v137
  v_exp_f32 v138, v34
  v_exp_f32 v139, v35
  s_nop 0
  v_cvt_pk_bf16_f32 v81, v138, v139
  v_exp_f32 v140, v36
  v_exp_f32 v141, v37
  s_nop 0
  v_cvt_pk_bf16_f32 v84, v140, v141
  v_exp_f32 v142, v38
  v_exp_f32 v143, v39
  s_nop 0
  v_cvt_pk_bf16_f32 v85, v142, v143
  v_exp_f32 v136, v40
  v_exp_f32 v137, v41
  s_nop 0
  v_cvt_pk_bf16_f32 v74, v136, v137
  v_exp_f32 v138, v42
  v_exp_f32 v139, v43
  s_nop 0
  v_cvt_pk_bf16_f32 v75, v138, v139
  v_exp_f32 v140, v44
  v_exp_f32 v141, v45
  s_nop 0
  v_cvt_pk_bf16_f32 v78, v140, v141
  v_exp_f32 v142, v46
  v_exp_f32 v143, v47
  s_nop 0
  v_cvt_pk_bf16_f32 v79, v142, v143
  v_exp_f32 v136, v48
  v_exp_f32 v137, v49
  s_nop 0
  v_cvt_pk_bf16_f32 v82, v136, v137
  v_exp_f32 v138, v50
  v_exp_f32 v139, v51
  s_nop 0
  v_cvt_pk_bf16_f32 v83, v138, v139
  v_exp_f32 v140, v52
  v_exp_f32 v141, v53
  s_nop 0
  v_cvt_pk_bf16_f32 v86, v140, v141
  v_exp_f32 v142, v54
  v_exp_f32 v143, v55
  s_nop 0
  v_cvt_pk_bf16_f32 v87, v142, v143
  v_mfma_f32_16x16x32_bf16 v[120:123], v[144:147], v[72:75], v[104:107]
  v_mfma_f32_16x16x32_bf16 v[124:127], v[144:147], v[76:79], v[108:111]
  v_mfma_f32_16x16x32_bf16 v[128:131], v[144:147], v[80:83], v[112:115]
  v_mfma_f32_16x16x32_bf16 v[132:135], v[144:147], v[84:87], v[116:119]
  s_nop 7
  s_setpc_b64 s[40:41]
attn_kernel_codeend:
.section .rodata,"a"
.p2align 6
.amdhsa_kernel attn_kernel
  .amdhsa_next_free_vgpr 512
  .amdhsa_next_free_sgpr 102
  .amdhsa_accum_offset 256
  .amdhsa_group_segment_fixed_size 0
  .amdhsa_kernarg_size 112
  .amdhsa_user_sgpr_count 2
  .amdhsa_user_sgpr_kernarg_segment_ptr 1
  .amdhsa_system_sgpr_workgroup_id_x 1
.end_amdhsa_kernel
.text
.globl wo_kernel
.p2align 8
.type wo_kernel,@function
wo_kernel:
  s_cmp_ge_u32 s2, 0x100
  s_cbranch_scc1 tail_end
  s_load_dwordx2 s[4:5], s[0:1], 104
  s_load_dwordx2 s[80:81], s[0:1], 48
  s_load_dwordx2 s[82:83], s[0:1], 56
  s_load_dwordx2 s[84:85], s[0:1], 64
  s_load_dwordx2 s[6:7], s[0:1], 32
  s_load_dwordx2 s[44:45], s[0:1], 0
  s_load_dwordx2 s[46:47], s[0:1], 88
  s_mov_b32 s100, 1
  v_lshrrev_b32 v1, 6, v0
  s_nop 0
  v_readfirstlane_b32 s101, v1
  s_waitcnt lgkmcnt(0)
  s_getpc_b64 s[72:73]
tail_pc1:
  s_add_u32 s72, s72, rd1_code-tail_pc1
  s_addc_u32 s73, s73, 0
  s_mov_b32 s74, glu_kernel_codeend-rd1_code
  s_mov_b32 s75, 0x20000
  s_bfe_u32 s63, s2, 0x20001
  s_bfe_u32 s62, s2, 0x20003
  s_mul_i32 s60, s101, 0x2400
  s_mul_i32 s61, s63, 0x120000
  s_mul_i32 s34, s101, 0x9000
  s_add_u32 s61, s61, s34
  s_mul_i32 s34, s62, 0x120
  s_add_u32 s61, s61, s34
  s_mov_b32 s34, 0xe38e38f
  v_and_b32 v251, 63, v0
  v_add_u32 v249, 0, v251
  v_mul_hi_u32 v250, v249, s34
  v_mul_u32_u24 v250, 0x360, v250
  v_lshl_add_u32 v250, v249, 4, v250
  v_subrev_u32 v240, 0, v250
  v_add_u32 v249, 64, v251
  v_mul_hi_u32 v250, v249, s34
  v_mul_u32_u24 v250, 0x360, v250
  v_lshl_add_u32 v250, v249, 4, v250
  v_subrev_u32 v241, 0x400, v250
  v_add_u32 v249, 0x80, v251
  v_mul_hi_u32 v250, v249, s34
  v_mul_u32_u24 v250, 0x360, v250
  v_lshl_add_u32 v250, v249, 4, v250
  v_subrev_u32 v242, 0x800, v250
  v_add_u32 v249, 0xc0, v251
  v_mul_hi_u32 v250, v249, s34
  v_mul_u32_u24 v250, 0x360, v250
  v_lshl_add_u32 v250, v249, 4, v250
  v_subrev_u32 v243, 0xc00, v250
  v_add_u32 v249, 0x100, v251
  v_mul_hi_u32 v250, v249, s34
  v_mul_u32_u24 v250, 0x360, v250
  v_lshl_add_u32 v250, v249, 4, v250
  v_subrev_u32 v244, 0, v250
  v_add_u32 v249, 0x140, v251
  v_mul_hi_u32 v250, v249, s34
  v_mul_u32_u24 v250, 0x360, v250
  v_lshl_add_u32 v250, v249, 4, v250
  v_subrev_u32 v245, 0x400, v250
  v_add_u32 v249, 0x180, v251
  v_mul_hi_u32 v250, v249, s34
  v_mul_u32_u24 v250, 0x360, v250
  v_lshl_add_u32 v250, v249, 4, v250
  v_subrev_u32 v246, 0x800, v250
  v_add_u32 v249, 0x1c0, v251
  v_mul_hi_u32 v250, v249, s34
  v_mul_u32_u24 v250, 0x360, v250
  v_lshl_add_u32 v250, v249, 4, v250
  v_subrev_u32 v247, 0xc00, v250
  v_add_u32 v249, 0x200, v251
  v_mul_hi_u32 v250, v249, s34
  v_mul_u32_u24 v250, 0x360, v250
  v_lshl_add_u32 v250, v249, 4, v250
  v_subrev_u32 v248, 0, v250
  s_mov_b32 s56, s6
  s_mov_b32 s57, s7
  s_mov_b32 s58, 0x480000
  s_mov_b32 s59, 0x20000
  v_and_b32 v1, 63, v0
  s_and_b32 s39, s2, 1
  s_lshl_b32 s39, s39, 3
  s_lshr_b32 s34, s2, 5
  s_add_u32 s39, s39, s34
  s_lshl_b32 s33, s39, 3
  s_lshl_b32 s34, s101, 1
  s_add_u32 s33, s33, s34
  s_and_b32 s36, s62, 1
  s_mul_i32 s30, s63, 0x8000
  s_mul_i32 s34, s33, 0x20000
  v_lshlrev_b32 v6, 4, v1
  v_add_u32 v161, s34, v6
  v_add_u32 v162, 0x20000, v161
  s_add_u32 s8, s4, 0x400000
  s_addc_u32 s9, s5, 0
  s_mov_b32 s10, 0x1000000
  s_mov_b32 s11, 0x20000
  s_add_u32 s20, s4, 0x40000
  s_addc_u32 s21, s5, 0
  s_mov_b32 s22, 0x30000
  s_mov_b32 s23, 0x20000
  s_add_u32 m0, s60, 0
  s_nop 0
  buffer_load_dwordx4 v240, s[56:59], s61 offen lds
  buffer_load_dwordx4 v241, s[56:59], s61 offen offset:1024 lds
  buffer_load_dwordx4 v242, s[56:59], s61 offen offset:2048 lds
  buffer_load_dwordx4 v243, s[56:59], s61 offen offset:3072 lds
  s_add_u32 m0, s60, 0x1000
  s_nop 0
  buffer_load_dwordx4 v244, s[56:59], s61 offen lds
  buffer_load_dwordx4 v245, s[56:59], s61 offen offset:1024 lds
  buffer_load_dwordx4 v246, s[56:59], s61 offen offset:2048 lds
  buffer_load_dwordx4 v247, s[56:59], s61 offen offset:3072 lds
  s_add_u32 m0, s60, 0x2000
  s_nop 0
  buffer_load_dwordx4 v248, s[56:59], s61 offen lds
  s_add_u32 s61, s61, 0x24000
  buffer_load_dwordx4 a[48:51], v161, s[8:11], s30 offen
  buffer_load_dwordx4 a[52:55], v162, s[8:11], s30 offen
  buffer_load_dwordx4 a[56:59], v161, s[8:11], s30 offen offset:1024
  buffer_load_dwordx4 a[60:63], v162, s[8:11], s30 offen offset:1024
  buffer_load_dwordx4 a[64:67], v161, s[8:11], s30 offen offset:2048
  buffer_load_dwordx4 a[68:71], v162, s[8:11], s30 offen offset:2048
  buffer_load_dwordx4 a[72:75], v161, s[8:11], s30 offen offset:3072
  buffer_load_dwordx4 a[76:79], v162, s[8:11], s30 offen offset:3072
  s_add_u32 s30, s30, 0x1000
  s_add_u32 m0, s60, 0x9000
  s_nop 0
  buffer_load_dwordx4 v240, s[56:59], s61 offen lds
  buffer_load_dwordx4 v241, s[56:59], s61 offen offset:1024 lds
  buffer_load_dwordx4 v242, s[56:59], s61 offen offset:2048 lds
  buffer_load_dwordx4 v243, s[56:59], s61 offen offset:3072 lds
  s_add_u32 m0, s60, 0xa000
  s_nop 0
  buffer_load_dwordx4 v244, s[56:59], s61 offen lds
  buffer_load_dwordx4 v245, s[56:59], s61 offen offset:1024 lds
  buffer_load_dwordx4 v246, s[56:59], s61 offen offset:2048 lds
  buffer_load_dwordx4 v247, s[56:59], s61 offen offset:3072 lds
  s_add_u32 m0, s60, 0xb000
  s_nop 0
  buffer_load_dwordx4 v248, s[56:59], s61 offen lds
  s_add_u32 s61, s61, 0x24000
  buffer_load_dwordx4 a[80:83], v161, s[8:11], s30 offen
  buffer_load_dwordx4 a[84:87], v162, s[8:11], s30 offen
  buffer_load_dwordx4 a[88:91], v161, s[8:11], s30 offen offset:1024
  buffer_load_dwordx4 a[92:95], v162, s[8:11], s30 offen offset:1024
  buffer_load_dwordx4 a[96:99], v161, s[8:11], s30 offen offset:2048
  buffer_load_dwordx4 a[100:103], v162, s[8:11], s30 offen offset:2048
  buffer_load_dwordx4 a[104:107], v161, s[8:11], s30 offen offset:3072
  buffer_load_dwordx4 a[108:111], v162, s[8:11], s30 offen offset:3072
  s_add_u32 s30, s30, 0x1000
  s_add_u32 s16, s4, 0x3400000
  s_addc_u32 s17, s5, 0
  s_mov_b32 s18, 0x900000
  s_mov_b32 s19, 0x20000
  v_lshrrev_b32 v3, 2, v1
  v_mul_u32_u24 v3, 0x120, v3
  v_and_b32 v4, 3, v1
  v_lshl_add_u32 v3, v4, 3, v3
  s_lshl_b32 s34, s36, 5
  s_xor_b32 s35, s36, 1
  s_lshl_b32 s35, s35, 8
  v_add_u32 v165, s34, v3
  v_add_u32 v166, s35, v3
  v_add_u32 v167, 0x9000, v165
  v_add_u32 v168, 0x9000, v166
  v_add_u32 v169, 0x12000, v165
  v_add_u32 v170, 0x12000, v166
  v_add_u32 v171, 0x1b000, v165
  v_add_u32 v172, 0x1b000, v166
  s_mul_i32 s34, s62, 9
  s_add_u32 s34, s34, 1
  s_lshr_b32 s34, s34, 1
  s_lshl_b32 s34, s34, 10
  s_mul_i32 s35, s33, 0x4800
  s_add_u32 s34, s34, s35
  s_mul_i32 s35, s63, 0x240000
  s_add_u32 s34, s34, s35
  v_add_u32 v173, s34, v6
  s_mul_i32 s35, s36, 0xffffec08
  s_add_u32 s35, s35, 0x1000
  v_add_u32 v174, s35, v173
  s_mov_b32 s48, 0
  s_mov_b32 s49, 0x4800
  s_lshl_b32 s38, s39, 11
  s_lshl_b32 s34, s63, 9
  s_add_u32 s38, s38, s34
  s_lshl_b32 s34, s62, 7
  s_add_u32 s38, s38, s34
  s_add_u32 s38, s38, 0
  s_waitcnt vmcnt(25)
  s_barrier
  ds_read_b64_tr_b16 a[0:1], v166
  ds_read_b64_tr_b16 a[2:3], v166 offset:4608
  ds_read_b64_tr_b16 a[4:5], v165
  ds_read_b64_tr_b16 a[6:7], v165 offset:4608
  ds_read_b64_tr_b16 a[8:9], v165 offset:32
  ds_read_b64_tr_b16 a[10:11], v165 offset:4640
  ds_read_b64_tr_b16 a[12:13], v165 offset:64
  ds_read_b64_tr_b16 a[14:15], v165 offset:4672
  ds_read_b64_tr_b16 a[16:17], v165 offset:96
  ds_read_b64_tr_b16 a[18:19], v165 offset:4704
  ds_read_b64_tr_b16 a[20:21], v165 offset:128
  ds_read_b64_tr_b16 a[22:23], v165 offset:4736
  ds_read_b64_tr_b16 a[24:25], v165 offset:160
  ds_read_b64_tr_b16 a[26:27], v165 offset:4768
  ds_read_b64_tr_b16 a[28:29], v165 offset:192
  ds_read_b64_tr_b16 a[30:31], v165 offset:4800
  s_waitcnt vmcnt(23) lgkmcnt(8)
  v_mfma_f32_16x16x32_bf16 v[8:11], a[0:3], a[48:51], 0
  ds_read_b64_tr_b16 a[32:33], v165 offset:224
  v_mfma_f32_16x16x32_bf16 v[12:15], a[0:3], a[52:55], 0
  ds_read_b64_tr_b16 a[34:35], v165 offset:4832
  v_mfma_f32_16x16x32_bf16 v[16:19], a[4:7], a[48:51], 0
  ds_read_b64_tr_b16 a[36:37], v166 offset:9216
  s_add_u32 m0, s60, 0x12000
  s_nop 0
  buffer_load_dwordx4 v240, s[56:59], s61 offen lds
  v_mfma_f32_16x16x32_bf16 v[20:23], a[4:7], a[52:55], 0
  ds_read_b64_tr_b16 a[38:39], v166 offset:13824
  buffer_load_dwordx4 v241, s[56:59], s61 offen offset:1024 lds
  v_mfma_f32_16x16x32_bf16 v[24:27], a[8:11], a[48:51], 0
  ds_read_b64_tr_b16 a[40:41], v165 offset:9216
  buffer_load_dwordx4 v242, s[56:59], s61 offen offset:2048 lds
  v_mfma_f32_16x16x32_bf16 v[28:31], a[8:11], a[52:55], 0
  ds_read_b64_tr_b16 a[42:43], v165 offset:13824
  v_mfma_f32_16x16x32_bf16 v[32:35], a[12:15], a[48:51], 0
  ds_read_b64_tr_b16 a[44:45], v165 offset:9248
  buffer_load_dwordx4 v243, s[56:59], s61 offen offset:3072 lds
  v_mfma_f32_16x16x32_bf16 v[36:39], a[12:15], a[52:55], 0
  ds_read_b64_tr_b16 a[46:47], v165 offset:13856
  s_add_u32 m0, s60, 0x13000
  s_nop 0
  buffer_load_dwordx4 v244, s[56:59], s61 offen lds
  s_waitcnt lgkmcnt(8)
  v_mfma_f32_16x16x32_bf16 v[40:43], a[16:19], a[48:51], 0
  ds_read_b64_tr_b16 a[0:1], v165 offset:9280
  v_mfma_f32_16x16x32_bf16 v[44:47], a[16:19], a[52:55], 0
  ds_read_b64_tr_b16 a[2:3], v165 offset:13888
  buffer_load_dwordx4 v245, s[56:59], s61 offen offset:1024 lds
  v_mfma_f32_16x16x32_bf16 v[48:51], a[20:23], a[48:51], 0
  ds_read_b64_tr_b16 a[4:5], v165 offset:9312
  buffer_load_dwordx4 v246, s[56:59], s61 offen offset:2048 lds
  v_mfma_f32_16x16x32_bf16 v[52:55], a[20:23], a[52:55], 0
  ds_read_b64_tr_b16 a[6:7], v165 offset:13920
  v_mfma_f32_16x16x32_bf16 v[56:59], a[24:27], a[48:51], 0
  ds_read_b64_tr_b16 a[8:9], v165 offset:9344
  buffer_load_dwordx4 v247, s[56:59], s61 offen offset:3072 lds
  v_mfma_f32_16x16x32_bf16 v[60:63], a[24:27], a[52:55], 0
  ds_read_b64_tr_b16 a[10:11], v165 offset:13952
  s_add_u32 m0, s60, 0x14000
  s_nop 0
  buffer_load_dwordx4 v248, s[56:59], s61 offen lds
  v_mfma_f32_16x16x32_bf16 v[64:67], a[28:31], a[48:51], 0
  ds_read_b64_tr_b16 a[12:13], v165 offset:9376
  s_add_u32 s61, s61, 0x24000
  v_mfma_f32_16x16x32_bf16 v[68:71], a[28:31], a[52:55], 0
  ds_read_b64_tr_b16 a[14:15], v165 offset:13984
  buffer_load_dwordx4 a[112:115], v161, s[8:11], s30 offen
  s_waitcnt vmcnt(31) lgkmcnt(8)
  v_mfma_f32_16x16x32_bf16 v[72:75], a[32:35], a[48:51], 0
  ds_read_b64_tr_b16 a[16:17], v165 offset:9408
  buffer_load_dwordx4 a[116:119], v162, s[8:11], s30 offen
  v_mfma_f32_16x16x32_bf16 v[76:79], a[32:35], a[52:55], 0
  ds_read_b64_tr_b16 a[18:19], v165 offset:14016
  v_mfma_f32_16x16x32_bf16 v[8:11], a[36:39], a[56:59], v[8:11]
  ds_read_b64_tr_b16 a[20:21], v165 offset:9440
  buffer_load_dwordx4 a[120:123], v161, s[8:11], s30 offen offset:1024
  v_mfma_f32_16x16x32_bf16 v[12:15], a[36:39], a[60:63], v[12:15]
  ds_read_b64_tr_b16 a[22:23], v165 offset:14048
  buffer_load_dwordx4 a[124:127], v162, s[8:11], s30 offen offset:1024
  v_mfma_f32_16x16x32_bf16 v[16:19], a[40:43], a[56:59], v[16:19]
  ds_read_b64_tr_b16 a[24:25], v166 offset:18432
  v_mfma_f32_16x16x32_bf16 v[20:23], a[40:43], a[60:63], v[20:23]
  ds_read_b64_tr_b16 a[26:27], v166 offset:23040
  buffer_load_dwordx4 a[128:131], v161, s[8:11], s30 offen offset:2048
  v_mfma_f32_16x16x32_bf16 v[24:27], a[44:47], a[56:59], v[24:27]
  ds_read_b64_tr_b16 a[28:29], v165 offset:18432
  buffer_load_dwordx4 a[132:135], v162, s[8:11], s30 offen offset:2048
  v_mfma_f32_16x16x32_bf16 v[28:31], a[44:47], a[60:63], v[28:31]
  ds_read_b64_tr_b16 a[30:31], v165 offset:23040
  s_waitcnt lgkmcnt(8)
  v_mfma_f32_16x16x32_bf16 v[32:35], a[0:3], a[56:59], v[32:35]
  ds_read_b64_tr_b16 a[32:33], v165 offset:18464
  buffer_load_dwordx4 a[136:139], v161, s[8:11], s30 offen offset:3072
  v_mfma_f32_16x16x32_bf16 v[36:39], a[0:3], a[60:63], v[36:39]
  ds_read_b64_tr_b16 a[34:35], v165 offset:23072
  buffer_load_dwordx4 a[140:143], v162, s[8:11], s30 offen offset:3072
  v_mfma_f32_16x16x32_bf16 v[40:43], a[4:7], a[56:59], v[40:43]
  ds_read_b64_tr_b16 a[36:37], v165 offset:18496
  s_add_u32 s30, s30, 0x1000
  v_mfma_f32_16x16x32_bf16 v[44:47], a[4:7], a[60:63], v[44:47]
  ds_read_b64_tr_b16 a[38:39], v165 offset:23104
  s_add_u32 m0, s60, 0x1b000
  s_nop 0
  buffer_load_dwordx4 v240, s[56:59], s61 offen lds
  v_mfma_f32_16x16x32_bf16 v[48:51], a[8:11], a[56:59], v[48:51]
  ds_read_b64_tr_b16 a[40:41], v165 offset:18528
  buffer_load_dwordx4 v241, s[56:59], s61 offen offset:1024 lds
  v_mfma_f32_16x16x32_bf16 v[52:55], a[8:11], a[60:63], v[52:55]
  ds_read_b64_tr_b16 a[42:43], v165 offset:23136
  buffer_load_dwordx4 v242, s[56:59], s61 offen offset:2048 lds
  v_mfma_f32_16x16x32_bf16 v[56:59], a[12:15], a[56:59], v[56:59]
  ds_read_b64_tr_b16 a[44:45], v165 offset:18560
  v_mfma_f32_16x16x32_bf16 v[60:63], a[12:15], a[60:63], v[60:63]
  ds_read_b64_tr_b16 a[46:47], v165 offset:23168
  buffer_load_dwordx4 v243, s[56:59], s61 offen offset:3072 lds
  s_waitcnt vmcnt(40) lgkmcnt(8)
  v_mfma_f32_16x16x32_bf16 v[64:67], a[16:19], a[56:59], v[64:67]
  ds_read_b64_tr_b16 a[0:1], v165 offset:18592
  s_add_u32 m0, s60, 0x1c000
  s_nop 0
  buffer_load_dwordx4 v244, s[56:59], s61 offen lds
  v_mfma_f32_16x16x32_bf16 v[68:71], a[16:19], a[60:63], v[68:71]
  ds_read_b64_tr_b16 a[2:3], v165 offset:23200
  v_mfma_f32_16x16x32_bf16 v[72:75], a[20:23], a[56:59], v[72:75]
  ds_read_b64_tr_b16 a[4:5], v165 offset:18624
  buffer_load_dwordx4 v245, s[56:59], s61 offen offset:1024 lds
  v_mfma_f32_16x16x32_bf16 v[76:79], a[20:23], a[60:63], v[76:79]
  ds_read_b64_tr_b16 a[6:7], v165 offset:23232
  buffer_load_dwordx4 v246, s[56:59], s61 offen offset:2048 lds
  v_mfma_f32_16x16x32_bf16 v[8:11], a[24:27], a[64:67], v[8:11]
  ds_read_b64_tr_b16 a[8:9], v165 offset:18656
  v_mfma_f32_16x16x32_bf16 v[12:15], a[24:27], a[68:71], v[12:15]
  ds_read_b64_tr_b16 a[10:11], v165 offset:23264
  buffer_load_dwordx4 v247, s[56:59], s61 offen offset:3072 lds
  v_mfma_f32_16x16x32_bf16 v[16:19], a[28:31], a[64:67], v[16:19]
  ds_read_b64_tr_b16 a[12:13], v166 offset:27648
  s_add_u32 m0, s60, 0x1d000
  s_nop 0
  buffer_load_dwordx4 v248, s[56:59], s61 offen lds
  v_mfma_f32_16x16x32_bf16 v[20:23], a[28:31], a[68:71], v[20:23]
  ds_read_b64_tr_b16 a[14:15], v166 offset:32256
  s_add_u32 s61, s61, 0x24000
  s_waitcnt lgkmcnt(8)
  v_mfma_f32_16x16x32_bf16 v[24:27], a[32:35], a[64:67], v[24:27]
  ds_read_b64_tr_b16 a[16:17], v165 offset:27648
  buffer_load_dwordx4 a[144:147], v161, s[8:11], s30 offen
  v_mfma_f32_16x16x32_bf16 v[28:31], a[32:35], a[68:71], v[28:31]
  ds_read_b64_tr_b16 a[18:19], v165 offset:32256
  buffer_load_dwordx4 a[148:151], v162, s[8:11], s30 offen
  v_mfma_f32_16x16x32_bf16 v[32:35], a[36:39], a[64:67], v[32:35]
  ds_read_b64_tr_b16 a[20:21], v165 offset:27680
  v_mfma_f32_16x16x32_bf16 v[36:39], a[36:39], a[68:71], v[36:39]
  ds_read_b64_tr_b16 a[22:23], v165 offset:32288
  buffer_load_dwordx4 a[152:155], v161, s[8:11], s30 offen offset:1024
  v_mfma_f32_16x16x32_bf16 v[40:43], a[40:43], a[64:67], v[40:43]
  ds_read_b64_tr_b16 a[24:25], v165 offset:27712
  buffer_load_dwordx4 a[156:159], v162, s[8:11], s30 offen offset:1024
  v_mfma_f32_16x16x32_bf16 v[44:47], a[40:43], a[68:71], v[44:47]
  ds_read_b64_tr_b16 a[26:27], v165 offset:32320
  v_mfma_f32_16x16x32_bf16 v[48:51], a[44:47], a[64:67], v[48:51]
  ds_read_b64_tr_b16 a[28:29], v165 offset:27744
  buffer_load_dwordx4 a[160:163], v161, s[8:11], s30 offen offset:2048
  v_mfma_f32_16x16x32_bf16 v[52:55], a[44:47], a[68:71], v[52:55]
  ds_read_b64_tr_b16 a[30:31], v165 offset:32352
  buffer_load_dwordx4 a[164:167], v162, s[8:11], s30 offen offset:2048
  s_waitcnt vmcnt(50) lgkmcnt(8)
  v_mfma_f32_16x16x32_bf16 v[56:59], a[0:3], a[64:67], v[56:59]
  ds_read_b64_tr_b16 a[32:33], v165 offset:27776
  v_mfma_f32_16x16x32_bf16 v[60:63], a[0:3], a[68:71], v[60:63]
  ds_read_b64_tr_b16 a[34:35], v165 offset:32384
  buffer_load_dwordx4 a[168:171], v161, s[8:11], s30 offen offset:3072
  v_mfma_f32_16x16x32_bf16 v[64:67], a[4:7], a[64:67], v[64:67]
  ds_read_b64_tr_b16 a[36:37], v165 offset:27808
  buffer_load_dwordx4 a[172:175], v162, s[8:11], s30 offen offset:3072
  v_mfma_f32_16x16x32_bf16 v[68:71], a[4:7], a[68:71], v[68:71]
  ds_read_b64_tr_b16 a[38:39], v165 offset:32416
  s_add_u32 s30, s30, 0x1000
  v_mfma_f32_16x16x32_bf16 v[72:75], a[8:11], a[64:67], v[72:75]
  ds_read_b64_tr_b16 a[40:41], v165 offset:27840
  v_mfma_f32_16x16x32_bf16 v[76:79], a[8:11], a[68:71], v[76:79]
  ds_read_b64_tr_b16 a[42:43], v165 offset:32448
  v_mfma_f32_16x16x32_bf16 v[8:11], a[12:15], a[72:75], v[8:11]
  ds_read_b64_tr_b16 a[44:45], v165 offset:27872
  s_waitcnt vmcnt(42)
  s_barrier
  v_mfma_f32_16x16x32_bf16 v[12:15], a[12:15], a[76:79], v[12:15]
  ds_read_b64_tr_b16 a[46:47], v165 offset:32480
  s_waitcnt lgkmcnt(8)
  v_mfma_f32_16x16x32_bf16 v[16:19], a[16:19], a[72:75], v[16:19]
  ds_read_b64_tr_b16 a[0:1], v168
  v_mfma_f32_16x16x32_bf16 v[20:23], a[16:19], a[76:79], v[20:23]
  ds_read_b64_tr_b16 a[2:3], v168 offset:4608
  v_mfma_f32_16x16x32_bf16 v[24:27], a[20:23], a[72:75], v[24:27]
  ds_read_b64_tr_b16 a[4:5], v167
  v_mfma_f32_16x16x32_bf16 v[28:31], a[20:23], a[76:79], v[28:31]
  ds_read_b64_tr_b16 a[6:7], v167 offset:4608
  v_mfma_f32_16x16x32_bf16 v[32:35], a[24:27], a[72:75], v[32:35]
  ds_read_b64_tr_b16 a[8:9], v167 offset:32
  v_mfma_f32_16x16x32_bf16 v[36:39], a[24:27], a[76:79], v[36:39]
  ds_read_b64_tr_b16 a[10:11], v167 offset:4640
  v_mfma_f32_16x16x32_bf16 v[40:43], a[28:31], a[72:75], v[40:43]
  ds_read_b64_tr_b16 a[12:13], v167 offset:64
  v_mfma_f32_16x16x32_bf16 v[44:47], a[28:31], a[76:79], v[44:47]
  ds_read_b64_tr_b16 a[14:15], v167 offset:4672
  s_waitcnt lgkmcnt(8)
  v_mfma_f32_16x16x32_bf16 v[48:51], a[32:35], a[72:75], v[48:51]
  ds_read_b64_tr_b16 a[16:17], v167 offset:96
  v_mfma_f32_16x16x32_bf16 v[52:55], a[32:35], a[76:79], v[52:55]
  ds_read_b64_tr_b16 a[18:19], v167 offset:4704
  v_mfma_f32_16x16x32_bf16 v[56:59], a[36:39], a[72:75], v[56:59]
  ds_read_b64_tr_b16 a[20:21], v167 offset:128
  v_mfma_f32_16x16x32_bf16 v[60:63], a[36:39], a[76:79], v[60:63]
  ds_read_b64_tr_b16 a[22:23], v167 offset:4736
  v_mfma_f32_16x16x32_bf16 v[64:67], a[40:43], a[72:75], v[64:67]
  ds_read_b64_tr_b16 a[24:25], v167 offset:160
  v_mfma_f32_16x16x32_bf16 v[68:71], a[40:43], a[76:79], v[68:71]
  ds_read_b64_tr_b16 a[26:27], v167 offset:4768
  v_mfma_f32_16x16x32_bf16 v[72:75], a[44:47], a[72:75], v[72:75]
  ds_read_b64_tr_b16 a[28:29], v167 offset:192
  v_mfma_f32_16x16x32_bf16 v[76:79], a[44:47], a[76:79], v[76:79]
  ds_read_b64_tr_b16 a[30:31], v167 offset:4800
  s_waitcnt vmcnt(40) lgkmcnt(14)
  v_mfma_f32_16x16x32_bf16 v[8:11], a[0:3], a[80:83], v[8:11]
  ds_read_b64_tr_b16 a[32:33], v167 offset:224
  v_mfma_f32_16x16x32_bf16 v[12:15], a[0:3], a[84:87], v[12:15]
  ds_read_b64_tr_b16 a[34:35], v167 offset:4832
  s_waitcnt vmcnt(25) lgkmcnt(10)
  s_barrier
  v_mfma_f32_16x16x32_bf16 v[16:19], a[4:7], a[80:83], v[16:19]
  ds_read_b64_tr_b16 a[36:37], v168 offset:9216
  s_add_u32 m0, s60, 0
  s_nop 0
  buffer_load_dwordx4 v240, s[56:59], s61 offen lds
  v_mfma_f32_16x16x32_bf16 v[20:23], a[4:7], a[84:87], v[20:23]
  ds_read_b64_tr_b16 a[38:39], v168 offset:13824
  v_mfma_f32_16x16x32_bf16 v[24:27], a[8:11], a[80:83], v[24:27]
  ds_read_b64_tr_b16 a[40:41], v167 offset:9216
  buffer_load_dwordx4 v241, s[56:59], s61 offen offset:1024 lds
  v_mfma_f32_16x16x32_bf16 v[28:31], a[8:11], a[84:87], v[28:31]
  ds_read_b64_tr_b16 a[42:43], v167 offset:13824
  v_mfma_f32_16x16x32_bf16 v[32:35], a[12:15], a[80:83], v[32:35]
  ds_read_b64_tr_b16 a[44:45], v167 offset:9248
  v_mfma_f32_16x16x32_bf16 v[36:39], a[12:15], a[84:87], v[36:39]
  ds_read_b64_tr_b16 a[46:47], v167 offset:13856
  buffer_load_dwordx4 v242, s[56:59], s61 offen offset:2048 lds
  s_waitcnt lgkmcnt(8)
  v_mfma_f32_16x16x32_bf16 v[40:43], a[16:19], a[80:83], v[40:43]
  ds_read_b64_tr_b16 a[0:1], v167 offset:9280
  v_mfma_f32_16x16x32_bf16 v[44:47], a[16:19], a[84:87], v[44:47]
  ds_read_b64_tr_b16 a[2:3], v167 offset:13888
  buffer_load_dwordx4 v243, s[56:59], s61 offen offset:3072 lds
  v_mfma_f32_16x16x32_bf16 v[48:51], a[20:23], a[80:83], v[48:51]
  ds_read_b64_tr_b16 a[4:5], v167 offset:9312
  s_add_u32 m0, s60, 0x1000
  v_mfma_f32_16x16x32_bf16 v[52:55], a[20:23], a[84:87], v[52:55]
  ds_read_b64_tr_b16 a[6:7], v167 offset:13920
  v_mfma_f32_16x16x32_bf16 v[56:59], a[24:27], a[80:83], v[56:59]
  ds_read_b64_tr_b16 a[8:9], v167 offset:9344
  buffer_load_dwordx4 v244, s[56:59], s61 offen lds
  v_mfma_f32_16x16x32_bf16 v[60:63], a[24:27], a[84:87], v[60:63]
  ds_read_b64_tr_b16 a[10:11], v167 offset:13952
  v_mfma_f32_16x16x32_bf16 v[64:67], a[28:31], a[80:83], v[64:67]
  ds_read_b64_tr_b16 a[12:13], v167 offset:9376
  v_mfma_f32_16x16x32_bf16 v[68:71], a[28:31], a[84:87], v[68:71]
  ds_read_b64_tr_b16 a[14:15], v167 offset:13984
  buffer_load_dwordx4 v245, s[56:59], s61 offen offset:1024 lds
  s_waitcnt lgkmcnt(8)
  v_mfma_f32_16x16x32_bf16 v[72:75], a[32:35], a[80:83], v[72:75]
  ds_read_b64_tr_b16 a[16:17], v167 offset:9408
  v_mfma_f32_16x16x32_bf16 v[76:79], a[32:35], a[84:87], v[76:79]
  ds_read_b64_tr_b16 a[18:19], v167 offset:14016
  buffer_load_dwordx4 v246, s[56:59], s61 offen offset:2048 lds
  v_mfma_f32_16x16x32_bf16 v[8:11], a[36:39], a[88:91], v[8:11]
  ds_read_b64_tr_b16 a[20:21], v167 offset:9440
  v_mfma_f32_16x16x32_bf16 v[12:15], a[36:39], a[92:95], v[12:15]
  ds_read_b64_tr_b16 a[22:23], v167 offset:14048
  v_mfma_f32_16x16x32_bf16 v[16:19], a[40:43], a[88:91], v[16:19]
  ds_read_b64_tr_b16 a[24:25], v168 offset:18432
  buffer_load_dwordx4 v247, s[56:59], s61 offen offset:3072 lds
  v_mfma_f32_16x16x32_bf16 v[20:23], a[40:43], a[92:95], v[20:23]
  ds_read_b64_tr_b16 a[26:27], v168 offset:23040
  s_add_u32 m0, s60, 0x2000
  v_mfma_f32_16x16x32_bf16 v[24:27], a[44:47], a[88:91], v[24:27]
  ds_read_b64_tr_b16 a[28:29], v167 offset:18432
  v_mfma_f32_16x16x32_bf16 v[28:31], a[44:47], a[92:95], v[28:31]
  ds_read_b64_tr_b16 a[30:31], v167 offset:23040
  buffer_load_dwordx4 v248, s[56:59], s61 offen lds
  s_waitcnt lgkmcnt(8)
  v_mfma_f32_16x16x32_bf16 v[32:35], a[0:3], a[88:91], v[32:35]
  ds_read_b64_tr_b16 a[32:33], v167 offset:18464
  s_add_u32 s61, s61, 0x24000
  v_mfma_f32_16x16x32_bf16 v[36:39], a[0:3], a[92:95], v[36:39]
  ds_read_b64_tr_b16 a[34:35], v167 offset:23072
  buffer_load_dwordx4 a[176:179], v161, s[8:11], s30 offen
  v_mfma_f32_16x16x32_bf16 v[40:43], a[4:7], a[88:91], v[40:43]
  ds_read_b64_tr_b16 a[36:37], v167 offset:18496
  v_mfma_f32_16x16x32_bf16 v[44:47], a[4:7], a[92:95], v[44:47]
  ds_read_b64_tr_b16 a[38:39], v167 offset:23104
  v_mfma_f32_16x16x32_bf16 v[48:51], a[8:11], a[88:91], v[48:51]
  ds_read_b64_tr_b16 a[40:41], v167 offset:18528
  buffer_load_dwordx4 a[180:183], v162, s[8:11], s30 offen
  v_mfma_f32_16x16x32_bf16 v[52:55], a[8:11], a[92:95], v[52:55]
  ds_read_b64_tr_b16 a[42:43], v167 offset:23136
  v_mfma_f32_16x16x32_bf16 v[56:59], a[12:15], a[88:91], v[56:59]
  ds_read_b64_tr_b16 a[44:45], v167 offset:18560
  v_mfma_f32_16x16x32_bf16 v[60:63], a[12:15], a[92:95], v[60:63]
  ds_read_b64_tr_b16 a[46:47], v167 offset:23168
  buffer_load_dwordx4 a[184:187], v161, s[8:11], s30 offen offset:1024
  s_waitcnt lgkmcnt(8)
  v_mfma_f32_16x16x32_bf16 v[64:67], a[16:19], a[88:91], v[64:67]
  ds_read_b64_tr_b16 a[0:1], v167 offset:18592
  v_mfma_f32_16x16x32_bf16 v[68:71], a[16:19], a[92:95], v[68:71]
  ds_read_b64_tr_b16 a[2:3], v167 offset:23200
  buffer_load_dwordx4 a[188:191], v162, s[8:11], s30 offen offset:1024
  v_mfma_f32_16x16x32_bf16 v[72:75], a[20:23], a[88:91], v[72:75]
  ds_read_b64_tr_b16 a[4:5], v167 offset:18624
  v_mfma_f32_16x16x32_bf16 v[76:79], a[20:23], a[92:95], v[76:79]
  ds_read_b64_tr_b16 a[6:7], v167 offset:23232
  v_mfma_f32_16x16x32_bf16 v[8:11], a[24:27], a[96:99], v[8:11]
  ds_read_b64_tr_b16 a[8:9], v167 offset:18656
  buffer_load_dwordx4 a[192:195], v161, s[8:11], s30 offen offset:2048
  v_mfma_f32_16x16x32_bf16 v[12:15], a[24:27], a[100:103], v[12:15]
  ds_read_b64_tr_b16 a[10:11], v167 offset:23264
  v_mfma_f32_16x16x32_bf16 v[16:19], a[28:31], a[96:99], v[16:19]
  ds_read_b64_tr_b16 a[12:13], v168 offset:27648
  buffer_load_dwordx4 a[196:199], v162, s[8:11], s30 offen offset:2048
  v_mfma_f32_16x16x32_bf16 v[20:23], a[28:31], a[100:103], v[20:23]
  ds_read_b64_tr_b16 a[14:15], v168 offset:32256
  s_waitcnt lgkmcnt(8)
  v_mfma_f32_16x16x32_bf16 v[24:27], a[32:35], a[96:99], v[24:27]
  ds_read_b64_tr_b16 a[16:17], v167 offset:27648
  v_mfma_f32_16x16x32_bf16 v[28:31], a[32:35], a[100:103], v[28:31]
  ds_read_b64_tr_b16 a[18:19], v167 offset:32256
  buffer_load_dwordx4 a[200:203], v161, s[8:11], s30 offen offset:3072
  v_mfma_f32_16x16x32_bf16 v[32:35], a[36:39], a[96:99], v[32:35]
  ds_read_b64_tr_b16 a[20:21], v167 offset:27680
  v_mfma_f32_16x16x32_bf16 v[36:39], a[36:39], a[100:103], v[36:39]
  ds_read_b64_tr_b16 a[22:23], v167 offset:32288
  v_mfma_f32_16x16x32_bf16 v[40:43], a[40:43], a[96:99], v[40:43]
  ds_read_b64_tr_b16 a[24:25], v167 offset:27712
  buffer_load_dwordx4 a[204:207], v162, s[8:11], s30 offen offset:3072
  v_mfma_f32_16x16x32_bf16 v[44:47], a[40:43], a[100:103], v[44:47]
  ds_read_b64_tr_b16 a[26:27], v167 offset:32320
  s_add_u32 s30, s30, 0x1000
  v_mfma_f32_16x16x32_bf16 v[48:51], a[44:47], a[96:99], v[48:51]
  ds_read_b64_tr_b16 a[28:29], v167 offset:27744
  buffer_load_dwordx4 a[208:211], v161, s[8:11], s30 offen
  v_mfma_f32_16x16x32_bf16 v[52:55], a[44:47], a[100:103], v[52:55]
  ds_read_b64_tr_b16 a[30:31], v167 offset:32352
  s_waitcnt lgkmcnt(8)
  v_mfma_f32_16x16x32_bf16 v[56:59], a[0:3], a[96:99], v[56:59]
  ds_read_b64_tr_b16 a[32:33], v167 offset:27776
  v_mfma_f32_16x16x32_bf16 v[60:63], a[0:3], a[100:103], v[60:63]
  ds_read_b64_tr_b16 a[34:35], v167 offset:32384
  buffer_load_dwordx4 a[212:215], v162, s[8:11], s30 offen
  v_mfma_f32_16x16x32_bf16 v[64:67], a[4:7], a[96:99], v[64:67]
  ds_read_b64_tr_b16 a[36:37], v167 offset:27808
  v_mfma_f32_16x16x32_bf16 v[68:71], a[4:7], a[100:103], v[68:71]
  ds_read_b64_tr_b16 a[38:39], v167 offset:32416
  v_mfma_f32_16x16x32_bf16 v[72:75], a[8:11], a[96:99], v[72:75]
  ds_read_b64_tr_b16 a[40:41], v167 offset:27840
  buffer_load_dwordx4 a[216:219], v161, s[8:11], s30 offen offset:1024
  v_mfma_f32_16x16x32_bf16 v[76:79], a[8:11], a[100:103], v[76:79]
  ds_read_b64_tr_b16 a[42:43], v167 offset:32448
  v_mfma_f32_16x16x32_bf16 v[8:11], a[12:15], a[104:107], v[8:11]
  ds_read_b64_tr_b16 a[44:45], v167 offset:27872
  buffer_load_dwordx4 a[220:223], v162, s[8:11], s30 offen offset:1024
  v_mfma_f32_16x16x32_bf16 v[12:15], a[12:15], a[108:111], v[12:15]
  ds_read_b64_tr_b16 a[46:47], v167 offset:32480
  s_waitcnt lgkmcnt(8)
  v_mfma_f32_16x16x32_bf16 v[16:19], a[16:19], a[104:107], v[16:19]
  ds_read_b64_tr_b16 a[0:1], v170
  v_mfma_f32_16x16x32_bf16 v[20:23], a[16:19], a[108:111], v[20:23]
  ds_read_b64_tr_b16 a[2:3], v170 offset:4608
  buffer_load_dwordx4 a[224:227], v161, s[8:11], s30 offen offset:2048
  v_mfma_f32_16x16x32_bf16 v[24:27], a[20:23], a[104:107], v[24:27]
  ds_read_b64_tr_b16 a[4:5], v169
  v_mfma_f32_16x16x32_bf16 v[28:31], a[20:23], a[108:111], v[28:31]
  ds_read_b64_tr_b16 a[6:7], v169 offset:4608
  v_mfma_f32_16x16x32_bf16 v[32:35], a[24:27], a[104:107], v[32:35]
  ds_read_b64_tr_b16 a[8:9], v169 offset:32
  buffer_load_dwordx4 a[228:231], v162, s[8:11], s30 offen offset:2048
  v_mfma_f32_16x16x32_bf16 v[36:39], a[24:27], a[108:111], v[36:39]
  ds_read_b64_tr_b16 a[10:11], v169 offset:4640
  v_mfma_f32_16x16x32_bf16 v[40:43], a[28:31], a[104:107], v[40:43]
  ds_read_b64_tr_b16 a[12:13], v169 offset:64
  buffer_load_dwordx4 a[232:235], v161, s[8:11], s30 offen offset:3072
  v_mfma_f32_16x16x32_bf16 v[44:47], a[28:31], a[108:111], v[44:47]
  ds_read_b64_tr_b16 a[14:15], v169 offset:4672
  s_waitcnt lgkmcnt(8)
  v_mfma_f32_16x16x32_bf16 v[48:51], a[32:35], a[104:107], v[48:51]
  ds_read_b64_tr_b16 a[16:17], v169 offset:96
  v_mfma_f32_16x16x32_bf16 v[52:55], a[32:35], a[108:111], v[52:55]
  ds_read_b64_tr_b16 a[18:19], v169 offset:4704
  buffer_load_dwordx4 a[236:239], v162, s[8:11], s30 offen offset:3072
  v_mfma_f32_16x16x32_bf16 v[56:59], a[36:39], a[104:107], v[56:59]
  ds_read_b64_tr_b16 a[20:21], v169 offset:128
  s_add_u32 s30, s30, 0x1000
  v_mfma_f32_16x16x32_bf16 v[60:63], a[36:39], a[108:111], v[60:63]
  ds_read_b64_tr_b16 a[22:23], v169 offset:4736
  v_mfma_f32_16x16x32_bf16 v[64:67], a[40:43], a[104:107], v[64:67]
  ds_read_b64_tr_b16 a[24:25], v169 offset:160
  v_mfma_f32_16x16x32_bf16 v[68:71], a[40:43], a[108:111], v[68:71]
  ds_read_b64_tr_b16 a[26:27], v169 offset:4768
  v_mfma_f32_16x16x32_bf16 v[72:75], a[44:47], a[104:107], v[72:75]
  ds_read_b64_tr_b16 a[28:29], v169 offset:192
  v_mfma_f32_16x16x32_bf16 v[76:79], a[44:47], a[108:111], v[76:79]
  ds_read_b64_tr_b16 a[30:31], v169 offset:4800
  s_waitcnt vmcnt(48) lgkmcnt(14)
  v_mfma_f32_16x16x32_bf16 v[8:11], a[0:3], a[112:115], v[8:11]
  ds_read_b64_tr_b16 a[32:33], v169 offset:224
  v_mfma_f32_16x16x32_bf16 v[12:15], a[0:3], a[116:119], v[12:15]
  ds_read_b64_tr_b16 a[34:35], v169 offset:4832
  s_waitcnt vmcnt(33) lgkmcnt(10)
  s_barrier
  v_mfma_f32_16x16x32_bf16 v[16:19], a[4:7], a[112:115], v[16:19]
  ds_read_b64_tr_b16 a[36:37], v170 offset:9216
  s_add_u32 m0, s60, 0x9000
  s_nop 0
  buffer_load_dwordx4 v240, s[56:59], s61 offen lds
  v_mfma_f32_16x16x32_bf16 v[20:23], a[4:7], a[116:119], v[20:23]
  ds_read_b64_tr_b16 a[38:39], v170 offset:13824
  v_mfma_f32_16x16x32_bf16 v[24:27], a[8:11], a[112:115], v[24:27]
  ds_read_b64_tr_b16 a[40:41], v169 offset:9216
  buffer_load_dwordx4 v241, s[56:59], s61 offen offset:1024 lds
  v_mfma_f32_16x16x32_bf16 v[28:31], a[8:11], a[116:119], v[28:31]
  ds_read_b64_tr_b16 a[42:43], v169 offset:13824
  v_mfma_f32_16x16x32_bf16 v[32:35], a[12:15], a[112:115], v[32:35]
  ds_read_b64_tr_b16 a[44:45], v169 offset:9248
  v_mfma_f32_16x16x32_bf16 v[36:39], a[12:15], a[116:119], v[36:39]
  ds_read_b64_tr_b16 a[46:47], v169 offset:13856
  buffer_load_dwordx4 v242, s[56:59], s61 offen offset:2048 lds
  s_waitcnt lgkmcnt(8)
  v_mfma_f32_16x16x32_bf16 v[40:43], a[16:19], a[112:115], v[40:43]
  ds_read_b64_tr_b16 a[0:1], v169 offset:9280
  v_mfma_f32_16x16x32_bf16 v[44:47], a[16:19], a[116:119], v[44:47]
  ds_read_b64_tr_b16 a[2:3], v169 offset:13888
  buffer_load_dwordx4 v243, s[56:59], s61 offen offset:3072 lds
  v_mfma_f32_16x16x32_bf16 v[48:51], a[20:23], a[112:115], v[48:51]
  ds_read_b64_tr_b16 a[4:5], v169 offset:9312
  s_add_u32 m0, s60, 0xa000
  v_mfma_f32_16x16x32_bf16 v[52:55], a[20:23], a[116:119], v[52:55]
  ds_read_b64_tr_b16 a[6:7], v169 offset:13920
  v_mfma_f32_16x16x32_bf16 v[56:59], a[24:27], a[112:115], v[56:59]
  ds_read_b64_tr_b16 a[8:9], v169 offset:9344
  buffer_load_dwordx4 v244, s[56:59], s61 offen lds
  v_mfma_f32_16x16x32_bf16 v[60:63], a[24:27], a[116:119], v[60:63]
  ds_read_b64_tr_b16 a[10:11], v169 offset:13952
  v_mfma_f32_16x16x32_bf16 v[64:67], a[28:31], a[112:115], v[64:67]
  ds_read_b64_tr_b16 a[12:13], v169 offset:9376
  v_mfma_f32_16x16x32_bf16 v[68:71], a[28:31], a[116:119], v[68:71]
  ds_read_b64_tr_b16 a[14:15], v169 offset:13984
  buffer_load_dwordx4 v245, s[56:59], s61 offen offset:1024 lds
  s_waitcnt lgkmcnt(8)
  v_mfma_f32_16x16x32_bf16 v[72:75], a[32:35], a[112:115], v[72:75]
  ds_read_b64_tr_b16 a[16:17], v169 offset:9408
  v_mfma_f32_16x16x32_bf16 v[76:79], a[32:35], a[116:119], v[76:79]
  ds_read_b64_tr_b16 a[18:19], v169 offset:14016
  buffer_load_dwordx4 v246, s[56:59], s61 offen offset:2048 lds
  v_mfma_f32_16x16x32_bf16 v[8:11], a[36:39], a[120:123], v[8:11]
  ds_read_b64_tr_b16 a[20:21], v169 offset:9440
  v_mfma_f32_16x16x32_bf16 v[12:15], a[36:39], a[124:127], v[12:15]
  ds_read_b64_tr_b16 a[22:23], v169 offset:14048
  v_mfma_f32_16x16x32_bf16 v[16:19], a[40:43], a[120:123], v[16:19]
  ds_read_b64_tr_b16 a[24:25], v170 offset:18432
  buffer_load_dwordx4 v247, s[56:59], s61 offen offset:3072 lds
  v_mfma_f32_16x16x32_bf16 v[20:23], a[40:43], a[124:127], v[20:23]
  ds_read_b64_tr_b16 a[26:27], v170 offset:23040
  s_add_u32 m0, s60, 0xb000
  v_mfma_f32_16x16x32_bf16 v[24:27], a[44:47], a[120:123], v[24:27]
  ds_read_b64_tr_b16 a[28:29], v169 offset:18432
  v_mfma_f32_16x16x32_bf16 v[28:31], a[44:47], a[124:127], v[28:31]
  ds_read_b64_tr_b16 a[30:31], v169 offset:23040
  buffer_load_dwordx4 v248, s[56:59], s61 offen lds
  s_waitcnt lgkmcnt(8)
  v_mfma_f32_16x16x32_bf16 v[32:35], a[0:3], a[120:123], v[32:35]
  ds_read_b64_tr_b16 a[32:33], v169 offset:18464
  s_add_u32 s61, s61, 0x24000
  v_mfma_f32_16x16x32_bf16 v[36:39], a[0:3], a[124:127], v[36:39]
  ds_read_b64_tr_b16 a[34:35], v169 offset:23072
  buffer_load_dwordx4 a[48:51], v161, s[8:11], s30 offen
  v_mfma_f32_16x16x32_bf16 v[40:43], a[4:7], a[120:123], v[40:43]
  ds_read_b64_tr_b16 a[36:37], v169 offset:18496
  v_mfma_f32_16x16x32_bf16 v[44:47], a[4:7], a[124:127], v[44:47]
  ds_read_b64_tr_b16 a[38:39], v169 offset:23104
  v_mfma_f32_16x16x32_bf16 v[48:51], a[8:11], a[120:123], v[48:51]
  ds_read_b64_tr_b16 a[40:41], v169 offset:18528
  buffer_load_dwordx4 a[52:55], v162, s[8:11], s30 offen
  v_mfma_f32_16x16x32_bf16 v[52:55], a[8:11], a[124:127], v[52:55]
  ds_read_b64_tr_b16 a[42:43], v169 offset:23136
  v_mfma_f32_16x16x32_bf16 v[56:59], a[12:15], a[120:123], v[56:59]
  ds_read_b64_tr_b16 a[44:45], v169 offset:18560
  v_mfma_f32_16x16x32_bf16 v[60:63], a[12:15], a[124:127], v[60:63]
  ds_read_b64_tr_b16 a[46:47], v169 offset:23168
  buffer_load_dwordx4 a[56:59], v161, s[8:11], s30 offen offset:1024
  s_waitcnt lgkmcnt(8)
  v_mfma_f32_16x16x32_bf16 v[64:67], a[16:19], a[120:123], v[64:67]
  ds_read_b64_tr_b16 a[0:1], v169 offset:18592
  v_mfma_f32_16x16x32_bf16 v[68:71], a[16:19], a[124:127], v[68:71]
  ds_read_b64_tr_b16 a[2:3], v169 offset:23200
  buffer_load_dwordx4 a[60:63], v162, s[8:11], s30 offen offset:1024
  v_mfma_f32_16x16x32_bf16 v[72:75], a[20:23], a[120:123], v[72:75]
  ds_read_b64_tr_b16 a[4:5], v169 offset:18624
  v_mfma_f32_16x16x32_bf16 v[76:79], a[20:23], a[124:127], v[76:79]
  ds_read_b64_tr_b16 a[6:7], v169 offset:23232
  v_mfma_f32_16x16x32_bf16 v[8:11], a[24:27], a[128:131], v[8:11]
  ds_read_b64_tr_b16 a[8:9], v169 offset:18656
  buffer_load_dwordx4 a[64:67], v161, s[8:11], s30 offen offset:2048
  v_mfma_f32_16x16x32_bf16 v[12:15], a[24:27], a[132:135], v[12:15]
  ds_read_b64_tr_b16 a[10:11], v169 offset:23264
  v_mfma_f32_16x16x32_bf16 v[16:19], a[28:31], a[128:131], v[16:19]
  ds_read_b64_tr_b16 a[12:13], v170 offset:27648
  buffer_load_dwordx4 a[68:71], v162, s[8:11], s30 offen offset:2048
  v_mfma_f32_16x16x32_bf16 v[20:23], a[28:31], a[132:135], v[20:23]
  ds_read_b64_tr_b16 a[14:15], v170 offset:32256
  s_waitcnt lgkmcnt(8)
  v_mfma_f32_16x16x32_bf16 v[24:27], a[32:35], a[128:131], v[24:27]
  ds_read_b64_tr_b16 a[16:17], v169 offset:27648
  v_mfma_f32_16x16x32_bf16 v[28:31], a[32:35], a[132:135], v[28:31]
  ds_read_b64_tr_b16 a[18:19], v169 offset:32256
  buffer_load_dwordx4 a[72:75], v161, s[8:11], s30 offen offset:3072
  v_mfma_f32_16x16x32_bf16 v[32:35], a[36:39], a[128:131], v[32:35]
  ds_read_b64_tr_b16 a[20:21], v169 offset:27680
  v_mfma_f32_16x16x32_bf16 v[36:39], a[36:39], a[132:135], v[36:39]
  ds_read_b64_tr_b16 a[22:23], v169 offset:32288
  v_mfma_f32_16x16x32_bf16 v[40:43], a[40:43], a[128:131], v[40:43]
  ds_read_b64_tr_b16 a[24:25], v169 offset:27712
  buffer_load_dwordx4 a[76:79], v162, s[8:11], s30 offen offset:3072
  v_mfma_f32_16x16x32_bf16 v[44:47], a[40:43], a[132:135], v[44:47]
  ds_read_b64_tr_b16 a[26:27], v169 offset:32320
  s_add_u32 s30, s30, 0x1000
  v_mfma_f32_16x16x32_bf16 v[48:51], a[44:47], a[128:131], v[48:51]
  ds_read_b64_tr_b16 a[28:29], v169 offset:27744
  buffer_load_dwordx4 a[80:83], v161, s[8:11], s30 offen
  v_mfma_f32_16x16x32_bf16 v[52:55], a[44:47], a[132:135], v[52:55]
  ds_read_b64_tr_b16 a[30:31], v169 offset:32352
  s_waitcnt lgkmcnt(8)
  v_mfma_f32_16x16x32_bf16 v[56:59], a[0:3], a[128:131], v[56:59]
  ds_read_b64_tr_b16 a[32:33], v169 offset:27776
  v_mfma_f32_16x16x32_bf16 v[60:63], a[0:3], a[132:135], v[60:63]
  ds_read_b64_tr_b16 a[34:35], v169 offset:32384
  buffer_load_dwordx4 a[84:87], v162, s[8:11], s30 offen
  v_mfma_f32_16x16x32_bf16 v[64:67], a[4:7], a[128:131], v[64:67]
  ds_read_b64_tr_b16 a[36:37], v169 offset:27808
  v_mfma_f32_16x16x32_bf16 v[68:71], a[4:7], a[132:135], v[68:71]
  ds_read_b64_tr_b16 a[38:39], v169 offset:32416
  v_mfma_f32_16x16x32_bf16 v[72:75], a[8:11], a[128:131], v[72:75]
  ds_read_b64_tr_b16 a[40:41], v169 offset:27840
  buffer_load_dwordx4 a[88:91], v161, s[8:11], s30 offen offset:1024
  v_mfma_f32_16x16x32_bf16 v[76:79], a[8:11], a[132:135], v[76:79]
  ds_read_b64_tr_b16 a[42:43], v169 offset:32448
  v_mfma_f32_16x16x32_bf16 v[8:11], a[12:15], a[136:139], v[8:11]
  ds_read_b64_tr_b16 a[44:45], v169 offset:27872
  buffer_load_dwordx4 a[92:95], v162, s[8:11], s30 offen offset:1024
  v_mfma_f32_16x16x32_bf16 v[12:15], a[12:15], a[140:143], v[12:15]
  ds_read_b64_tr_b16 a[46:47], v169 offset:32480
  s_waitcnt lgkmcnt(8)
  v_mfma_f32_16x16x32_bf16 v[16:19], a[16:19], a[136:139], v[16:19]
  ds_read_b64_tr_b16 a[0:1], v172
  v_mfma_f32_16x16x32_bf16 v[20:23], a[16:19], a[140:143], v[20:23]
  ds_read_b64_tr_b16 a[2:3], v172 offset:4608
  buffer_load_dwordx4 a[96:99], v161, s[8:11], s30 offen offset:2048
  v_mfma_f32_16x16x32_bf16 v[24:27], a[20:23], a[136:139], v[24:27]
  ds_read_b64_tr_b16 a[4:5], v171
  v_mfma_f32_16x16x32_bf16 v[28:31], a[20:23], a[140:143], v[28:31]
  ds_read_b64_tr_b16 a[6:7], v171 offset:4608
  v_mfma_f32_16x16x32_bf16 v[32:35], a[24:27], a[136:139], v[32:35]
  ds_read_b64_tr_b16 a[8:9], v171 offset:32
  buffer_load_dwordx4 a[100:103], v162, s[8:11], s30 offen offset:2048
  v_mfma_f32_16x16x32_bf16 v[36:39], a[24:27], a[140:143], v[36:39]
  ds_read_b64_tr_b16 a[10:11], v171 offset:4640
  v_mfma_f32_16x16x32_bf16 v[40:43], a[28:31], a[136:139], v[40:43]
  ds_read_b64_tr_b16 a[12:13], v171 offset:64
  buffer_load_dwordx4 a[104:107], v161, s[8:11], s30 offen offset:3072
  v_mfma_f32_16x16x32_bf16 v[44:47], a[28:31], a[140:143], v[44:47]
  ds_read_b64_tr_b16 a[14:15], v171 offset:4672
  s_waitcnt lgkmcnt(8)
  v_mfma_f32_16x16x32_bf16 v[48:51], a[32:35], a[136:139], v[48:51]
  ds_read_b64_tr_b16 a[16:17], v171 offset:96
  v_mfma_f32_16x16x32_bf16 v[52:55], a[32:35], a[140:143], v[52:55]
  ds_read_b64_tr_b16 a[18:19], v171 offset:4704
  buffer_load_dwordx4 a[108:111], v162, s[8:11], s30 offen offset:3072
  v_mfma_f32_16x16x32_bf16 v[56:59], a[36:39], a[136:139], v[56:59]
  ds_read_b64_tr_b16 a[20:21], v171 offset:128
  s_add_u32 s30, s30, 0x1000
  v_mfma_f32_16x16x32_bf16 v[60:63], a[36:39], a[140:143], v[60:63]
  ds_read_b64_tr_b16 a[22:23], v171 offset:4736
  v_mfma_f32_16x16x32_bf16 v[64:67], a[40:43], a[136:139], v[64:67]
  ds_read_b64_tr_b16 a[24:25], v171 offset:160
  v_mfma_f32_16x16x32_bf16 v[68:71], a[40:43], a[140:143], v[68:71]
  ds_read_b64_tr_b16 a[26:27], v171 offset:4768
  v_mfma_f32_16x16x32_bf16 v[72:75], a[44:47], a[136:139], v[72:75]
  ds_read_b64_tr_b16 a[28:29], v171 offset:192
  v_mfma_f32_16x16x32_bf16 v[76:79], a[44:47], a[140:143], v[76:79]
  ds_read_b64_tr_b16 a[30:31], v171 offset:4800
  s_waitcnt vmcnt(56) lgkmcnt(14)
  v_mfma_f32_16x16x32_bf16 v[8:11], a[0:3], a[144:147], v[8:11]
  ds_read_b64_tr_b16 a[32:33], v171 offset:224
  v_mfma_f32_16x16x32_bf16 v[12:15], a[0:3], a[148:151], v[12:15]
  ds_read_b64_tr_b16 a[34:35], v171 offset:4832
  s_waitcnt vmcnt(41) lgkmcnt(10)
  s_barrier
  v_mfma_f32_16x16x32_bf16 v[16:19], a[4:7], a[144:147], v[16:19]
  ds_read_b64_tr_b16 a[36:37], v172 offset:9216
  s_add_u32 m0, s60, 0x12000
  s_nop 0
  buffer_load_dwordx4 v240, s[56:59], s61 offen lds
  v_mfma_f32_16x16x32_bf16 v[20:23], a[4:7], a[148:151], v[20:23]
  ds_read_b64_tr_b16 a[38:39], v172 offset:13824
  v_mfma_f32_16x16x32_bf16 v[24:27], a[8:11], a[144:147], v[24:27]
  ds_read_b64_tr_b16 a[40:41], v171 offset:9216
  buffer_load_dwordx4 v241, s[56:59], s61 offen offset:1024 lds
  v_mfma_f32_16x16x32_bf16 v[28:31], a[8:11], a[148:151], v[28:31]
  ds_read_b64_tr_b16 a[42:43], v171 offset:13824
  v_mfma_f32_16x16x32_bf16 v[32:35], a[12:15], a[144:147], v[32:35]
  ds_read_b64_tr_b16 a[44:45], v171 offset:9248
  v_mfma_f32_16x16x32_bf16 v[36:39], a[12:15], a[148:151], v[36:39]
  ds_read_b64_tr_b16 a[46:47], v171 offset:13856
  buffer_load_dwordx4 v242, s[56:59], s61 offen offset:2048 lds
  s_waitcnt lgkmcnt(8)
  v_mfma_f32_16x16x32_bf16 v[40:43], a[16:19], a[144:147], v[40:43]
  ds_read_b64_tr_b16 a[0:1], v171 offset:9280
  v_mfma_f32_16x16x32_bf16 v[44:47], a[16:19], a[148:151], v[44:47]
  ds_read_b64_tr_b16 a[2:3], v171 offset:13888
  v_mfma_f32_16x16x32_bf16 v[48:51], a[20:23], a[144:147], v[48:51]
  ds_read_b64_tr_b16 a[4:5], v171 offset:9312
  buffer_load_dwordx4 v243, s[56:59], s61 offen offset:3072 lds
  v_mfma_f32_16x16x32_bf16 v[52:55], a[20:23], a[148:151], v[52:55]
  ds_read_b64_tr_b16 a[6:7], v171 offset:13920
  s_add_u32 m0, s60, 0x13000
  v_mfma_f32_16x16x32_bf16 v[56:59], a[24:27], a[144:147], v[56:59]
  ds_read_b64_tr_b16 a[8:9], v171 offset:9344
  v_mfma_f32_16x16x32_bf16 v[60:63], a[24:27], a[148:151], v[60:63]
  ds_read_b64_tr_b16 a[10:11], v171 offset:13952
  buffer_load_dwordx4 v244, s[56:59], s61 offen lds
  v_mfma_f32_16x16x32_bf16 v[64:67], a[28:31], a[144:147], v[64:67]
  ds_read_b64_tr_b16 a[12:13], v171 offset:9376
  v_mfma_f32_16x16x32_bf16 v[68:71], a[28:31], a[148:151], v[68:71]
  ds_read_b64_tr_b16 a[14:15], v171 offset:13984
  buffer_load_dwordx4 v245, s[56:59], s61 offen offset:1024 lds
  s_waitcnt lgkmcnt(8)
  v_mfma_f32_16x16x32_bf16 v[72:75], a[32:35], a[144:147], v[72:75]
  ds_read_b64_tr_b16 a[16:17], v171 offset:9408
  v_mfma_f32_16x16x32_bf16 v[76:79], a[32:35], a[148:151], v[76:79]
  ds_read_b64_tr_b16 a[18:19], v171 offset:14016
  v_mfma_f32_16x16x32_bf16 v[8:11], a[36:39], a[152:155], v[8:11]
  ds_read_b64_tr_b16 a[20:21], v171 offset:9440
  buffer_load_dwordx4 v246, s[56:59], s61 offen offset:2048 lds
  v_mfma_f32_16x16x32_bf16 v[12:15], a[36:39], a[156:159], v[12:15]
  ds_read_b64_tr_b16 a[22:23], v171 offset:14048
  v_mfma_f32_16x16x32_bf16 v[16:19], a[40:43], a[152:155], v[16:19]
  ds_read_b64_tr_b16 a[24:25], v172 offset:18432
  v_mfma_f32_16x16x32_bf16 v[20:23], a[40:43], a[156:159], v[20:23]
  ds_read_b64_tr_b16 a[26:27], v172 offset:23040
  buffer_load_dwordx4 v247, s[56:59], s61 offen offset:3072 lds
  v_mfma_f32_16x16x32_bf16 v[24:27], a[44:47], a[152:155], v[24:27]
  ds_read_b64_tr_b16 a[28:29], v171 offset:18432
  s_add_u32 m0, s60, 0x14000
  v_mfma_f32_16x16x32_bf16 v[28:31], a[44:47], a[156:159], v[28:31]
  ds_read_b64_tr_b16 a[30:31], v171 offset:23040
  s_waitcnt lgkmcnt(8)
  v_mfma_f32_16x16x32_bf16 v[32:35], a[0:3], a[152:155], v[32:35]
  ds_read_b64_tr_b16 a[32:33], v171 offset:18464
  buffer_load_dwordx4 v248, s[56:59], s61 offen lds
  v_mfma_f32_16x16x32_bf16 v[36:39], a[0:3], a[156:159], v[36:39]
  ds_read_b64_tr_b16 a[34:35], v171 offset:23072
  s_add_u32 s61, s61, 0x24000
  v_mfma_f32_16x16x32_bf16 v[40:43], a[4:7], a[152:155], v[40:43]
  ds_read_b64_tr_b16 a[36:37], v171 offset:18496
  s_mov_b32 s40, s44
  v_mfma_f32_16x16x32_bf16 v[44:47], a[4:7], a[156:159], v[44:47]
  ds_read_b64_tr_b16 a[38:39], v171 offset:23104
  s_mov_b32 s41, s45
  v_mfma_f32_16x16x32_bf16 v[48:51], a[8:11], a[152:155], v[48:51]
  ds_read_b64_tr_b16 a[40:41], v171 offset:18528
  s_mov_b32 s42, 0x240000
  v_mfma_f32_16x16x32_bf16 v[52:55], a[8:11], a[156:159], v[52:55]
  ds_read_b64_tr_b16 a[42:43], v171 offset:23136
  s_mov_b32 s43, 0x20000
  v_mfma_f32_16x16x32_bf16 v[56:59], a[12:15], a[152:155], v[56:59]
  ds_read_b64_tr_b16 a[44:45], v171 offset:18560
  s_add_u32 s64, s4, 0x1200
  v_mfma_f32_16x16x32_bf16 v[60:63], a[12:15], a[156:159], v[60:63]
  ds_read_b64_tr_b16 a[46:47], v171 offset:23168
  s_addc_u32 s65, s5, 0
  s_waitcnt lgkmcnt(8)
  v_mfma_f32_16x16x32_bf16 v[64:67], a[16:19], a[152:155], v[64:67]
  ds_read_b64_tr_b16 a[0:1], v171 offset:18592
  s_mov_b32 s66, 0x9000
  v_mfma_f32_16x16x32_bf16 v[68:71], a[16:19], a[156:159], v[68:71]
  ds_read_b64_tr_b16 a[2:3], v171 offset:23200
  s_mov_b32 s67, 0x20000
  v_mfma_f32_16x16x32_bf16 v[72:75], a[20:23], a[152:155], v[72:75]
  ds_read_b64_tr_b16 a[4:5], v171 offset:18624
  v_lshrrev_b32 v224, 3, v0
  v_mfma_f32_16x16x32_bf16 v[76:79], a[20:23], a[156:159], v[76:79]
  ds_read_b64_tr_b16 a[6:7], v171 offset:23232
  v_lshrrev_b32 v226, 2, v224
  v_mfma_f32_16x16x32_bf16 v[8:11], a[24:27], a[160:163], v[8:11]
  ds_read_b64_tr_b16 a[8:9], v171 offset:18656
  v_lshlrev_b32 v226, 6, v226
  v_mfma_f32_16x16x32_bf16 v[12:15], a[24:27], a[164:167], v[12:15]
  ds_read_b64_tr_b16 a[10:11], v171 offset:23264
  v_and_b32 v224, 3, v224
  v_mfma_f32_16x16x32_bf16 v[16:19], a[28:31], a[160:163], v[16:19]
  ds_read_b64_tr_b16 a[12:13], v172 offset:27648
  v_lshl_add_u32 v226, v224, 3, v226
  v_mfma_f32_16x16x32_bf16 v[20:23], a[28:31], a[164:167], v[20:23]
  ds_read_b64_tr_b16 a[14:15], v172 offset:32256
  v_and_b32 v225, 7, v0
  s_waitcnt lgkmcnt(8)
  v_mfma_f32_16x16x32_bf16 v[24:27], a[32:35], a[160:163], v[24:27]
  ds_read_b64_tr_b16 a[16:17], v171 offset:27648
  s_lshl_b32 s34, s2, 3
  v_mfma_f32_16x16x32_bf16 v[28:31], a[32:35], a[164:167], v[28:31]
  ds_read_b64_tr_b16 a[18:19], v171 offset:32256
  v_add_u32 v225, s34, v225
  v_mfma_f32_16x16x32_bf16 v[32:35], a[36:39], a[160:163], v[32:35]
  ds_read_b64_tr_b16 a[20:21], v171 offset:27680
  v_mul_u32_u24 v225, 0x480, v225
  v_mfma_f32_16x16x32_bf16 v[36:39], a[36:39], a[164:167], v[36:39]
  ds_read_b64_tr_b16 a[22:23], v171 offset:32288
  v_add_u32 v226, v226, v225
  v_mfma_f32_16x16x32_bf16 v[40:43], a[40:43], a[160:163], v[40:43]
  ds_read_b64_tr_b16 a[24:25], v171 offset:27712
  v_lshlrev_b32 v227, 4, v0
  v_mfma_f32_16x16x32_bf16 v[44:47], a[40:43], a[164:167], v[44:47]
  ds_read_b64_tr_b16 a[26:27], v171 offset:32320
  v_add_u32 v224, 0x1000, v227
  v_mfma_f32_16x16x32_bf16 v[48:51], a[44:47], a[160:163], v[48:51]
  ds_read_b64_tr_b16 a[28:29], v171 offset:27744
  v_add_u32 v225, 0x2000, v227
  v_mfma_f32_16x16x32_bf16 v[52:55], a[44:47], a[164:167], v[52:55]
  ds_read_b64_tr_b16 a[30:31], v171 offset:32352
  s_mov_b32 s76, 0x3600
  s_waitcnt lgkmcnt(8)
  v_mfma_f32_16x16x32_bf16 v[56:59], a[0:3], a[160:163], v[56:59]
  ds_read_b64_tr_b16 a[32:33], v171 offset:27776
  s_mov_b32 s77, 0x6c00
  buffer_load_dwordx4 v[188:191], v227, s[64:67], 0 offen
  buffer_load_dwordx4 v[192:195], v224, s[64:67], 0 offen
  buffer_load_dwordx4 v[196:199], v225, s[64:67], 0 offen
  buffer_load_dwordx4 v[200:203], v227, s[64:67], s76 offen
  buffer_load_dwordx4 v[204:207], v224, s[64:67], s76 offen
  buffer_load_dwordx4 v[208:211], v225, s[64:67], s76 offen
  buffer_load_dwordx4 v[212:215], v227, s[64:67], s77 offen
  buffer_load_dwordx4 v[216:219], v224, s[64:67], s77 offen
  buffer_load_dwordx4 v[220:223], v225, s[64:67], s77 offen
  v_mfma_f32_16x16x32_bf16 v[60:63], a[0:3], a[164:167], v[60:63]
  ds_read_b64_tr_b16 a[34:35], v171 offset:32384
  v_mfma_f32_16x16x32_bf16 v[64:67], a[4:7], a[160:163], v[64:67]
  ds_read_b64_tr_b16 a[36:37], v171 offset:27808
  v_mfma_f32_16x16x32_bf16 v[68:71], a[4:7], a[164:167], v[68:71]
  ds_read_b64_tr_b16 a[38:39], v171 offset:32416
  buffer_load_dwordx2 v[176:177], v226, s[40:43], 0 offen
  v_mfma_f32_16x16x32_bf16 v[72:75], a[8:11], a[160:163], v[72:75]
  ds_read_b64_tr_b16 a[40:41], v171 offset:27840
  v_mfma_f32_16x16x32_bf16 v[76:79], a[8:11], a[164:167], v[76:79]
  ds_read_b64_tr_b16 a[42:43], v171 offset:32448
  v_mfma_f32_16x16x32_bf16 v[8:11], a[12:15], a[168:171], v[8:11]
  ds_read_b64_tr_b16 a[44:45], v171 offset:27872
  buffer_load_dwordx2 v[178:179], v226, s[40:43], 0 offen offset:32
  v_mfma_f32_16x16x32_bf16 v[12:15], a[12:15], a[172:175], v[12:15]
  ds_read_b64_tr_b16 a[46:47], v171 offset:32480
  s_waitcnt lgkmcnt(8)
  v_mfma_f32_16x16x32_bf16 v[16:19], a[16:19], a[168:171], v[16:19]
  ds_read_b64_tr_b16 a[0:1], v166
  v_mfma_f32_16x16x32_bf16 v[20:23], a[16:19], a[172:175], v[20:23]
  ds_read_b64_tr_b16 a[2:3], v166 offset:4608
  buffer_load_dwordx2 v[180:181], v226, s[40:43], 0 offen offset:512
  v_mfma_f32_16x16x32_bf16 v[24:27], a[20:23], a[168:171], v[24:27]
  ds_read_b64_tr_b16 a[4:5], v165
  v_mfma_f32_16x16x32_bf16 v[28:31], a[20:23], a[172:175], v[28:31]
  ds_read_b64_tr_b16 a[6:7], v165 offset:4608
  buffer_load_dwordx2 v[182:183], v226, s[40:43], 0 offen offset:544
  v_mfma_f32_16x16x32_bf16 v[32:35], a[24:27], a[168:171], v[32:35]
  ds_read_b64_tr_b16 a[8:9], v165 offset:32
  v_mfma_f32_16x16x32_bf16 v[36:39], a[24:27], a[172:175], v[36:39]
  ds_read_b64_tr_b16 a[10:11], v165 offset:4640
  v_mfma_f32_16x16x32_bf16 v[40:43], a[28:31], a[168:171], v[40:43]
  ds_read_b64_tr_b16 a[12:13], v165 offset:64
  buffer_load_dwordx2 v[184:185], v226, s[40:43], 0 offen offset:1024
  v_mfma_f32_16x16x32_bf16 v[44:47], a[28:31], a[172:175], v[44:47]
  ds_read_b64_tr_b16 a[14:15], v165 offset:4672
  s_waitcnt lgkmcnt(8)
  v_mfma_f32_16x16x32_bf16 v[48:51], a[32:35], a[168:171], v[48:51]
  ds_read_b64_tr_b16 a[16:17], v165 offset:96
  v_mfma_f32_16x16x32_bf16 v[52:55], a[32:35], a[172:175], v[52:55]
  ds_read_b64_tr_b16 a[18:19], v165 offset:4704
  buffer_load_dwordx2 v[186:187], v226, s[40:43], 0 offen offset:1056
  v_mfma_f32_16x16x32_bf16 v[56:59], a[36:39], a[168:171], v[56:59]
  ds_read_b64_tr_b16 a[20:21], v165 offset:128
  v_mfma_f32_16x16x32_bf16 v[60:63], a[36:39], a[172:175], v[60:63]
  ds_read_b64_tr_b16 a[22:23], v165 offset:4736
  v_mfma_f32_16x16x32_bf16 v[64:67], a[40:43], a[168:171], v[64:67]
  ds_read_b64_tr_b16 a[24:25], v165 offset:160
  v_mfma_f32_16x16x32_bf16 v[68:71], a[40:43], a[172:175], v[68:71]
  ds_read_b64_tr_b16 a[26:27], v165 offset:4768
  v_mfma_f32_16x16x32_bf16 v[72:75], a[44:47], a[168:171], v[72:75]
  ds_read_b64_tr_b16 a[28:29], v165 offset:192
  v_mfma_f32_16x16x32_bf16 v[76:79], a[44:47], a[172:175], v[76:79]
  ds_read_b64_tr_b16 a[30:31], v165 offset:4800
  s_waitcnt vmcnt(63) lgkmcnt(14)
  v_mfma_f32_16x16x32_bf16 v[8:11], a[0:3], a[176:179], v[8:11]
  ds_read_b64_tr_b16 a[32:33], v165 offset:224
  v_mfma_f32_16x16x32_bf16 v[12:15], a[0:3], a[180:183], v[12:15]
  ds_read_b64_tr_b16 a[34:35], v165 offset:4832
  s_waitcnt vmcnt(40) lgkmcnt(10)
  s_barrier
  v_mfma_f32_16x16x32_bf16 v[16:19], a[4:7], a[176:179], v[16:19]
  ds_read_b64_tr_b16 a[36:37], v166 offset:9216
  s_add_u32 m0, s60, 0x1b000
  s_nop 0
  buffer_load_dwordx4 v240, s[56:59], s61 offen lds
  v_mfma_f32_16x16x32_bf16 v[20:23], a[4:7], a[180:183], v[20:23]
  ds_read_b64_tr_b16 a[38:39], v166 offset:13824
  s_waitcnt vmcnt(9)
  v_mfma_f32_16x16x32_bf16 v[24:27], a[8:11], a[176:179], v[24:27]
  ds_read_b64_tr_b16 a[40:41], v165 offset:9216
  v_add_u32 v227, 0x24100, v227
  v_mfma_f32_16x16x32_bf16 v[28:31], a[8:11], a[180:183], v[28:31]
  ds_read_b64_tr_b16 a[42:43], v165 offset:13824
  v_add_f32 v188, v188, v200
  v_mfma_f32_16x16x32_bf16 v[32:35], a[12:15], a[176:179], v[32:35]
  ds_read_b64_tr_b16 a[44:45], v165 offset:9248
  v_add_f32 v189, v189, v201
  v_mfma_f32_16x16x32_bf16 v[36:39], a[12:15], a[180:183], v[36:39]
  ds_read_b64_tr_b16 a[46:47], v165 offset:13856
  buffer_load_dwordx4 v241, s[56:59], s61 offen offset:1024 lds
  s_waitcnt lgkmcnt(8)
  v_mfma_f32_16x16x32_bf16 v[40:43], a[16:19], a[176:179], v[40:43]
  ds_read_b64_tr_b16 a[0:1], v165 offset:9280
  v_add_f32 v190, v190, v202
  v_mfma_f32_16x16x32_bf16 v[44:47], a[16:19], a[180:183], v[44:47]
  ds_read_b64_tr_b16 a[2:3], v165 offset:13888
  v_add_f32 v191, v191, v203
  v_mfma_f32_16x16x32_bf16 v[48:51], a[20:23], a[176:179], v[48:51]
  ds_read_b64_tr_b16 a[4:5], v165 offset:9312
  v_add_f32 v188, v188, v212
  v_mfma_f32_16x16x32_bf16 v[52:55], a[20:23], a[180:183], v[52:55]
  ds_read_b64_tr_b16 a[6:7], v165 offset:13920
  v_add_f32 v189, v189, v213
  v_mfma_f32_16x16x32_bf16 v[56:59], a[24:27], a[176:179], v[56:59]
  ds_read_b64_tr_b16 a[8:9], v165 offset:9344
  buffer_load_dwordx4 v242, s[56:59], s61 offen offset:2048 lds
  v_mfma_f32_16x16x32_bf16 v[60:63], a[24:27], a[180:183], v[60:63]
  ds_read_b64_tr_b16 a[10:11], v165 offset:13952
  v_add_f32 v190, v190, v214
  v_mfma_f32_16x16x32_bf16 v[64:67], a[28:31], a[176:179], v[64:67]
  ds_read_b64_tr_b16 a[12:13], v165 offset:9376
  v_add_f32 v191, v191, v215
  v_mfma_f32_16x16x32_bf16 v[68:71], a[28:31], a[180:183], v[68:71]
  ds_read_b64_tr_b16 a[14:15], v165 offset:13984
  v_cvt_pk_bf16_f32 v189, v188, v189
  s_waitcnt vmcnt(10) lgkmcnt(8)
  v_mfma_f32_16x16x32_bf16 v[72:75], a[32:35], a[176:179], v[72:75]
  ds_read_b64_tr_b16 a[16:17], v165 offset:9408
  v_lshlrev_b32 v188, 16, v189
  v_mfma_f32_16x16x32_bf16 v[76:79], a[32:35], a[180:183], v[76:79]
  ds_read_b64_tr_b16 a[18:19], v165 offset:14016
  buffer_load_dwordx4 v243, s[56:59], s61 offen offset:3072 lds
  v_mfma_f32_16x16x32_bf16 v[8:11], a[36:39], a[184:187], v[8:11]
  ds_read_b64_tr_b16 a[20:21], v165 offset:9440
  s_add_u32 m0, s60, 0x1c000
  v_mfma_f32_16x16x32_bf16 v[12:15], a[36:39], a[188:191], v[12:15]
  ds_read_b64_tr_b16 a[22:23], v165 offset:14048
  v_and_b32 v189, 0xffff0000, v189
  v_mfma_f32_16x16x32_bf16 v[16:19], a[40:43], a[184:187], v[16:19]
  ds_read_b64_tr_b16 a[24:25], v166 offset:18432
  v_cvt_pk_bf16_f32 v191, v190, v191
  v_mfma_f32_16x16x32_bf16 v[20:23], a[40:43], a[188:191], v[20:23]
  ds_read_b64_tr_b16 a[26:27], v166 offset:23040
  v_lshlrev_b32 v190, 16, v191
  v_mfma_f32_16x16x32_bf16 v[24:27], a[44:47], a[184:187], v[24:27]
  ds_read_b64_tr_b16 a[28:29], v165 offset:18432
  buffer_load_dwordx4 v244, s[56:59], s61 offen lds
  v_mfma_f32_16x16x32_bf16 v[28:31], a[44:47], a[188:191], v[28:31]
  ds_read_b64_tr_b16 a[30:31], v165 offset:23040
  v_and_b32 v191, 0xffff0000, v191
  s_waitcnt lgkmcnt(8)
  v_mfma_f32_16x16x32_bf16 v[32:35], a[0:3], a[184:187], v[32:35]
  ds_read_b64_tr_b16 a[32:33], v165 offset:18464
  ds_write_b128 v227, v[188:191]
  v_mfma_f32_16x16x32_bf16 v[36:39], a[0:3], a[188:191], v[36:39]
  ds_read_b64_tr_b16 a[34:35], v165 offset:23072
  v_add_f32 v192, v192, v204
  v_mfma_f32_16x16x32_bf16 v[40:43], a[4:7], a[184:187], v[40:43]
  ds_read_b64_tr_b16 a[36:37], v165 offset:18496
  v_add_f32 v193, v193, v205
  v_mfma_f32_16x16x32_bf16 v[44:47], a[4:7], a[188:191], v[44:47]
  ds_read_b64_tr_b16 a[38:39], v165 offset:23104
  buffer_load_dwordx4 v245, s[56:59], s61 offen offset:1024 lds
  v_mfma_f32_16x16x32_bf16 v[48:51], a[8:11], a[184:187], v[48:51]
  ds_read_b64_tr_b16 a[40:41], v165 offset:18528
  v_add_f32 v194, v194, v206
  v_mfma_f32_16x16x32_bf16 v[52:55], a[8:11], a[188:191], v[52:55]
  ds_read_b64_tr_b16 a[42:43], v165 offset:23136
  v_add_f32 v195, v195, v207
  v_mfma_f32_16x16x32_bf16 v[56:59], a[12:15], a[184:187], v[56:59]
  ds_read_b64_tr_b16 a[44:45], v165 offset:18560
  v_add_f32 v192, v192, v216
  v_mfma_f32_16x16x32_bf16 v[60:63], a[12:15], a[188:191], v[60:63]
  ds_read_b64_tr_b16 a[46:47], v165 offset:23168
  v_add_f32 v193, v193, v217
  s_waitcnt lgkmcnt(9)
  v_mfma_f32_16x16x32_bf16 v[64:67], a[16:19], a[184:187], v[64:67]
  ds_read_b64_tr_b16 a[0:1], v165 offset:18592
  buffer_load_dwordx4 v246, s[56:59], s61 offen offset:2048 lds
  v_mfma_f32_16x16x32_bf16 v[68:71], a[16:19], a[188:191], v[68:71]
  ds_read_b64_tr_b16 a[2:3], v165 offset:23200
  v_add_f32 v194, v194, v218
  v_mfma_f32_16x16x32_bf16 v[72:75], a[20:23], a[184:187], v[72:75]
  ds_read_b64_tr_b16 a[4:5], v165 offset:18624
  v_add_f32 v195, v195, v219
  v_mfma_f32_16x16x32_bf16 v[76:79], a[20:23], a[188:191], v[76:79]
  ds_read_b64_tr_b16 a[6:7], v165 offset:23232
  v_cvt_pk_bf16_f32 v193, v192, v193
  v_mfma_f32_16x16x32_bf16 v[8:11], a[24:27], a[192:195], v[8:11]
  ds_read_b64_tr_b16 a[8:9], v165 offset:18656
  v_lshlrev_b32 v192, 16, v193
  v_mfma_f32_16x16x32_bf16 v[12:15], a[24:27], a[196:199], v[12:15]
  ds_read_b64_tr_b16 a[10:11], v165 offset:23264
  buffer_load_dwordx4 v247, s[56:59], s61 offen offset:3072 lds
  v_mfma_f32_16x16x32_bf16 v[16:19], a[28:31], a[192:195], v[16:19]
  ds_read_b64_tr_b16 a[12:13], v166 offset:27648
  s_add_u32 m0, s60, 0x1d000
  v_mfma_f32_16x16x32_bf16 v[20:23], a[28:31], a[196:199], v[20:23]
  ds_read_b64_tr_b16 a[14:15], v166 offset:32256
  v_and_b32 v193, 0xffff0000, v193
  s_waitcnt lgkmcnt(8)
  v_mfma_f32_16x16x32_bf16 v[24:27], a[32:35], a[192:195], v[24:27]
  ds_read_b64_tr_b16 a[16:17], v165 offset:27648
  v_cvt_pk_bf16_f32 v195, v194, v195
  v_mfma_f32_16x16x32_bf16 v[28:31], a[32:35], a[196:199], v[28:31]
  ds_read_b64_tr_b16 a[18:19], v165 offset:32256
  v_lshlrev_b32 v194, 16, v195
  v_mfma_f32_16x16x32_bf16 v[32:35], a[36:39], a[192:195], v[32:35]
  ds_read_b64_tr_b16 a[20:21], v165 offset:27680
  buffer_load_dwordx4 v248, s[56:59], s61 offen lds
  v_mfma_f32_16x16x32_bf16 v[36:39], a[36:39], a[196:199], v[36:39]
  ds_read_b64_tr_b16 a[22:23], v165 offset:32288
  s_add_u32 s61, s61, 0x24000
  v_mfma_f32_16x16x32_bf16 v[40:43], a[40:43], a[192:195], v[40:43]
  ds_read_b64_tr_b16 a[24:25], v165 offset:27712
  v_lshlrev_b32 v252, 7, v0
  v_mfma_f32_16x16x32_bf16 v[44:47], a[40:43], a[196:199], v[44:47]
  ds_read_b64_tr_b16 a[26:27], v165 offset:32320
  v_and_b32 v195, 0xffff0000, v195
  v_mfma_f32_16x16x32_bf16 v[48:51], a[44:47], a[192:195], v[48:51]
  ds_read_b64_tr_b16 a[28:29], v165 offset:27744
  ds_write_b128 v227, v[192:195] offset:4096
  v_mfma_f32_16x16x32_bf16 v[52:55], a[44:47], a[196:199], v[52:55]
  ds_read_b64_tr_b16 a[30:31], v165 offset:32352
  buffer_load_dword v253, v252, s[72:75], 0 offen
  s_waitcnt vmcnt(16) lgkmcnt(9)
  v_mfma_f32_16x16x32_bf16 v[56:59], a[0:3], a[192:195], v[56:59]
  ds_read_b64_tr_b16 a[32:33], v165 offset:27776
  v_add_f32 v196, v196, v208
  v_mfma_f32_16x16x32_bf16 v[60:63], a[0:3], a[196:199], v[60:63]
  ds_read_b64_tr_b16 a[34:35], v165 offset:32384
  v_add_f32 v197, v197, v209
  v_mfma_f32_16x16x32_bf16 v[64:67], a[4:7], a[192:195], v[64:67]
  ds_read_b64_tr_b16 a[36:37], v165 offset:27808
  v_add_f32 v198, v198, v210
  v_mfma_f32_16x16x32_bf16 v[68:71], a[4:7], a[196:199], v[68:71]
  ds_read_b64_tr_b16 a[38:39], v165 offset:32416
  v_add_f32 v199, v199, v211
  v_mfma_f32_16x16x32_bf16 v[72:75], a[8:11], a[192:195], v[72:75]
  ds_read_b64_tr_b16 a[40:41], v165 offset:27840
  v_add_f32 v196, v196, v220
  v_mfma_f32_16x16x32_bf16 v[76:79], a[8:11], a[196:199], v[76:79]
  ds_read_b64_tr_b16 a[42:43], v165 offset:32448
  v_add_f32 v197, v197, v221
  v_mfma_f32_16x16x32_bf16 v[8:11], a[12:15], a[200:203], v[8:11]
  ds_read_b64_tr_b16 a[44:45], v165 offset:27872
  v_add_f32 v198, v198, v222
  s_waitcnt vmcnt(25)
  s_barrier
  v_mfma_f32_16x16x32_bf16 v[12:15], a[12:15], a[204:207], v[12:15]
  ds_read_b64_tr_b16 a[46:47], v165 offset:32480
  v_add_f32 v199, v199, v223
  s_waitcnt lgkmcnt(8)
  v_mfma_f32_16x16x32_bf16 v[16:19], a[16:19], a[200:203], v[16:19]
  ds_read_b64_tr_b16 a[0:1], v168
  v_cvt_pk_bf16_f32 v197, v196, v197
  v_mfma_f32_16x16x32_bf16 v[20:23], a[16:19], a[204:207], v[20:23]
  ds_read_b64_tr_b16 a[2:3], v168 offset:4608
  v_lshlrev_b32 v196, 16, v197
  v_mfma_f32_16x16x32_bf16 v[24:27], a[20:23], a[200:203], v[24:27]
  ds_read_b64_tr_b16 a[4:5], v168 offset:9216
  v_and_b32 v197, 0xffff0000, v197
  v_mfma_f32_16x16x32_bf16 v[28:31], a[20:23], a[204:207], v[28:31]
  ds_read_b64_tr_b16 a[6:7], v168 offset:13824
  v_cvt_pk_bf16_f32 v199, v198, v199
  v_mfma_f32_16x16x32_bf16 v[32:35], a[24:27], a[200:203], v[32:35]
  ds_read_b64_tr_b16 a[8:9], v168 offset:18432
  v_lshlrev_b32 v198, 16, v199
  v_mfma_f32_16x16x32_bf16 v[36:39], a[24:27], a[204:207], v[36:39]
  ds_read_b64_tr_b16 a[10:11], v168 offset:23040
  v_and_b32 v199, 0xffff0000, v199
  v_mfma_f32_16x16x32_bf16 v[40:43], a[28:31], a[200:203], v[40:43]
  ds_read_b64_tr_b16 a[12:13], v168 offset:27648
  ds_write_b128 v227, v[196:199] offset:8192
  v_mfma_f32_16x16x32_bf16 v[44:47], a[28:31], a[204:207], v[44:47]
  ds_read_b64_tr_b16 a[14:15], v168 offset:32256
  s_waitcnt lgkmcnt(9)
  v_mfma_f32_16x16x32_bf16 v[48:51], a[32:35], a[200:203], v[48:51]
  ds_read_b64_tr_b16 a[16:17], v170
  v_mfma_f32_16x16x32_bf16 v[52:55], a[32:35], a[204:207], v[52:55]
  ds_read_b64_tr_b16 a[18:19], v170 offset:4608
  v_mfma_f32_16x16x32_bf16 v[56:59], a[36:39], a[200:203], v[56:59]
  ds_read_b64_tr_b16 a[20:21], v170 offset:9216
  v_mfma_f32_16x16x32_bf16 v[60:63], a[36:39], a[204:207], v[60:63]
  ds_read_b64_tr_b16 a[22:23], v170 offset:13824
  v_mfma_f32_16x16x32_bf16 v[64:67], a[40:43], a[200:203], v[64:67]
  ds_read_b64_tr_b16 a[24:25], v170 offset:18432
  v_mfma_f32_16x16x32_bf16 v[68:71], a[40:43], a[204:207], v[68:71]
  ds_read_b64_tr_b16 a[26:27], v170 offset:23040
  v_mfma_f32_16x16x32_bf16 v[72:75], a[44:47], a[200:203], v[72:75]
  ds_read_b64_tr_b16 a[28:29], v170 offset:27648
  v_mfma_f32_16x16x32_bf16 v[76:79], a[44:47], a[204:207], v[76:79]
  ds_read_b64_tr_b16 a[30:31], v170 offset:32256
  s_nop 0
  s_waitcnt vmcnt(1) lgkmcnt(8)
  s_barrier
  v_mfma_f32_16x16x32_bf16 v[8:11], a[0:3], a[208:211], v[8:11]
  ds_read_b64_tr_b16 a[32:33], v172
  v_lshrrev_b32 v4, 3, v0
  v_mfma_f32_16x16x32_bf16 v[12:15], a[0:3], a[212:215], v[12:15]
  ds_read_b64_tr_b16 a[34:35], v172 offset:4608
  v_and_b32 v5, 7, v0
  v_mfma_f32_16x16x32_bf16 v[8:11], a[4:7], a[216:219], v[8:11]
  ds_read_b64_tr_b16 a[36:37], v172 offset:9216
  v_lshlrev_b32 v1, 8, v4
  v_mfma_f32_16x16x32_bf16 v[12:15], a[4:7], a[220:223], v[12:15]
  ds_read_b64_tr_b16 a[38:39], v172 offset:13824
  v_lshl_add_u32 v1, v5, 4, v1
  v_mfma_f32_16x16x32_bf16 v[8:11], a[8:11], a[224:227], v[8:11]
  ds_read_b64_tr_b16 a[40:41], v172 offset:18432
  s_lshr_b32 s34, s2, 1
  v_mfma_f32_16x16x32_bf16 v[12:15], a[8:11], a[228:231], v[12:15]
  ds_read_b64_tr_b16 a[42:43], v172 offset:23040
  s_mul_i32 s34, s34, 0x4800
  v_mfma_f32_16x16x32_bf16 v[8:11], a[12:15], a[232:235], v[8:11]
  ds_read_b64_tr_b16 a[44:45], v172 offset:27648
  s_and_b32 s35, s2, 1
  v_mfma_f32_16x16x32_bf16 v[12:15], a[12:15], a[236:239], v[12:15]
  ds_read_b64_tr_b16 a[46:47], v172 offset:32256
  s_waitcnt lgkmcnt(8)
  v_mfma_f32_16x16x32_bf16 v[8:11], a[16:19], a[48:51], v[8:11]
  ds_read_b64_tr_b16 a[0:1], v167
  s_lshl_b32 s35, s35, 7
  v_mfma_f32_16x16x32_bf16 v[12:15], a[16:19], a[52:55], v[12:15]
  ds_read_b64_tr_b16 a[2:3], v167 offset:4608
  s_add_u32 s34, s34, s35
  v_mfma_f32_16x16x32_bf16 v[8:11], a[20:23], a[56:59], v[8:11]
  ds_read_b64_tr_b16 a[4:5], v167 offset:9216
  v_add_u32 v1, s34, v1
  v_mfma_f32_16x16x32_bf16 v[12:15], a[20:23], a[60:63], v[12:15]
  ds_read_b64_tr_b16 a[6:7], v167 offset:13824
  v_cmp_gt_u32 vcc, 64, v0
  v_mfma_f32_16x16x32_bf16 v[8:11], a[24:27], a[64:67], v[8:11]
  ds_read_b64_tr_b16 a[8:9], v167 offset:18432
  v_mov_b32 v6, 0x40000000
  v_mfma_f32_16x16x32_bf16 v[12:15], a[24:27], a[68:71], v[12:15]
  ds_read_b64_tr_b16 a[10:11], v167 offset:23040
  s_mov_b64 s[54:55], vcc
  v_mfma_f32_16x16x32_bf16 v[8:11], a[28:31], a[72:75], v[8:11]
  ds_read_b64_tr_b16 a[12:13], v167 offset:27648
  v_add_u32 v7, 0x4000, v1
  v_mfma_f32_16x16x32_bf16 v[12:15], a[28:31], a[76:79], v[12:15]
  ds_read_b64_tr_b16 a[14:15], v167 offset:32256
  s_waitcnt lgkmcnt(8)
  v_mfma_f32_16x16x32_bf16 v[8:11], a[32:35], a[80:83], v[8:11]
  ds_read_b64_tr_b16 a[16:17], v169
  v_cndmask_b32 v7, v6, v7, vcc
  v_mfma_f32_16x16x32_bf16 v[12:15], a[32:35], a[84:87], v[12:15]
  ds_read_b64_tr_b16 a[18:19], v169 offset:4608
  v_lshrrev_b32 v3, 2, v4
  v_mfma_f32_16x16x32_bf16 v[8:11], a[36:39], a[88:91], v[8:11]
  ds_read_b64_tr_b16 a[20:21], v169 offset:9216
  v_lshlrev_b32 v3, 6, v3
  v_mfma_f32_16x16x32_bf16 v[12:15], a[36:39], a[92:95], v[12:15]
  ds_read_b64_tr_b16 a[22:23], v169 offset:13824
  v_and_b32 v6, 3, v4
  v_mfma_f32_16x16x32_bf16 v[8:11], a[40:43], a[96:99], v[8:11]
  ds_read_b64_tr_b16 a[24:25], v169 offset:18432
  v_lshl_add_u32 v3, v6, 3, v3
  v_mfma_f32_16x16x32_bf16 v[12:15], a[40:43], a[100:103], v[12:15]
  ds_read_b64_tr_b16 a[26:27], v169 offset:23040
  s_lshl_b32 s34, s2, 3
  v_mfma_f32_16x16x32_bf16 v[8:11], a[44:47], a[104:107], v[8:11]
  ds_read_b64_tr_b16 a[28:29], v169 offset:27648
  v_add_u32 v2, s34, v5
  v_mfma_f32_16x16x32_bf16 v[12:15], a[44:47], a[108:111], v[12:15]
  ds_read_b64_tr_b16 a[30:31], v169 offset:32256
  s_waitcnt lgkmcnt(8)
  v_mfma_f32_16x16x32_bf16 v[16:19], a[0:3], a[208:211], v[16:19]
  ds_read_b64_tr_b16 a[32:33], v171
  v_mul_u32_u24 v2, 0x480, v2
  v_mfma_f32_16x16x32_bf16 v[20:23], a[0:3], a[212:215], v[20:23]
  ds_read_b64_tr_b16 a[34:35], v171 offset:4608
  v_add_u32 v2, v2, v3
  v_mfma_f32_16x16x32_bf16 v[16:19], a[4:7], a[216:219], v[16:19]
  ds_read_b64_tr_b16 a[36:37], v171 offset:9216
  v_lshlrev_b32 v3, 1, v3
  v_mfma_f32_16x16x32_bf16 v[20:23], a[4:7], a[220:223], v[20:23]
  ds_read_b64_tr_b16 a[38:39], v171 offset:13824
  s_add_u32 s8, s4, 0x3400000
  v_mfma_f32_16x16x32_bf16 v[16:19], a[8:11], a[224:227], v[16:19]
  ds_read_b64_tr_b16 a[40:41], v171 offset:18432
  s_addc_u32 s9, s5, 0
  v_mfma_f32_16x16x32_bf16 v[20:23], a[8:11], a[228:231], v[20:23]
  ds_read_b64_tr_b16 a[42:43], v171 offset:23040
  s_mov_b32 s10, 0x900000
  v_mfma_f32_16x16x32_bf16 v[16:19], a[12:15], a[232:235], v[16:19]
  ds_read_b64_tr_b16 a[44:45], v171 offset:27648
  v_cvt_pk_bf16_f32 v8, v8, v9
  v_mfma_f32_16x16x32_bf16 v[20:23], a[12:15], a[236:239], v[20:23]
  ds_read_b64_tr_b16 a[46:47], v171 offset:32256
  s_waitcnt lgkmcnt(8)
  v_mfma_f32_16x16x32_bf16 v[16:19], a[16:19], a[48:51], v[16:19]
  ds_read_b64_tr_b16 a[0:1], v167 offset:32
  v_cvt_pk_bf16_f32 v9, v10, v11
  v_mfma_f32_16x16x32_bf16 v[20:23], a[16:19], a[52:55], v[20:23]
  ds_read_b64_tr_b16 a[2:3], v167 offset:4640
  s_mov_b32 s11, 0x20000
  v_mfma_f32_16x16x32_bf16 v[16:19], a[20:23], a[56:59], v[16:19]
  ds_read_b64_tr_b16 a[4:5], v167 offset:9248
  v_cvt_pk_bf16_f32 v12, v12, v13
  v_mfma_f32_16x16x32_bf16 v[20:23], a[20:23], a[60:63], v[20:23]
  ds_read_b64_tr_b16 a[6:7], v167 offset:13856
  s_add_u32 s24, s4, 0x1900000
  v_mfma_f32_16x16x32_bf16 v[16:19], a[24:27], a[64:67], v[16:19]
  ds_read_b64_tr_b16 a[8:9], v167 offset:18464
  v_cvt_pk_bf16_f32 v13, v14, v15
  v_mfma_f32_16x16x32_bf16 v[20:23], a[24:27], a[68:71], v[20:23]
  ds_read_b64_tr_b16 a[10:11], v167 offset:23072
  s_addc_u32 s25, s5, 0
  v_mfma_f32_16x16x32_bf16 v[16:19], a[28:31], a[72:75], v[16:19]
  ds_read_b64_tr_b16 a[12:13], v167 offset:27680
  buffer_store_dwordx2 v[8:9], v174, s[16:19], s48 offen sc1
  v_mfma_f32_16x16x32_bf16 v[20:23], a[28:31], a[76:79], v[20:23]
  ds_read_b64_tr_b16 a[14:15], v167 offset:32288
  s_waitcnt lgkmcnt(8)
  v_mfma_f32_16x16x32_bf16 v[16:19], a[32:35], a[80:83], v[16:19]
  ds_read_b64_tr_b16 a[16:17], v169 offset:32
  buffer_store_dwordx2 v[12:13], v174, s[16:19], s49 offen sc1
  v_mfma_f32_16x16x32_bf16 v[20:23], a[32:35], a[84:87], v[20:23]
  ds_read_b64_tr_b16 a[18:19], v169 offset:4640
  s_mov_b32 s26, 0x240000
  v_mfma_f32_16x16x32_bf16 v[16:19], a[36:39], a[88:91], v[16:19]
  ds_read_b64_tr_b16 a[20:21], v169 offset:9248
  s_mov_b32 s27, 0x20000
  v_mfma_f32_16x16x32_bf16 v[20:23], a[36:39], a[92:95], v[20:23]
  ds_read_b64_tr_b16 a[22:23], v169 offset:13856
  s_mov_b32 s79, 0x2000
  v_mfma_f32_16x16x32_bf16 v[16:19], a[40:43], a[96:99], v[16:19]
  ds_read_b64_tr_b16 a[24:25], v169 offset:18464
  v_add_u32 v3, 0x24100, v3
  v_mfma_f32_16x16x32_bf16 v[20:23], a[40:43], a[100:103], v[20:23]
  ds_read_b64_tr_b16 a[26:27], v169 offset:23072
  s_mov_b32 s56, 0
  v_mfma_f32_16x16x32_bf16 v[16:19], a[44:47], a[104:107], v[16:19]
  ds_read_b64_tr_b16 a[28:29], v169 offset:27680
  s_mov_b32 s60, 0x2000
  v_mfma_f32_16x16x32_bf16 v[20:23], a[44:47], a[108:111], v[20:23]
  ds_read_b64_tr_b16 a[30:31], v169 offset:32288
  s_waitcnt lgkmcnt(8)
  v_mfma_f32_16x16x32_bf16 v[24:27], a[0:3], a[208:211], v[24:27]
  ds_read_b64_tr_b16 a[32:33], v171 offset:32
  s_mov_b32 s57, 0x240000
  v_mfma_f32_16x16x32_bf16 v[28:31], a[0:3], a[212:215], v[28:31]
  ds_read_b64_tr_b16 a[34:35], v171 offset:4640
  s_mov_b32 s61, 0x242000
  v_mfma_f32_16x16x32_bf16 v[24:27], a[4:7], a[216:219], v[24:27]
  ds_read_b64_tr_b16 a[36:37], v171 offset:9248
  s_mov_b32 s58, 0x480000
  v_mfma_f32_16x16x32_bf16 v[28:31], a[4:7], a[220:223], v[28:31]
  ds_read_b64_tr_b16 a[38:39], v171 offset:13856
  s_mov_b32 s62, 0x482000
  v_mfma_f32_16x16x32_bf16 v[24:27], a[8:11], a[224:227], v[24:27]
  ds_read_b64_tr_b16 a[40:41], v171 offset:18464
  s_mov_b32 s59, 0x6c0000
  v_mfma_f32_16x16x32_bf16 v[28:31], a[8:11], a[228:231], v[28:31]
  ds_read_b64_tr_b16 a[42:43], v171 offset:23072
  s_mov_b32 s63, 0x6c2000
  v_mfma_f32_16x16x32_bf16 v[24:27], a[12:15], a[232:235], v[24:27]
  ds_read_b64_tr_b16 a[44:45], v171 offset:27680
  v_cvt_pk_bf16_f32 v16, v16, v17
  v_mfma_f32_16x16x32_bf16 v[28:31], a[12:15], a[236:239], v[28:31]
  ds_read_b64_tr_b16 a[46:47], v171 offset:32288
  s_waitcnt lgkmcnt(8)
  v_mfma_f32_16x16x32_bf16 v[24:27], a[16:19], a[48:51], v[24:27]
  ds_read_b64_tr_b16 a[0:1], v167 offset:64
  v_cvt_pk_bf16_f32 v17, v18, v19
  v_mfma_f32_16x16x32_bf16 v[28:31], a[16:19], a[52:55], v[28:31]
  ds_read_b64_tr_b16 a[2:3], v167 offset:4672
  s_lshr_b32 s34, s2, 4
  v_mfma_f32_16x16x32_bf16 v[24:27], a[20:23], a[56:59], v[24:27]
  ds_read_b64_tr_b16 a[4:5], v167 offset:9280
  v_cvt_pk_bf16_f32 v20, v20, v21
  v_mfma_f32_16x16x32_bf16 v[28:31], a[20:23], a[60:63], v[28:31]
  ds_read_b64_tr_b16 a[6:7], v167 offset:13888
  s_lshl_b32 s34, s34, 11
  v_mfma_f32_16x16x32_bf16 v[24:27], a[24:27], a[64:67], v[24:27]
  ds_read_b64_tr_b16 a[8:9], v167 offset:18496
  v_cvt_pk_bf16_f32 v21, v22, v23
  v_mfma_f32_16x16x32_bf16 v[28:31], a[24:27], a[68:71], v[28:31]
  ds_read_b64_tr_b16 a[10:11], v167 offset:23104
  s_add_u32 s34, s34, 0
  v_mfma_f32_16x16x32_bf16 v[24:27], a[28:31], a[72:75], v[24:27]
  ds_read_b64_tr_b16 a[12:13], v167 offset:27712
  v_and_b32 v4, 15, v0
  v_mfma_f32_16x16x32_bf16 v[28:31], a[28:31], a[76:79], v[28:31]
  ds_read_b64_tr_b16 a[14:15], v167 offset:32320
  s_waitcnt lgkmcnt(8)
  v_mfma_f32_16x16x32_bf16 v[24:27], a[32:35], a[80:83], v[24:27]
  ds_read_b64_tr_b16 a[16:17], v169 offset:64
  v_lshl_add_u32 v4, v4, 7, s34
  v_mfma_f32_16x16x32_bf16 v[28:31], a[32:35], a[84:87], v[28:31]
  ds_read_b64_tr_b16 a[18:19], v169 offset:4672
  v_mfma_f32_16x16x32_bf16 v[24:27], a[36:39], a[88:91], v[24:27]
  ds_read_b64_tr_b16 a[20:21], v169 offset:9280
  v_mfma_f32_16x16x32_bf16 v[28:31], a[36:39], a[92:95], v[28:31]
  ds_read_b64_tr_b16 a[22:23], v169 offset:13888
  v_mfma_f32_16x16x32_bf16 v[24:27], a[40:43], a[96:99], v[24:27]
  ds_read_b64_tr_b16 a[24:25], v169 offset:18496
  v_mfma_f32_16x16x32_bf16 v[28:31], a[40:43], a[100:103], v[28:31]
  ds_read_b64_tr_b16 a[26:27], v169 offset:23104
  v_mfma_f32_16x16x32_bf16 v[24:27], a[44:47], a[104:107], v[24:27]
  ds_read_b64_tr_b16 a[28:29], v169 offset:27712
  v_mfma_f32_16x16x32_bf16 v[28:31], a[44:47], a[108:111], v[28:31]
  ds_read_b64_tr_b16 a[30:31], v169 offset:32320
  s_waitcnt lgkmcnt(8)
  v_mfma_f32_16x16x32_bf16 v[32:35], a[0:3], a[208:211], v[32:35]
  ds_read_b64_tr_b16 a[32:33], v171 offset:64
  v_mfma_f32_16x16x32_bf16 v[36:39], a[0:3], a[212:215], v[36:39]
  ds_read_b64_tr_b16 a[34:35], v171 offset:4672
  v_mfma_f32_16x16x32_bf16 v[32:35], a[4:7], a[216:219], v[32:35]
  ds_read_b64_tr_b16 a[36:37], v171 offset:9280
  v_mfma_f32_16x16x32_bf16 v[36:39], a[4:7], a[220:223], v[36:39]
  ds_read_b64_tr_b16 a[38:39], v171 offset:13888
  v_mfma_f32_16x16x32_bf16 v[32:35], a[8:11], a[224:227], v[32:35]
  ds_read_b64_tr_b16 a[40:41], v171 offset:18496
  v_mfma_f32_16x16x32_bf16 v[36:39], a[8:11], a[228:231], v[36:39]
  ds_read_b64_tr_b16 a[42:43], v171 offset:23104
  v_mfma_f32_16x16x32_bf16 v[32:35], a[12:15], a[232:235], v[32:35]
  ds_read_b64_tr_b16 a[44:45], v171 offset:27712
  v_cvt_pk_bf16_f32 v18, v24, v25
  v_mfma_f32_16x16x32_bf16 v[36:39], a[12:15], a[236:239], v[36:39]
  ds_read_b64_tr_b16 a[46:47], v171 offset:32320
  s_waitcnt lgkmcnt(8)
  v_mfma_f32_16x16x32_bf16 v[32:35], a[16:19], a[48:51], v[32:35]
  ds_read_b64_tr_b16 a[0:1], v167 offset:96
  v_cvt_pk_bf16_f32 v19, v26, v27
  v_mfma_f32_16x16x32_bf16 v[36:39], a[16:19], a[52:55], v[36:39]
  ds_read_b64_tr_b16 a[2:3], v167 offset:4704
  v_mfma_f32_16x16x32_bf16 v[32:35], a[20:23], a[56:59], v[32:35]
  ds_read_b64_tr_b16 a[4:5], v167 offset:9312
  v_cvt_pk_bf16_f32 v22, v28, v29
  v_mfma_f32_16x16x32_bf16 v[36:39], a[20:23], a[60:63], v[36:39]
  ds_read_b64_tr_b16 a[6:7], v167 offset:13920
  v_mfma_f32_16x16x32_bf16 v[32:35], a[24:27], a[64:67], v[32:35]
  ds_read_b64_tr_b16 a[8:9], v167 offset:18528
  v_cvt_pk_bf16_f32 v23, v30, v31
  v_mfma_f32_16x16x32_bf16 v[36:39], a[24:27], a[68:71], v[36:39]
  ds_read_b64_tr_b16 a[10:11], v167 offset:23136
  v_mfma_f32_16x16x32_bf16 v[32:35], a[28:31], a[72:75], v[32:35]
  ds_read_b64_tr_b16 a[12:13], v167 offset:27744
  buffer_store_dwordx4 v[16:19], v173, s[16:19], s48 offen sc1
  v_mfma_f32_16x16x32_bf16 v[36:39], a[28:31], a[76:79], v[36:39]
  ds_read_b64_tr_b16 a[14:15], v167 offset:32352
  s_waitcnt lgkmcnt(8)
  v_mfma_f32_16x16x32_bf16 v[32:35], a[32:35], a[80:83], v[32:35]
  ds_read_b64_tr_b16 a[16:17], v169 offset:96
  buffer_store_dwordx4 v[20:23], v173, s[16:19], s49 offen sc1
  v_mfma_f32_16x16x32_bf16 v[36:39], a[32:35], a[84:87], v[36:39]
  ds_read_b64_tr_b16 a[18:19], v169 offset:4704
  v_mfma_f32_16x16x32_bf16 v[32:35], a[36:39], a[88:91], v[32:35]
  ds_read_b64_tr_b16 a[20:21], v169 offset:9312
  v_mfma_f32_16x16x32_bf16 v[36:39], a[36:39], a[92:95], v[36:39]
  ds_read_b64_tr_b16 a[22:23], v169 offset:13920
  v_mfma_f32_16x16x32_bf16 v[32:35], a[40:43], a[96:99], v[32:35]
  ds_read_b64_tr_b16 a[24:25], v169 offset:18528
  v_mfma_f32_16x16x32_bf16 v[36:39], a[40:43], a[100:103], v[36:39]
  ds_read_b64_tr_b16 a[26:27], v169 offset:23136
  v_mfma_f32_16x16x32_bf16 v[32:35], a[44:47], a[104:107], v[32:35]
  ds_read_b64_tr_b16 a[28:29], v169 offset:27744
  v_mfma_f32_16x16x32_bf16 v[36:39], a[44:47], a[108:111], v[36:39]
  ds_read_b64_tr_b16 a[30:31], v169 offset:32352
  s_waitcnt lgkmcnt(8)
  v_mfma_f32_16x16x32_bf16 v[40:43], a[0:3], a[208:211], v[40:43]
  ds_read_b64_tr_b16 a[32:33], v171 offset:96
  v_mfma_f32_16x16x32_bf16 v[44:47], a[0:3], a[212:215], v[44:47]
  ds_read_b64_tr_b16 a[34:35], v171 offset:4704
  v_mfma_f32_16x16x32_bf16 v[40:43], a[4:7], a[216:219], v[40:43]
  ds_read_b64_tr_b16 a[36:37], v171 offset:9312
  v_mfma_f32_16x16x32_bf16 v[44:47], a[4:7], a[220:223], v[44:47]
  ds_read_b64_tr_b16 a[38:39], v171 offset:13920
  v_mfma_f32_16x16x32_bf16 v[40:43], a[8:11], a[224:227], v[40:43]
  ds_read_b64_tr_b16 a[40:41], v171 offset:18528
  v_mfma_f32_16x16x32_bf16 v[44:47], a[8:11], a[228:231], v[44:47]
  ds_read_b64_tr_b16 a[42:43], v171 offset:23136
  v_mfma_f32_16x16x32_bf16 v[40:43], a[12:15], a[232:235], v[40:43]
  ds_read_b64_tr_b16 a[44:45], v171 offset:27744
  v_cvt_pk_bf16_f32 v32, v32, v33
  v_mfma_f32_16x16x32_bf16 v[44:47], a[12:15], a[236:239], v[44:47]
  ds_read_b64_tr_b16 a[46:47], v171 offset:32352
  s_waitcnt lgkmcnt(8)
  v_mfma_f32_16x16x32_bf16 v[40:43], a[16:19], a[48:51], v[40:43]
  ds_read_b64_tr_b16 a[0:1], v167 offset:128
  v_cvt_pk_bf16_f32 v33, v34, v35
  v_mfma_f32_16x16x32_bf16 v[44:47], a[16:19], a[52:55], v[44:47]
  ds_read_b64_tr_b16 a[2:3], v167 offset:4736
  v_mfma_f32_16x16x32_bf16 v[40:43], a[20:23], a[56:59], v[40:43]
  ds_read_b64_tr_b16 a[4:5], v167 offset:9344
  v_cvt_pk_bf16_f32 v36, v36, v37
  v_mfma_f32_16x16x32_bf16 v[44:47], a[20:23], a[60:63], v[44:47]
  ds_read_b64_tr_b16 a[6:7], v167 offset:13952
  v_mfma_f32_16x16x32_bf16 v[40:43], a[24:27], a[64:67], v[40:43]
  ds_read_b64_tr_b16 a[8:9], v167 offset:18560
  v_cvt_pk_bf16_f32 v37, v38, v39
  v_mfma_f32_16x16x32_bf16 v[44:47], a[24:27], a[68:71], v[44:47]
  ds_read_b64_tr_b16 a[10:11], v167 offset:23168
  v_mfma_f32_16x16x32_bf16 v[40:43], a[28:31], a[72:75], v[40:43]
  ds_read_b64_tr_b16 a[12:13], v167 offset:27776
  v_mfma_f32_16x16x32_bf16 v[44:47], a[28:31], a[76:79], v[44:47]
  ds_read_b64_tr_b16 a[14:15], v167 offset:32384
  s_waitcnt lgkmcnt(8)
  v_mfma_f32_16x16x32_bf16 v[40:43], a[32:35], a[80:83], v[40:43]
  ds_read_b64_tr_b16 a[16:17], v169 offset:128
  v_mfma_f32_16x16x32_bf16 v[44:47], a[32:35], a[84:87], v[44:47]
  ds_read_b64_tr_b16 a[18:19], v169 offset:4736
  v_mfma_f32_16x16x32_bf16 v[40:43], a[36:39], a[88:91], v[40:43]
  ds_read_b64_tr_b16 a[20:21], v169 offset:9344
  v_mfma_f32_16x16x32_bf16 v[44:47], a[36:39], a[92:95], v[44:47]
  ds_read_b64_tr_b16 a[22:23], v169 offset:13952
  v_mfma_f32_16x16x32_bf16 v[40:43], a[40:43], a[96:99], v[40:43]
  ds_read_b64_tr_b16 a[24:25], v169 offset:18560
  v_mfma_f32_16x16x32_bf16 v[44:47], a[40:43], a[100:103], v[44:47]
  ds_read_b64_tr_b16 a[26:27], v169 offset:23168
  v_mfma_f32_16x16x32_bf16 v[40:43], a[44:47], a[104:107], v[40:43]
  ds_read_b64_tr_b16 a[28:29], v169 offset:27776
  v_mfma_f32_16x16x32_bf16 v[44:47], a[44:47], a[108:111], v[44:47]
  ds_read_b64_tr_b16 a[30:31], v169 offset:32384
  s_waitcnt lgkmcnt(8)
  v_mfma_f32_16x16x32_bf16 v[48:51], a[0:3], a[208:211], v[48:51]
  ds_read_b64_tr_b16 a[32:33], v171 offset:128
  v_mfma_f32_16x16x32_bf16 v[52:55], a[0:3], a[212:215], v[52:55]
  ds_read_b64_tr_b16 a[34:35], v171 offset:4736
  v_mfma_f32_16x16x32_bf16 v[48:51], a[4:7], a[216:219], v[48:51]
  ds_read_b64_tr_b16 a[36:37], v171 offset:9344
  v_mfma_f32_16x16x32_bf16 v[52:55], a[4:7], a[220:223], v[52:55]
  ds_read_b64_tr_b16 a[38:39], v171 offset:13952
  v_mfma_f32_16x16x32_bf16 v[48:51], a[8:11], a[224:227], v[48:51]
  ds_read_b64_tr_b16 a[40:41], v171 offset:18560
  v_mfma_f32_16x16x32_bf16 v[52:55], a[8:11], a[228:231], v[52:55]
  ds_read_b64_tr_b16 a[42:43], v171 offset:23168
  v_mfma_f32_16x16x32_bf16 v[48:51], a[12:15], a[232:235], v[48:51]
  ds_read_b64_tr_b16 a[44:45], v171 offset:27776
  v_cvt_pk_bf16_f32 v34, v40, v41
  v_mfma_f32_16x16x32_bf16 v[52:55], a[12:15], a[236:239], v[52:55]
  ds_read_b64_tr_b16 a[46:47], v171 offset:32384
  s_waitcnt lgkmcnt(8)
  v_mfma_f32_16x16x32_bf16 v[48:51], a[16:19], a[48:51], v[48:51]
  ds_read_b64_tr_b16 a[0:1], v167 offset:160
  v_cvt_pk_bf16_f32 v35, v42, v43
  v_mfma_f32_16x16x32_bf16 v[52:55], a[16:19], a[52:55], v[52:55]
  ds_read_b64_tr_b16 a[2:3], v167 offset:4768
  v_mfma_f32_16x16x32_bf16 v[48:51], a[20:23], a[56:59], v[48:51]
  ds_read_b64_tr_b16 a[4:5], v167 offset:9376
  v_cvt_pk_bf16_f32 v38, v44, v45
  v_mfma_f32_16x16x32_bf16 v[52:55], a[20:23], a[60:63], v[52:55]
  ds_read_b64_tr_b16 a[6:7], v167 offset:13984
  v_mfma_f32_16x16x32_bf16 v[48:51], a[24:27], a[64:67], v[48:51]
  ds_read_b64_tr_b16 a[8:9], v167 offset:18592
  v_cvt_pk_bf16_f32 v39, v46, v47
  v_mfma_f32_16x16x32_bf16 v[52:55], a[24:27], a[68:71], v[52:55]
  ds_read_b64_tr_b16 a[10:11], v167 offset:23200
  v_mfma_f32_16x16x32_bf16 v[48:51], a[28:31], a[72:75], v[48:51]
  ds_read_b64_tr_b16 a[12:13], v167 offset:27808
  buffer_store_dwordx4 v[32:35], v173, s[16:19], s48 offen offset:1024 sc1
  v_mfma_f32_16x16x32_bf16 v[52:55], a[28:31], a[76:79], v[52:55]
  ds_read_b64_tr_b16 a[14:15], v167 offset:32416
  s_waitcnt lgkmcnt(8)
  v_mfma_f32_16x16x32_bf16 v[48:51], a[32:35], a[80:83], v[48:51]
  ds_read_b64_tr_b16 a[16:17], v169 offset:160
  buffer_store_dwordx4 v[36:39], v173, s[16:19], s49 offen offset:1024 sc1
  v_mfma_f32_16x16x32_bf16 v[52:55], a[32:35], a[84:87], v[52:55]
  ds_read_b64_tr_b16 a[18:19], v169 offset:4768
  v_mfma_f32_16x16x32_bf16 v[48:51], a[36:39], a[88:91], v[48:51]
  ds_read_b64_tr_b16 a[20:21], v169 offset:9376
  v_mfma_f32_16x16x32_bf16 v[52:55], a[36:39], a[92:95], v[52:55]
  ds_read_b64_tr_b16 a[22:23], v169 offset:13984
  v_mfma_f32_16x16x32_bf16 v[48:51], a[40:43], a[96:99], v[48:51]
  ds_read_b64_tr_b16 a[24:25], v169 offset:18592
  v_mfma_f32_16x16x32_bf16 v[52:55], a[40:43], a[100:103], v[52:55]
  ds_read_b64_tr_b16 a[26:27], v169 offset:23200
  v_mfma_f32_16x16x32_bf16 v[48:51], a[44:47], a[104:107], v[48:51]
  ds_read_b64_tr_b16 a[28:29], v169 offset:27808
  v_mfma_f32_16x16x32_bf16 v[52:55], a[44:47], a[108:111], v[52:55]
  ds_read_b64_tr_b16 a[30:31], v169 offset:32416
  s_waitcnt lgkmcnt(8)
  v_mfma_f32_16x16x32_bf16 v[56:59], a[0:3], a[208:211], v[56:59]
  ds_read_b64_tr_b16 a[32:33], v171 offset:160
  v_mfma_f32_16x16x32_bf16 v[60:63], a[0:3], a[212:215], v[60:63]
  ds_read_b64_tr_b16 a[34:35], v171 offset:4768
  v_mfma_f32_16x16x32_bf16 v[56:59], a[4:7], a[216:219], v[56:59]
  ds_read_b64_tr_b16 a[36:37], v171 offset:9376
  v_mfma_f32_16x16x32_bf16 v[60:63], a[4:7], a[220:223], v[60:63]
  ds_read_b64_tr_b16 a[38:39], v171 offset:13984
  v_mfma_f32_16x16x32_bf16 v[56:59], a[8:11], a[224:227], v[56:59]
  ds_read_b64_tr_b16 a[40:41], v171 offset:18592
  v_mfma_f32_16x16x32_bf16 v[60:63], a[8:11], a[228:231], v[60:63]
  ds_read_b64_tr_b16 a[42:43], v171 offset:23200
  v_mfma_f32_16x16x32_bf16 v[56:59], a[12:15], a[232:235], v[56:59]
  ds_read_b64_tr_b16 a[44:45], v171 offset:27808
  v_cvt_pk_bf16_f32 v48, v48, v49
  v_mfma_f32_16x16x32_bf16 v[60:63], a[12:15], a[236:239], v[60:63]
  ds_read_b64_tr_b16 a[46:47], v171 offset:32416
  s_waitcnt lgkmcnt(8)
  v_mfma_f32_16x16x32_bf16 v[56:59], a[16:19], a[48:51], v[56:59]
  ds_read_b64_tr_b16 a[0:1], v167 offset:192
  v_cvt_pk_bf16_f32 v49, v50, v51
  v_mfma_f32_16x16x32_bf16 v[60:63], a[16:19], a[52:55], v[60:63]
  ds_read_b64_tr_b16 a[2:3], v167 offset:4800
  v_mfma_f32_16x16x32_bf16 v[56:59], a[20:23], a[56:59], v[56:59]
  ds_read_b64_tr_b16 a[4:5], v167 offset:9408
  v_cvt_pk_bf16_f32 v52, v52, v53
  v_mfma_f32_16x16x32_bf16 v[60:63], a[20:23], a[60:63], v[60:63]
  ds_read_b64_tr_b16 a[6:7], v167 offset:14016
  v_mfma_f32_16x16x32_bf16 v[56:59], a[24:27], a[64:67], v[56:59]
  ds_read_b64_tr_b16 a[8:9], v167 offset:18624
  v_cvt_pk_bf16_f32 v53, v54, v55
  v_mfma_f32_16x16x32_bf16 v[60:63], a[24:27], a[68:71], v[60:63]
  ds_read_b64_tr_b16 a[10:11], v167 offset:23232
  v_mfma_f32_16x16x32_bf16 v[56:59], a[28:31], a[72:75], v[56:59]
  ds_read_b64_tr_b16 a[12:13], v167 offset:27840
  v_mfma_f32_16x16x32_bf16 v[60:63], a[28:31], a[76:79], v[60:63]
  ds_read_b64_tr_b16 a[14:15], v167 offset:32448
  s_waitcnt lgkmcnt(8)
  v_mfma_f32_16x16x32_bf16 v[56:59], a[32:35], a[80:83], v[56:59]
  ds_read_b64_tr_b16 a[16:17], v169 offset:192
  v_mfma_f32_16x16x32_bf16 v[60:63], a[32:35], a[84:87], v[60:63]
  ds_read_b64_tr_b16 a[18:19], v169 offset:4800
  v_mfma_f32_16x16x32_bf16 v[56:59], a[36:39], a[88:91], v[56:59]
  ds_read_b64_tr_b16 a[20:21], v169 offset:9408
  v_mfma_f32_16x16x32_bf16 v[60:63], a[36:39], a[92:95], v[60:63]
  ds_read_b64_tr_b16 a[22:23], v169 offset:14016
  v_mfma_f32_16x16x32_bf16 v[56:59], a[40:43], a[96:99], v[56:59]
  ds_read_b64_tr_b16 a[24:25], v169 offset:18624
  v_mfma_f32_16x16x32_bf16 v[60:63], a[40:43], a[100:103], v[60:63]
  ds_read_b64_tr_b16 a[26:27], v169 offset:23232
  v_mfma_f32_16x16x32_bf16 v[56:59], a[44:47], a[104:107], v[56:59]
  ds_read_b64_tr_b16 a[28:29], v169 offset:27840
  v_mfma_f32_16x16x32_bf16 v[60:63], a[44:47], a[108:111], v[60:63]
  ds_read_b64_tr_b16 a[30:31], v169 offset:32448
  s_waitcnt lgkmcnt(8)
  v_mfma_f32_16x16x32_bf16 v[64:67], a[0:3], a[208:211], v[64:67]
  ds_read_b64_tr_b16 a[32:33], v171 offset:192
  v_mfma_f32_16x16x32_bf16 v[68:71], a[0:3], a[212:215], v[68:71]
  ds_read_b64_tr_b16 a[34:35], v171 offset:4800
  v_mfma_f32_16x16x32_bf16 v[64:67], a[4:7], a[216:219], v[64:67]
  ds_read_b64_tr_b16 a[36:37], v171 offset:9408
  v_mfma_f32_16x16x32_bf16 v[68:71], a[4:7], a[220:223], v[68:71]
  ds_read_b64_tr_b16 a[38:39], v171 offset:14016
  v_mfma_f32_16x16x32_bf16 v[64:67], a[8:11], a[224:227], v[64:67]
  ds_read_b64_tr_b16 a[40:41], v171 offset:18624
  v_mfma_f32_16x16x32_bf16 v[68:71], a[8:11], a[228:231], v[68:71]
  ds_read_b64_tr_b16 a[42:43], v171 offset:23232
  v_mfma_f32_16x16x32_bf16 v[64:67], a[12:15], a[232:235], v[64:67]
  ds_read_b64_tr_b16 a[44:45], v171 offset:27840
  v_cvt_pk_bf16_f32 v50, v56, v57
  v_mfma_f32_16x16x32_bf16 v[68:71], a[12:15], a[236:239], v[68:71]
  ds_read_b64_tr_b16 a[46:47], v171 offset:32448
  s_waitcnt lgkmcnt(8)
  v_mfma_f32_16x16x32_bf16 v[64:67], a[16:19], a[48:51], v[64:67]
  ds_read_b64_tr_b16 a[0:1], v167 offset:224
  v_cvt_pk_bf16_f32 v51, v58, v59
  v_mfma_f32_16x16x32_bf16 v[68:71], a[16:19], a[52:55], v[68:71]
  ds_read_b64_tr_b16 a[2:3], v167 offset:4832
  v_mfma_f32_16x16x32_bf16 v[64:67], a[20:23], a[56:59], v[64:67]
  ds_read_b64_tr_b16 a[4:5], v167 offset:9440
  v_cvt_pk_bf16_f32 v54, v60, v61
  v_mfma_f32_16x16x32_bf16 v[68:71], a[20:23], a[60:63], v[68:71]
  ds_read_b64_tr_b16 a[6:7], v167 offset:14048
  v_mfma_f32_16x16x32_bf16 v[64:67], a[24:27], a[64:67], v[64:67]
  ds_read_b64_tr_b16 a[8:9], v167 offset:18656
  v_cvt_pk_bf16_f32 v55, v62, v63
  v_mfma_f32_16x16x32_bf16 v[68:71], a[24:27], a[68:71], v[68:71]
  ds_read_b64_tr_b16 a[10:11], v167 offset:23264
  v_mfma_f32_16x16x32_bf16 v[64:67], a[28:31], a[72:75], v[64:67]
  ds_read_b64_tr_b16 a[12:13], v167 offset:27872
  buffer_store_dwordx4 v[48:51], v173, s[16:19], s48 offen offset:2048 sc1
  v_mfma_f32_16x16x32_bf16 v[68:71], a[28:31], a[76:79], v[68:71]
  ds_read_b64_tr_b16 a[14:15], v167 offset:32480
  s_waitcnt lgkmcnt(8)
  v_mfma_f32_16x16x32_bf16 v[64:67], a[32:35], a[80:83], v[64:67]
  ds_read_b64_tr_b16 a[16:17], v169 offset:224
  buffer_store_dwordx4 v[52:55], v173, s[16:19], s49 offen offset:2048 sc1
  v_mfma_f32_16x16x32_bf16 v[68:71], a[32:35], a[84:87], v[68:71]
  ds_read_b64_tr_b16 a[18:19], v169 offset:4832
  v_mfma_f32_16x16x32_bf16 v[64:67], a[36:39], a[88:91], v[64:67]
  ds_read_b64_tr_b16 a[20:21], v169 offset:9440
  v_mfma_f32_16x16x32_bf16 v[68:71], a[36:39], a[92:95], v[68:71]
  ds_read_b64_tr_b16 a[22:23], v169 offset:14048
  v_mfma_f32_16x16x32_bf16 v[64:67], a[40:43], a[96:99], v[64:67]
  ds_read_b64_tr_b16 a[24:25], v169 offset:18656
  v_mfma_f32_16x16x32_bf16 v[68:71], a[40:43], a[100:103], v[68:71]
  ds_read_b64_tr_b16 a[26:27], v169 offset:23264
  v_mfma_f32_16x16x32_bf16 v[64:67], a[44:47], a[104:107], v[64:67]
  ds_read_b64_tr_b16 a[28:29], v169 offset:27872
  v_mfma_f32_16x16x32_bf16 v[68:71], a[44:47], a[108:111], v[68:71]
  ds_read_b64_tr_b16 a[30:31], v169 offset:32480
  s_waitcnt lgkmcnt(8)
  v_mfma_f32_16x16x32_bf16 v[72:75], a[0:3], a[208:211], v[72:75]
  ds_read_b64_tr_b16 a[32:33], v171 offset:224
  v_mfma_f32_16x16x32_bf16 v[76:79], a[0:3], a[212:215], v[76:79]
  ds_read_b64_tr_b16 a[34:35], v171 offset:4832
  v_mfma_f32_16x16x32_bf16 v[72:75], a[4:7], a[216:219], v[72:75]
  ds_read_b64_tr_b16 a[36:37], v171 offset:9440
  v_mfma_f32_16x16x32_bf16 v[76:79], a[4:7], a[220:223], v[76:79]
  ds_read_b64_tr_b16 a[38:39], v171 offset:14048
  v_mfma_f32_16x16x32_bf16 v[72:75], a[8:11], a[224:227], v[72:75]
  ds_read_b64_tr_b16 a[40:41], v171 offset:18656
  v_mfma_f32_16x16x32_bf16 v[76:79], a[8:11], a[228:231], v[76:79]
  ds_read_b64_tr_b16 a[42:43], v171 offset:23264
  v_mfma_f32_16x16x32_bf16 v[72:75], a[12:15], a[232:235], v[72:75]
  ds_read_b64_tr_b16 a[44:45], v171 offset:27872
  v_cvt_pk_bf16_f32 v64, v64, v65
  v_mfma_f32_16x16x32_bf16 v[76:79], a[12:15], a[236:239], v[76:79]
  ds_read_b64_tr_b16 a[46:47], v171 offset:32480
  s_waitcnt lgkmcnt(8)
  v_mfma_f32_16x16x32_bf16 v[72:75], a[16:19], a[48:51], v[72:75]
  v_cvt_pk_bf16_f32 v65, v66, v67
  v_mfma_f32_16x16x32_bf16 v[76:79], a[16:19], a[52:55], v[76:79]
  v_mfma_f32_16x16x32_bf16 v[72:75], a[20:23], a[56:59], v[72:75]
  v_cvt_pk_bf16_f32 v68, v68, v69
  v_mfma_f32_16x16x32_bf16 v[76:79], a[20:23], a[60:63], v[76:79]
  v_mfma_f32_16x16x32_bf16 v[72:75], a[24:27], a[64:67], v[72:75]
  v_cvt_pk_bf16_f32 v69, v70, v71
  v_mfma_f32_16x16x32_bf16 v[76:79], a[24:27], a[68:71], v[76:79]
  v_mfma_f32_16x16x32_bf16 v[72:75], a[28:31], a[72:75], v[72:75]
  v_mfma_f32_16x16x32_bf16 v[76:79], a[28:31], a[76:79], v[76:79]
  s_waitcnt lgkmcnt(0)
  v_mfma_f32_16x16x32_bf16 v[72:75], a[32:35], a[80:83], v[72:75]
  v_mfma_f32_16x16x32_bf16 v[76:79], a[32:35], a[84:87], v[76:79]
  v_mfma_f32_16x16x32_bf16 v[72:75], a[36:39], a[88:91], v[72:75]
  v_mfma_f32_16x16x32_bf16 v[76:79], a[36:39], a[92:95], v[76:79]
  v_mfma_f32_16x16x32_bf16 v[72:75], a[40:43], a[96:99], v[72:75]
  v_mfma_f32_16x16x32_bf16 v[76:79], a[40:43], a[100:103], v[76:79]
  v_mfma_f32_16x16x32_bf16 v[72:75], a[44:47], a[104:107], v[72:75]
  v_mfma_f32_16x16x32_bf16 v[76:79], a[44:47], a[108:111], v[76:79]
  s_nop 0
  s_nop 5
  v_cvt_pk_bf16_f32 v66, v72, v73
  v_cvt_pk_bf16_f32 v67, v74, v75
  v_cvt_pk_bf16_f32 v70, v76, v77
  v_cvt_pk_bf16_f32 v71, v78, v79
  buffer_store_dwordx4 v[64:67], v173, s[16:19], s48 offen offset:3072 sc1
  buffer_store_dwordx4 v[68:71], v173, s[16:19], s49 offen offset:3072 sc1
rd1_code:
  s_waitcnt vmcnt(0)
  s_barrier
  s_cmp_lg_u32 s101, 0
  s_cbranch_scc1 rd1_pub
  s_mov_b64 exec, 1
  v_mov_b32 v6, s100
  buffer_store_dword v6, off, s[20:23], s38 sc1
  s_mov_b64 exec, -1
rd1_pub:
  ds_read_b128 v[88:91], v3
  ds_read_b128 v[92:95], v3 offset:64
  ds_read_b128 v[112:115], v3 offset:4608
  ds_read_b128 v[116:119], v3 offset:4672
  ds_read_b128 v[136:139], v3 offset:2304
  ds_read_b128 v[140:143], v3 offset:2368
  ds_read_b128 v[96:99], v3 offset:1024
  ds_read_b128 v[100:103], v3 offset:1088
  ds_read_b128 v[120:123], v3 offset:5632
  ds_read_b128 v[124:127], v3 offset:5696
  ds_read_b128 v[144:147], v3 offset:3328
  ds_read_b128 v[148:151], v3 offset:3392
  ds_read_b128 v[104:107], v3 offset:2048
  ds_read_b128 v[108:111], v3 offset:2112
  ds_read_b128 v[128:131], v3 offset:6656
  ds_read_b128 v[132:135], v3 offset:6720
  ds_read_b128 v[152:155], v3 offset:4352
  ds_read_b128 v[156:159], v3 offset:4416
  s_cmp_lg_u32 s101, 0
  s_cbranch_scc1 rd1_poll_ok
  s_mov_b32 s34, 0x40000
rd1_poll:
  buffer_load_dword v5, v4, s[20:23], 0 offen sc1
  s_waitcnt vmcnt(0)
  v_cmp_ne_u32 vcc, s100, v5
  s_nop 1
  s_cbranch_vccz rd1_poll_ok
  s_sleep 1
  s_sub_u32 s34, s34, 1
  s_cbranch_scc0 rd1_poll
rd1_poll_ok:
  s_barrier
  buffer_load_dwordx4 v[8:11], v1, s[8:11], s56 offen sc1
  buffer_load_dwordx4 v[12:15], v1, s[8:11], s60 offen sc1
  buffer_load_dwordx4 v[16:19], v7, s[8:11], s56 offen sc1
  buffer_load_dwordx4 v[20:23], v1, s[8:11], s57 offen sc1
  buffer_load_dwordx4 v[24:27], v1, s[8:11], s61 offen sc1
  buffer_load_dwordx4 v[28:31], v7, s[8:11], s57 offen sc1
  buffer_load_dwordx4 v[32:35], v1, s[8:11], s58 offen sc1
  buffer_load_dwordx4 v[36:39], v1, s[8:11], s62 offen sc1
  buffer_load_dwordx4 v[40:43], v7, s[8:11], s58 offen sc1
  buffer_load_dwordx4 v[44:47], v1, s[8:11], s59 offen sc1
  buffer_load_dwordx4 v[48:51], v1, s[8:11], s63 offen sc1
  buffer_load_dwordx4 v[52:55], v7, s[8:11], s59 offen sc1
  v_and_b32 v233, 63, v0
  s_and_b32 s32, s2, 7
  s_lshl_b32 s32, s32, 2
  s_lshr_b32 s33, s2, 3
  s_and_b32 s36, s33, 3
  s_add_u32 s32, s32, s36
  s_lshr_b32 s33, s33, 2
  s_lshl_b32 s33, s33, 4
  s_lshl_b32 s36, s101, 2
  s_add_u32 s33, s33, s36
  s_and_b32 s31, s32, 1
  s_mul_i32 s28, s101, 0x2400
  s_and_b32 s36, s101, 1
  s_mul_i32 s29, s36, 0x48000
  s_mul_i32 s36, s32, 0x120
  s_add_u32 s29, s29, s36
  s_mov_b32 s30, 0
  s_mov_b32 s36, 0xe38e38f
  v_add_u32 v234, 0, v233
  v_mul_hi_u32 v235, v234, s36
  v_mul_u32_u24 v236, 0x22e0, v235
  v_lshl_add_u32 v236, v234, 4, v236
  v_subrev_u32 v224, 0, v236
  v_add_u32 v234, 64, v233
  v_mul_hi_u32 v235, v234, s36
  v_mul_u32_u24 v236, 0x22e0, v235
  v_lshl_add_u32 v236, v234, 4, v236
  v_subrev_u32 v225, 0x400, v236
  v_add_u32 v234, 0x80, v233
  v_mul_hi_u32 v235, v234, s36
  v_mul_u32_u24 v236, 0x22e0, v235
  v_lshl_add_u32 v236, v234, 4, v236
  v_subrev_u32 v226, 0x800, v236
  v_add_u32 v234, 0xc0, v233
  v_mul_hi_u32 v235, v234, s36
  v_mul_u32_u24 v236, 0x22e0, v235
  v_lshl_add_u32 v236, v234, 4, v236
  v_subrev_u32 v227, 0xc00, v236
  v_add_u32 v234, 0x100, v233
  v_mul_hi_u32 v235, v234, s36
  v_mul_u32_u24 v236, 0x22e0, v235
  v_lshl_add_u32 v236, v234, 4, v236
  v_subrev_u32 v228, 0, v236
  v_add_u32 v234, 0x140, v233
  v_mul_hi_u32 v235, v234, s36
  v_mul_u32_u24 v236, 0x22e0, v235
  v_lshl_add_u32 v236, v234, 4, v236
  v_subrev_u32 v229, 0x400, v236
  v_add_u32 v234, 0x180, v233
  v_mul_hi_u32 v235, v234, s36
  v_mul_u32_u24 v236, 0x22e0, v235
  v_lshl_add_u32 v236, v234, 4, v236
  v_subrev_u32 v230, 0x800, v236
  v_add_u32 v234, 0x1c0, v233
  v_mul_hi_u32 v235, v234, s36
  v_mul_u32_u24 v236, 0x22e0, v235
  v_lshl_add_u32 v236, v234, 4, v236
  v_subrev_u32 v231, 0xc00, v236
  v_add_u32 v234, 0x200, v233
  v_mul_hi_u32 v235, v234, s36
  v_mul_u32_u24 v236, 0x22e0, v235
  v_lshl_add_u32 v236, v234, 4, v236
  v_subrev_u32 v232, 0, v236
  s_cmp_ge_u32 s101, 2
  s_cselect_b32 s12, s82, s80
  s_cselect_b32 s13, s83, s81
  s_mov_b32 s14, 0x510000
  s_mov_b32 s15, 0x20000
  s_add_u32 m0, s28, 0
  s_nop 0
  buffer_load_dwordx4 v224, s[12:15], s29 offen lds
  buffer_load_dwordx4 v225, s[12:15], s29 offen offset:1024 lds
  buffer_load_dwordx4 v226, s[12:15], s29 offen offset:2048 lds
  buffer_load_dwordx4 v227, s[12:15], s29 offen offset:3072 lds
  s_add_u32 m0, s28, 0x1000
  s_nop 0
  buffer_load_dwordx4 v228, s[12:15], s29 offen lds
  buffer_load_dwordx4 v229, s[12:15], s29 offen offset:1024 lds
  buffer_load_dwordx4 v230, s[12:15], s29 offen offset:2048 lds
  buffer_load_dwordx4 v231, s[12:15], s29 offen offset:3072 lds
  s_add_u32 m0, s28, 0x2000
  s_nop 0
  buffer_load_dwordx4 v232, s[12:15], s29 offen lds
  s_add_u32 s29, s29, 0x90000
  s_add_u32 m0, s28, 0x9000
  s_nop 0
  buffer_load_dwordx4 v224, s[12:15], s29 offen lds
  buffer_load_dwordx4 v225, s[12:15], s29 offen offset:1024 lds
  buffer_load_dwordx4 v226, s[12:15], s29 offen offset:2048 lds
  buffer_load_dwordx4 v227, s[12:15], s29 offen offset:3072 lds
  s_add_u32 m0, s28, 0xa000
  s_nop 0
  buffer_load_dwordx4 v228, s[12:15], s29 offen lds
  buffer_load_dwordx4 v229, s[12:15], s29 offen offset:1024 lds
  buffer_load_dwordx4 v230, s[12:15], s29 offen offset:2048 lds
  buffer_load_dwordx4 v231, s[12:15], s29 offen offset:3072 lds
  s_add_u32 m0, s28, 0xb000
  s_nop 0
  buffer_load_dwordx4 v232, s[12:15], s29 offen lds
  s_add_u32 s29, s29, 0x90000
  s_waitcnt vmcnt(29)
  v_lshlrev_b32 v188, 16, v8
  v_and_b32 v189, 0xffff0000, v8
  v_lshlrev_b32 v190, 16, v9
  v_and_b32 v191, 0xffff0000, v9
  v_lshlrev_b32 v192, 16, v10
  v_and_b32 v193, 0xffff0000, v10
  v_lshlrev_b32 v194, 16, v11
  v_and_b32 v195, 0xffff0000, v11
  s_waitcnt vmcnt(28)
  v_lshlrev_b32 v196, 16, v12
  v_and_b32 v197, 0xffff0000, v12
  v_lshlrev_b32 v198, 16, v13
  v_and_b32 v199, 0xffff0000, v13
  v_lshlrev_b32 v200, 16, v14
  v_and_b32 v201, 0xffff0000, v14
  v_lshlrev_b32 v202, 16, v15
  v_and_b32 v203, 0xffff0000, v15
  s_waitcnt vmcnt(27)
  v_lshlrev_b32 v204, 16, v16
  v_and_b32 v205, 0xffff0000, v16
  v_lshlrev_b32 v206, 16, v17
  v_and_b32 v207, 0xffff0000, v17
  v_lshlrev_b32 v208, 16, v18
  v_and_b32 v209, 0xffff0000, v18
  v_lshlrev_b32 v210, 16, v19
  v_and_b32 v211, 0xffff0000, v19
  s_waitcnt vmcnt(26)
  v_lshlrev_b32 v212, 16, v20
  v_and_b32 v213, 0xffff0000, v20
  v_lshlrev_b32 v214, 16, v21
  v_and_b32 v215, 0xffff0000, v21
  v_lshlrev_b32 v216, 16, v22
  v_and_b32 v217, 0xffff0000, v22
  v_lshlrev_b32 v218, 16, v23
  v_and_b32 v219, 0xffff0000, v23
  v_pk_add_f32 v[188:189], v[188:189], v[212:213]
  v_pk_add_f32 v[190:191], v[190:191], v[214:215]
  v_pk_add_f32 v[192:193], v[192:193], v[216:217]
  v_pk_add_f32 v[194:195], v[194:195], v[218:219]
  s_waitcnt vmcnt(25)
  v_lshlrev_b32 v212, 16, v24
  v_and_b32 v213, 0xffff0000, v24
  v_lshlrev_b32 v214, 16, v25
  v_and_b32 v215, 0xffff0000, v25
  v_lshlrev_b32 v216, 16, v26
  v_and_b32 v217, 0xffff0000, v26
  v_lshlrev_b32 v218, 16, v27
  v_and_b32 v219, 0xffff0000, v27
  v_pk_add_f32 v[196:197], v[196:197], v[212:213]
  v_pk_add_f32 v[198:199], v[198:199], v[214:215]
  v_pk_add_f32 v[200:201], v[200:201], v[216:217]
  v_pk_add_f32 v[202:203], v[202:203], v[218:219]
  s_waitcnt vmcnt(24)
  v_lshlrev_b32 v212, 16, v28
  v_and_b32 v213, 0xffff0000, v28
  v_lshlrev_b32 v214, 16, v29
  v_and_b32 v215, 0xffff0000, v29
  v_lshlrev_b32 v216, 16, v30
  v_and_b32 v217, 0xffff0000, v30
  v_lshlrev_b32 v218, 16, v31
  v_and_b32 v219, 0xffff0000, v31
  v_pk_add_f32 v[204:205], v[204:205], v[212:213]
  v_pk_add_f32 v[206:207], v[206:207], v[214:215]
  v_pk_add_f32 v[208:209], v[208:209], v[216:217]
  v_pk_add_f32 v[210:211], v[210:211], v[218:219]
  s_waitcnt vmcnt(23)
  v_lshlrev_b32 v212, 16, v32
  v_and_b32 v213, 0xffff0000, v32
  v_lshlrev_b32 v214, 16, v33
  v_and_b32 v215, 0xffff0000, v33
  v_lshlrev_b32 v216, 16, v34
  v_and_b32 v217, 0xffff0000, v34
  v_lshlrev_b32 v218, 16, v35
  v_and_b32 v219, 0xffff0000, v35
  v_pk_add_f32 v[188:189], v[188:189], v[212:213]
  v_pk_add_f32 v[190:191], v[190:191], v[214:215]
  v_pk_add_f32 v[192:193], v[192:193], v[216:217]
  v_pk_add_f32 v[194:195], v[194:195], v[218:219]
  s_waitcnt vmcnt(22)
  v_lshlrev_b32 v212, 16, v36
  v_and_b32 v213, 0xffff0000, v36
  v_lshlrev_b32 v214, 16, v37
  v_and_b32 v215, 0xffff0000, v37
  v_lshlrev_b32 v216, 16, v38
  v_and_b32 v217, 0xffff0000, v38
  v_lshlrev_b32 v218, 16, v39
  v_and_b32 v219, 0xffff0000, v39
  v_pk_add_f32 v[196:197], v[196:197], v[212:213]
  v_pk_add_f32 v[198:199], v[198:199], v[214:215]
  v_pk_add_f32 v[200:201], v[200:201], v[216:217]
  v_pk_add_f32 v[202:203], v[202:203], v[218:219]
  s_waitcnt vmcnt(21)
  v_lshlrev_b32 v212, 16, v40
  v_and_b32 v213, 0xffff0000, v40
  v_lshlrev_b32 v214, 16, v41
  v_and_b32 v215, 0xffff0000, v41
  v_lshlrev_b32 v216, 16, v42
  v_and_b32 v217, 0xffff0000, v42
  v_lshlrev_b32 v218, 16, v43
  v_and_b32 v219, 0xffff0000, v43
  v_pk_add_f32 v[204:205], v[204:205], v[212:213]
  v_pk_add_f32 v[206:207], v[206:207], v[214:215]
  v_pk_add_f32 v[208:209], v[208:209], v[216:217]
  v_pk_add_f32 v[210:211], v[210:211], v[218:219]
  s_waitcnt vmcnt(20)
  v_lshlrev_b32 v212, 16, v44
  v_and_b32 v213, 0xffff0000, v44
  v_lshlrev_b32 v214, 16, v45
  v_and_b32 v215, 0xffff0000, v45
  v_lshlrev_b32 v216, 16, v46
  v_and_b32 v217, 0xffff0000, v46
  v_lshlrev_b32 v218, 16, v47
  v_and_b32 v219, 0xffff0000, v47
  v_pk_add_f32 v[188:189], v[188:189], v[212:213]
  v_pk_add_f32 v[190:191], v[190:191], v[214:215]
  v_pk_add_f32 v[192:193], v[192:193], v[216:217]
  v_pk_add_f32 v[194:195], v[194:195], v[218:219]
  s_waitcnt vmcnt(19)
  v_lshlrev_b32 v212, 16, v48
  v_and_b32 v213, 0xffff0000, v48
  v_lshlrev_b32 v214, 16, v49
  v_and_b32 v215, 0xffff0000, v49
  v_lshlrev_b32 v216, 16, v50
  v_and_b32 v217, 0xffff0000, v50
  v_lshlrev_b32 v218, 16, v51
  v_and_b32 v219, 0xffff0000, v51
  v_pk_add_f32 v[196:197], v[196:197], v[212:213]
  v_pk_add_f32 v[198:199], v[198:199], v[214:215]
  v_pk_add_f32 v[200:201], v[200:201], v[216:217]
  v_pk_add_f32 v[202:203], v[202:203], v[218:219]
  s_waitcnt vmcnt(18)
  v_lshlrev_b32 v212, 16, v52
  v_and_b32 v213, 0xffff0000, v52
  v_lshlrev_b32 v214, 16, v53
  v_and_b32 v215, 0xffff0000, v53
  v_lshlrev_b32 v216, 16, v54
  v_and_b32 v217, 0xffff0000, v54
  v_lshlrev_b32 v218, 16, v55
  v_and_b32 v219, 0xffff0000, v55
  v_pk_add_f32 v[204:205], v[204:205], v[212:213]
  v_pk_add_f32 v[206:207], v[206:207], v[214:215]
  v_pk_add_f32 v[208:209], v[208:209], v[216:217]
  v_pk_add_f32 v[210:211], v[210:211], v[218:219]
  v_lshlrev_b32 v212, 16, v176
  v_and_b32 v213, 0xffff0000, v176
  v_lshlrev_b32 v214, 16, v177
  v_and_b32 v215, 0xffff0000, v177
  v_lshlrev_b32 v216, 16, v178
  v_and_b32 v217, 0xffff0000, v178
  v_lshlrev_b32 v218, 16, v179
  v_and_b32 v219, 0xffff0000, v179
  s_waitcnt lgkmcnt(15)
  v_pk_fma_f32 v[188:189], v[88:89], v[188:189], v[212:213]
  v_pk_fma_f32 v[190:191], v[90:91], v[190:191], v[214:215]
  s_waitcnt lgkmcnt(15)
  v_pk_fma_f32 v[192:193], v[92:93], v[192:193], v[216:217]
  v_pk_fma_f32 v[194:195], v[94:95], v[194:195], v[218:219]
  v_cvt_pk_bf16_f32 v176, v188, v189
  v_cvt_pk_bf16_f32 v177, v190, v191
  v_cvt_pk_bf16_f32 v178, v192, v193
  v_cvt_pk_bf16_f32 v179, v194, v195
  v_lshlrev_b32 v212, 16, v180
  v_and_b32 v213, 0xffff0000, v180
  v_lshlrev_b32 v214, 16, v181
  v_and_b32 v215, 0xffff0000, v181
  v_lshlrev_b32 v216, 16, v182
  v_and_b32 v217, 0xffff0000, v182
  v_lshlrev_b32 v218, 16, v183
  v_and_b32 v219, 0xffff0000, v183
  s_waitcnt lgkmcnt(11)
  v_pk_fma_f32 v[196:197], v[96:97], v[196:197], v[212:213]
  v_pk_fma_f32 v[198:199], v[98:99], v[198:199], v[214:215]
  s_waitcnt lgkmcnt(10)
  v_pk_fma_f32 v[200:201], v[100:101], v[200:201], v[216:217]
  v_pk_fma_f32 v[202:203], v[102:103], v[202:203], v[218:219]
  v_cvt_pk_bf16_f32 v180, v196, v197
  v_cvt_pk_bf16_f32 v181, v198, v199
  v_cvt_pk_bf16_f32 v182, v200, v201
  v_cvt_pk_bf16_f32 v183, v202, v203
  v_lshlrev_b32 v212, 16, v184
  v_and_b32 v213, 0xffff0000, v184
  v_lshlrev_b32 v214, 16, v185
  v_and_b32 v215, 0xffff0000, v185
  v_lshlrev_b32 v216, 16, v186
  v_and_b32 v217, 0xffff0000, v186
  v_lshlrev_b32 v218, 16, v187
  v_and_b32 v219, 0xffff0000, v187
  s_waitcnt lgkmcnt(5)
  v_pk_fma_f32 v[204:205], v[104:105], v[204:205], v[212:213]
  v_pk_fma_f32 v[206:207], v[106:107], v[206:207], v[214:215]
  s_waitcnt lgkmcnt(4)
  v_pk_fma_f32 v[208:209], v[108:109], v[208:209], v[216:217]
  v_pk_fma_f32 v[210:211], v[110:111], v[210:211], v[218:219]
  v_cvt_pk_bf16_f32 v184, v204, v205
  v_cvt_pk_bf16_f32 v185, v206, v207
  v_cvt_pk_bf16_f32 v186, v208, v209
  v_cvt_pk_bf16_f32 v187, v210, v211
  v_cndmask_b32_e64 v213, 0, 1.0, s[54:55]
  v_cndmask_b32_e64 v212, 0, 1.0, s[54:55]
  v_pk_mul_f32 v[204:205], v[204:205], v[212:213]
  v_pk_mul_f32 v[206:207], v[206:207], v[212:213]
  v_pk_mul_f32 v[208:209], v[208:209], v[212:213]
  v_pk_mul_f32 v[210:211], v[210:211], v[212:213]
  v_pk_mul_f32 v[10:11], v[188:189], v[188:189]
  v_mov_b32 v8, v188
  v_mov_b32 v9, v189
  v_pk_fma_f32 v[10:11], v[190:191], v[190:191], v[10:11]
  v_pk_add_f32 v[8:9], v[8:9], v[190:191]
  v_pk_fma_f32 v[10:11], v[192:193], v[192:193], v[10:11]
  v_pk_add_f32 v[8:9], v[8:9], v[192:193]
  v_pk_fma_f32 v[10:11], v[194:195], v[194:195], v[10:11]
  v_pk_add_f32 v[8:9], v[8:9], v[194:195]
  v_pk_fma_f32 v[10:11], v[196:197], v[196:197], v[10:11]
  v_pk_add_f32 v[8:9], v[8:9], v[196:197]
  v_pk_fma_f32 v[10:11], v[198:199], v[198:199], v[10:11]
  v_pk_add_f32 v[8:9], v[8:9], v[198:199]
  v_pk_fma_f32 v[10:11], v[200:201], v[200:201], v[10:11]
  v_pk_add_f32 v[8:9], v[8:9], v[200:201]
  v_pk_fma_f32 v[10:11], v[202:203], v[202:203], v[10:11]
  v_pk_add_f32 v[8:9], v[8:9], v[202:203]
  v_pk_fma_f32 v[10:11], v[204:205], v[204:205], v[10:11]
  v_pk_add_f32 v[8:9], v[8:9], v[204:205]
  v_pk_fma_f32 v[10:11], v[206:207], v[206:207], v[10:11]
  v_pk_add_f32 v[8:9], v[8:9], v[206:207]
  v_pk_fma_f32 v[10:11], v[208:209], v[208:209], v[10:11]
  v_pk_add_f32 v[8:9], v[8:9], v[208:209]
  v_pk_fma_f32 v[10:11], v[210:211], v[210:211], v[10:11]
  v_pk_add_f32 v[8:9], v[8:9], v[210:211]
  v_add_f32 v8, v8, v9
  v_add_f32 v9, v10, v11
  s_nop 0
  v_add_f32_dpp v8, v8, v8 row_ror:8 row_mask:0xf bank_mask:0xf
  v_add_f32_dpp v9, v9, v9 row_ror:8 row_mask:0xf bank_mask:0xf
  v_mov_b32 v10, v8
  v_mov_b32 v11, v9
  s_nop 0
  v_permlane16_swap_b32 v8, v10
  v_permlane16_swap_b32 v9, v11
  v_pk_add_f32 v[8:9], v[8:9], v[10:11]
  v_mov_b32 v10, v8
  v_mov_b32 v11, v9
  s_nop 0
  v_permlane32_swap_b32 v8, v10
  v_permlane32_swap_b32 v9, v11
  v_pk_add_f32 v[8:9], v[8:9], v[10:11]
  v_and_b32 v4, 7, v0
  v_lshlrev_b32 v4, 3, v4
  v_add_u32 v4, 0x24000, v4
  s_lshl_b32 s34, s101, 6
  v_add_u32 v5, s34, v4
  ds_write_b64 v5, v[8:9]
  buffer_store_dwordx4 v[176:179], v1, s[24:27], 0 offen
  buffer_store_dwordx4 v[180:183], v1, s[24:27], s79 offen
  buffer_store_dwordx4 v[184:187], v7, s[24:27], 0 offen
  s_add_u32 s24, s4, 0x1600000
  s_addc_u32 s25, s5, 0
  s_mov_b32 s26, 0x240000
  s_mov_b32 s27, 0x20000
  s_waitcnt lgkmcnt(0)
  s_barrier
  ds_read_b64 v[12:13], v4
  ds_read_b64 v[14:15], v4 offset:64
  ds_read_b64 v[16:17], v4 offset:128
  ds_read_b64 v[18:19], v4 offset:192
  v_mov_b32 v20, 1.0
  v_mov_b32 v21, 1.0
  v_pk_add_f32 v[112:113], v[112:113], v[20:21]
  v_pk_add_f32 v[114:115], v[114:115], v[20:21]
  v_pk_add_f32 v[116:117], v[116:117], v[20:21]
  v_pk_add_f32 v[118:119], v[118:119], v[20:21]
  v_pk_add_f32 v[120:121], v[120:121], v[20:21]
  v_pk_add_f32 v[122:123], v[122:123], v[20:21]
  v_pk_add_f32 v[124:125], v[124:125], v[20:21]
  v_pk_add_f32 v[126:127], v[126:127], v[20:21]
  v_pk_add_f32 v[128:129], v[128:129], v[20:21]
  v_pk_add_f32 v[130:131], v[130:131], v[20:21]
  v_pk_add_f32 v[132:133], v[132:133], v[20:21]
  v_pk_add_f32 v[134:135], v[134:135], v[20:21]
  s_waitcnt lgkmcnt(2)
  v_pk_add_f32 v[12:13], v[12:13], v[14:15]
  s_waitcnt lgkmcnt(0)
  v_pk_add_f32 v[16:17], v[16:17], v[18:19]
  v_pk_add_f32 v[8:9], v[12:13], v[16:17]
  v_mul_f32 v8, 0x3ae38e39, v8
  v_mov_b32 v5, 0x3727c5ac
  v_fmac_f32 v5, 0x3ae38e39, v9
  v_fma_f32 v5, -v8, v8, v5
  v_max_f32 v5, 0x3727c5ac, v5
  v_rsq_f32 v9, v5
  s_nop 0
  v_mul_f32 v8, v8, v9
  v_pk_fma_f32 v[188:189], v[188:189], v[8:9], v[8:9] op_sel:[0,1,0] op_sel_hi:[1,1,0] neg_lo:[0,0,1] neg_hi:[0,0,1]
  v_pk_fma_f32 v[190:191], v[190:191], v[8:9], v[8:9] op_sel:[0,1,0] op_sel_hi:[1,1,0] neg_lo:[0,0,1] neg_hi:[0,0,1]
  v_pk_fma_f32 v[192:193], v[192:193], v[8:9], v[8:9] op_sel:[0,1,0] op_sel_hi:[1,1,0] neg_lo:[0,0,1] neg_hi:[0,0,1]
  v_pk_fma_f32 v[194:195], v[194:195], v[8:9], v[8:9] op_sel:[0,1,0] op_sel_hi:[1,1,0] neg_lo:[0,0,1] neg_hi:[0,0,1]
  v_pk_fma_f32 v[188:189], v[188:189], v[112:113], v[136:137]
  v_pk_fma_f32 v[190:191], v[190:191], v[114:115], v[138:139]
  v_pk_fma_f32 v[192:193], v[192:193], v[116:117], v[140:141]
  v_pk_fma_f32 v[194:195], v[194:195], v[118:119], v[142:143]
  v_cvt_pk_bf16_f32 v24, v188, v189
  v_cvt_pk_bf16_f32 v25, v190, v191
  v_cvt_pk_bf16_f32 v26, v192, v193
  v_cvt_pk_bf16_f32 v27, v194, v195
  buffer_store_dwordx4 v[24:27], v1, s[24:27], 0 offen sc1
  v_pk_fma_f32 v[196:197], v[196:197], v[8:9], v[8:9] op_sel:[0,1,0] op_sel_hi:[1,1,0] neg_lo:[0,0,1] neg_hi:[0,0,1]
  v_pk_fma_f32 v[198:199], v[198:199], v[8:9], v[8:9] op_sel:[0,1,0] op_sel_hi:[1,1,0] neg_lo:[0,0,1] neg_hi:[0,0,1]
  v_pk_fma_f32 v[200:201], v[200:201], v[8:9], v[8:9] op_sel:[0,1,0] op_sel_hi:[1,1,0] neg_lo:[0,0,1] neg_hi:[0,0,1]
  v_pk_fma_f32 v[202:203], v[202:203], v[8:9], v[8:9] op_sel:[0,1,0] op_sel_hi:[1,1,0] neg_lo:[0,0,1] neg_hi:[0,0,1]
  v_pk_fma_f32 v[196:197], v[196:197], v[120:121], v[144:145]
  v_pk_fma_f32 v[198:199], v[198:199], v[122:123], v[146:147]
  v_pk_fma_f32 v[200:201], v[200:201], v[124:125], v[148:149]
  v_pk_fma_f32 v[202:203], v[202:203], v[126:127], v[150:151]
  v_cvt_pk_bf16_f32 v28, v196, v197
  v_cvt_pk_bf16_f32 v29, v198, v199
  v_cvt_pk_bf16_f32 v30, v200, v201
  v_cvt_pk_bf16_f32 v31, v202, v203
  buffer_store_dwordx4 v[28:31], v1, s[24:27], s79 offen sc1
  v_pk_fma_f32 v[204:205], v[204:205], v[8:9], v[8:9] op_sel:[0,1,0] op_sel_hi:[1,1,0] neg_lo:[0,0,1] neg_hi:[0,0,1]
  v_pk_fma_f32 v[206:207], v[206:207], v[8:9], v[8:9] op_sel:[0,1,0] op_sel_hi:[1,1,0] neg_lo:[0,0,1] neg_hi:[0,0,1]
  v_pk_fma_f32 v[208:209], v[208:209], v[8:9], v[8:9] op_sel:[0,1,0] op_sel_hi:[1,1,0] neg_lo:[0,0,1] neg_hi:[0,0,1]
  v_pk_fma_f32 v[210:211], v[210:211], v[8:9], v[8:9] op_sel:[0,1,0] op_sel_hi:[1,1,0] neg_lo:[0,0,1] neg_hi:[0,0,1]
  v_pk_fma_f32 v[204:205], v[204:205], v[128:129], v[152:153]
  v_pk_fma_f32 v[206:207], v[206:207], v[130:131], v[154:155]
  v_pk_fma_f32 v[208:209], v[208:209], v[132:133], v[156:157]
  v_pk_fma_f32 v[210:211], v[210:211], v[134:135], v[158:159]
  v_cvt_pk_bf16_f32 v32, v204, v205
  v_cvt_pk_bf16_f32 v33, v206, v207
  v_cvt_pk_bf16_f32 v34, v208, v209
  v_cvt_pk_bf16_f32 v35, v210, v211
  buffer_store_dwordx4 v[32:35], v7, s[24:27], 0 offen sc1
glu_kernel:
  s_getpc_b64 s[72:73]
tail_pc2:
  s_add_u32 s72, s72, down_kernel-tail_pc2
  s_addc_u32 s73, s73, 0
  s_mov_b32 s74, down_kernel_codeend-down_kernel
  s_mov_b32 s75, 0x20000
  s_add_u32 s8, s4, 0x1600000
  s_addc_u32 s9, s5, 0
  s_mov_b32 s10, 0x240000
  s_mov_b32 s11, 0x20000
  s_add_u32 s24, s4, 0x2000000
  s_addc_u32 s25, s5, 0
  s_mov_b32 s26, 0x1200000
  s_mov_b32 s27, 0x20000
  s_mul_i32 s36, s33, 0x4800
  v_lshlrev_b32 v6, 4, v233
  v_add_u32 v209, s36, v6
  v_add_u32 v210, 0x4800, v209
  v_add_u32 v211, 0x9000, v209
  v_add_u32 v212, 0xd800, v209
  v_lshrrev_b32 v3, 2, v233
  v_mul_u32_u24 v3, 0x120, v3
  v_and_b32 v4, 3, v233
  v_lshl_add_u32 v3, v4, 3, v3
  s_lshl_b32 s36, s31, 5
  s_xor_b32 s37, s31, 1
  s_lshl_b32 s37, s37, 8
  v_add_u32 v213, s36, v3
  v_add_u32 v214, s37, v3
  v_add_u32 v215, 0x9000, v213
  v_add_u32 v216, 0x9000, v214
  v_add_u32 v217, 0x12000, v213
  v_add_u32 v218, 0x12000, v214
  v_add_u32 v219, 0x1b000, v213
  v_add_u32 v220, 0x1b000, v214
  s_mul_i32 s36, s32, 9
  s_add_u32 s36, s36, 1
  s_lshr_b32 s36, s36, 1
  s_lshl_b32 s36, s36, 10
  s_mul_i32 s37, s33, 0x24000
  s_add_u32 s36, s36, s37
  v_add_u32 v238, s36, v6
  s_mul_i32 s37, s31, 0xffffec08
  s_add_u32 s37, s37, 0x1000
  v_add_u32 v239, s37, v238
  s_mov_b32 s48, 0
  s_mov_b32 s49, 0x24000
  s_mov_b32 s50, 0x48000
  s_mov_b32 s51, 0x6c000
  s_lshl_b32 s36, s2, 7
  s_add_u32 s36, s36, 0x8000
  s_waitcnt vmcnt(0)
  s_barrier
  s_cmp_lg_u32 s101, 0
  s_cbranch_scc1 glu_pubin
  s_mov_b64 exec, 1
  v_mov_b32 v3, s100
  buffer_store_dword v3, off, s[20:23], s36 sc1
  s_mov_b64 exec, -1
glu_pubin:
  s_lshl_b32 s36, s33, 8
  s_add_u32 s36, s36, 0x8000
  v_and_b32 v3, 7, v233
  v_lshl_add_u32 v3, v3, 7, s36
  s_mov_b32 s36, 0x40000
glu_poll:
  buffer_load_dword v4, v3, s[20:23], 0 offen sc1
  s_waitcnt vmcnt(0)
  v_cmp_ne_u32 vcc, s100, v4
  s_nop 1
  s_cbranch_vccz glu_poll_ok
  s_sleep 1
  s_sub_u32 s36, s36, 1
  s_cbranch_scc0 glu_poll
glu_poll_ok:
  buffer_load_dwordx4 a[144:147], v209, s[8:11], s30 offen sc1
  buffer_load_dwordx4 a[148:151], v210, s[8:11], s30 offen sc1
  buffer_load_dwordx4 a[152:155], v211, s[8:11], s30 offen sc1
  buffer_load_dwordx4 a[156:159], v212, s[8:11], s30 offen sc1
  buffer_load_dwordx4 a[160:163], v209, s[8:11], s30 offen offset:1024 sc1
  buffer_load_dwordx4 a[164:167], v210, s[8:11], s30 offen offset:1024 sc1
  buffer_load_dwordx4 a[168:171], v211, s[8:11], s30 offen offset:1024 sc1
  buffer_load_dwordx4 a[172:175], v212, s[8:11], s30 offen offset:1024 sc1
  s_add_u32 s30, s30, 0x800
  ds_read_b64_tr_b16 a[96:97], v214
  ds_read_b64_tr_b16 a[98:99], v214 offset:4608
  ds_read_b64_tr_b16 a[100:101], v214 offset:18432
  ds_read_b64_tr_b16 a[102:103], v214 offset:23040
  ds_read_b64_tr_b16 a[104:105], v213
  ds_read_b64_tr_b16 a[106:107], v213 offset:4608
  ds_read_b64_tr_b16 a[108:109], v213 offset:18432
  ds_read_b64_tr_b16 a[110:111], v213 offset:23040
  ds_read_b64_tr_b16 a[112:113], v213 offset:32
  ds_read_b64_tr_b16 a[114:115], v213 offset:4640
  ds_read_b64_tr_b16 a[116:117], v213 offset:18464
  ds_read_b64_tr_b16 a[118:119], v213 offset:23072
  ds_read_b64_tr_b16 a[120:121], v213 offset:64
  ds_read_b64_tr_b16 a[122:123], v213 offset:4672
  ds_read_b64_tr_b16 a[124:125], v213 offset:18496
  ds_read_b64_tr_b16 a[126:127], v213 offset:23104
  s_waitcnt vmcnt(4) lgkmcnt(12)
  v_mfma_f32_16x16x32_bf16 v[8:11], a[96:99], a[144:147], 0
  ds_read_b64_tr_b16 a[128:129], v213 offset:96
  v_mfma_f32_16x16x32_bf16 v[12:15], a[96:99], a[148:151], 0
  buffer_load_dwordx4 a[176:179], v209, s[8:11], s30 offen sc1
  v_mfma_f32_16x16x32_bf16 v[16:19], a[96:99], a[152:155], 0
  ds_read_b64_tr_b16 a[130:131], v213 offset:4704
  v_mfma_f32_16x16x32_bf16 v[20:23], a[96:99], a[156:159], 0
  v_mfma_f32_16x16x32_bf16 v[24:27], a[100:103], a[144:147], 0
  ds_read_b64_tr_b16 a[132:133], v213 offset:18528
  v_mfma_f32_16x16x32_bf16 v[28:31], a[100:103], a[148:151], 0
  buffer_load_dwordx4 a[180:183], v210, s[8:11], s30 offen sc1
  v_mfma_f32_16x16x32_bf16 v[32:35], a[100:103], a[152:155], 0
  ds_read_b64_tr_b16 a[134:135], v213 offset:23136
  v_mfma_f32_16x16x32_bf16 v[36:39], a[100:103], a[156:159], 0
  s_waitcnt lgkmcnt(12)
  v_mfma_f32_16x16x32_bf16 v[40:43], a[104:107], a[144:147], 0
  ds_read_b64_tr_b16 a[136:137], v213 offset:128
  v_mfma_f32_16x16x32_bf16 v[44:47], a[104:107], a[148:151], 0
  buffer_load_dwordx4 a[184:187], v211, s[8:11], s30 offen sc1
  v_mfma_f32_16x16x32_bf16 v[48:51], a[104:107], a[152:155], 0
  ds_read_b64_tr_b16 a[138:139], v213 offset:4736
  v_mfma_f32_16x16x32_bf16 v[52:55], a[104:107], a[156:159], 0
  v_mfma_f32_16x16x32_bf16 v[56:59], a[108:111], a[144:147], 0
  ds_read_b64_tr_b16 a[140:141], v213 offset:18560
  v_mfma_f32_16x16x32_bf16 v[60:63], a[108:111], a[148:151], 0
  buffer_load_dwordx4 a[188:191], v212, s[8:11], s30 offen sc1
  v_mfma_f32_16x16x32_bf16 v[64:67], a[108:111], a[152:155], 0
  ds_read_b64_tr_b16 a[142:143], v213 offset:23168
  v_mfma_f32_16x16x32_bf16 v[68:71], a[108:111], a[156:159], 0
  s_waitcnt lgkmcnt(12)
  v_mfma_f32_16x16x32_bf16 v[72:75], a[112:115], a[144:147], 0
  ds_read_b64_tr_b16 a[96:97], v213 offset:160
  v_mfma_f32_16x16x32_bf16 v[76:79], a[112:115], a[148:151], 0
  buffer_load_dwordx4 a[192:195], v209, s[8:11], s30 offen offset:1024 sc1
  v_mfma_f32_16x16x32_bf16 v[80:83], a[112:115], a[152:155], 0
  ds_read_b64_tr_b16 a[98:99], v213 offset:4768
  v_mfma_f32_16x16x32_bf16 v[84:87], a[112:115], a[156:159], 0
  v_mfma_f32_16x16x32_bf16 v[88:91], a[116:119], a[144:147], 0
  ds_read_b64_tr_b16 a[100:101], v213 offset:18592
  v_mfma_f32_16x16x32_bf16 v[92:95], a[116:119], a[148:151], 0
  buffer_load_dwordx4 a[196:199], v210, s[8:11], s30 offen offset:1024 sc1
  v_mfma_f32_16x16x32_bf16 v[96:99], a[116:119], a[152:155], 0
  ds_read_b64_tr_b16 a[102:103], v213 offset:23200
  v_mfma_f32_16x16x32_bf16 v[100:103], a[116:119], a[156:159], 0
  s_waitcnt lgkmcnt(12)
  v_mfma_f32_16x16x32_bf16 v[104:107], a[120:123], a[144:147], 0
  ds_read_b64_tr_b16 a[104:105], v213 offset:192
  v_mfma_f32_16x16x32_bf16 v[108:111], a[120:123], a[148:151], 0
  buffer_load_dwordx4 a[200:203], v211, s[8:11], s30 offen offset:1024 sc1
  v_mfma_f32_16x16x32_bf16 v[112:115], a[120:123], a[152:155], 0
  ds_read_b64_tr_b16 a[106:107], v213 offset:4800
  v_mfma_f32_16x16x32_bf16 v[116:119], a[120:123], a[156:159], 0
  v_mfma_f32_16x16x32_bf16 v[120:123], a[124:127], a[144:147], 0
  ds_read_b64_tr_b16 a[108:109], v213 offset:18624
  v_mfma_f32_16x16x32_bf16 v[124:127], a[124:127], a[148:151], 0
  buffer_load_dwordx4 a[204:207], v212, s[8:11], s30 offen offset:1024 sc1
  s_add_u32 s30, s30, 0x800
  v_mfma_f32_16x16x32_bf16 v[128:131], a[124:127], a[152:155], 0
  ds_read_b64_tr_b16 a[110:111], v213 offset:23232
  s_add_u32 m0, s28, 0x12000
  v_mfma_f32_16x16x32_bf16 v[132:135], a[124:127], a[156:159], 0
  s_waitcnt lgkmcnt(12)
  v_mfma_f32_16x16x32_bf16 v[136:139], a[128:131], a[144:147], 0
  ds_read_b64_tr_b16 a[112:113], v213 offset:224
  v_mfma_f32_16x16x32_bf16 v[140:143], a[128:131], a[148:151], 0
  buffer_load_dwordx4 v224, s[12:15], s29 offen lds
  v_mfma_f32_16x16x32_bf16 v[144:147], a[128:131], a[152:155], 0
  ds_read_b64_tr_b16 a[114:115], v213 offset:4832
  v_mfma_f32_16x16x32_bf16 v[148:151], a[128:131], a[156:159], 0
  v_mfma_f32_16x16x32_bf16 v[152:155], a[132:135], a[144:147], 0
  ds_read_b64_tr_b16 a[116:117], v213 offset:18656
  v_mfma_f32_16x16x32_bf16 v[156:159], a[132:135], a[148:151], 0
  buffer_load_dwordx4 v225, s[12:15], s29 offen offset:1024 lds
  v_mfma_f32_16x16x32_bf16 v[160:163], a[132:135], a[152:155], 0
  ds_read_b64_tr_b16 a[118:119], v213 offset:23264
  v_mfma_f32_16x16x32_bf16 v[164:167], a[132:135], a[156:159], 0
  s_waitcnt lgkmcnt(12)
  v_mfma_f32_16x16x32_bf16 v[168:171], a[136:139], a[144:147], 0
  ds_read_b64_tr_b16 a[120:121], v214 offset:9216
  v_mfma_f32_16x16x32_bf16 v[172:175], a[136:139], a[148:151], 0
  buffer_load_dwordx4 v226, s[12:15], s29 offen offset:2048 lds
  v_mfma_f32_16x16x32_bf16 v[176:179], a[136:139], a[152:155], 0
  ds_read_b64_tr_b16 a[122:123], v214 offset:13824
  v_mfma_f32_16x16x32_bf16 v[180:183], a[136:139], a[156:159], 0
  v_mfma_f32_16x16x32_bf16 v[184:187], a[140:143], a[144:147], 0
  ds_read_b64_tr_b16 a[124:125], v214 offset:27648
  v_mfma_f32_16x16x32_bf16 v[188:191], a[140:143], a[148:151], 0
  buffer_load_dwordx4 v227, s[12:15], s29 offen offset:3072 lds
  s_add_u32 m0, s28, 0x13000
  v_mfma_f32_16x16x32_bf16 v[192:195], a[140:143], a[152:155], 0
  ds_read_b64_tr_b16 a[126:127], v214 offset:32256
  v_mfma_f32_16x16x32_bf16 v[196:199], a[140:143], a[156:159], 0
  s_waitcnt lgkmcnt(12)
  v_mfma_f32_16x16x32_bf16 a[0:3], a[96:99], a[144:147], 0
  ds_read_b64_tr_b16 a[128:129], v213 offset:9216
  v_mfma_f32_16x16x32_bf16 a[4:7], a[96:99], a[148:151], 0
  buffer_load_dwordx4 v228, s[12:15], s29 offen lds
  v_mfma_f32_16x16x32_bf16 a[8:11], a[96:99], a[152:155], 0
  ds_read_b64_tr_b16 a[130:131], v213 offset:13824
  v_mfma_f32_16x16x32_bf16 a[12:15], a[96:99], a[156:159], 0
  v_mfma_f32_16x16x32_bf16 a[16:19], a[100:103], a[144:147], 0
  ds_read_b64_tr_b16 a[132:133], v213 offset:27648
  v_mfma_f32_16x16x32_bf16 a[20:23], a[100:103], a[148:151], 0
  buffer_load_dwordx4 v229, s[12:15], s29 offen offset:1024 lds
  v_mfma_f32_16x16x32_bf16 a[24:27], a[100:103], a[152:155], 0
  ds_read_b64_tr_b16 a[134:135], v213 offset:32256
  v_mfma_f32_16x16x32_bf16 a[28:31], a[100:103], a[156:159], 0
  s_waitcnt lgkmcnt(12)
  v_mfma_f32_16x16x32_bf16 a[32:35], a[104:107], a[144:147], 0
  ds_read_b64_tr_b16 a[136:137], v213 offset:9248
  v_mfma_f32_16x16x32_bf16 a[36:39], a[104:107], a[148:151], 0
  buffer_load_dwordx4 v230, s[12:15], s29 offen offset:2048 lds
  v_mfma_f32_16x16x32_bf16 a[40:43], a[104:107], a[152:155], 0
  ds_read_b64_tr_b16 a[138:139], v213 offset:13856
  v_mfma_f32_16x16x32_bf16 a[44:47], a[104:107], a[156:159], 0
  v_mfma_f32_16x16x32_bf16 a[48:51], a[108:111], a[144:147], 0
  ds_read_b64_tr_b16 a[140:141], v213 offset:27680
  v_mfma_f32_16x16x32_bf16 a[52:55], a[108:111], a[148:151], 0
  buffer_load_dwordx4 v231, s[12:15], s29 offen offset:3072 lds
  s_add_u32 m0, s28, 0x14000
  v_mfma_f32_16x16x32_bf16 a[56:59], a[108:111], a[152:155], 0
  ds_read_b64_tr_b16 a[142:143], v213 offset:32288
  v_mfma_f32_16x16x32_bf16 a[60:63], a[108:111], a[156:159], 0
  s_waitcnt lgkmcnt(12)
  v_mfma_f32_16x16x32_bf16 a[64:67], a[112:115], a[144:147], 0
  ds_read_b64_tr_b16 a[96:97], v213 offset:9280
  v_mfma_f32_16x16x32_bf16 a[68:71], a[112:115], a[148:151], 0
  buffer_load_dwordx4 v232, s[12:15], s29 offen lds
  s_add_u32 s29, s29, 0x90000
  v_mfma_f32_16x16x32_bf16 a[72:75], a[112:115], a[152:155], 0
  ds_read_b64_tr_b16 a[98:99], v213 offset:13888
  v_mfma_f32_16x16x32_bf16 a[76:79], a[112:115], a[156:159], 0
  v_mfma_f32_16x16x32_bf16 a[80:83], a[116:119], a[144:147], 0
  ds_read_b64_tr_b16 a[100:101], v213 offset:27712
  v_mfma_f32_16x16x32_bf16 a[84:87], a[116:119], a[148:151], 0
  v_mfma_f32_16x16x32_bf16 a[88:91], a[116:119], a[152:155], 0
  ds_read_b64_tr_b16 a[102:103], v213 offset:32320
  v_mfma_f32_16x16x32_bf16 a[92:95], a[116:119], a[156:159], 0
  buffer_load_dwordx4 a[208:211], v209, s[8:11], s30 offen sc1
  s_waitcnt vmcnt(18) lgkmcnt(12)
  v_mfma_f32_16x16x32_bf16 v[8:11], a[120:123], a[160:163], v[8:11]
  ds_read_b64_tr_b16 a[104:105], v213 offset:9312
  v_mfma_f32_16x16x32_bf16 v[12:15], a[120:123], a[164:167], v[12:15]
  v_mfma_f32_16x16x32_bf16 v[16:19], a[120:123], a[168:171], v[16:19]
  ds_read_b64_tr_b16 a[106:107], v213 offset:13920
  v_mfma_f32_16x16x32_bf16 v[20:23], a[120:123], a[172:175], v[20:23]
  buffer_load_dwordx4 a[212:215], v210, s[8:11], s30 offen sc1
  v_mfma_f32_16x16x32_bf16 v[24:27], a[124:127], a[160:163], v[24:27]
  ds_read_b64_tr_b16 a[108:109], v213 offset:27744
  v_mfma_f32_16x16x32_bf16 v[28:31], a[124:127], a[164:167], v[28:31]
  v_mfma_f32_16x16x32_bf16 v[32:35], a[124:127], a[168:171], v[32:35]
  ds_read_b64_tr_b16 a[110:111], v213 offset:32352
  v_mfma_f32_16x16x32_bf16 v[36:39], a[124:127], a[172:175], v[36:39]
  buffer_load_dwordx4 a[216:219], v211, s[8:11], s30 offen sc1
  s_waitcnt lgkmcnt(12)
  v_mfma_f32_16x16x32_bf16 v[40:43], a[128:131], a[160:163], v[40:43]
  ds_read_b64_tr_b16 a[112:113], v213 offset:9344
  v_mfma_f32_16x16x32_bf16 v[44:47], a[128:131], a[164:167], v[44:47]
  v_mfma_f32_16x16x32_bf16 v[48:51], a[128:131], a[168:171], v[48:51]
  ds_read_b64_tr_b16 a[114:115], v213 offset:13952
  v_mfma_f32_16x16x32_bf16 v[52:55], a[128:131], a[172:175], v[52:55]
  buffer_load_dwordx4 a[220:223], v212, s[8:11], s30 offen sc1
  v_mfma_f32_16x16x32_bf16 v[56:59], a[132:135], a[160:163], v[56:59]
  ds_read_b64_tr_b16 a[116:117], v213 offset:27776
  v_mfma_f32_16x16x32_bf16 v[60:63], a[132:135], a[164:167], v[60:63]
  v_mfma_f32_16x16x32_bf16 v[64:67], a[132:135], a[168:171], v[64:67]
  ds_read_b64_tr_b16 a[118:119], v213 offset:32384
  v_mfma_f32_16x16x32_bf16 v[68:71], a[132:135], a[172:175], v[68:71]
  buffer_load_dwordx4 a[224:227], v209, s[8:11], s30 offen offset:1024 sc1
  s_waitcnt lgkmcnt(12)
  v_mfma_f32_16x16x32_bf16 v[72:75], a[136:139], a[160:163], v[72:75]
  ds_read_b64_tr_b16 a[120:121], v213 offset:9376
  v_mfma_f32_16x16x32_bf16 v[76:79], a[136:139], a[164:167], v[76:79]
  v_mfma_f32_16x16x32_bf16 v[80:83], a[136:139], a[168:171], v[80:83]
  ds_read_b64_tr_b16 a[122:123], v213 offset:13984
  v_mfma_f32_16x16x32_bf16 v[84:87], a[136:139], a[172:175], v[84:87]
  buffer_load_dwordx4 a[228:231], v210, s[8:11], s30 offen offset:1024 sc1
  v_mfma_f32_16x16x32_bf16 v[88:91], a[140:143], a[160:163], v[88:91]
  ds_read_b64_tr_b16 a[124:125], v213 offset:27808
  v_mfma_f32_16x16x32_bf16 v[92:95], a[140:143], a[164:167], v[92:95]
  v_mfma_f32_16x16x32_bf16 v[96:99], a[140:143], a[168:171], v[96:99]
  ds_read_b64_tr_b16 a[126:127], v213 offset:32416
  v_mfma_f32_16x16x32_bf16 v[100:103], a[140:143], a[172:175], v[100:103]
  buffer_load_dwordx4 a[232:235], v211, s[8:11], s30 offen offset:1024 sc1
  s_waitcnt lgkmcnt(12)
  v_mfma_f32_16x16x32_bf16 v[104:107], a[96:99], a[160:163], v[104:107]
  ds_read_b64_tr_b16 a[128:129], v213 offset:9408
  v_mfma_f32_16x16x32_bf16 v[108:111], a[96:99], a[164:167], v[108:111]
  v_mfma_f32_16x16x32_bf16 v[112:115], a[96:99], a[168:171], v[112:115]
  ds_read_b64_tr_b16 a[130:131], v213 offset:14016
  v_mfma_f32_16x16x32_bf16 v[116:119], a[96:99], a[172:175], v[116:119]
  buffer_load_dwordx4 a[236:239], v212, s[8:11], s30 offen offset:1024 sc1
  s_add_u32 s30, s30, 0x800
  v_mfma_f32_16x16x32_bf16 v[120:123], a[100:103], a[160:163], v[120:123]
  ds_read_b64_tr_b16 a[132:133], v213 offset:27840
  v_mfma_f32_16x16x32_bf16 v[124:127], a[100:103], a[164:167], v[124:127]
  v_mfma_f32_16x16x32_bf16 v[128:131], a[100:103], a[168:171], v[128:131]
  ds_read_b64_tr_b16 a[134:135], v213 offset:32448
  v_mfma_f32_16x16x32_bf16 v[132:135], a[100:103], a[172:175], v[132:135]
  s_waitcnt lgkmcnt(12)
  v_mfma_f32_16x16x32_bf16 v[136:139], a[104:107], a[160:163], v[136:139]
  ds_read_b64_tr_b16 a[136:137], v213 offset:9440
  v_mfma_f32_16x16x32_bf16 v[140:143], a[104:107], a[164:167], v[140:143]
  v_mfma_f32_16x16x32_bf16 v[144:147], a[104:107], a[168:171], v[144:147]
  ds_read_b64_tr_b16 a[138:139], v213 offset:14048
  v_mfma_f32_16x16x32_bf16 v[148:151], a[104:107], a[172:175], v[148:151]
  v_mfma_f32_16x16x32_bf16 v[152:155], a[108:111], a[160:163], v[152:155]
  ds_read_b64_tr_b16 a[140:141], v213 offset:27872
  v_mfma_f32_16x16x32_bf16 v[156:159], a[108:111], a[164:167], v[156:159]
  s_waitcnt vmcnt(40)
  s_barrier
  v_mfma_f32_16x16x32_bf16 v[160:163], a[108:111], a[168:171], v[160:163]
  ds_read_b64_tr_b16 a[142:143], v213 offset:32480
  v_mfma_f32_16x16x32_bf16 v[164:167], a[108:111], a[172:175], v[164:167]
  s_waitcnt lgkmcnt(12)
  v_mfma_f32_16x16x32_bf16 v[168:171], a[112:115], a[160:163], v[168:171]
  ds_read_b64_tr_b16 a[96:97], v216
  v_mfma_f32_16x16x32_bf16 v[172:175], a[112:115], a[164:167], v[172:175]
  v_mfma_f32_16x16x32_bf16 v[176:179], a[112:115], a[168:171], v[176:179]
  ds_read_b64_tr_b16 a[98:99], v216 offset:4608
  v_mfma_f32_16x16x32_bf16 v[180:183], a[112:115], a[172:175], v[180:183]
  v_mfma_f32_16x16x32_bf16 v[184:187], a[116:119], a[160:163], v[184:187]
  ds_read_b64_tr_b16 a[100:101], v216 offset:18432
  v_mfma_f32_16x16x32_bf16 v[188:191], a[116:119], a[164:167], v[188:191]
  v_mfma_f32_16x16x32_bf16 v[192:195], a[116:119], a[168:171], v[192:195]
  ds_read_b64_tr_b16 a[102:103], v216 offset:23040
  v_mfma_f32_16x16x32_bf16 v[196:199], a[116:119], a[172:175], v[196:199]
  s_waitcnt lgkmcnt(12)
  v_mfma_f32_16x16x32_bf16 a[0:3], a[120:123], a[160:163], a[0:3]
  ds_read_b64_tr_b16 a[104:105], v215
  v_mfma_f32_16x16x32_bf16 a[4:7], a[120:123], a[164:167], a[4:7]
  v_mfma_f32_16x16x32_bf16 a[8:11], a[120:123], a[168:171], a[8:11]
  ds_read_b64_tr_b16 a[106:107], v215 offset:4608
  v_mfma_f32_16x16x32_bf16 a[12:15], a[120:123], a[172:175], a[12:15]
  v_mfma_f32_16x16x32_bf16 a[16:19], a[124:127], a[160:163], a[16:19]
  ds_read_b64_tr_b16 a[108:109], v215 offset:18432
  v_mfma_f32_16x16x32_bf16 a[20:23], a[124:127], a[164:167], a[20:23]
  v_mfma_f32_16x16x32_bf16 a[24:27], a[124:127], a[168:171], a[24:27]
  ds_read_b64_tr_b16 a[110:111], v215 offset:23040
  v_mfma_f32_16x16x32_bf16 a[28:31], a[124:127], a[172:175], a[28:31]
  s_waitcnt lgkmcnt(12)
  v_mfma_f32_16x16x32_bf16 a[32:35], a[128:131], a[160:163], a[32:35]
  ds_read_b64_tr_b16 a[112:113], v215 offset:32
  v_mfma_f32_16x16x32_bf16 a[36:39], a[128:131], a[164:167], a[36:39]
  v_mfma_f32_16x16x32_bf16 a[40:43], a[128:131], a[168:171], a[40:43]
  ds_read_b64_tr_b16 a[114:115], v215 offset:4640
  v_mfma_f32_16x16x32_bf16 a[44:47], a[128:131], a[172:175], a[44:47]
  v_mfma_f32_16x16x32_bf16 a[48:51], a[132:135], a[160:163], a[48:51]
  ds_read_b64_tr_b16 a[116:117], v215 offset:18464
  v_mfma_f32_16x16x32_bf16 a[52:55], a[132:135], a[164:167], a[52:55]
  v_mfma_f32_16x16x32_bf16 a[56:59], a[132:135], a[168:171], a[56:59]
  ds_read_b64_tr_b16 a[118:119], v215 offset:23072
  v_mfma_f32_16x16x32_bf16 a[60:63], a[132:135], a[172:175], a[60:63]
  s_waitcnt lgkmcnt(12)
  v_mfma_f32_16x16x32_bf16 a[64:67], a[136:139], a[160:163], a[64:67]
  ds_read_b64_tr_b16 a[120:121], v215 offset:64
  v_mfma_f32_16x16x32_bf16 a[68:71], a[136:139], a[164:167], a[68:71]
  v_mfma_f32_16x16x32_bf16 a[72:75], a[136:139], a[168:171], a[72:75]
  ds_read_b64_tr_b16 a[122:123], v215 offset:4672
  v_mfma_f32_16x16x32_bf16 a[76:79], a[136:139], a[172:175], a[76:79]
  v_mfma_f32_16x16x32_bf16 a[80:83], a[140:143], a[160:163], a[80:83]
  ds_read_b64_tr_b16 a[124:125], v215 offset:18496
  v_mfma_f32_16x16x32_bf16 a[84:87], a[140:143], a[164:167], a[84:87]
  v_mfma_f32_16x16x32_bf16 a[88:91], a[140:143], a[168:171], a[88:91]
  ds_read_b64_tr_b16 a[126:127], v215 offset:23104
  v_mfma_f32_16x16x32_bf16 a[92:95], a[140:143], a[172:175], a[92:95]
  s_waitcnt vmcnt(21) lgkmcnt(12)
  v_mfma_f32_16x16x32_bf16 v[8:11], a[96:99], a[176:179], v[8:11]
  ds_read_b64_tr_b16 a[128:129], v215 offset:96
  s_add_u32 m0, s28, 0x1b000
  v_mfma_f32_16x16x32_bf16 v[12:15], a[96:99], a[180:183], v[12:15]
  buffer_load_dwordx4 v224, s[12:15], s29 offen lds
  v_mfma_f32_16x16x32_bf16 v[16:19], a[96:99], a[184:187], v[16:19]
  ds_read_b64_tr_b16 a[130:131], v215 offset:4704
  v_mfma_f32_16x16x32_bf16 v[20:23], a[96:99], a[188:191], v[20:23]
  v_mfma_f32_16x16x32_bf16 v[24:27], a[100:103], a[176:179], v[24:27]
  ds_read_b64_tr_b16 a[132:133], v215 offset:18528
  v_mfma_f32_16x16x32_bf16 v[28:31], a[100:103], a[180:183], v[28:31]
  v_mfma_f32_16x16x32_bf16 v[32:35], a[100:103], a[184:187], v[32:35]
  ds_read_b64_tr_b16 a[134:135], v215 offset:23136
  v_mfma_f32_16x16x32_bf16 v[36:39], a[100:103], a[188:191], v[36:39]
  buffer_load_dwordx4 v225, s[12:15], s29 offen offset:1024 lds
  s_waitcnt lgkmcnt(12)
  v_mfma_f32_16x16x32_bf16 v[40:43], a[104:107], a[176:179], v[40:43]
  ds_read_b64_tr_b16 a[136:137], v215 offset:128
  v_mfma_f32_16x16x32_bf16 v[44:47], a[104:107], a[180:183], v[44:47]
  v_mfma_f32_16x16x32_bf16 v[48:51], a[104:107], a[184:187], v[48:51]
  ds_read_b64_tr_b16 a[138:139], v215 offset:4736
  v_mfma_f32_16x16x32_bf16 v[52:55], a[104:107], a[188:191], v[52:55]
  v_mfma_f32_16x16x32_bf16 v[56:59], a[108:111], a[176:179], v[56:59]
  ds_read_b64_tr_b16 a[140:141], v215 offset:18560
  v_mfma_f32_16x16x32_bf16 v[60:63], a[108:111], a[180:183], v[60:63]
  buffer_load_dwordx4 v226, s[12:15], s29 offen offset:2048 lds
  v_mfma_f32_16x16x32_bf16 v[64:67], a[108:111], a[184:187], v[64:67]
  ds_read_b64_tr_b16 a[142:143], v215 offset:23168
  v_mfma_f32_16x16x32_bf16 v[68:71], a[108:111], a[188:191], v[68:71]
  s_waitcnt lgkmcnt(12)
  v_mfma_f32_16x16x32_bf16 v[72:75], a[112:115], a[176:179], v[72:75]
  ds_read_b64_tr_b16 a[96:97], v215 offset:160
  v_mfma_f32_16x16x32_bf16 v[76:79], a[112:115], a[180:183], v[76:79]
  v_mfma_f32_16x16x32_bf16 v[80:83], a[112:115], a[184:187], v[80:83]
  ds_read_b64_tr_b16 a[98:99], v215 offset:4768
  v_mfma_f32_16x16x32_bf16 v[84:87], a[112:115], a[188:191], v[84:87]
  buffer_load_dwordx4 v227, s[12:15], s29 offen offset:3072 lds
  s_add_u32 m0, s28, 0x1c000
  v_mfma_f32_16x16x32_bf16 v[88:91], a[116:119], a[176:179], v[88:91]
  ds_read_b64_tr_b16 a[100:101], v215 offset:18592
  v_mfma_f32_16x16x32_bf16 v[92:95], a[116:119], a[180:183], v[92:95]
  v_mfma_f32_16x16x32_bf16 v[96:99], a[116:119], a[184:187], v[96:99]
  ds_read_b64_tr_b16 a[102:103], v215 offset:23200
  v_mfma_f32_16x16x32_bf16 v[100:103], a[116:119], a[188:191], v[100:103]
  s_waitcnt lgkmcnt(12)
  v_mfma_f32_16x16x32_bf16 v[104:107], a[120:123], a[176:179], v[104:107]
  ds_read_b64_tr_b16 a[104:105], v215 offset:192
  v_mfma_f32_16x16x32_bf16 v[108:111], a[120:123], a[180:183], v[108:111]
  buffer_load_dwordx4 v228, s[12:15], s29 offen lds
  v_mfma_f32_16x16x32_bf16 v[112:115], a[120:123], a[184:187], v[112:115]
  ds_read_b64_tr_b16 a[106:107], v215 offset:4800
  v_mfma_f32_16x16x32_bf16 v[116:119], a[120:123], a[188:191], v[116:119]
  v_mfma_f32_16x16x32_bf16 v[120:123], a[124:127], a[176:179], v[120:123]
  ds_read_b64_tr_b16 a[108:109], v215 offset:18624
  v_mfma_f32_16x16x32_bf16 v[124:127], a[124:127], a[180:183], v[124:127]
  v_mfma_f32_16x16x32_bf16 v[128:131], a[124:127], a[184:187], v[128:131]
  ds_read_b64_tr_b16 a[110:111], v215 offset:23232
  v_mfma_f32_16x16x32_bf16 v[132:135], a[124:127], a[188:191], v[132:135]
  buffer_load_dwordx4 v229, s[12:15], s29 offen offset:1024 lds
  s_waitcnt lgkmcnt(12)
  v_mfma_f32_16x16x32_bf16 v[136:139], a[128:131], a[176:179], v[136:139]
  ds_read_b64_tr_b16 a[112:113], v215 offset:224
  v_mfma_f32_16x16x32_bf16 v[140:143], a[128:131], a[180:183], v[140:143]
  v_mfma_f32_16x16x32_bf16 v[144:147], a[128:131], a[184:187], v[144:147]
  ds_read_b64_tr_b16 a[114:115], v215 offset:4832
  v_mfma_f32_16x16x32_bf16 v[148:151], a[128:131], a[188:191], v[148:151]
  v_mfma_f32_16x16x32_bf16 v[152:155], a[132:135], a[176:179], v[152:155]
  ds_read_b64_tr_b16 a[116:117], v215 offset:18656
  v_mfma_f32_16x16x32_bf16 v[156:159], a[132:135], a[180:183], v[156:159]
  buffer_load_dwordx4 v230, s[12:15], s29 offen offset:2048 lds
  v_mfma_f32_16x16x32_bf16 v[160:163], a[132:135], a[184:187], v[160:163]
  ds_read_b64_tr_b16 a[118:119], v215 offset:23264
  v_mfma_f32_16x16x32_bf16 v[164:167], a[132:135], a[188:191], v[164:167]
  s_waitcnt lgkmcnt(12)
  v_mfma_f32_16x16x32_bf16 v[168:171], a[136:139], a[176:179], v[168:171]
  ds_read_b64_tr_b16 a[120:121], v216 offset:9216
  v_mfma_f32_16x16x32_bf16 v[172:175], a[136:139], a[180:183], v[172:175]
  v_mfma_f32_16x16x32_bf16 v[176:179], a[136:139], a[184:187], v[176:179]
  ds_read_b64_tr_b16 a[122:123], v216 offset:13824
  v_mfma_f32_16x16x32_bf16 v[180:183], a[136:139], a[188:191], v[180:183]
  buffer_load_dwordx4 v231, s[12:15], s29 offen offset:3072 lds
  s_add_u32 m0, s28, 0x1d000
  v_mfma_f32_16x16x32_bf16 v[184:187], a[140:143], a[176:179], v[184:187]
  ds_read_b64_tr_b16 a[124:125], v216 offset:27648
  v_mfma_f32_16x16x32_bf16 v[188:191], a[140:143], a[180:183], v[188:191]
  v_mfma_f32_16x16x32_bf16 v[192:195], a[140:143], a[184:187], v[192:195]
  ds_read_b64_tr_b16 a[126:127], v216 offset:32256
  v_mfma_f32_16x16x32_bf16 v[196:199], a[140:143], a[188:191], v[196:199]
  s_waitcnt lgkmcnt(12)
  v_mfma_f32_16x16x32_bf16 a[0:3], a[96:99], a[176:179], a[0:3]
  ds_read_b64_tr_b16 a[128:129], v215 offset:9216
  v_mfma_f32_16x16x32_bf16 a[4:7], a[96:99], a[180:183], a[4:7]
  buffer_load_dwordx4 v232, s[12:15], s29 offen lds
  s_add_u32 s29, s29, 0x90000
  v_mfma_f32_16x16x32_bf16 a[8:11], a[96:99], a[184:187], a[8:11]
  ds_read_b64_tr_b16 a[130:131], v215 offset:13824
  v_mfma_f32_16x16x32_bf16 a[12:15], a[96:99], a[188:191], a[12:15]
  v_mfma_f32_16x16x32_bf16 a[16:19], a[100:103], a[176:179], a[16:19]
  ds_read_b64_tr_b16 a[132:133], v215 offset:27648
  v_mfma_f32_16x16x32_bf16 a[20:23], a[100:103], a[180:183], a[20:23]
  v_mfma_f32_16x16x32_bf16 a[24:27], a[100:103], a[184:187], a[24:27]
  ds_read_b64_tr_b16 a[134:135], v215 offset:32256
  v_mfma_f32_16x16x32_bf16 a[28:31], a[100:103], a[188:191], a[28:31]
  buffer_load_dwordx4 a[144:147], v209, s[8:11], s30 offen sc1
  s_waitcnt lgkmcnt(12)
  v_mfma_f32_16x16x32_bf16 a[32:35], a[104:107], a[176:179], a[32:35]
  ds_read_b64_tr_b16 a[136:137], v215 offset:9248
  v_mfma_f32_16x16x32_bf16 a[36:39], a[104:107], a[180:183], a[36:39]
  v_mfma_f32_16x16x32_bf16 a[40:43], a[104:107], a[184:187], a[40:43]
  ds_read_b64_tr_b16 a[138:139], v215 offset:13856
  v_mfma_f32_16x16x32_bf16 a[44:47], a[104:107], a[188:191], a[44:47]
  v_mfma_f32_16x16x32_bf16 a[48:51], a[108:111], a[176:179], a[48:51]
  ds_read_b64_tr_b16 a[140:141], v215 offset:27680
  v_mfma_f32_16x16x32_bf16 a[52:55], a[108:111], a[180:183], a[52:55]
  buffer_load_dwordx4 a[148:151], v210, s[8:11], s30 offen sc1
  v_mfma_f32_16x16x32_bf16 a[56:59], a[108:111], a[184:187], a[56:59]
  ds_read_b64_tr_b16 a[142:143], v215 offset:32288
  v_mfma_f32_16x16x32_bf16 a[60:63], a[108:111], a[188:191], a[60:63]
  s_waitcnt lgkmcnt(12)
  v_mfma_f32_16x16x32_bf16 a[64:67], a[112:115], a[176:179], a[64:67]
  ds_read_b64_tr_b16 a[96:97], v215 offset:9280
  v_mfma_f32_16x16x32_bf16 a[68:71], a[112:115], a[180:183], a[68:71]
  v_mfma_f32_16x16x32_bf16 a[72:75], a[112:115], a[184:187], a[72:75]
  ds_read_b64_tr_b16 a[98:99], v215 offset:13888
  v_mfma_f32_16x16x32_bf16 a[76:79], a[112:115], a[188:191], a[76:79]
  buffer_load_dwordx4 a[152:155], v211, s[8:11], s30 offen sc1
  v_mfma_f32_16x16x32_bf16 a[80:83], a[116:119], a[176:179], a[80:83]
  ds_read_b64_tr_b16 a[100:101], v215 offset:27712
  v_mfma_f32_16x16x32_bf16 a[84:87], a[116:119], a[180:183], a[84:87]
  v_mfma_f32_16x16x32_bf16 a[88:91], a[116:119], a[184:187], a[88:91]
  ds_read_b64_tr_b16 a[102:103], v215 offset:32320
  v_mfma_f32_16x16x32_bf16 a[92:95], a[116:119], a[188:191], a[92:95]
  s_waitcnt vmcnt(29) lgkmcnt(12)
  v_mfma_f32_16x16x32_bf16 v[8:11], a[120:123], a[192:195], v[8:11]
  ds_read_b64_tr_b16 a[104:105], v215 offset:9312
  v_mfma_f32_16x16x32_bf16 v[12:15], a[120:123], a[196:199], v[12:15]
  buffer_load_dwordx4 a[156:159], v212, s[8:11], s30 offen sc1
  v_mfma_f32_16x16x32_bf16 v[16:19], a[120:123], a[200:203], v[16:19]
  ds_read_b64_tr_b16 a[106:107], v215 offset:13920
  v_mfma_f32_16x16x32_bf16 v[20:23], a[120:123], a[204:207], v[20:23]
  v_mfma_f32_16x16x32_bf16 v[24:27], a[124:127], a[192:195], v[24:27]
  ds_read_b64_tr_b16 a[108:109], v215 offset:27744
  v_mfma_f32_16x16x32_bf16 v[28:31], a[124:127], a[196:199], v[28:31]
  v_mfma_f32_16x16x32_bf16 v[32:35], a[124:127], a[200:203], v[32:35]
  ds_read_b64_tr_b16 a[110:111], v215 offset:32352
  v_mfma_f32_16x16x32_bf16 v[36:39], a[124:127], a[204:207], v[36:39]
  buffer_load_dwordx4 a[160:163], v209, s[8:11], s30 offen offset:1024 sc1
  s_waitcnt lgkmcnt(12)
  v_mfma_f32_16x16x32_bf16 v[40:43], a[128:131], a[192:195], v[40:43]
  ds_read_b64_tr_b16 a[112:113], v215 offset:9344
  v_mfma_f32_16x16x32_bf16 v[44:47], a[128:131], a[196:199], v[44:47]
  v_mfma_f32_16x16x32_bf16 v[48:51], a[128:131], a[200:203], v[48:51]
  ds_read_b64_tr_b16 a[114:115], v215 offset:13952
  v_mfma_f32_16x16x32_bf16 v[52:55], a[128:131], a[204:207], v[52:55]
  v_mfma_f32_16x16x32_bf16 v[56:59], a[132:135], a[192:195], v[56:59]
  ds_read_b64_tr_b16 a[116:117], v215 offset:27776
  v_mfma_f32_16x16x32_bf16 v[60:63], a[132:135], a[196:199], v[60:63]
  buffer_load_dwordx4 a[164:167], v210, s[8:11], s30 offen offset:1024 sc1
  v_mfma_f32_16x16x32_bf16 v[64:67], a[132:135], a[200:203], v[64:67]
  ds_read_b64_tr_b16 a[118:119], v215 offset:32384
  v_mfma_f32_16x16x32_bf16 v[68:71], a[132:135], a[204:207], v[68:71]
  s_waitcnt lgkmcnt(12)
  v_mfma_f32_16x16x32_bf16 v[72:75], a[136:139], a[192:195], v[72:75]
  ds_read_b64_tr_b16 a[120:121], v215 offset:9376
  v_mfma_f32_16x16x32_bf16 v[76:79], a[136:139], a[196:199], v[76:79]
  v_mfma_f32_16x16x32_bf16 v[80:83], a[136:139], a[200:203], v[80:83]
  ds_read_b64_tr_b16 a[122:123], v215 offset:13984
  v_mfma_f32_16x16x32_bf16 v[84:87], a[136:139], a[204:207], v[84:87]
  buffer_load_dwordx4 a[168:171], v211, s[8:11], s30 offen offset:1024 sc1
  v_mfma_f32_16x16x32_bf16 v[88:91], a[140:143], a[192:195], v[88:91]
  ds_read_b64_tr_b16 a[124:125], v215 offset:27808
  v_mfma_f32_16x16x32_bf16 v[92:95], a[140:143], a[196:199], v[92:95]
  v_mfma_f32_16x16x32_bf16 v[96:99], a[140:143], a[200:203], v[96:99]
  ds_read_b64_tr_b16 a[126:127], v215 offset:32416
  v_mfma_f32_16x16x32_bf16 v[100:103], a[140:143], a[204:207], v[100:103]
  s_waitcnt lgkmcnt(12)
  v_mfma_f32_16x16x32_bf16 v[104:107], a[96:99], a[192:195], v[104:107]
  ds_read_b64_tr_b16 a[128:129], v215 offset:9408
  v_mfma_f32_16x16x32_bf16 v[108:111], a[96:99], a[196:199], v[108:111]
  buffer_load_dwordx4 a[172:175], v212, s[8:11], s30 offen offset:1024 sc1
  s_add_u32 s30, s30, 0x800
  v_mfma_f32_16x16x32_bf16 v[112:115], a[96:99], a[200:203], v[112:115]
  ds_read_b64_tr_b16 a[130:131], v215 offset:14016
  v_mfma_f32_16x16x32_bf16 v[116:119], a[96:99], a[204:207], v[116:119]
  v_mfma_f32_16x16x32_bf16 v[120:123], a[100:103], a[192:195], v[120:123]
  ds_read_b64_tr_b16 a[132:133], v215 offset:27840
  v_mfma_f32_16x16x32_bf16 v[124:127], a[100:103], a[196:199], v[124:127]
  v_mfma_f32_16x16x32_bf16 v[128:131], a[100:103], a[200:203], v[128:131]
  ds_read_b64_tr_b16 a[134:135], v215 offset:32448
  v_mfma_f32_16x16x32_bf16 v[132:135], a[100:103], a[204:207], v[132:135]
  s_waitcnt lgkmcnt(12)
  v_mfma_f32_16x16x32_bf16 v[136:139], a[104:107], a[192:195], v[136:139]
  ds_read_b64_tr_b16 a[136:137], v215 offset:9440
  v_mfma_f32_16x16x32_bf16 v[140:143], a[104:107], a[196:199], v[140:143]
  v_mfma_f32_16x16x32_bf16 v[144:147], a[104:107], a[200:203], v[144:147]
  ds_read_b64_tr_b16 a[138:139], v215 offset:14048
  v_mfma_f32_16x16x32_bf16 v[148:151], a[104:107], a[204:207], v[148:151]
  v_mfma_f32_16x16x32_bf16 v[152:155], a[108:111], a[192:195], v[152:155]
  ds_read_b64_tr_b16 a[140:141], v215 offset:27872
  v_mfma_f32_16x16x32_bf16 v[156:159], a[108:111], a[196:199], v[156:159]
  s_waitcnt vmcnt(25)
  s_barrier
  v_mfma_f32_16x16x32_bf16 v[160:163], a[108:111], a[200:203], v[160:163]
  ds_read_b64_tr_b16 a[142:143], v215 offset:32480
  v_mfma_f32_16x16x32_bf16 v[164:167], a[108:111], a[204:207], v[164:167]
  s_waitcnt lgkmcnt(12)
  v_mfma_f32_16x16x32_bf16 v[168:171], a[112:115], a[192:195], v[168:171]
  ds_read_b64_tr_b16 a[96:97], v218
  v_mfma_f32_16x16x32_bf16 v[172:175], a[112:115], a[196:199], v[172:175]
  v_mfma_f32_16x16x32_bf16 v[176:179], a[112:115], a[200:203], v[176:179]
  ds_read_b64_tr_b16 a[98:99], v218 offset:4608
  v_mfma_f32_16x16x32_bf16 v[180:183], a[112:115], a[204:207], v[180:183]
  v_mfma_f32_16x16x32_bf16 v[184:187], a[116:119], a[192:195], v[184:187]
  ds_read_b64_tr_b16 a[100:101], v218 offset:18432
  v_mfma_f32_16x16x32_bf16 v[188:191], a[116:119], a[196:199], v[188:191]
  v_mfma_f32_16x16x32_bf16 v[192:195], a[116:119], a[200:203], v[192:195]
  ds_read_b64_tr_b16 a[102:103], v218 offset:23040
  v_mfma_f32_16x16x32_bf16 v[196:199], a[116:119], a[204:207], v[196:199]
  s_waitcnt lgkmcnt(12)
  v_mfma_f32_16x16x32_bf16 a[0:3], a[120:123], a[192:195], a[0:3]
  ds_read_b64_tr_b16 a[104:105], v217
  v_mfma_f32_16x16x32_bf16 a[4:7], a[120:123], a[196:199], a[4:7]
  v_mfma_f32_16x16x32_bf16 a[8:11], a[120:123], a[200:203], a[8:11]
  ds_read_b64_tr_b16 a[106:107], v217 offset:4608
  v_mfma_f32_16x16x32_bf16 a[12:15], a[120:123], a[204:207], a[12:15]
  v_mfma_f32_16x16x32_bf16 a[16:19], a[124:127], a[192:195], a[16:19]
  ds_read_b64_tr_b16 a[108:109], v217 offset:18432
  v_mfma_f32_16x16x32_bf16 a[20:23], a[124:127], a[196:199], a[20:23]
  v_mfma_f32_16x16x32_bf16 a[24:27], a[124:127], a[200:203], a[24:27]
  ds_read_b64_tr_b16 a[110:111], v217 offset:23040
  v_mfma_f32_16x16x32_bf16 a[28:31], a[124:127], a[204:207], a[28:31]
  s_waitcnt lgkmcnt(12)
  v_mfma_f32_16x16x32_bf16 a[32:35], a[128:131], a[192:195], a[32:35]
  ds_read_b64_tr_b16 a[112:113], v217 offset:32
  v_mfma_f32_16x16x32_bf16 a[36:39], a[128:131], a[196:199], a[36:39]
  v_mfma_f32_16x16x32_bf16 a[40:43], a[128:131], a[200:203], a[40:43]
  ds_read_b64_tr_b16 a[114:115], v217 offset:4640
  v_mfma_f32_16x16x32_bf16 a[44:47], a[128:131], a[204:207], a[44:47]
  v_mfma_f32_16x16x32_bf16 a[48:51], a[132:135], a[192:195], a[48:51]
  ds_read_b64_tr_b16 a[116:117], v217 offset:18464
  v_mfma_f32_16x16x32_bf16 a[52:55], a[132:135], a[196:199], a[52:55]
  v_mfma_f32_16x16x32_bf16 a[56:59], a[132:135], a[200:203], a[56:59]
  ds_read_b64_tr_b16 a[118:119], v217 offset:23072
  v_mfma_f32_16x16x32_bf16 a[60:63], a[132:135], a[204:207], a[60:63]
  s_waitcnt lgkmcnt(12)
  v_mfma_f32_16x16x32_bf16 a[64:67], a[136:139], a[192:195], a[64:67]
  ds_read_b64_tr_b16 a[120:121], v217 offset:64
  v_mfma_f32_16x16x32_bf16 a[68:71], a[136:139], a[196:199], a[68:71]
  v_mfma_f32_16x16x32_bf16 a[72:75], a[136:139], a[200:203], a[72:75]
  ds_read_b64_tr_b16 a[122:123], v217 offset:4672
  v_mfma_f32_16x16x32_bf16 a[76:79], a[136:139], a[204:207], a[76:79]
  v_mfma_f32_16x16x32_bf16 a[80:83], a[140:143], a[192:195], a[80:83]
  ds_read_b64_tr_b16 a[124:125], v217 offset:18496
  v_mfma_f32_16x16x32_bf16 a[84:87], a[140:143], a[196:199], a[84:87]
  v_mfma_f32_16x16x32_bf16 a[88:91], a[140:143], a[200:203], a[88:91]
  ds_read_b64_tr_b16 a[126:127], v217 offset:23104
  v_mfma_f32_16x16x32_bf16 a[92:95], a[140:143], a[204:207], a[92:95]
  s_waitcnt vmcnt(21) lgkmcnt(12)
  v_mfma_f32_16x16x32_bf16 v[8:11], a[96:99], a[208:211], v[8:11]
  ds_read_b64_tr_b16 a[128:129], v217 offset:96
  s_add_u32 m0, s28, 0
  v_mfma_f32_16x16x32_bf16 v[12:15], a[96:99], a[212:215], v[12:15]
  buffer_load_dwordx4 v224, s[12:15], s29 offen lds
  v_mfma_f32_16x16x32_bf16 v[16:19], a[96:99], a[216:219], v[16:19]
  ds_read_b64_tr_b16 a[130:131], v217 offset:4704
  v_mfma_f32_16x16x32_bf16 v[20:23], a[96:99], a[220:223], v[20:23]
  v_mfma_f32_16x16x32_bf16 v[24:27], a[100:103], a[208:211], v[24:27]
  ds_read_b64_tr_b16 a[132:133], v217 offset:18528
  v_mfma_f32_16x16x32_bf16 v[28:31], a[100:103], a[212:215], v[28:31]
  v_mfma_f32_16x16x32_bf16 v[32:35], a[100:103], a[216:219], v[32:35]
  ds_read_b64_tr_b16 a[134:135], v217 offset:23136
  v_mfma_f32_16x16x32_bf16 v[36:39], a[100:103], a[220:223], v[36:39]
  buffer_load_dwordx4 v225, s[12:15], s29 offen offset:1024 lds
  s_waitcnt lgkmcnt(12)
  v_mfma_f32_16x16x32_bf16 v[40:43], a[104:107], a[208:211], v[40:43]
  ds_read_b64_tr_b16 a[136:137], v217 offset:128
  v_mfma_f32_16x16x32_bf16 v[44:47], a[104:107], a[212:215], v[44:47]
  v_mfma_f32_16x16x32_bf16 v[48:51], a[104:107], a[216:219], v[48:51]
  ds_read_b64_tr_b16 a[138:139], v217 offset:4736
  v_mfma_f32_16x16x32_bf16 v[52:55], a[104:107], a[220:223], v[52:55]
  v_mfma_f32_16x16x32_bf16 v[56:59], a[108:111], a[208:211], v[56:59]
  ds_read_b64_tr_b16 a[140:141], v217 offset:18560
  v_mfma_f32_16x16x32_bf16 v[60:63], a[108:111], a[212:215], v[60:63]
  buffer_load_dwordx4 v226, s[12:15], s29 offen offset:2048 lds
  v_mfma_f32_16x16x32_bf16 v[64:67], a[108:111], a[216:219], v[64:67]
  ds_read_b64_tr_b16 a[142:143], v217 offset:23168
  v_mfma_f32_16x16x32_bf16 v[68:71], a[108:111], a[220:223], v[68:71]
  s_waitcnt lgkmcnt(12)
  v_mfma_f32_16x16x32_bf16 v[72:75], a[112:115], a[208:211], v[72:75]
  ds_read_b64_tr_b16 a[96:97], v217 offset:160
  v_mfma_f32_16x16x32_bf16 v[76:79], a[112:115], a[212:215], v[76:79]
  v_mfma_f32_16x16x32_bf16 v[80:83], a[112:115], a[216:219], v[80:83]
  ds_read_b64_tr_b16 a[98:99], v217 offset:4768
  v_mfma_f32_16x16x32_bf16 v[84:87], a[112:115], a[220:223], v[84:87]
  buffer_load_dwordx4 v227, s[12:15], s29 offen offset:3072 lds
  s_add_u32 m0, s28, 0x1000
  v_mfma_f32_16x16x32_bf16 v[88:91], a[116:119], a[208:211], v[88:91]
  ds_read_b64_tr_b16 a[100:101], v217 offset:18592
  v_mfma_f32_16x16x32_bf16 v[92:95], a[116:119], a[212:215], v[92:95]
  v_mfma_f32_16x16x32_bf16 v[96:99], a[116:119], a[216:219], v[96:99]
  ds_read_b64_tr_b16 a[102:103], v217 offset:23200
  v_mfma_f32_16x16x32_bf16 v[100:103], a[116:119], a[220:223], v[100:103]
  s_waitcnt lgkmcnt(12)
  v_mfma_f32_16x16x32_bf16 v[104:107], a[120:123], a[208:211], v[104:107]
  ds_read_b64_tr_b16 a[104:105], v217 offset:192
  v_mfma_f32_16x16x32_bf16 v[108:111], a[120:123], a[212:215], v[108:111]
  buffer_load_dwordx4 v228, s[12:15], s29 offen lds
  v_mfma_f32_16x16x32_bf16 v[112:115], a[120:123], a[216:219], v[112:115]
  ds_read_b64_tr_b16 a[106:107], v217 offset:4800
  v_mfma_f32_16x16x32_bf16 v[116:119], a[120:123], a[220:223], v[116:119]
  v_mfma_f32_16x16x32_bf16 v[120:123], a[124:127], a[208:211], v[120:123]
  ds_read_b64_tr_b16 a[108:109], v217 offset:18624
  v_mfma_f32_16x16x32_bf16 v[124:127], a[124:127], a[212:215], v[124:127]
  v_mfma_f32_16x16x32_bf16 v[128:131], a[124:127], a[216:219], v[128:131]
  ds_read_b64_tr_b16 a[110:111], v217 offset:23232
  v_mfma_f32_16x16x32_bf16 v[132:135], a[124:127], a[220:223], v[132:135]
  buffer_load_dwordx4 v229, s[12:15], s29 offen offset:1024 lds
  s_waitcnt lgkmcnt(12)
  v_mfma_f32_16x16x32_bf16 v[136:139], a[128:131], a[208:211], v[136:139]
  ds_read_b64_tr_b16 a[112:113], v217 offset:224
  v_mfma_f32_16x16x32_bf16 v[140:143], a[128:131], a[212:215], v[140:143]
  v_mfma_f32_16x16x32_bf16 v[144:147], a[128:131], a[216:219], v[144:147]
  ds_read_b64_tr_b16 a[114:115], v217 offset:4832
  v_mfma_f32_16x16x32_bf16 v[148:151], a[128:131], a[220:223], v[148:151]
  v_mfma_f32_16x16x32_bf16 v[152:155], a[132:135], a[208:211], v[152:155]
  ds_read_b64_tr_b16 a[116:117], v217 offset:18656
  v_mfma_f32_16x16x32_bf16 v[156:159], a[132:135], a[212:215], v[156:159]
  buffer_load_dwordx4 v230, s[12:15], s29 offen offset:2048 lds
  v_mfma_f32_16x16x32_bf16 v[160:163], a[132:135], a[216:219], v[160:163]
  ds_read_b64_tr_b16 a[118:119], v217 offset:23264
  v_mfma_f32_16x16x32_bf16 v[164:167], a[132:135], a[220:223], v[164:167]
  s_waitcnt lgkmcnt(12)
  v_mfma_f32_16x16x32_bf16 v[168:171], a[136:139], a[208:211], v[168:171]
  ds_read_b64_tr_b16 a[120:121], v218 offset:9216
  v_mfma_f32_16x16x32_bf16 v[172:175], a[136:139], a[212:215], v[172:175]
  v_mfma_f32_16x16x32_bf16 v[176:179], a[136:139], a[216:219], v[176:179]
  ds_read_b64_tr_b16 a[122:123], v218 offset:13824
  v_mfma_f32_16x16x32_bf16 v[180:183], a[136:139], a[220:223], v[180:183]
  buffer_load_dwordx4 v231, s[12:15], s29 offen offset:3072 lds
  s_add_u32 m0, s28, 0x2000
  v_mfma_f32_16x16x32_bf16 v[184:187], a[140:143], a[208:211], v[184:187]
  ds_read_b64_tr_b16 a[124:125], v218 offset:27648
  v_mfma_f32_16x16x32_bf16 v[188:191], a[140:143], a[212:215], v[188:191]
  v_mfma_f32_16x16x32_bf16 v[192:195], a[140:143], a[216:219], v[192:195]
  ds_read_b64_tr_b16 a[126:127], v218 offset:32256
  v_mfma_f32_16x16x32_bf16 v[196:199], a[140:143], a[220:223], v[196:199]
  s_waitcnt lgkmcnt(12)
  v_mfma_f32_16x16x32_bf16 a[0:3], a[96:99], a[208:211], a[0:3]
  ds_read_b64_tr_b16 a[128:129], v217 offset:9216
  v_mfma_f32_16x16x32_bf16 a[4:7], a[96:99], a[212:215], a[4:7]
  buffer_load_dwordx4 v232, s[12:15], s29 offen lds
  s_add_u32 s29, s29, 0x90000
  v_mfma_f32_16x16x32_bf16 a[8:11], a[96:99], a[216:219], a[8:11]
  ds_read_b64_tr_b16 a[130:131], v217 offset:13824
  v_mfma_f32_16x16x32_bf16 a[12:15], a[96:99], a[220:223], a[12:15]
  v_mfma_f32_16x16x32_bf16 a[16:19], a[100:103], a[208:211], a[16:19]
  ds_read_b64_tr_b16 a[132:133], v217 offset:27648
  v_mfma_f32_16x16x32_bf16 a[20:23], a[100:103], a[212:215], a[20:23]
  v_mfma_f32_16x16x32_bf16 a[24:27], a[100:103], a[216:219], a[24:27]
  ds_read_b64_tr_b16 a[134:135], v217 offset:32256
  v_mfma_f32_16x16x32_bf16 a[28:31], a[100:103], a[220:223], a[28:31]
  buffer_load_dwordx4 a[176:179], v209, s[8:11], s30 offen sc1
  s_waitcnt lgkmcnt(12)
  v_mfma_f32_16x16x32_bf16 a[32:35], a[104:107], a[208:211], a[32:35]
  ds_read_b64_tr_b16 a[136:137], v217 offset:9248
  v_mfma_f32_16x16x32_bf16 a[36:39], a[104:107], a[212:215], a[36:39]
  v_mfma_f32_16x16x32_bf16 a[40:43], a[104:107], a[216:219], a[40:43]
  ds_read_b64_tr_b16 a[138:139], v217 offset:13856
  v_mfma_f32_16x16x32_bf16 a[44:47], a[104:107], a[220:223], a[44:47]
  v_mfma_f32_16x16x32_bf16 a[48:51], a[108:111], a[208:211], a[48:51]
  ds_read_b64_tr_b16 a[140:141], v217 offset:27680
  v_mfma_f32_16x16x32_bf16 a[52:55], a[108:111], a[212:215], a[52:55]
  buffer_load_dwordx4 a[180:183], v210, s[8:11], s30 offen sc1
  v_mfma_f32_16x16x32_bf16 a[56:59], a[108:111], a[216:219], a[56:59]
  ds_read_b64_tr_b16 a[142:143], v217 offset:32288
  v_mfma_f32_16x16x32_bf16 a[60:63], a[108:111], a[220:223], a[60:63]
  s_waitcnt lgkmcnt(12)
  v_mfma_f32_16x16x32_bf16 a[64:67], a[112:115], a[208:211], a[64:67]
  ds_read_b64_tr_b16 a[96:97], v217 offset:9280
  v_mfma_f32_16x16x32_bf16 a[68:71], a[112:115], a[212:215], a[68:71]
  v_mfma_f32_16x16x32_bf16 a[72:75], a[112:115], a[216:219], a[72:75]
  ds_read_b64_tr_b16 a[98:99], v217 offset:13888
  v_mfma_f32_16x16x32_bf16 a[76:79], a[112:115], a[220:223], a[76:79]
  buffer_load_dwordx4 a[184:187], v211, s[8:11], s30 offen sc1
  v_mfma_f32_16x16x32_bf16 a[80:83], a[116:119], a[208:211], a[80:83]
  ds_read_b64_tr_b16 a[100:101], v217 offset:27712
  v_mfma_f32_16x16x32_bf16 a[84:87], a[116:119], a[212:215], a[84:87]
  v_mfma_f32_16x16x32_bf16 a[88:91], a[116:119], a[216:219], a[88:91]
  ds_read_b64_tr_b16 a[102:103], v217 offset:32320
  v_mfma_f32_16x16x32_bf16 a[92:95], a[116:119], a[220:223], a[92:95]
  s_waitcnt vmcnt(29) lgkmcnt(12)
  v_mfma_f32_16x16x32_bf16 v[8:11], a[120:123], a[224:227], v[8:11]
  ds_read_b64_tr_b16 a[104:105], v217 offset:9312
  v_mfma_f32_16x16x32_bf16 v[12:15], a[120:123], a[228:231], v[12:15]
  buffer_load_dwordx4 a[188:191], v212, s[8:11], s30 offen sc1
  v_mfma_f32_16x16x32_bf16 v[16:19], a[120:123], a[232:235], v[16:19]
  ds_read_b64_tr_b16 a[106:107], v217 offset:13920
  v_mfma_f32_16x16x32_bf16 v[20:23], a[120:123], a[236:239], v[20:23]
  v_mfma_f32_16x16x32_bf16 v[24:27], a[124:127], a[224:227], v[24:27]
  ds_read_b64_tr_b16 a[108:109], v217 offset:27744
  v_mfma_f32_16x16x32_bf16 v[28:31], a[124:127], a[228:231], v[28:31]
  v_mfma_f32_16x16x32_bf16 v[32:35], a[124:127], a[232:235], v[32:35]
  ds_read_b64_tr_b16 a[110:111], v217 offset:32352
  v_mfma_f32_16x16x32_bf16 v[36:39], a[124:127], a[236:239], v[36:39]
  buffer_load_dwordx4 a[192:195], v209, s[8:11], s30 offen offset:1024 sc1
  s_waitcnt lgkmcnt(12)
  v_mfma_f32_16x16x32_bf16 v[40:43], a[128:131], a[224:227], v[40:43]
  ds_read_b64_tr_b16 a[112:113], v217 offset:9344
  v_mfma_f32_16x16x32_bf16 v[44:47], a[128:131], a[228:231], v[44:47]
  v_mfma_f32_16x16x32_bf16 v[48:51], a[128:131], a[232:235], v[48:51]
  ds_read_b64_tr_b16 a[114:115], v217 offset:13952
  v_mfma_f32_16x16x32_bf16 v[52:55], a[128:131], a[236:239], v[52:55]
  v_mfma_f32_16x16x32_bf16 v[56:59], a[132:135], a[224:227], v[56:59]
  ds_read_b64_tr_b16 a[116:117], v217 offset:27776
  v_mfma_f32_16x16x32_bf16 v[60:63], a[132:135], a[228:231], v[60:63]
  buffer_load_dwordx4 a[196:199], v210, s[8:11], s30 offen offset:1024 sc1
  v_mfma_f32_16x16x32_bf16 v[64:67], a[132:135], a[232:235], v[64:67]
  ds_read_b64_tr_b16 a[118:119], v217 offset:32384
  v_mfma_f32_16x16x32_bf16 v[68:71], a[132:135], a[236:239], v[68:71]
  s_waitcnt lgkmcnt(12)
  v_mfma_f32_16x16x32_bf16 v[72:75], a[136:139], a[224:227], v[72:75]
  ds_read_b64_tr_b16 a[120:121], v217 offset:9376
  v_mfma_f32_16x16x32_bf16 v[76:79], a[136:139], a[228:231], v[76:79]
  v_mfma_f32_16x16x32_bf16 v[80:83], a[136:139], a[232:235], v[80:83]
  ds_read_b64_tr_b16 a[122:123], v217 offset:13984
  v_mfma_f32_16x16x32_bf16 v[84:87], a[136:139], a[236:239], v[84:87]
  buffer_load_dwordx4 a[200:203], v211, s[8:11], s30 offen offset:1024 sc1
  v_mfma_f32_16x16x32_bf16 v[88:91], a[140:143], a[224:227], v[88:91]
  ds_read_b64_tr_b16 a[124:125], v217 offset:27808
  v_mfma_f32_16x16x32_bf16 v[92:95], a[140:143], a[228:231], v[92:95]
  v_mfma_f32_16x16x32_bf16 v[96:99], a[140:143], a[232:235], v[96:99]
  ds_read_b64_tr_b16 a[126:127], v217 offset:32416
  v_mfma_f32_16x16x32_bf16 v[100:103], a[140:143], a[236:239], v[100:103]
  s_waitcnt lgkmcnt(12)
  v_mfma_f32_16x16x32_bf16 v[104:107], a[96:99], a[224:227], v[104:107]
  ds_read_b64_tr_b16 a[128:129], v217 offset:9408
  v_mfma_f32_16x16x32_bf16 v[108:111], a[96:99], a[228:231], v[108:111]
  buffer_load_dwordx4 a[204:207], v212, s[8:11], s30 offen offset:1024 sc1
  s_add_u32 s30, s30, 0x800
  v_mfma_f32_16x16x32_bf16 v[112:115], a[96:99], a[232:235], v[112:115]
  ds_read_b64_tr_b16 a[130:131], v217 offset:14016
  v_mfma_f32_16x16x32_bf16 v[116:119], a[96:99], a[236:239], v[116:119]
  v_mfma_f32_16x16x32_bf16 v[120:123], a[100:103], a[224:227], v[120:123]
  ds_read_b64_tr_b16 a[132:133], v217 offset:27840
  v_mfma_f32_16x16x32_bf16 v[124:127], a[100:103], a[228:231], v[124:127]
  v_mfma_f32_16x16x32_bf16 v[128:131], a[100:103], a[232:235], v[128:131]
  ds_read_b64_tr_b16 a[134:135], v217 offset:32448
  v_mfma_f32_16x16x32_bf16 v[132:135], a[100:103], a[236:239], v[132:135]
  s_waitcnt lgkmcnt(12)
  v_mfma_f32_16x16x32_bf16 v[136:139], a[104:107], a[224:227], v[136:139]
  ds_read_b64_tr_b16 a[136:137], v217 offset:9440
  v_mfma_f32_16x16x32_bf16 v[140:143], a[104:107], a[228:231], v[140:143]
  v_mfma_f32_16x16x32_bf16 v[144:147], a[104:107], a[232:235], v[144:147]
  ds_read_b64_tr_b16 a[138:139], v217 offset:14048
  v_mfma_f32_16x16x32_bf16 v[148:151], a[104:107], a[236:239], v[148:151]
  v_mfma_f32_16x16x32_bf16 v[152:155], a[108:111], a[224:227], v[152:155]
  ds_read_b64_tr_b16 a[140:141], v217 offset:27872
  v_mfma_f32_16x16x32_bf16 v[156:159], a[108:111], a[228:231], v[156:159]
  s_waitcnt vmcnt(25)
  s_barrier
  v_mfma_f32_16x16x32_bf16 v[160:163], a[108:111], a[232:235], v[160:163]
  ds_read_b64_tr_b16 a[142:143], v217 offset:32480
  v_mfma_f32_16x16x32_bf16 v[164:167], a[108:111], a[236:239], v[164:167]
  s_waitcnt lgkmcnt(12)
  v_mfma_f32_16x16x32_bf16 v[168:171], a[112:115], a[224:227], v[168:171]
  ds_read_b64_tr_b16 a[96:97], v220
  v_mfma_f32_16x16x32_bf16 v[172:175], a[112:115], a[228:231], v[172:175]
  v_mfma_f32_16x16x32_bf16 v[176:179], a[112:115], a[232:235], v[176:179]
  ds_read_b64_tr_b16 a[98:99], v220 offset:4608
  v_mfma_f32_16x16x32_bf16 v[180:183], a[112:115], a[236:239], v[180:183]
  v_mfma_f32_16x16x32_bf16 v[184:187], a[116:119], a[224:227], v[184:187]
  ds_read_b64_tr_b16 a[100:101], v220 offset:18432
  v_mfma_f32_16x16x32_bf16 v[188:191], a[116:119], a[228:231], v[188:191]
  v_mfma_f32_16x16x32_bf16 v[192:195], a[116:119], a[232:235], v[192:195]
  ds_read_b64_tr_b16 a[102:103], v220 offset:23040
  v_mfma_f32_16x16x32_bf16 v[196:199], a[116:119], a[236:239], v[196:199]
  s_waitcnt lgkmcnt(12)
  v_mfma_f32_16x16x32_bf16 a[0:3], a[120:123], a[224:227], a[0:3]
  ds_read_b64_tr_b16 a[104:105], v219
  v_mfma_f32_16x16x32_bf16 a[4:7], a[120:123], a[228:231], a[4:7]
  v_mfma_f32_16x16x32_bf16 a[8:11], a[120:123], a[232:235], a[8:11]
  ds_read_b64_tr_b16 a[106:107], v219 offset:4608
  v_mfma_f32_16x16x32_bf16 a[12:15], a[120:123], a[236:239], a[12:15]
  v_mfma_f32_16x16x32_bf16 a[16:19], a[124:127], a[224:227], a[16:19]
  ds_read_b64_tr_b16 a[108:109], v219 offset:18432
  v_mfma_f32_16x16x32_bf16 a[20:23], a[124:127], a[228:231], a[20:23]
  v_mfma_f32_16x16x32_bf16 a[24:27], a[124:127], a[232:235], a[24:27]
  ds_read_b64_tr_b16 a[110:111], v219 offset:23040
  v_mfma_f32_16x16x32_bf16 a[28:31], a[124:127], a[236:239], a[28:31]
  s_waitcnt lgkmcnt(12)
  v_mfma_f32_16x16x32_bf16 a[32:35], a[128:131], a[224:227], a[32:35]
  ds_read_b64_tr_b16 a[112:113], v219 offset:32
  v_mfma_f32_16x16x32_bf16 a[36:39], a[128:131], a[228:231], a[36:39]
  v_mfma_f32_16x16x32_bf16 a[40:43], a[128:131], a[232:235], a[40:43]
  ds_read_b64_tr_b16 a[114:115], v219 offset:4640
  v_mfma_f32_16x16x32_bf16 a[44:47], a[128:131], a[236:239], a[44:47]
  v_mfma_f32_16x16x32_bf16 a[48:51], a[132:135], a[224:227], a[48:51]
  ds_read_b64_tr_b16 a[116:117], v219 offset:18464
  v_mfma_f32_16x16x32_bf16 a[52:55], a[132:135], a[228:231], a[52:55]
  v_mfma_f32_16x16x32_bf16 a[56:59], a[132:135], a[232:235], a[56:59]
  ds_read_b64_tr_b16 a[118:119], v219 offset:23072
  v_mfma_f32_16x16x32_bf16 a[60:63], a[132:135], a[236:239], a[60:63]
  s_waitcnt lgkmcnt(12)
  v_mfma_f32_16x16x32_bf16 a[64:67], a[136:139], a[224:227], a[64:67]
  ds_read_b64_tr_b16 a[120:121], v219 offset:64
  v_mfma_f32_16x16x32_bf16 a[68:71], a[136:139], a[228:231], a[68:71]
  v_mfma_f32_16x16x32_bf16 a[72:75], a[136:139], a[232:235], a[72:75]
  ds_read_b64_tr_b16 a[122:123], v219 offset:4672
  v_mfma_f32_16x16x32_bf16 a[76:79], a[136:139], a[236:239], a[76:79]
  v_mfma_f32_16x16x32_bf16 a[80:83], a[140:143], a[224:227], a[80:83]
  ds_read_b64_tr_b16 a[124:125], v219 offset:18496
  v_mfma_f32_16x16x32_bf16 a[84:87], a[140:143], a[228:231], a[84:87]
  v_mfma_f32_16x16x32_bf16 a[88:91], a[140:143], a[232:235], a[88:91]
  ds_read_b64_tr_b16 a[126:127], v219 offset:23104
  v_mfma_f32_16x16x32_bf16 a[92:95], a[140:143], a[236:239], a[92:95]
  s_waitcnt vmcnt(21) lgkmcnt(12)
  v_mfma_f32_16x16x32_bf16 v[8:11], a[96:99], a[144:147], v[8:11]
  ds_read_b64_tr_b16 a[128:129], v219 offset:96
  s_add_u32 m0, s28, 0x9000
  v_mfma_f32_16x16x32_bf16 v[12:15], a[96:99], a[148:151], v[12:15]
  buffer_load_dwordx4 v224, s[12:15], s29 offen lds
  v_mfma_f32_16x16x32_bf16 v[16:19], a[96:99], a[152:155], v[16:19]
  ds_read_b64_tr_b16 a[130:131], v219 offset:4704
  v_mfma_f32_16x16x32_bf16 v[20:23], a[96:99], a[156:159], v[20:23]
  v_mfma_f32_16x16x32_bf16 v[24:27], a[100:103], a[144:147], v[24:27]
  ds_read_b64_tr_b16 a[132:133], v219 offset:18528
  v_mfma_f32_16x16x32_bf16 v[28:31], a[100:103], a[148:151], v[28:31]
  v_mfma_f32_16x16x32_bf16 v[32:35], a[100:103], a[152:155], v[32:35]
  ds_read_b64_tr_b16 a[134:135], v219 offset:23136
  v_mfma_f32_16x16x32_bf16 v[36:39], a[100:103], a[156:159], v[36:39]
  buffer_load_dwordx4 v225, s[12:15], s29 offen offset:1024 lds
  s_waitcnt lgkmcnt(12)
  v_mfma_f32_16x16x32_bf16 v[40:43], a[104:107], a[144:147], v[40:43]
  ds_read_b64_tr_b16 a[136:137], v219 offset:128
  v_mfma_f32_16x16x32_bf16 v[44:47], a[104:107], a[148:151], v[44:47]
  v_mfma_f32_16x16x32_bf16 v[48:51], a[104:107], a[152:155], v[48:51]
  ds_read_b64_tr_b16 a[138:139], v219 offset:4736
  v_mfma_f32_16x16x32_bf16 v[52:55], a[104:107], a[156:159], v[52:55]
  v_mfma_f32_16x16x32_bf16 v[56:59], a[108:111], a[144:147], v[56:59]
  ds_read_b64_tr_b16 a[140:141], v219 offset:18560
  v_mfma_f32_16x16x32_bf16 v[60:63], a[108:111], a[148:151], v[60:63]
  buffer_load_dwordx4 v226, s[12:15], s29 offen offset:2048 lds
  v_mfma_f32_16x16x32_bf16 v[64:67], a[108:111], a[152:155], v[64:67]
  ds_read_b64_tr_b16 a[142:143], v219 offset:23168
  v_mfma_f32_16x16x32_bf16 v[68:71], a[108:111], a[156:159], v[68:71]
  s_waitcnt lgkmcnt(12)
  v_mfma_f32_16x16x32_bf16 v[72:75], a[112:115], a[144:147], v[72:75]
  ds_read_b64_tr_b16 a[96:97], v219 offset:160
  v_mfma_f32_16x16x32_bf16 v[76:79], a[112:115], a[148:151], v[76:79]
  v_mfma_f32_16x16x32_bf16 v[80:83], a[112:115], a[152:155], v[80:83]
  ds_read_b64_tr_b16 a[98:99], v219 offset:4768
  v_mfma_f32_16x16x32_bf16 v[84:87], a[112:115], a[156:159], v[84:87]
  buffer_load_dwordx4 v227, s[12:15], s29 offen offset:3072 lds
  s_add_u32 m0, s28, 0xa000
  v_mfma_f32_16x16x32_bf16 v[88:91], a[116:119], a[144:147], v[88:91]
  ds_read_b64_tr_b16 a[100:101], v219 offset:18592
  v_mfma_f32_16x16x32_bf16 v[92:95], a[116:119], a[148:151], v[92:95]
  v_mfma_f32_16x16x32_bf16 v[96:99], a[116:119], a[152:155], v[96:99]
  ds_read_b64_tr_b16 a[102:103], v219 offset:23200
  v_mfma_f32_16x16x32_bf16 v[100:103], a[116:119], a[156:159], v[100:103]
  s_waitcnt lgkmcnt(12)
  v_mfma_f32_16x16x32_bf16 v[104:107], a[120:123], a[144:147], v[104:107]
  ds_read_b64_tr_b16 a[104:105], v219 offset:192
  v_mfma_f32_16x16x32_bf16 v[108:111], a[120:123], a[148:151], v[108:111]
  buffer_load_dwordx4 v228, s[12:15], s29 offen lds
  v_mfma_f32_16x16x32_bf16 v[112:115], a[120:123], a[152:155], v[112:115]
  ds_read_b64_tr_b16 a[106:107], v219 offset:4800
  v_mfma_f32_16x16x32_bf16 v[116:119], a[120:123], a[156:159], v[116:119]
  v_mfma_f32_16x16x32_bf16 v[120:123], a[124:127], a[144:147], v[120:123]
  ds_read_b64_tr_b16 a[108:109], v219 offset:18624
  v_mfma_f32_16x16x32_bf16 v[124:127], a[124:127], a[148:151], v[124:127]
  v_mfma_f32_16x16x32_bf16 v[128:131], a[124:127], a[152:155], v[128:131]
  ds_read_b64_tr_b16 a[110:111], v219 offset:23232
  v_mfma_f32_16x16x32_bf16 v[132:135], a[124:127], a[156:159], v[132:135]
  buffer_load_dwordx4 v229, s[12:15], s29 offen offset:1024 lds
  s_waitcnt lgkmcnt(12)
  v_mfma_f32_16x16x32_bf16 v[136:139], a[128:131], a[144:147], v[136:139]
  ds_read_b64_tr_b16 a[112:113], v219 offset:224
  v_mfma_f32_16x16x32_bf16 v[140:143], a[128:131], a[148:151], v[140:143]
  v_mfma_f32_16x16x32_bf16 v[144:147], a[128:131], a[152:155], v[144:147]
  ds_read_b64_tr_b16 a[114:115], v219 offset:4832
  v_mfma_f32_16x16x32_bf16 v[148:151], a[128:131], a[156:159], v[148:151]
  v_mfma_f32_16x16x32_bf16 v[152:155], a[132:135], a[144:147], v[152:155]
  ds_read_b64_tr_b16 a[116:117], v219 offset:18656
  v_mfma_f32_16x16x32_bf16 v[156:159], a[132:135], a[148:151], v[156:159]
  buffer_load_dwordx4 v230, s[12:15], s29 offen offset:2048 lds
  v_mfma_f32_16x16x32_bf16 v[160:163], a[132:135], a[152:155], v[160:163]
  ds_read_b64_tr_b16 a[118:119], v219 offset:23264
  v_mfma_f32_16x16x32_bf16 v[164:167], a[132:135], a[156:159], v[164:167]
  s_waitcnt lgkmcnt(12)
  v_mfma_f32_16x16x32_bf16 v[168:171], a[136:139], a[144:147], v[168:171]
  ds_read_b64_tr_b16 a[120:121], v220 offset:9216
  v_mfma_f32_16x16x32_bf16 v[172:175], a[136:139], a[148:151], v[172:175]
  v_mfma_f32_16x16x32_bf16 v[176:179], a[136:139], a[152:155], v[176:179]
  ds_read_b64_tr_b16 a[122:123], v220 offset:13824
  v_mfma_f32_16x16x32_bf16 v[180:183], a[136:139], a[156:159], v[180:183]
  buffer_load_dwordx4 v231, s[12:15], s29 offen offset:3072 lds
  s_add_u32 m0, s28, 0xb000
  v_mfma_f32_16x16x32_bf16 v[184:187], a[140:143], a[144:147], v[184:187]
  ds_read_b64_tr_b16 a[124:125], v220 offset:27648
  v_mfma_f32_16x16x32_bf16 v[188:191], a[140:143], a[148:151], v[188:191]
  v_mfma_f32_16x16x32_bf16 v[192:195], a[140:143], a[152:155], v[192:195]
  ds_read_b64_tr_b16 a[126:127], v220 offset:32256
  v_mfma_f32_16x16x32_bf16 v[196:199], a[140:143], a[156:159], v[196:199]
  s_waitcnt lgkmcnt(12)
  v_mfma_f32_16x16x32_bf16 a[0:3], a[96:99], a[144:147], a[0:3]
  ds_read_b64_tr_b16 a[128:129], v219 offset:9216
  v_mfma_f32_16x16x32_bf16 a[4:7], a[96:99], a[148:151], a[4:7]
  buffer_load_dwordx4 v232, s[12:15], s29 offen lds
  s_add_u32 s29, s29, 0x90000
  v_mfma_f32_16x16x32_bf16 a[8:11], a[96:99], a[152:155], a[8:11]
  ds_read_b64_tr_b16 a[130:131], v219 offset:13824
  v_mfma_f32_16x16x32_bf16 a[12:15], a[96:99], a[156:159], a[12:15]
  v_mfma_f32_16x16x32_bf16 a[16:19], a[100:103], a[144:147], a[16:19]
  ds_read_b64_tr_b16 a[132:133], v219 offset:27648
  v_mfma_f32_16x16x32_bf16 a[20:23], a[100:103], a[148:151], a[20:23]
  v_mfma_f32_16x16x32_bf16 a[24:27], a[100:103], a[152:155], a[24:27]
  ds_read_b64_tr_b16 a[134:135], v219 offset:32256
  v_mfma_f32_16x16x32_bf16 a[28:31], a[100:103], a[156:159], a[28:31]
  buffer_load_dwordx4 a[208:211], v209, s[8:11], s30 offen sc1
  s_waitcnt lgkmcnt(12)
  v_mfma_f32_16x16x32_bf16 a[32:35], a[104:107], a[144:147], a[32:35]
  ds_read_b64_tr_b16 a[136:137], v219 offset:9248
  v_mfma_f32_16x16x32_bf16 a[36:39], a[104:107], a[148:151], a[36:39]
  v_mfma_f32_16x16x32_bf16 a[40:43], a[104:107], a[152:155], a[40:43]
  ds_read_b64_tr_b16 a[138:139], v219 offset:13856
  v_mfma_f32_16x16x32_bf16 a[44:47], a[104:107], a[156:159], a[44:47]
  v_mfma_f32_16x16x32_bf16 a[48:51], a[108:111], a[144:147], a[48:51]
  ds_read_b64_tr_b16 a[140:141], v219 offset:27680
  v_mfma_f32_16x16x32_bf16 a[52:55], a[108:111], a[148:151], a[52:55]
  buffer_load_dwordx4 a[212:215], v210, s[8:11], s30 offen sc1
  v_mfma_f32_16x16x32_bf16 a[56:59], a[108:111], a[152:155], a[56:59]
  ds_read_b64_tr_b16 a[142:143], v219 offset:32288
  v_mfma_f32_16x16x32_bf16 a[60:63], a[108:111], a[156:159], a[60:63]
  s_waitcnt lgkmcnt(12)
  v_mfma_f32_16x16x32_bf16 a[64:67], a[112:115], a[144:147], a[64:67]
  ds_read_b64_tr_b16 a[96:97], v219 offset:9280
  v_mfma_f32_16x16x32_bf16 a[68:71], a[112:115], a[148:151], a[68:71]
  v_mfma_f32_16x16x32_bf16 a[72:75], a[112:115], a[152:155], a[72:75]
  ds_read_b64_tr_b16 a[98:99], v219 offset:13888
  v_mfma_f32_16x16x32_bf16 a[76:79], a[112:115], a[156:159], a[76:79]
  buffer_load_dwordx4 a[216:219], v211, s[8:11], s30 offen sc1
  v_mfma_f32_16x16x32_bf16 a[80:83], a[116:119], a[144:147], a[80:83]
  ds_read_b64_tr_b16 a[100:101], v219 offset:27712
  v_mfma_f32_16x16x32_bf16 a[84:87], a[116:119], a[148:151], a[84:87]
  v_mfma_f32_16x16x32_bf16 a[88:91], a[116:119], a[152:155], a[88:91]
  ds_read_b64_tr_b16 a[102:103], v219 offset:32320
  v_mfma_f32_16x16x32_bf16 a[92:95], a[116:119], a[156:159], a[92:95]
  s_waitcnt vmcnt(29) lgkmcnt(12)
  v_mfma_f32_16x16x32_bf16 v[8:11], a[120:123], a[160:163], v[8:11]
  ds_read_b64_tr_b16 a[104:105], v219 offset:9312
  v_mfma_f32_16x16x32_bf16 v[12:15], a[120:123], a[164:167], v[12:15]
  buffer_load_dwordx4 a[220:223], v212, s[8:11], s30 offen sc1
  v_mfma_f32_16x16x32_bf16 v[16:19], a[120:123], a[168:171], v[16:19]
  ds_read_b64_tr_b16 a[106:107], v219 offset:13920
  v_mfma_f32_16x16x32_bf16 v[20:23], a[120:123], a[172:175], v[20:23]
  v_mfma_f32_16x16x32_bf16 v[24:27], a[124:127], a[160:163], v[24:27]
  ds_read_b64_tr_b16 a[108:109], v219 offset:27744
  v_mfma_f32_16x16x32_bf16 v[28:31], a[124:127], a[164:167], v[28:31]
  v_mfma_f32_16x16x32_bf16 v[32:35], a[124:127], a[168:171], v[32:35]
  ds_read_b64_tr_b16 a[110:111], v219 offset:32352
  v_mfma_f32_16x16x32_bf16 v[36:39], a[124:127], a[172:175], v[36:39]
  buffer_load_dwordx4 a[224:227], v209, s[8:11], s30 offen offset:1024 sc1
  s_waitcnt lgkmcnt(12)
  v_mfma_f32_16x16x32_bf16 v[40:43], a[128:131], a[160:163], v[40:43]
  ds_read_b64_tr_b16 a[112:113], v219 offset:9344
  v_mfma_f32_16x16x32_bf16 v[44:47], a[128:131], a[164:167], v[44:47]
  v_mfma_f32_16x16x32_bf16 v[48:51], a[128:131], a[168:171], v[48:51]
  ds_read_b64_tr_b16 a[114:115], v219 offset:13952
  v_mfma_f32_16x16x32_bf16 v[52:55], a[128:131], a[172:175], v[52:55]
  v_mfma_f32_16x16x32_bf16 v[56:59], a[132:135], a[160:163], v[56:59]
  ds_read_b64_tr_b16 a[116:117], v219 offset:27776
  v_mfma_f32_16x16x32_bf16 v[60:63], a[132:135], a[164:167], v[60:63]
  buffer_load_dwordx4 a[228:231], v210, s[8:11], s30 offen offset:1024 sc1
  v_mfma_f32_16x16x32_bf16 v[64:67], a[132:135], a[168:171], v[64:67]
  ds_read_b64_tr_b16 a[118:119], v219 offset:32384
  v_mfma_f32_16x16x32_bf16 v[68:71], a[132:135], a[172:175], v[68:71]
  s_waitcnt lgkmcnt(12)
  v_mfma_f32_16x16x32_bf16 v[72:75], a[136:139], a[160:163], v[72:75]
  ds_read_b64_tr_b16 a[120:121], v219 offset:9376
  v_mfma_f32_16x16x32_bf16 v[76:79], a[136:139], a[164:167], v[76:79]
  v_mfma_f32_16x16x32_bf16 v[80:83], a[136:139], a[168:171], v[80:83]
  ds_read_b64_tr_b16 a[122:123], v219 offset:13984
  v_mfma_f32_16x16x32_bf16 v[84:87], a[136:139], a[172:175], v[84:87]
  buffer_load_dwordx4 a[232:235], v211, s[8:11], s30 offen offset:1024 sc1
  v_mfma_f32_16x16x32_bf16 v[88:91], a[140:143], a[160:163], v[88:91]
  ds_read_b64_tr_b16 a[124:125], v219 offset:27808
  v_mfma_f32_16x16x32_bf16 v[92:95], a[140:143], a[164:167], v[92:95]
  v_mfma_f32_16x16x32_bf16 v[96:99], a[140:143], a[168:171], v[96:99]
  ds_read_b64_tr_b16 a[126:127], v219 offset:32416
  v_mfma_f32_16x16x32_bf16 v[100:103], a[140:143], a[172:175], v[100:103]
  s_waitcnt lgkmcnt(12)
  v_mfma_f32_16x16x32_bf16 v[104:107], a[96:99], a[160:163], v[104:107]
  ds_read_b64_tr_b16 a[128:129], v219 offset:9408
  v_mfma_f32_16x16x32_bf16 v[108:111], a[96:99], a[164:167], v[108:111]
  buffer_load_dwordx4 a[236:239], v212, s[8:11], s30 offen offset:1024 sc1
  s_add_u32 s30, s30, 0x800
  v_mfma_f32_16x16x32_bf16 v[112:115], a[96:99], a[168:171], v[112:115]
  ds_read_b64_tr_b16 a[130:131], v219 offset:14016
  v_mfma_f32_16x16x32_bf16 v[116:119], a[96:99], a[172:175], v[116:119]
  v_mfma_f32_16x16x32_bf16 v[120:123], a[100:103], a[160:163], v[120:123]
  ds_read_b64_tr_b16 a[132:133], v219 offset:27840
  v_mfma_f32_16x16x32_bf16 v[124:127], a[100:103], a[164:167], v[124:127]
  v_mfma_f32_16x16x32_bf16 v[128:131], a[100:103], a[168:171], v[128:131]
  ds_read_b64_tr_b16 a[134:135], v219 offset:32448
  v_mfma_f32_16x16x32_bf16 v[132:135], a[100:103], a[172:175], v[132:135]
  s_waitcnt lgkmcnt(12)
  v_mfma_f32_16x16x32_bf16 v[136:139], a[104:107], a[160:163], v[136:139]
  ds_read_b64_tr_b16 a[136:137], v219 offset:9440
  v_mfma_f32_16x16x32_bf16 v[140:143], a[104:107], a[164:167], v[140:143]
  v_mfma_f32_16x16x32_bf16 v[144:147], a[104:107], a[168:171], v[144:147]
  ds_read_b64_tr_b16 a[138:139], v219 offset:14048
  v_mfma_f32_16x16x32_bf16 v[148:151], a[104:107], a[172:175], v[148:151]
  v_mfma_f32_16x16x32_bf16 v[152:155], a[108:111], a[160:163], v[152:155]
  ds_read_b64_tr_b16 a[140:141], v219 offset:27872
  v_mfma_f32_16x16x32_bf16 v[156:159], a[108:111], a[164:167], v[156:159]
  s_waitcnt vmcnt(25)
  s_barrier
  v_mfma_f32_16x16x32_bf16 v[160:163], a[108:111], a[168:171], v[160:163]
  ds_read_b64_tr_b16 a[142:143], v219 offset:32480
  v_mfma_f32_16x16x32_bf16 v[164:167], a[108:111], a[172:175], v[164:167]
  s_waitcnt lgkmcnt(12)
  v_mfma_f32_16x16x32_bf16 v[168:171], a[112:115], a[160:163], v[168:171]
  ds_read_b64_tr_b16 a[96:97], v214
  v_mfma_f32_16x16x32_bf16 v[172:175], a[112:115], a[164:167], v[172:175]
  v_mfma_f32_16x16x32_bf16 v[176:179], a[112:115], a[168:171], v[176:179]
  ds_read_b64_tr_b16 a[98:99], v214 offset:4608
  v_mfma_f32_16x16x32_bf16 v[180:183], a[112:115], a[172:175], v[180:183]
  v_mfma_f32_16x16x32_bf16 v[184:187], a[116:119], a[160:163], v[184:187]
  ds_read_b64_tr_b16 a[100:101], v214 offset:18432
  v_mfma_f32_16x16x32_bf16 v[188:191], a[116:119], a[164:167], v[188:191]
  v_mfma_f32_16x16x32_bf16 v[192:195], a[116:119], a[168:171], v[192:195]
  ds_read_b64_tr_b16 a[102:103], v214 offset:23040
  v_mfma_f32_16x16x32_bf16 v[196:199], a[116:119], a[172:175], v[196:199]
  s_waitcnt lgkmcnt(12)
  v_mfma_f32_16x16x32_bf16 a[0:3], a[120:123], a[160:163], a[0:3]
  ds_read_b64_tr_b16 a[104:105], v213
  v_mfma_f32_16x16x32_bf16 a[4:7], a[120:123], a[164:167], a[4:7]
  v_mfma_f32_16x16x32_bf16 a[8:11], a[120:123], a[168:171], a[8:11]
  ds_read_b64_tr_b16 a[106:107], v213 offset:4608
  v_mfma_f32_16x16x32_bf16 a[12:15], a[120:123], a[172:175], a[12:15]
  v_mfma_f32_16x16x32_bf16 a[16:19], a[124:127], a[160:163], a[16:19]
  ds_read_b64_tr_b16 a[108:109], v213 offset:18432
  v_mfma_f32_16x16x32_bf16 a[20:23], a[124:127], a[164:167], a[20:23]
  v_mfma_f32_16x16x32_bf16 a[24:27], a[124:127], a[168:171], a[24:27]
  ds_read_b64_tr_b16 a[110:111], v213 offset:23040
  v_mfma_f32_16x16x32_bf16 a[28:31], a[124:127], a[172:175], a[28:31]
  s_waitcnt lgkmcnt(12)
  v_mfma_f32_16x16x32_bf16 a[32:35], a[128:131], a[160:163], a[32:35]
  ds_read_b64_tr_b16 a[112:113], v213 offset:32
  v_mfma_f32_16x16x32_bf16 a[36:39], a[128:131], a[164:167], a[36:39]
  v_mfma_f32_16x16x32_bf16 a[40:43], a[128:131], a[168:171], a[40:43]
  ds_read_b64_tr_b16 a[114:115], v213 offset:4640
  v_mfma_f32_16x16x32_bf16 a[44:47], a[128:131], a[172:175], a[44:47]
  v_mfma_f32_16x16x32_bf16 a[48:51], a[132:135], a[160:163], a[48:51]
  ds_read_b64_tr_b16 a[116:117], v213 offset:18464
  v_mfma_f32_16x16x32_bf16 a[52:55], a[132:135], a[164:167], a[52:55]
  v_mfma_f32_16x16x32_bf16 a[56:59], a[132:135], a[168:171], a[56:59]
  ds_read_b64_tr_b16 a[118:119], v213 offset:23072
  v_mfma_f32_16x16x32_bf16 a[60:63], a[132:135], a[172:175], a[60:63]
  s_waitcnt lgkmcnt(12)
  v_mfma_f32_16x16x32_bf16 a[64:67], a[136:139], a[160:163], a[64:67]
  ds_read_b64_tr_b16 a[120:121], v213 offset:64
  v_mfma_f32_16x16x32_bf16 a[68:71], a[136:139], a[164:167], a[68:71]
  v_mfma_f32_16x16x32_bf16 a[72:75], a[136:139], a[168:171], a[72:75]
  ds_read_b64_tr_b16 a[122:123], v213 offset:4672
  v_mfma_f32_16x16x32_bf16 a[76:79], a[136:139], a[172:175], a[76:79]
  v_mfma_f32_16x16x32_bf16 a[80:83], a[140:143], a[160:163], a[80:83]
  ds_read_b64_tr_b16 a[124:125], v213 offset:18496
  v_mfma_f32_16x16x32_bf16 a[84:87], a[140:143], a[164:167], a[84:87]
  v_mfma_f32_16x16x32_bf16 a[88:91], a[140:143], a[168:171], a[88:91]
  ds_read_b64_tr_b16 a[126:127], v213 offset:23104
  v_mfma_f32_16x16x32_bf16 a[92:95], a[140:143], a[172:175], a[92:95]
  s_waitcnt vmcnt(21) lgkmcnt(12)
  v_mfma_f32_16x16x32_bf16 v[8:11], a[96:99], a[176:179], v[8:11]
  ds_read_b64_tr_b16 a[128:129], v213 offset:96
  s_add_u32 m0, s28, 0x12000
  v_mfma_f32_16x16x32_bf16 v[12:15], a[96:99], a[180:183], v[12:15]
  buffer_load_dwordx4 v224, s[12:15], s29 offen lds
  s_bfe_u32 s63, s2, 0x20001
  v_mfma_f32_16x16x32_bf16 v[16:19], a[96:99], a[184:187], v[16:19]
  ds_read_b64_tr_b16 a[130:131], v213 offset:4704
  s_bfe_u32 s62, s2, 0x20003
  v_mfma_f32_16x16x32_bf16 v[20:23], a[96:99], a[188:191], v[20:23]
  s_mul_i32 s60, s101, 0x2400
  v_mfma_f32_16x16x32_bf16 v[24:27], a[100:103], a[176:179], v[24:27]
  ds_read_b64_tr_b16 a[132:133], v213 offset:18528
  s_mul_i32 s61, s63, 0x144000
  v_mfma_f32_16x16x32_bf16 v[28:31], a[100:103], a[180:183], v[28:31]
  s_mul_i32 s34, s101, 0x9000
  v_mfma_f32_16x16x32_bf16 v[32:35], a[100:103], a[184:187], v[32:35]
  ds_read_b64_tr_b16 a[134:135], v213 offset:23136
  s_add_u32 s61, s61, s34
  v_mfma_f32_16x16x32_bf16 v[36:39], a[100:103], a[188:191], v[36:39]
  buffer_load_dwordx4 v225, s[12:15], s29 offen offset:1024 lds
  s_waitcnt lgkmcnt(12)
  v_mfma_f32_16x16x32_bf16 v[40:43], a[104:107], a[176:179], v[40:43]
  ds_read_b64_tr_b16 a[136:137], v213 offset:128
  s_mul_i32 s34, s62, 0x120
  v_mfma_f32_16x16x32_bf16 v[44:47], a[104:107], a[180:183], v[44:47]
  s_add_u32 s61, s61, s34
  v_mfma_f32_16x16x32_bf16 v[48:51], a[104:107], a[184:187], v[48:51]
  ds_read_b64_tr_b16 a[138:139], v213 offset:4736
  s_mov_b32 s34, 0xe38e38f
  v_mfma_f32_16x16x32_bf16 v[52:55], a[104:107], a[188:191], v[52:55]
  v_and_b32 v251, 63, v0
  v_mfma_f32_16x16x32_bf16 v[56:59], a[108:111], a[176:179], v[56:59]
  ds_read_b64_tr_b16 a[140:141], v213 offset:18560
  v_add_u32 v249, 0, v251
  v_mfma_f32_16x16x32_bf16 v[60:63], a[108:111], a[180:183], v[60:63]
  buffer_load_dwordx4 v226, s[12:15], s29 offen offset:2048 lds
  v_mul_hi_u32 v250, v249, s34
  v_mfma_f32_16x16x32_bf16 v[64:67], a[108:111], a[184:187], v[64:67]
  ds_read_b64_tr_b16 a[142:143], v213 offset:23168
  v_mul_u32_u24 v250, 0x360, v250
  v_mfma_f32_16x16x32_bf16 v[68:71], a[108:111], a[188:191], v[68:71]
  s_waitcnt lgkmcnt(12)
  v_mfma_f32_16x16x32_bf16 v[72:75], a[112:115], a[176:179], v[72:75]
  ds_read_b64_tr_b16 a[96:97], v213 offset:160
  v_lshl_add_u32 v250, v249, 4, v250
  v_mfma_f32_16x16x32_bf16 v[76:79], a[112:115], a[180:183], v[76:79]
  v_subrev_u32 v240, 0, v250
  v_mfma_f32_16x16x32_bf16 v[80:83], a[112:115], a[184:187], v[80:83]
  ds_read_b64_tr_b16 a[98:99], v213 offset:4768
  v_add_u32 v249, 64, v251
  v_mfma_f32_16x16x32_bf16 v[84:87], a[112:115], a[188:191], v[84:87]
  buffer_load_dwordx4 v227, s[12:15], s29 offen offset:3072 lds
  s_add_u32 m0, s28, 0x13000
  v_mfma_f32_16x16x32_bf16 v[88:91], a[116:119], a[176:179], v[88:91]
  ds_read_b64_tr_b16 a[100:101], v213 offset:18592
  v_mul_hi_u32 v250, v249, s34
  v_mfma_f32_16x16x32_bf16 v[92:95], a[116:119], a[180:183], v[92:95]
  v_mul_u32_u24 v250, 0x360, v250
  v_mfma_f32_16x16x32_bf16 v[96:99], a[116:119], a[184:187], v[96:99]
  ds_read_b64_tr_b16 a[102:103], v213 offset:23200
  v_lshl_add_u32 v250, v249, 4, v250
  v_mfma_f32_16x16x32_bf16 v[100:103], a[116:119], a[188:191], v[100:103]
  s_waitcnt lgkmcnt(12)
  v_mfma_f32_16x16x32_bf16 v[104:107], a[120:123], a[176:179], v[104:107]
  ds_read_b64_tr_b16 a[104:105], v213 offset:192
  v_subrev_u32 v241, 0x400, v250
  v_mfma_f32_16x16x32_bf16 v[108:111], a[120:123], a[180:183], v[108:111]
  buffer_load_dwordx4 v228, s[12:15], s29 offen lds
  v_add_u32 v249, 0x80, v251
  v_mfma_f32_16x16x32_bf16 v[112:115], a[120:123], a[184:187], v[112:115]
  ds_read_b64_tr_b16 a[106:107], v213 offset:4800
  v_mul_hi_u32 v250, v249, s34
  v_mfma_f32_16x16x32_bf16 v[116:119], a[120:123], a[188:191], v[116:119]
  v_mul_u32_u24 v250, 0x360, v250
  v_mfma_f32_16x16x32_bf16 v[120:123], a[124:127], a[176:179], v[120:123]
  ds_read_b64_tr_b16 a[108:109], v213 offset:18624
  v_lshl_add_u32 v250, v249, 4, v250
  v_mfma_f32_16x16x32_bf16 v[124:127], a[124:127], a[180:183], v[124:127]
  v_subrev_u32 v242, 0x800, v250
  v_mfma_f32_16x16x32_bf16 v[128:131], a[124:127], a[184:187], v[128:131]
  ds_read_b64_tr_b16 a[110:111], v213 offset:23232
  v_add_u32 v249, 0xc0, v251
  v_mfma_f32_16x16x32_bf16 v[132:135], a[124:127], a[188:191], v[132:135]
  buffer_load_dwordx4 v229, s[12:15], s29 offen offset:1024 lds
  s_waitcnt lgkmcnt(12)
  v_mfma_f32_16x16x32_bf16 v[136:139], a[128:131], a[176:179], v[136:139]
  ds_read_b64_tr_b16 a[112:113], v213 offset:224
  v_mul_hi_u32 v250, v249, s34
  v_mfma_f32_16x16x32_bf16 v[140:143], a[128:131], a[180:183], v[140:143]
  v_mul_u32_u24 v250, 0x360, v250
  v_mfma_f32_16x16x32_bf16 v[144:147], a[128:131], a[184:187], v[144:147]
  ds_read_b64_tr_b16 a[114:115], v213 offset:4832
  v_lshl_add_u32 v250, v249, 4, v250
  v_mfma_f32_16x16x32_bf16 v[148:151], a[128:131], a[188:191], v[148:151]
  v_subrev_u32 v243, 0xc00, v250
  v_mfma_f32_16x16x32_bf16 v[152:155], a[132:135], a[176:179], v[152:155]
  ds_read_b64_tr_b16 a[116:117], v213 offset:18656
  v_add_u32 v249, 0x100, v251
  v_mfma_f32_16x16x32_bf16 v[156:159], a[132:135], a[180:183], v[156:159]
  buffer_load_dwordx4 v230, s[12:15], s29 offen offset:2048 lds
  v_mul_hi_u32 v250, v249, s34
  v_mfma_f32_16x16x32_bf16 v[160:163], a[132:135], a[184:187], v[160:163]
  ds_read_b64_tr_b16 a[118:119], v213 offset:23264
  v_mul_u32_u24 v250, 0x360, v250
  v_mfma_f32_16x16x32_bf16 v[164:167], a[132:135], a[188:191], v[164:167]
  s_waitcnt lgkmcnt(12)
  v_mfma_f32_16x16x32_bf16 v[168:171], a[136:139], a[176:179], v[168:171]
  ds_read_b64_tr_b16 a[120:121], v214 offset:9216
  v_lshl_add_u32 v250, v249, 4, v250
  v_mfma_f32_16x16x32_bf16 v[172:175], a[136:139], a[180:183], v[172:175]
  v_subrev_u32 v244, 0, v250
  v_mfma_f32_16x16x32_bf16 v[176:179], a[136:139], a[184:187], v[176:179]
  ds_read_b64_tr_b16 a[122:123], v214 offset:13824
  v_add_u32 v249, 0x140, v251
  v_mfma_f32_16x16x32_bf16 v[180:183], a[136:139], a[188:191], v[180:183]
  buffer_load_dwordx4 v231, s[12:15], s29 offen offset:3072 lds
  s_add_u32 m0, s28, 0x14000
  v_mfma_f32_16x16x32_bf16 v[184:187], a[140:143], a[176:179], v[184:187]
  ds_read_b64_tr_b16 a[124:125], v214 offset:27648
  v_mul_hi_u32 v250, v249, s34
  v_mfma_f32_16x16x32_bf16 v[188:191], a[140:143], a[180:183], v[188:191]
  v_mul_u32_u24 v250, 0x360, v250
  v_mfma_f32_16x16x32_bf16 v[192:195], a[140:143], a[184:187], v[192:195]
  ds_read_b64_tr_b16 a[126:127], v214 offset:32256
  v_lshl_add_u32 v250, v249, 4, v250
  v_mfma_f32_16x16x32_bf16 v[196:199], a[140:143], a[188:191], v[196:199]
  s_waitcnt lgkmcnt(12)
  v_mfma_f32_16x16x32_bf16 a[0:3], a[96:99], a[176:179], a[0:3]
  ds_read_b64_tr_b16 a[128:129], v213 offset:9216
  v_subrev_u32 v245, 0x400, v250
  v_mfma_f32_16x16x32_bf16 a[4:7], a[96:99], a[180:183], a[4:7]
  buffer_load_dwordx4 v232, s[12:15], s29 offen lds
  s_add_u32 s29, s29, 0x90000
  v_mfma_f32_16x16x32_bf16 a[8:11], a[96:99], a[184:187], a[8:11]
  ds_read_b64_tr_b16 a[130:131], v213 offset:13824
  v_add_u32 v249, 0x180, v251
  v_mfma_f32_16x16x32_bf16 a[12:15], a[96:99], a[188:191], a[12:15]
  v_mul_hi_u32 v250, v249, s34
  v_mfma_f32_16x16x32_bf16 a[16:19], a[100:103], a[176:179], a[16:19]
  ds_read_b64_tr_b16 a[132:133], v213 offset:27648
  v_mul_u32_u24 v250, 0x360, v250
  v_mfma_f32_16x16x32_bf16 a[20:23], a[100:103], a[180:183], a[20:23]
  v_lshl_add_u32 v250, v249, 4, v250
  v_mfma_f32_16x16x32_bf16 a[24:27], a[100:103], a[184:187], a[24:27]
  ds_read_b64_tr_b16 a[134:135], v213 offset:32256
  v_subrev_u32 v246, 0x800, v250
  v_mfma_f32_16x16x32_bf16 a[28:31], a[100:103], a[188:191], a[28:31]
  buffer_load_dwordx4 a[144:147], v209, s[8:11], s30 offen sc1
  s_waitcnt lgkmcnt(12)
  v_mfma_f32_16x16x32_bf16 a[32:35], a[104:107], a[176:179], a[32:35]
  ds_read_b64_tr_b16 a[136:137], v213 offset:9248
  v_add_u32 v249, 0x1c0, v251
  v_mfma_f32_16x16x32_bf16 a[36:39], a[104:107], a[180:183], a[36:39]
  v_mul_hi_u32 v250, v249, s34
  v_mfma_f32_16x16x32_bf16 a[40:43], a[104:107], a[184:187], a[40:43]
  ds_read_b64_tr_b16 a[138:139], v213 offset:13856
  v_mul_u32_u24 v250, 0x360, v250
  v_mfma_f32_16x16x32_bf16 a[44:47], a[104:107], a[188:191], a[44:47]
  v_lshl_add_u32 v250, v249, 4, v250
  v_mfma_f32_16x16x32_bf16 a[48:51], a[108:111], a[176:179], a[48:51]
  ds_read_b64_tr_b16 a[140:141], v213 offset:27680
  v_subrev_u32 v247, 0xc00, v250
  v_mfma_f32_16x16x32_bf16 a[52:55], a[108:111], a[180:183], a[52:55]
  buffer_load_dwordx4 a[148:151], v210, s[8:11], s30 offen sc1
  v_add_u32 v249, 0x200, v251
  v_mfma_f32_16x16x32_bf16 a[56:59], a[108:111], a[184:187], a[56:59]
  ds_read_b64_tr_b16 a[142:143], v213 offset:32288
  v_mul_hi_u32 v250, v249, s34
  v_mfma_f32_16x16x32_bf16 a[60:63], a[108:111], a[188:191], a[60:63]
  s_waitcnt lgkmcnt(12)
  v_mfma_f32_16x16x32_bf16 a[64:67], a[112:115], a[176:179], a[64:67]
  ds_read_b64_tr_b16 a[96:97], v213 offset:9280
  v_mul_u32_u24 v250, 0x360, v250
  v_mfma_f32_16x16x32_bf16 a[68:71], a[112:115], a[180:183], a[68:71]
  v_lshl_add_u32 v250, v249, 4, v250
  v_mfma_f32_16x16x32_bf16 a[72:75], a[112:115], a[184:187], a[72:75]
  ds_read_b64_tr_b16 a[98:99], v213 offset:13888
  v_subrev_u32 v248, 0, v250
  v_mfma_f32_16x16x32_bf16 a[76:79], a[112:115], a[188:191], a[76:79]
  buffer_load_dwordx4 a[152:155], v211, s[8:11], s30 offen sc1
  s_mov_b32 s56, s84
  v_mfma_f32_16x16x32_bf16 a[80:83], a[116:119], a[176:179], a[80:83]
  ds_read_b64_tr_b16 a[100:101], v213 offset:27712
  s_mov_b32 s57, s85
  v_mfma_f32_16x16x32_bf16 a[84:87], a[116:119], a[180:183], a[84:87]
  s_mov_b32 s58, 0x510000
  v_mfma_f32_16x16x32_bf16 a[88:91], a[116:119], a[184:187], a[88:91]
  ds_read_b64_tr_b16 a[102:103], v213 offset:32320
  s_mov_b32 s59, 0x20000
  v_mfma_f32_16x16x32_bf16 a[92:95], a[116:119], a[188:191], a[92:95]
  s_waitcnt vmcnt(29) lgkmcnt(12)
  v_mfma_f32_16x16x32_bf16 v[8:11], a[120:123], a[192:195], v[8:11]
  ds_read_b64_tr_b16 a[104:105], v213 offset:9312
  v_mfma_f32_16x16x32_bf16 v[12:15], a[120:123], a[196:199], v[12:15]
  buffer_load_dwordx4 a[156:159], v212, s[8:11], s30 offen sc1
  v_mfma_f32_16x16x32_bf16 v[16:19], a[120:123], a[200:203], v[16:19]
  ds_read_b64_tr_b16 a[106:107], v213 offset:13920
  v_mfma_f32_16x16x32_bf16 v[20:23], a[120:123], a[204:207], v[20:23]
  v_mfma_f32_16x16x32_bf16 v[24:27], a[124:127], a[192:195], v[24:27]
  ds_read_b64_tr_b16 a[108:109], v213 offset:27744
  v_mfma_f32_16x16x32_bf16 v[28:31], a[124:127], a[196:199], v[28:31]
  v_mfma_f32_16x16x32_bf16 v[32:35], a[124:127], a[200:203], v[32:35]
  ds_read_b64_tr_b16 a[110:111], v213 offset:32352
  v_mfma_f32_16x16x32_bf16 v[36:39], a[124:127], a[204:207], v[36:39]
  buffer_load_dwordx4 a[160:163], v209, s[8:11], s30 offen offset:1024 sc1
  s_waitcnt lgkmcnt(12)
  v_mfma_f32_16x16x32_bf16 v[40:43], a[128:131], a[192:195], v[40:43]
  ds_read_b64_tr_b16 a[112:113], v213 offset:9344
  v_mfma_f32_16x16x32_bf16 v[44:47], a[128:131], a[196:199], v[44:47]
  v_mfma_f32_16x16x32_bf16 v[48:51], a[128:131], a[200:203], v[48:51]
  ds_read_b64_tr_b16 a[114:115], v213 offset:13952
  v_mfma_f32_16x16x32_bf16 v[52:55], a[128:131], a[204:207], v[52:55]
  v_mfma_f32_16x16x32_bf16 v[56:59], a[132:135], a[192:195], v[56:59]
  ds_read_b64_tr_b16 a[116:117], v213 offset:27776
  v_mfma_f32_16x16x32_bf16 v[60:63], a[132:135], a[196:199], v[60:63]
  buffer_load_dwordx4 a[164:167], v210, s[8:11], s30 offen offset:1024 sc1
  v_mfma_f32_16x16x32_bf16 v[64:67], a[132:135], a[200:203], v[64:67]
  ds_read_b64_tr_b16 a[118:119], v213 offset:32384
  v_mfma_f32_16x16x32_bf16 v[68:71], a[132:135], a[204:207], v[68:71]
  s_waitcnt lgkmcnt(12)
  v_mfma_f32_16x16x32_bf16 v[72:75], a[136:139], a[192:195], v[72:75]
  ds_read_b64_tr_b16 a[120:121], v213 offset:9376
  v_mfma_f32_16x16x32_bf16 v[76:79], a[136:139], a[196:199], v[76:79]
  v_mfma_f32_16x16x32_bf16 v[80:83], a[136:139], a[200:203], v[80:83]
  ds_read_b64_tr_b16 a[122:123], v213 offset:13984
  v_mfma_f32_16x16x32_bf16 v[84:87], a[136:139], a[204:207], v[84:87]
  buffer_load_dwordx4 a[168:171], v211, s[8:11], s30 offen offset:1024 sc1
  v_mfma_f32_16x16x32_bf16 v[88:91], a[140:143], a[192:195], v[88:91]
  ds_read_b64_tr_b16 a[124:125], v213 offset:27808
  v_mfma_f32_16x16x32_bf16 v[92:95], a[140:143], a[196:199], v[92:95]
  v_mfma_f32_16x16x32_bf16 v[96:99], a[140:143], a[200:203], v[96:99]
  ds_read_b64_tr_b16 a[126:127], v213 offset:32416
  v_mfma_f32_16x16x32_bf16 v[100:103], a[140:143], a[204:207], v[100:103]
  s_waitcnt lgkmcnt(12)
  v_mfma_f32_16x16x32_bf16 v[104:107], a[96:99], a[192:195], v[104:107]
  ds_read_b64_tr_b16 a[128:129], v213 offset:9408
  v_mfma_f32_16x16x32_bf16 v[108:111], a[96:99], a[196:199], v[108:111]
  buffer_load_dwordx4 a[172:175], v212, s[8:11], s30 offen offset:1024 sc1
  s_add_u32 s30, s30, 0x800
  v_mfma_f32_16x16x32_bf16 v[112:115], a[96:99], a[200:203], v[112:115]
  ds_read_b64_tr_b16 a[130:131], v213 offset:14016
  v_mfma_f32_16x16x32_bf16 v[116:119], a[96:99], a[204:207], v[116:119]
  v_mfma_f32_16x16x32_bf16 v[120:123], a[100:103], a[192:195], v[120:123]
  ds_read_b64_tr_b16 a[132:133], v213 offset:27840
  v_mfma_f32_16x16x32_bf16 v[124:127], a[100:103], a[196:199], v[124:127]
  v_mfma_f32_16x16x32_bf16 v[128:131], a[100:103], a[200:203], v[128:131]
  ds_read_b64_tr_b16 a[134:135], v213 offset:32448
  v_mfma_f32_16x16x32_bf16 v[132:135], a[100:103], a[204:207], v[132:135]
  s_waitcnt lgkmcnt(12)
  v_mfma_f32_16x16x32_bf16 v[136:139], a[104:107], a[192:195], v[136:139]
  ds_read_b64_tr_b16 a[136:137], v213 offset:9440
  v_mfma_f32_16x16x32_bf16 v[140:143], a[104:107], a[196:199], v[140:143]
  v_mfma_f32_16x16x32_bf16 v[144:147], a[104:107], a[200:203], v[144:147]
  ds_read_b64_tr_b16 a[138:139], v213 offset:14048
  v_mfma_f32_16x16x32_bf16 v[148:151], a[104:107], a[204:207], v[148:151]
  v_mfma_f32_16x16x32_bf16 v[152:155], a[108:111], a[192:195], v[152:155]
  ds_read_b64_tr_b16 a[140:141], v213 offset:27872
  v_mfma_f32_16x16x32_bf16 v[156:159], a[108:111], a[196:199], v[156:159]
  s_waitcnt vmcnt(25)
  s_barrier
  v_mfma_f32_16x16x32_bf16 v[160:163], a[108:111], a[200:203], v[160:163]
  ds_read_b64_tr_b16 a[142:143], v213 offset:32480
  v_mfma_f32_16x16x32_bf16 v[164:167], a[108:111], a[204:207], v[164:167]
  s_waitcnt lgkmcnt(12)
  v_mfma_f32_16x16x32_bf16 v[168:171], a[112:115], a[192:195], v[168:171]
  ds_read_b64_tr_b16 a[96:97], v216
  v_mfma_f32_16x16x32_bf16 v[172:175], a[112:115], a[196:199], v[172:175]
  v_mfma_f32_16x16x32_bf16 v[176:179], a[112:115], a[200:203], v[176:179]
  ds_read_b64_tr_b16 a[98:99], v216 offset:4608
  v_mfma_f32_16x16x32_bf16 v[180:183], a[112:115], a[204:207], v[180:183]
  v_mfma_f32_16x16x32_bf16 v[184:187], a[116:119], a[192:195], v[184:187]
  ds_read_b64_tr_b16 a[100:101], v216 offset:18432
  v_mfma_f32_16x16x32_bf16 v[188:191], a[116:119], a[196:199], v[188:191]
  v_mfma_f32_16x16x32_bf16 v[192:195], a[116:119], a[200:203], v[192:195]
  ds_read_b64_tr_b16 a[102:103], v216 offset:23040
  v_mfma_f32_16x16x32_bf16 v[196:199], a[116:119], a[204:207], v[196:199]
  s_waitcnt lgkmcnt(12)
  v_mfma_f32_16x16x32_bf16 a[0:3], a[120:123], a[192:195], a[0:3]
  ds_read_b64_tr_b16 a[104:105], v215
  v_mfma_f32_16x16x32_bf16 a[4:7], a[120:123], a[196:199], a[4:7]
  v_mfma_f32_16x16x32_bf16 a[8:11], a[120:123], a[200:203], a[8:11]
  ds_read_b64_tr_b16 a[106:107], v215 offset:4608
  v_mfma_f32_16x16x32_bf16 a[12:15], a[120:123], a[204:207], a[12:15]
  v_mfma_f32_16x16x32_bf16 a[16:19], a[124:127], a[192:195], a[16:19]
  ds_read_b64_tr_b16 a[108:109], v215 offset:18432
  v_mfma_f32_16x16x32_bf16 a[20:23], a[124:127], a[196:199], a[20:23]
  v_mfma_f32_16x16x32_bf16 a[24:27], a[124:127], a[200:203], a[24:27]
  ds_read_b64_tr_b16 a[110:111], v215 offset:23040
  v_mfma_f32_16x16x32_bf16 a[28:31], a[124:127], a[204:207], a[28:31]
  s_waitcnt lgkmcnt(12)
  v_mfma_f32_16x16x32_bf16 a[32:35], a[128:131], a[192:195], a[32:35]
  ds_read_b64_tr_b16 a[112:113], v215 offset:32
  v_mfma_f32_16x16x32_bf16 a[36:39], a[128:131], a[196:199], a[36:39]
  v_mfma_f32_16x16x32_bf16 a[40:43], a[128:131], a[200:203], a[40:43]
  ds_read_b64_tr_b16 a[114:115], v215 offset:4640
  v_mfma_f32_16x16x32_bf16 a[44:47], a[128:131], a[204:207], a[44:47]
  v_mfma_f32_16x16x32_bf16 a[48:51], a[132:135], a[192:195], a[48:51]
  ds_read_b64_tr_b16 a[116:117], v215 offset:18464
  v_mfma_f32_16x16x32_bf16 a[52:55], a[132:135], a[196:199], a[52:55]
  v_mfma_f32_16x16x32_bf16 a[56:59], a[132:135], a[200:203], a[56:59]
  ds_read_b64_tr_b16 a[118:119], v215 offset:23072
  v_mfma_f32_16x16x32_bf16 a[60:63], a[132:135], a[204:207], a[60:63]
  s_waitcnt lgkmcnt(12)
  v_mfma_f32_16x16x32_bf16 a[64:67], a[136:139], a[192:195], a[64:67]
  ds_read_b64_tr_b16 a[120:121], v215 offset:64
  v_mfma_f32_16x16x32_bf16 a[68:71], a[136:139], a[196:199], a[68:71]
  v_mfma_f32_16x16x32_bf16 a[72:75], a[136:139], a[200:203], a[72:75]
  ds_read_b64_tr_b16 a[122:123], v215 offset:4672
  v_mfma_f32_16x16x32_bf16 a[76:79], a[136:139], a[204:207], a[76:79]
  v_mfma_f32_16x16x32_bf16 a[80:83], a[140:143], a[192:195], a[80:83]
  ds_read_b64_tr_b16 a[124:125], v215 offset:18496
  v_mfma_f32_16x16x32_bf16 a[84:87], a[140:143], a[196:199], a[84:87]
  v_mfma_f32_16x16x32_bf16 a[88:91], a[140:143], a[200:203], a[88:91]
  ds_read_b64_tr_b16 a[126:127], v215 offset:23104
  v_mfma_f32_16x16x32_bf16 a[92:95], a[140:143], a[204:207], a[92:95]
  s_waitcnt vmcnt(21) lgkmcnt(12)
  v_mfma_f32_16x16x32_bf16 v[8:11], a[96:99], a[208:211], v[8:11]
  ds_read_b64_tr_b16 a[128:129], v215 offset:96
  s_add_u32 m0, s28, 0x1b000
  v_mfma_f32_16x16x32_bf16 v[12:15], a[96:99], a[212:215], v[12:15]
  buffer_load_dwordx4 v224, s[12:15], s29 offen lds
  v_mfma_f32_16x16x32_bf16 v[16:19], a[96:99], a[216:219], v[16:19]
  ds_read_b64_tr_b16 a[130:131], v215 offset:4704
  v_mfma_f32_16x16x32_bf16 v[20:23], a[96:99], a[220:223], v[20:23]
  v_mfma_f32_16x16x32_bf16 v[24:27], a[100:103], a[208:211], v[24:27]
  ds_read_b64_tr_b16 a[132:133], v215 offset:18528
  v_mfma_f32_16x16x32_bf16 v[28:31], a[100:103], a[212:215], v[28:31]
  v_mfma_f32_16x16x32_bf16 v[32:35], a[100:103], a[216:219], v[32:35]
  ds_read_b64_tr_b16 a[134:135], v215 offset:23136
  v_mfma_f32_16x16x32_bf16 v[36:39], a[100:103], a[220:223], v[36:39]
  buffer_load_dwordx4 v225, s[12:15], s29 offen offset:1024 lds
  s_waitcnt lgkmcnt(12)
  v_mfma_f32_16x16x32_bf16 v[40:43], a[104:107], a[208:211], v[40:43]
  ds_read_b64_tr_b16 a[136:137], v215 offset:128
  v_mfma_f32_16x16x32_bf16 v[44:47], a[104:107], a[212:215], v[44:47]
  v_mfma_f32_16x16x32_bf16 v[48:51], a[104:107], a[216:219], v[48:51]
  ds_read_b64_tr_b16 a[138:139], v215 offset:4736
  v_mfma_f32_16x16x32_bf16 v[52:55], a[104:107], a[220:223], v[52:55]
  v_mfma_f32_16x16x32_bf16 v[56:59], a[108:111], a[208:211], v[56:59]
  ds_read_b64_tr_b16 a[140:141], v215 offset:18560
  v_mfma_f32_16x16x32_bf16 v[60:63], a[108:111], a[212:215], v[60:63]
  buffer_load_dwordx4 v226, s[12:15], s29 offen offset:2048 lds
  v_mfma_f32_16x16x32_bf16 v[64:67], a[108:111], a[216:219], v[64:67]
  ds_read_b64_tr_b16 a[142:143], v215 offset:23168
  v_mfma_f32_16x16x32_bf16 v[68:71], a[108:111], a[220:223], v[68:71]
  s_waitcnt lgkmcnt(12)
  v_mfma_f32_16x16x32_bf16 v[72:75], a[112:115], a[208:211], v[72:75]
  ds_read_b64_tr_b16 a[96:97], v215 offset:160
  v_mfma_f32_16x16x32_bf16 v[76:79], a[112:115], a[212:215], v[76:79]
  v_mfma_f32_16x16x32_bf16 v[80:83], a[112:115], a[216:219], v[80:83]
  ds_read_b64_tr_b16 a[98:99], v215 offset:4768
  v_mfma_f32_16x16x32_bf16 v[84:87], a[112:115], a[220:223], v[84:87]
  buffer_load_dwordx4 v227, s[12:15], s29 offen offset:3072 lds
  s_add_u32 m0, s28, 0x1c000
  v_mfma_f32_16x16x32_bf16 v[88:91], a[116:119], a[208:211], v[88:91]
  ds_read_b64_tr_b16 a[100:101], v215 offset:18592
  v_mfma_f32_16x16x32_bf16 v[92:95], a[116:119], a[212:215], v[92:95]
  v_mfma_f32_16x16x32_bf16 v[96:99], a[116:119], a[216:219], v[96:99]
  ds_read_b64_tr_b16 a[102:103], v215 offset:23200
  v_mfma_f32_16x16x32_bf16 v[100:103], a[116:119], a[220:223], v[100:103]
  s_waitcnt lgkmcnt(12)
  v_mfma_f32_16x16x32_bf16 v[104:107], a[120:123], a[208:211], v[104:107]
  ds_read_b64_tr_b16 a[104:105], v215 offset:192
  v_mfma_f32_16x16x32_bf16 v[108:111], a[120:123], a[212:215], v[108:111]
  buffer_load_dwordx4 v228, s[12:15], s29 offen lds
  v_mfma_f32_16x16x32_bf16 v[112:115], a[120:123], a[216:219], v[112:115]
  ds_read_b64_tr_b16 a[106:107], v215 offset:4800
  v_mfma_f32_16x16x32_bf16 v[116:119], a[120:123], a[220:223], v[116:119]
  v_mfma_f32_16x16x32_bf16 v[120:123], a[124:127], a[208:211], v[120:123]
  ds_read_b64_tr_b16 a[108:109], v215 offset:18624
  v_mfma_f32_16x16x32_bf16 v[124:127], a[124:127], a[212:215], v[124:127]
  v_mfma_f32_16x16x32_bf16 v[128:131], a[124:127], a[216:219], v[128:131]
  ds_read_b64_tr_b16 a[110:111], v215 offset:23232
  v_mfma_f32_16x16x32_bf16 v[132:135], a[124:127], a[220:223], v[132:135]
  buffer_load_dwordx4 v229, s[12:15], s29 offen offset:1024 lds
  s_waitcnt lgkmcnt(12)
  v_mfma_f32_16x16x32_bf16 v[136:139], a[128:131], a[208:211], v[136:139]
  ds_read_b64_tr_b16 a[112:113], v215 offset:224
  v_mfma_f32_16x16x32_bf16 v[140:143], a[128:131], a[212:215], v[140:143]
  v_mfma_f32_16x16x32_bf16 v[144:147], a[128:131], a[216:219], v[144:147]
  ds_read_b64_tr_b16 a[114:115], v215 offset:4832
  v_mfma_f32_16x16x32_bf16 v[148:151], a[128:131], a[220:223], v[148:151]
  v_mfma_f32_16x16x32_bf16 v[152:155], a[132:135], a[208:211], v[152:155]
  ds_read_b64_tr_b16 a[116:117], v215 offset:18656
  v_mfma_f32_16x16x32_bf16 v[156:159], a[132:135], a[212:215], v[156:159]
  buffer_load_dwordx4 v230, s[12:15], s29 offen offset:2048 lds
  v_mfma_f32_16x16x32_bf16 v[160:163], a[132:135], a[216:219], v[160:163]
  ds_read_b64_tr_b16 a[118:119], v215 offset:23264
  v_mfma_f32_16x16x32_bf16 v[164:167], a[132:135], a[220:223], v[164:167]
  s_waitcnt lgkmcnt(12)
  v_mfma_f32_16x16x32_bf16 v[168:171], a[136:139], a[208:211], v[168:171]
  ds_read_b64_tr_b16 a[120:121], v216 offset:9216
  v_mfma_f32_16x16x32_bf16 v[172:175], a[136:139], a[212:215], v[172:175]
  v_mfma_f32_16x16x32_bf16 v[176:179], a[136:139], a[216:219], v[176:179]
  ds_read_b64_tr_b16 a[122:123], v216 offset:13824
  v_mfma_f32_16x16x32_bf16 v[180:183], a[136:139], a[220:223], v[180:183]
  buffer_load_dwordx4 v231, s[12:15], s29 offen offset:3072 lds
  s_add_u32 m0, s28, 0x1d000
  v_mfma_f32_16x16x32_bf16 v[184:187], a[140:143], a[208:211], v[184:187]
  ds_read_b64_tr_b16 a[124:125], v216 offset:27648
  v_mfma_f32_16x16x32_bf16 v[188:191], a[140:143], a[212:215], v[188:191]
  v_mfma_f32_16x16x32_bf16 v[192:195], a[140:143], a[216:219], v[192:195]
  ds_read_b64_tr_b16 a[126:127], v216 offset:32256
  v_mfma_f32_16x16x32_bf16 v[196:199], a[140:143], a[220:223], v[196:199]
  s_waitcnt lgkmcnt(12)
  v_mfma_f32_16x16x32_bf16 a[0:3], a[96:99], a[208:211], a[0:3]
  ds_read_b64_tr_b16 a[128:129], v215 offset:9216
  v_mfma_f32_16x16x32_bf16 a[4:7], a[96:99], a[212:215], a[4:7]
  buffer_load_dwordx4 v232, s[12:15], s29 offen lds
  s_add_u32 s29, s29, 0x90000
  v_mfma_f32_16x16x32_bf16 a[8:11], a[96:99], a[216:219], a[8:11]
  ds_read_b64_tr_b16 a[130:131], v215 offset:13824
  v_mfma_f32_16x16x32_bf16 a[12:15], a[96:99], a[220:223], a[12:15]
  v_mfma_f32_16x16x32_bf16 a[16:19], a[100:103], a[208:211], a[16:19]
  ds_read_b64_tr_b16 a[132:133], v215 offset:27648
  v_mfma_f32_16x16x32_bf16 a[20:23], a[100:103], a[212:215], a[20:23]
  v_mfma_f32_16x16x32_bf16 a[24:27], a[100:103], a[216:219], a[24:27]
  ds_read_b64_tr_b16 a[134:135], v215 offset:32256
  v_mfma_f32_16x16x32_bf16 a[28:31], a[100:103], a[220:223], a[28:31]
  buffer_load_dwordx4 a[176:179], v209, s[8:11], s30 offen sc1
  s_waitcnt lgkmcnt(12)
  v_mfma_f32_16x16x32_bf16 a[32:35], a[104:107], a[208:211], a[32:35]
  ds_read_b64_tr_b16 a[136:137], v215 offset:9248
  v_mfma_f32_16x16x32_bf16 a[36:39], a[104:107], a[212:215], a[36:39]
  v_mfma_f32_16x16x32_bf16 a[40:43], a[104:107], a[216:219], a[40:43]
  ds_read_b64_tr_b16 a[138:139], v215 offset:13856
  v_mfma_f32_16x16x32_bf16 a[44:47], a[104:107], a[220:223], a[44:47]
  v_mfma_f32_16x16x32_bf16 a[48:51], a[108:111], a[208:211], a[48:51]
  ds_read_b64_tr_b16 a[140:141], v215 offset:27680
  v_mfma_f32_16x16x32_bf16 a[52:55], a[108:111], a[212:215], a[52:55]
  buffer_load_dwordx4 a[180:183], v210, s[8:11], s30 offen sc1
  v_mfma_f32_16x16x32_bf16 a[56:59], a[108:111], a[216:219], a[56:59]
  ds_read_b64_tr_b16 a[142:143], v215 offset:32288
  v_mfma_f32_16x16x32_bf16 a[60:63], a[108:111], a[220:223], a[60:63]
  s_waitcnt lgkmcnt(12)
  v_mfma_f32_16x16x32_bf16 a[64:67], a[112:115], a[208:211], a[64:67]
  ds_read_b64_tr_b16 a[96:97], v215 offset:9280
  v_mfma_f32_16x16x32_bf16 a[68:71], a[112:115], a[212:215], a[68:71]
  v_mfma_f32_16x16x32_bf16 a[72:75], a[112:115], a[216:219], a[72:75]
  ds_read_b64_tr_b16 a[98:99], v215 offset:13888
  v_mfma_f32_16x16x32_bf16 a[76:79], a[112:115], a[220:223], a[76:79]
  buffer_load_dwordx4 a[184:187], v211, s[8:11], s30 offen sc1
  v_mfma_f32_16x16x32_bf16 a[80:83], a[116:119], a[208:211], a[80:83]
  ds_read_b64_tr_b16 a[100:101], v215 offset:27712
  v_mfma_f32_16x16x32_bf16 a[84:87], a[116:119], a[212:215], a[84:87]
  v_mfma_f32_16x16x32_bf16 a[88:91], a[116:119], a[216:219], a[88:91]
  ds_read_b64_tr_b16 a[102:103], v215 offset:32320
  v_mfma_f32_16x16x32_bf16 a[92:95], a[116:119], a[220:223], a[92:95]
  s_waitcnt vmcnt(29) lgkmcnt(12)
  v_mfma_f32_16x16x32_bf16 v[8:11], a[120:123], a[224:227], v[8:11]
  ds_read_b64_tr_b16 a[104:105], v215 offset:9312
  v_mfma_f32_16x16x32_bf16 v[12:15], a[120:123], a[228:231], v[12:15]
  buffer_load_dwordx4 a[188:191], v212, s[8:11], s30 offen sc1
  v_mfma_f32_16x16x32_bf16 v[16:19], a[120:123], a[232:235], v[16:19]
  ds_read_b64_tr_b16 a[106:107], v215 offset:13920
  v_mfma_f32_16x16x32_bf16 v[20:23], a[120:123], a[236:239], v[20:23]
  v_mfma_f32_16x16x32_bf16 v[24:27], a[124:127], a[224:227], v[24:27]
  ds_read_b64_tr_b16 a[108:109], v215 offset:27744
  v_mfma_f32_16x16x32_bf16 v[28:31], a[124:127], a[228:231], v[28:31]
  v_mfma_f32_16x16x32_bf16 v[32:35], a[124:127], a[232:235], v[32:35]
  ds_read_b64_tr_b16 a[110:111], v215 offset:32352
  v_mfma_f32_16x16x32_bf16 v[36:39], a[124:127], a[236:239], v[36:39]
  buffer_load_dwordx4 a[192:195], v209, s[8:11], s30 offen offset:1024 sc1
  s_waitcnt lgkmcnt(12)
  v_mfma_f32_16x16x32_bf16 v[40:43], a[128:131], a[224:227], v[40:43]
  ds_read_b64_tr_b16 a[112:113], v215 offset:9344
  v_mfma_f32_16x16x32_bf16 v[44:47], a[128:131], a[228:231], v[44:47]
  v_mfma_f32_16x16x32_bf16 v[48:51], a[128:131], a[232:235], v[48:51]
  ds_read_b64_tr_b16 a[114:115], v215 offset:13952
  v_mfma_f32_16x16x32_bf16 v[52:55], a[128:131], a[236:239], v[52:55]
  v_mfma_f32_16x16x32_bf16 v[56:59], a[132:135], a[224:227], v[56:59]
  ds_read_b64_tr_b16 a[116:117], v215 offset:27776
  v_mfma_f32_16x16x32_bf16 v[60:63], a[132:135], a[228:231], v[60:63]
  buffer_load_dwordx4 a[196:199], v210, s[8:11], s30 offen offset:1024 sc1
  v_mfma_f32_16x16x32_bf16 v[64:67], a[132:135], a[232:235], v[64:67]
  ds_read_b64_tr_b16 a[118:119], v215 offset:32384
  v_mfma_f32_16x16x32_bf16 v[68:71], a[132:135], a[236:239], v[68:71]
  s_waitcnt lgkmcnt(12)
  v_mfma_f32_16x16x32_bf16 v[72:75], a[136:139], a[224:227], v[72:75]
  ds_read_b64_tr_b16 a[120:121], v215 offset:9376
  v_mfma_f32_16x16x32_bf16 v[76:79], a[136:139], a[228:231], v[76:79]
  v_mfma_f32_16x16x32_bf16 v[80:83], a[136:139], a[232:235], v[80:83]
  ds_read_b64_tr_b16 a[122:123], v215 offset:13984
  v_mfma_f32_16x16x32_bf16 v[84:87], a[136:139], a[236:239], v[84:87]
  buffer_load_dwordx4 a[200:203], v211, s[8:11], s30 offen offset:1024 sc1
  v_mfma_f32_16x16x32_bf16 v[88:91], a[140:143], a[224:227], v[88:91]
  ds_read_b64_tr_b16 a[124:125], v215 offset:27808
  v_mfma_f32_16x16x32_bf16 v[92:95], a[140:143], a[228:231], v[92:95]
  v_mfma_f32_16x16x32_bf16 v[96:99], a[140:143], a[232:235], v[96:99]
  ds_read_b64_tr_b16 a[126:127], v215 offset:32416
  v_mfma_f32_16x16x32_bf16 v[100:103], a[140:143], a[236:239], v[100:103]
  s_waitcnt lgkmcnt(12)
  v_mfma_f32_16x16x32_bf16 v[104:107], a[96:99], a[224:227], v[104:107]
  ds_read_b64_tr_b16 a[128:129], v215 offset:9408
  v_mfma_f32_16x16x32_bf16 v[108:111], a[96:99], a[228:231], v[108:111]
  buffer_load_dwordx4 a[204:207], v212, s[8:11], s30 offen offset:1024 sc1
  s_add_u32 s30, s30, 0x800
  v_mfma_f32_16x16x32_bf16 v[112:115], a[96:99], a[232:235], v[112:115]
  ds_read_b64_tr_b16 a[130:131], v215 offset:14016
  v_mfma_f32_16x16x32_bf16 v[116:119], a[96:99], a[236:239], v[116:119]
  v_mfma_f32_16x16x32_bf16 v[120:123], a[100:103], a[224:227], v[120:123]
  ds_read_b64_tr_b16 a[132:133], v215 offset:27840
  v_mfma_f32_16x16x32_bf16 v[124:127], a[100:103], a[228:231], v[124:127]
  v_mfma_f32_16x16x32_bf16 v[128:131], a[100:103], a[232:235], v[128:131]
  ds_read_b64_tr_b16 a[134:135], v215 offset:32448
  v_mfma_f32_16x16x32_bf16 v[132:135], a[100:103], a[236:239], v[132:135]
  s_waitcnt lgkmcnt(12)
  v_mfma_f32_16x16x32_bf16 v[136:139], a[104:107], a[224:227], v[136:139]
  ds_read_b64_tr_b16 a[136:137], v215 offset:9440
  v_mfma_f32_16x16x32_bf16 v[140:143], a[104:107], a[228:231], v[140:143]
  v_mfma_f32_16x16x32_bf16 v[144:147], a[104:107], a[232:235], v[144:147]
  ds_read_b64_tr_b16 a[138:139], v215 offset:14048
  v_mfma_f32_16x16x32_bf16 v[148:151], a[104:107], a[236:239], v[148:151]
  v_mfma_f32_16x16x32_bf16 v[152:155], a[108:111], a[224:227], v[152:155]
  ds_read_b64_tr_b16 a[140:141], v215 offset:27872
  v_mfma_f32_16x16x32_bf16 v[156:159], a[108:111], a[228:231], v[156:159]
  s_waitcnt vmcnt(25)
  s_barrier
  v_mfma_f32_16x16x32_bf16 v[160:163], a[108:111], a[232:235], v[160:163]
  ds_read_b64_tr_b16 a[142:143], v215 offset:32480
  s_add_u32 m0, s28, 0
  v_mfma_f32_16x16x32_bf16 v[164:167], a[108:111], a[236:239], v[164:167]
  buffer_load_dwordx4 v224, s[12:15], s29 offen lds
  s_waitcnt lgkmcnt(12)
  v_mfma_f32_16x16x32_bf16 v[168:171], a[112:115], a[224:227], v[168:171]
  ds_read_b64_tr_b16 a[96:97], v218
  v_mfma_f32_16x16x32_bf16 v[172:175], a[112:115], a[228:231], v[172:175]
  buffer_load_dwordx4 v225, s[12:15], s29 offen offset:1024 lds
  v_mfma_f32_16x16x32_bf16 v[176:179], a[112:115], a[232:235], v[176:179]
  ds_read_b64_tr_b16 a[98:99], v218 offset:4608
  v_mfma_f32_16x16x32_bf16 v[180:183], a[112:115], a[236:239], v[180:183]
  v_mfma_f32_16x16x32_bf16 v[184:187], a[116:119], a[224:227], v[184:187]
  ds_read_b64_tr_b16 a[100:101], v218 offset:18432
  v_mfma_f32_16x16x32_bf16 v[188:191], a[116:119], a[228:231], v[188:191]
  buffer_load_dwordx4 v226, s[12:15], s29 offen offset:2048 lds
  v_mfma_f32_16x16x32_bf16 v[192:195], a[116:119], a[232:235], v[192:195]
  ds_read_b64_tr_b16 a[102:103], v218 offset:23040
  v_mfma_f32_16x16x32_bf16 v[196:199], a[116:119], a[236:239], v[196:199]
  buffer_load_dwordx4 v227, s[12:15], s29 offen offset:3072 lds
  s_waitcnt lgkmcnt(12)
  v_mfma_f32_16x16x32_bf16 a[0:3], a[120:123], a[224:227], a[0:3]
  ds_read_b64_tr_b16 a[104:105], v217
  s_add_u32 m0, s28, 0x1000
  v_mfma_f32_16x16x32_bf16 a[4:7], a[120:123], a[228:231], a[4:7]
  v_mfma_f32_16x16x32_bf16 a[8:11], a[120:123], a[232:235], a[8:11]
  ds_read_b64_tr_b16 a[106:107], v217 offset:4608
  v_mfma_f32_16x16x32_bf16 a[12:15], a[120:123], a[236:239], a[12:15]
  buffer_load_dwordx4 v228, s[12:15], s29 offen lds
  v_mfma_f32_16x16x32_bf16 a[16:19], a[124:127], a[224:227], a[16:19]
  ds_read_b64_tr_b16 a[108:109], v217 offset:18432
  v_mfma_f32_16x16x32_bf16 a[20:23], a[124:127], a[228:231], a[20:23]
  buffer_load_dwordx4 v229, s[12:15], s29 offen offset:1024 lds
  v_mfma_f32_16x16x32_bf16 a[24:27], a[124:127], a[232:235], a[24:27]
  ds_read_b64_tr_b16 a[110:111], v217 offset:23040
  v_mfma_f32_16x16x32_bf16 a[28:31], a[124:127], a[236:239], a[28:31]
  s_waitcnt lgkmcnt(12)
  v_mfma_f32_16x16x32_bf16 a[32:35], a[128:131], a[224:227], a[32:35]
  ds_read_b64_tr_b16 a[112:113], v217 offset:32
  v_mfma_f32_16x16x32_bf16 a[36:39], a[128:131], a[228:231], a[36:39]
  buffer_load_dwordx4 v230, s[12:15], s29 offen offset:2048 lds
  v_mfma_f32_16x16x32_bf16 a[40:43], a[128:131], a[232:235], a[40:43]
  ds_read_b64_tr_b16 a[114:115], v217 offset:4640
  v_mfma_f32_16x16x32_bf16 a[44:47], a[128:131], a[236:239], a[44:47]
  buffer_load_dwordx4 v231, s[12:15], s29 offen offset:3072 lds
  s_add_u32 m0, s28, 0x2000
  v_mfma_f32_16x16x32_bf16 a[48:51], a[132:135], a[224:227], a[48:51]
  ds_read_b64_tr_b16 a[116:117], v217 offset:18464
  v_mfma_f32_16x16x32_bf16 a[52:55], a[132:135], a[228:231], a[52:55]
  v_mfma_f32_16x16x32_bf16 a[56:59], a[132:135], a[232:235], a[56:59]
  ds_read_b64_tr_b16 a[118:119], v217 offset:23072
  v_mfma_f32_16x16x32_bf16 a[60:63], a[132:135], a[236:239], a[60:63]
  buffer_load_dwordx4 v232, s[12:15], s29 offen lds
  s_waitcnt lgkmcnt(12)
  v_mfma_f32_16x16x32_bf16 a[64:67], a[136:139], a[224:227], a[64:67]
  ds_read_b64_tr_b16 a[120:121], v217 offset:64
  s_add_u32 s29, s29, 0x90000
  v_mfma_f32_16x16x32_bf16 a[68:71], a[136:139], a[228:231], a[68:71]
  v_mfma_f32_16x16x32_bf16 a[72:75], a[136:139], a[232:235], a[72:75]
  ds_read_b64_tr_b16 a[122:123], v217 offset:4672
  v_mfma_f32_16x16x32_bf16 a[76:79], a[136:139], a[236:239], a[76:79]
  v_mfma_f32_16x16x32_bf16 a[80:83], a[140:143], a[224:227], a[80:83]
  ds_read_b64_tr_b16 a[124:125], v217 offset:18496
  v_mfma_f32_16x16x32_bf16 a[84:87], a[140:143], a[228:231], a[84:87]
  v_mfma_f32_16x16x32_bf16 a[88:91], a[140:143], a[232:235], a[88:91]
  ds_read_b64_tr_b16 a[126:127], v217 offset:23104
  v_mfma_f32_16x16x32_bf16 a[92:95], a[140:143], a[236:239], a[92:95]
  s_waitcnt vmcnt(30) lgkmcnt(12)
  v_mfma_f32_16x16x32_bf16 v[8:11], a[96:99], a[144:147], v[8:11]
  ds_read_b64_tr_b16 a[128:129], v217 offset:96
  v_mfma_f32_16x16x32_bf16 v[12:15], a[96:99], a[148:151], v[12:15]
  buffer_load_dwordx4 a[208:211], v209, s[8:11], s30 offen sc1
  v_mfma_f32_16x16x32_bf16 v[16:19], a[96:99], a[152:155], v[16:19]
  ds_read_b64_tr_b16 a[130:131], v217 offset:4704
  v_mfma_f32_16x16x32_bf16 v[20:23], a[96:99], a[156:159], v[20:23]
  v_mfma_f32_16x16x32_bf16 v[24:27], a[100:103], a[144:147], v[24:27]
  ds_read_b64_tr_b16 a[132:133], v217 offset:18528
  v_mfma_f32_16x16x32_bf16 v[28:31], a[100:103], a[148:151], v[28:31]
  v_mfma_f32_16x16x32_bf16 v[32:35], a[100:103], a[152:155], v[32:35]
  ds_read_b64_tr_b16 a[134:135], v217 offset:23136
  v_mfma_f32_16x16x32_bf16 v[36:39], a[100:103], a[156:159], v[36:39]
  s_waitcnt lgkmcnt(12)
  v_mfma_f32_16x16x32_bf16 v[40:43], a[104:107], a[144:147], v[40:43]
  ds_read_b64_tr_b16 a[136:137], v217 offset:128
  v_mfma_f32_16x16x32_bf16 v[44:47], a[104:107], a[148:151], v[44:47]
  v_mfma_f32_16x16x32_bf16 v[48:51], a[104:107], a[152:155], v[48:51]
  ds_read_b64_tr_b16 a[138:139], v217 offset:4736
  v_mfma_f32_16x16x32_bf16 v[52:55], a[104:107], a[156:159], v[52:55]
  buffer_load_dwordx4 a[212:215], v210, s[8:11], s30 offen sc1
  v_mfma_f32_16x16x32_bf16 v[56:59], a[108:111], a[144:147], v[56:59]
  ds_read_b64_tr_b16 a[140:141], v217 offset:18560
  v_mfma_f32_16x16x32_bf16 v[60:63], a[108:111], a[148:151], v[60:63]
  v_mfma_f32_16x16x32_bf16 v[64:67], a[108:111], a[152:155], v[64:67]
  ds_read_b64_tr_b16 a[142:143], v217 offset:23168
  v_mfma_f32_16x16x32_bf16 v[68:71], a[108:111], a[156:159], v[68:71]
  s_waitcnt lgkmcnt(12)
  v_mfma_f32_16x16x32_bf16 v[72:75], a[112:115], a[144:147], v[72:75]
  ds_read_b64_tr_b16 a[96:97], v217 offset:160
  v_mfma_f32_16x16x32_bf16 v[76:79], a[112:115], a[148:151], v[76:79]
  v_mfma_f32_16x16x32_bf16 v[80:83], a[112:115], a[152:155], v[80:83]
  ds_read_b64_tr_b16 a[98:99], v217 offset:4768
  v_mfma_f32_16x16x32_bf16 v[84:87], a[112:115], a[156:159], v[84:87]
  v_mfma_f32_16x16x32_bf16 v[88:91], a[116:119], a[144:147], v[88:91]
  ds_read_b64_tr_b16 a[100:101], v217 offset:18592
  v_mfma_f32_16x16x32_bf16 v[92:95], a[116:119], a[148:151], v[92:95]
  v_mfma_f32_16x16x32_bf16 v[96:99], a[116:119], a[152:155], v[96:99]
  ds_read_b64_tr_b16 a[102:103], v217 offset:23200
  v_mfma_f32_16x16x32_bf16 v[100:103], a[116:119], a[156:159], v[100:103]
  buffer_load_dwordx4 a[216:219], v211, s[8:11], s30 offen sc1
  s_waitcnt lgkmcnt(12)
  v_mfma_f32_16x16x32_bf16 v[104:107], a[120:123], a[144:147], v[104:107]
  ds_read_b64_tr_b16 a[104:105], v217 offset:192
  v_mfma_f32_16x16x32_bf16 v[108:111], a[120:123], a[148:151], v[108:111]
  v_mfma_f32_16x16x32_bf16 v[112:115], a[120:123], a[152:155], v[112:115]
  ds_read_b64_tr_b16 a[106:107], v217 offset:4800
  v_mfma_f32_16x16x32_bf16 v[116:119], a[120:123], a[156:159], v[116:119]
  v_mfma_f32_16x16x32_bf16 v[120:123], a[124:127], a[144:147], v[120:123]
  ds_read_b64_tr_b16 a[108:109], v217 offset:18624
  v_mfma_f32_16x16x32_bf16 v[124:127], a[124:127], a[148:151], v[124:127]
  v_mfma_f32_16x16x32_bf16 v[128:131], a[124:127], a[152:155], v[128:131]
  ds_read_b64_tr_b16 a[110:111], v217 offset:23232
  v_mfma_f32_16x16x32_bf16 v[132:135], a[124:127], a[156:159], v[132:135]
  s_waitcnt lgkmcnt(12)
  v_mfma_f32_16x16x32_bf16 v[136:139], a[128:131], a[144:147], v[136:139]
  ds_read_b64_tr_b16 a[112:113], v217 offset:224
  v_mfma_f32_16x16x32_bf16 v[140:143], a[128:131], a[148:151], v[140:143]
  v_mfma_f32_16x16x32_bf16 v[144:147], a[128:131], a[152:155], v[144:147]
  ds_read_b64_tr_b16 a[114:115], v217 offset:4832
  v_mfma_f32_16x16x32_bf16 v[148:151], a[128:131], a[156:159], v[148:151]
  buffer_load_dwordx4 a[220:223], v212, s[8:11], s30 offen sc1
  v_mfma_f32_16x16x32_bf16 v[152:155], a[132:135], a[144:147], v[152:155]
  ds_read_b64_tr_b16 a[116:117], v217 offset:18656
  v_mfma_f32_16x16x32_bf16 v[156:159], a[132:135], a[148:151], v[156:159]
  v_mfma_f32_16x16x32_bf16 v[160:163], a[132:135], a[152:155], v[160:163]
  ds_read_b64_tr_b16 a[118:119], v217 offset:23264
  v_mfma_f32_16x16x32_bf16 v[164:167], a[132:135], a[156:159], v[164:167]
  s_waitcnt lgkmcnt(12)
  v_mfma_f32_16x16x32_bf16 v[168:171], a[136:139], a[144:147], v[168:171]
  ds_read_b64_tr_b16 a[120:121], v218 offset:9216
  v_mfma_f32_16x16x32_bf16 v[172:175], a[136:139], a[148:151], v[172:175]
  v_mfma_f32_16x16x32_bf16 v[176:179], a[136:139], a[152:155], v[176:179]
  ds_read_b64_tr_b16 a[122:123], v218 offset:13824
  v_mfma_f32_16x16x32_bf16 v[180:183], a[136:139], a[156:159], v[180:183]
  v_mfma_f32_16x16x32_bf16 v[184:187], a[140:143], a[144:147], v[184:187]
  ds_read_b64_tr_b16 a[124:125], v218 offset:27648
  v_mfma_f32_16x16x32_bf16 v[188:191], a[140:143], a[148:151], v[188:191]
  buffer_load_dwordx4 a[224:227], v209, s[8:11], s30 offen offset:1024 sc1
  v_mfma_f32_16x16x32_bf16 v[192:195], a[140:143], a[152:155], v[192:195]
  ds_read_b64_tr_b16 a[126:127], v218 offset:32256
  v_mfma_f32_16x16x32_bf16 v[196:199], a[140:143], a[156:159], v[196:199]
  s_waitcnt lgkmcnt(12)
  v_mfma_f32_16x16x32_bf16 a[0:3], a[96:99], a[144:147], a[0:3]
  ds_read_b64_tr_b16 a[128:129], v217 offset:9216
  v_mfma_f32_16x16x32_bf16 a[4:7], a[96:99], a[148:151], a[4:7]
  v_mfma_f32_16x16x32_bf16 a[8:11], a[96:99], a[152:155], a[8:11]
  ds_read_b64_tr_b16 a[130:131], v217 offset:13824
  v_mfma_f32_16x16x32_bf16 a[12:15], a[96:99], a[156:159], a[12:15]
  v_mfma_f32_16x16x32_bf16 a[16:19], a[100:103], a[144:147], a[16:19]
  ds_read_b64_tr_b16 a[132:133], v217 offset:27648
  v_mfma_f32_16x16x32_bf16 a[20:23], a[100:103], a[148:151], a[20:23]
  v_mfma_f32_16x16x32_bf16 a[24:27], a[100:103], a[152:155], a[24:27]
  ds_read_b64_tr_b16 a[134:135], v217 offset:32256
  v_mfma_f32_16x16x32_bf16 a[28:31], a[100:103], a[156:159], a[28:31]
  s_waitcnt lgkmcnt(12)
  v_mfma_f32_16x16x32_bf16 a[32:35], a[104:107], a[144:147], a[32:35]
  ds_read_b64_tr_b16 a[136:137], v217 offset:9248
  v_mfma_f32_16x16x32_bf16 a[36:39], a[104:107], a[148:151], a[36:39]
  buffer_load_dwordx4 a[228:231], v210, s[8:11], s30 offen offset:1024 sc1
  v_mfma_f32_16x16x32_bf16 a[40:43], a[104:107], a[152:155], a[40:43]
  ds_read_b64_tr_b16 a[138:139], v217 offset:13856
  v_mfma_f32_16x16x32_bf16 a[44:47], a[104:107], a[156:159], a[44:47]
  v_mfma_f32_16x16x32_bf16 a[48:51], a[108:111], a[144:147], a[48:51]
  ds_read_b64_tr_b16 a[140:141], v217 offset:27680
  v_mfma_f32_16x16x32_bf16 a[52:55], a[108:111], a[148:151], a[52:55]
  v_mfma_f32_16x16x32_bf16 a[56:59], a[108:111], a[152:155], a[56:59]
  ds_read_b64_tr_b16 a[142:143], v217 offset:32288
  v_mfma_f32_16x16x32_bf16 a[60:63], a[108:111], a[156:159], a[60:63]
  s_waitcnt lgkmcnt(12)
  v_mfma_f32_16x16x32_bf16 a[64:67], a[112:115], a[144:147], a[64:67]
  ds_read_b64_tr_b16 a[96:97], v217 offset:9280
  v_mfma_f32_16x16x32_bf16 a[68:71], a[112:115], a[148:151], a[68:71]
  v_mfma_f32_16x16x32_bf16 a[72:75], a[112:115], a[152:155], a[72:75]
  ds_read_b64_tr_b16 a[98:99], v217 offset:13888
  v_mfma_f32_16x16x32_bf16 a[76:79], a[112:115], a[156:159], a[76:79]
  v_mfma_f32_16x16x32_bf16 a[80:83], a[116:119], a[144:147], a[80:83]
  ds_read_b64_tr_b16 a[100:101], v217 offset:27712
  v_mfma_f32_16x16x32_bf16 a[84:87], a[116:119], a[148:151], a[84:87]
  buffer_load_dwordx4 a[232:235], v211, s[8:11], s30 offen offset:1024 sc1
  v_mfma_f32_16x16x32_bf16 a[88:91], a[116:119], a[152:155], a[88:91]
  ds_read_b64_tr_b16 a[102:103], v217 offset:32320
  v_mfma_f32_16x16x32_bf16 a[92:95], a[116:119], a[156:159], a[92:95]
  s_waitcnt vmcnt(33) lgkmcnt(12)
  v_mfma_f32_16x16x32_bf16 v[8:11], a[120:123], a[160:163], v[8:11]
  ds_read_b64_tr_b16 a[104:105], v217 offset:9312
  v_mfma_f32_16x16x32_bf16 v[12:15], a[120:123], a[164:167], v[12:15]
  v_mfma_f32_16x16x32_bf16 v[16:19], a[120:123], a[168:171], v[16:19]
  ds_read_b64_tr_b16 a[106:107], v217 offset:13920
  v_mfma_f32_16x16x32_bf16 v[20:23], a[120:123], a[172:175], v[20:23]
  v_mfma_f32_16x16x32_bf16 v[24:27], a[124:127], a[160:163], v[24:27]
  ds_read_b64_tr_b16 a[108:109], v217 offset:27744
  v_mfma_f32_16x16x32_bf16 v[28:31], a[124:127], a[164:167], v[28:31]
  v_mfma_f32_16x16x32_bf16 v[32:35], a[124:127], a[168:171], v[32:35]
  ds_read_b64_tr_b16 a[110:111], v217 offset:32352
  v_mfma_f32_16x16x32_bf16 v[36:39], a[124:127], a[172:175], v[36:39]
  s_waitcnt lgkmcnt(12)
  v_mfma_f32_16x16x32_bf16 v[40:43], a[128:131], a[160:163], v[40:43]
  ds_read_b64_tr_b16 a[112:113], v217 offset:9344
  v_mfma_f32_16x16x32_bf16 v[44:47], a[128:131], a[164:167], v[44:47]
  buffer_load_dwordx4 a[236:239], v212, s[8:11], s30 offen offset:1024 sc1
  s_add_u32 s30, s30, 0x800
  v_mfma_f32_16x16x32_bf16 v[48:51], a[128:131], a[168:171], v[48:51]
  ds_read_b64_tr_b16 a[114:115], v217 offset:13952
  v_lshlrev_b32 v252, 7, v0
  v_mfma_f32_16x16x32_bf16 v[52:55], a[128:131], a[172:175], v[52:55]
  v_mfma_f32_16x16x32_bf16 v[56:59], a[132:135], a[160:163], v[56:59]
  ds_read_b64_tr_b16 a[116:117], v217 offset:27776
  v_mfma_f32_16x16x32_bf16 v[60:63], a[132:135], a[164:167], v[60:63]
  v_mfma_f32_16x16x32_bf16 v[64:67], a[132:135], a[168:171], v[64:67]
  ds_read_b64_tr_b16 a[118:119], v217 offset:32384
  v_mfma_f32_16x16x32_bf16 v[68:71], a[132:135], a[172:175], v[68:71]
  s_waitcnt lgkmcnt(12)
  v_mfma_f32_16x16x32_bf16 v[72:75], a[136:139], a[160:163], v[72:75]
  ds_read_b64_tr_b16 a[120:121], v217 offset:9376
  v_mfma_f32_16x16x32_bf16 v[76:79], a[136:139], a[164:167], v[76:79]
  v_mfma_f32_16x16x32_bf16 v[80:83], a[136:139], a[168:171], v[80:83]
  ds_read_b64_tr_b16 a[122:123], v217 offset:13984
  v_mfma_f32_16x16x32_bf16 v[84:87], a[136:139], a[172:175], v[84:87]
  buffer_load_dword v253, v252, s[72:75], 0 offen
  v_mfma_f32_16x16x32_bf16 v[88:91], a[140:143], a[160:163], v[88:91]
  ds_read_b64_tr_b16 a[124:125], v217 offset:27808
  v_mfma_f32_16x16x32_bf16 v[92:95], a[140:143], a[164:167], v[92:95]
  v_mfma_f32_16x16x32_bf16 v[96:99], a[140:143], a[168:171], v[96:99]
  ds_read_b64_tr_b16 a[126:127], v217 offset:32416
  v_mfma_f32_16x16x32_bf16 v[100:103], a[140:143], a[172:175], v[100:103]
  s_waitcnt lgkmcnt(12)
  v_mfma_f32_16x16x32_bf16 v[104:107], a[96:99], a[160:163], v[104:107]
  ds_read_b64_tr_b16 a[128:129], v217 offset:9408
  v_mfma_f32_16x16x32_bf16 v[108:111], a[96:99], a[164:167], v[108:111]
  v_mfma_f32_16x16x32_bf16 v[112:115], a[96:99], a[168:171], v[112:115]
  ds_read_b64_tr_b16 a[130:131], v217 offset:14016
  v_mfma_f32_16x16x32_bf16 v[116:119], a[96:99], a[172:175], v[116:119]
  v_mfma_f32_16x16x32_bf16 v[120:123], a[100:103], a[160:163], v[120:123]
  ds_read_b64_tr_b16 a[132:133], v217 offset:27840
  v_mfma_f32_16x16x32_bf16 v[124:127], a[100:103], a[164:167], v[124:127]
  v_mfma_f32_16x16x32_bf16 v[128:131], a[100:103], a[168:171], v[128:131]
  ds_read_b64_tr_b16 a[134:135], v217 offset:32448
  v_mfma_f32_16x16x32_bf16 v[132:135], a[100:103], a[172:175], v[132:135]
  s_waitcnt lgkmcnt(12)
  v_mfma_f32_16x16x32_bf16 v[136:139], a[104:107], a[160:163], v[136:139]
  ds_read_b64_tr_b16 a[136:137], v217 offset:9440
  v_mfma_f32_16x16x32_bf16 v[140:143], a[104:107], a[164:167], v[140:143]
  v_mfma_f32_16x16x32_bf16 v[144:147], a[104:107], a[168:171], v[144:147]
  ds_read_b64_tr_b16 a[138:139], v217 offset:14048
  v_mfma_f32_16x16x32_bf16 v[148:151], a[104:107], a[172:175], v[148:151]
  v_mfma_f32_16x16x32_bf16 v[152:155], a[108:111], a[160:163], v[152:155]
  ds_read_b64_tr_b16 a[140:141], v217 offset:27872
  v_mfma_f32_16x16x32_bf16 v[156:159], a[108:111], a[164:167], v[156:159]
  s_waitcnt vmcnt(9)
  s_barrier
  v_mfma_f32_16x16x32_bf16 v[160:163], a[108:111], a[168:171], v[160:163]
  ds_read_b64_tr_b16 a[142:143], v217 offset:32480
  v_mfma_f32_16x16x32_bf16 v[164:167], a[108:111], a[172:175], v[164:167]
  s_waitcnt lgkmcnt(12)
  v_mfma_f32_16x16x32_bf16 v[168:171], a[112:115], a[160:163], v[168:171]
  ds_read_b64_tr_b16 a[96:97], v220
  v_mfma_f32_16x16x32_bf16 v[172:175], a[112:115], a[164:167], v[172:175]
  v_mfma_f32_16x16x32_bf16 v[176:179], a[112:115], a[168:171], v[176:179]
  ds_read_b64_tr_b16 a[98:99], v220 offset:4608
  v_mfma_f32_16x16x32_bf16 v[180:183], a[112:115], a[172:175], v[180:183]
  v_mfma_f32_16x16x32_bf16 v[184:187], a[116:119], a[160:163], v[184:187]
  ds_read_b64_tr_b16 a[100:101], v220 offset:9216
  v_mfma_f32_16x16x32_bf16 v[188:191], a[116:119], a[164:167], v[188:191]
  v_mfma_f32_16x16x32_bf16 v[192:195], a[116:119], a[168:171], v[192:195]
  ds_read_b64_tr_b16 a[102:103], v220 offset:13824
  v_mfma_f32_16x16x32_bf16 v[196:199], a[116:119], a[172:175], v[196:199]
  s_waitcnt lgkmcnt(12)
  v_mfma_f32_16x16x32_bf16 a[0:3], a[120:123], a[160:163], a[0:3]
  ds_read_b64_tr_b16 a[104:105], v214
  v_mfma_f32_16x16x32_bf16 a[4:7], a[120:123], a[164:167], a[4:7]
  v_mfma_f32_16x16x32_bf16 a[8:11], a[120:123], a[168:171], a[8:11]
  ds_read_b64_tr_b16 a[106:107], v214 offset:4608
  v_mfma_f32_16x16x32_bf16 a[12:15], a[120:123], a[172:175], a[12:15]
  v_mfma_f32_16x16x32_bf16 a[16:19], a[124:127], a[160:163], a[16:19]
  ds_read_b64_tr_b16 a[108:109], v214 offset:9216
  v_mfma_f32_16x16x32_bf16 a[20:23], a[124:127], a[164:167], a[20:23]
  v_mfma_f32_16x16x32_bf16 a[24:27], a[124:127], a[168:171], a[24:27]
  ds_read_b64_tr_b16 a[110:111], v214 offset:13824
  v_mfma_f32_16x16x32_bf16 a[28:31], a[124:127], a[172:175], a[28:31]
  s_waitcnt lgkmcnt(12)
  v_mfma_f32_16x16x32_bf16 a[32:35], a[128:131], a[160:163], a[32:35]
  ds_read_b64_tr_b16 a[112:113], v220 offset:18432
  v_mfma_f32_16x16x32_bf16 a[36:39], a[128:131], a[164:167], a[36:39]
  v_mfma_f32_16x16x32_bf16 a[40:43], a[128:131], a[168:171], a[40:43]
  ds_read_b64_tr_b16 a[114:115], v220 offset:23040
  v_mfma_f32_16x16x32_bf16 a[44:47], a[128:131], a[172:175], a[44:47]
  v_mfma_f32_16x16x32_bf16 a[48:51], a[132:135], a[160:163], a[48:51]
  ds_read_b64_tr_b16 a[116:117], v220 offset:27648
  v_mfma_f32_16x16x32_bf16 a[52:55], a[132:135], a[164:167], a[52:55]
  v_mfma_f32_16x16x32_bf16 a[56:59], a[132:135], a[168:171], a[56:59]
  ds_read_b64_tr_b16 a[118:119], v220 offset:32256
  v_mfma_f32_16x16x32_bf16 a[60:63], a[132:135], a[172:175], a[60:63]
  s_waitcnt lgkmcnt(12)
  v_mfma_f32_16x16x32_bf16 a[64:67], a[136:139], a[160:163], a[64:67]
  ds_read_b64_tr_b16 a[120:121], v214 offset:18432
  v_mfma_f32_16x16x32_bf16 a[68:71], a[136:139], a[164:167], a[68:71]
  v_mfma_f32_16x16x32_bf16 a[72:75], a[136:139], a[168:171], a[72:75]
  ds_read_b64_tr_b16 a[122:123], v214 offset:23040
  v_mfma_f32_16x16x32_bf16 a[76:79], a[136:139], a[172:175], a[76:79]
  v_mfma_f32_16x16x32_bf16 a[80:83], a[140:143], a[160:163], a[80:83]
  ds_read_b64_tr_b16 a[124:125], v214 offset:27648
  v_mfma_f32_16x16x32_bf16 a[84:87], a[140:143], a[164:167], a[84:87]
  v_mfma_f32_16x16x32_bf16 a[88:91], a[140:143], a[168:171], a[88:91]
  ds_read_b64_tr_b16 a[126:127], v214 offset:32256
  v_mfma_f32_16x16x32_bf16 a[92:95], a[140:143], a[172:175], a[92:95]
  s_waitcnt lgkmcnt(12)
  v_mfma_f32_16x16x32_bf16 v[8:11], a[96:99], a[176:179], v[8:11]
  ds_read_b64_tr_b16 a[128:129], v219
  s_add_u32 m0, s60, 0x9000
  v_mfma_f32_16x16x32_bf16 v[12:15], a[96:99], a[180:183], v[12:15]
  buffer_load_dwordx4 v240, s[56:59], s61 offen lds
  v_mfma_f32_16x16x32_bf16 v[16:19], a[96:99], a[184:187], v[16:19]
  ds_read_b64_tr_b16 a[130:131], v219 offset:4608
  v_mfma_f32_16x16x32_bf16 v[20:23], a[96:99], a[188:191], v[20:23]
  buffer_load_dwordx4 v241, s[56:59], s61 offen offset:1024 lds
  v_mfma_f32_16x16x32_bf16 v[8:11], a[100:103], a[192:195], v[8:11]
  ds_read_b64_tr_b16 a[132:133], v219 offset:9216
  v_mfma_f32_16x16x32_bf16 v[12:15], a[100:103], a[196:199], v[12:15]
  buffer_load_dwordx4 v242, s[56:59], s61 offen offset:2048 lds
  v_mfma_f32_16x16x32_bf16 v[16:19], a[100:103], a[200:203], v[16:19]
  ds_read_b64_tr_b16 a[134:135], v219 offset:13824
  v_mfma_f32_16x16x32_bf16 v[20:23], a[100:103], a[204:207], v[20:23]
  buffer_load_dwordx4 v243, s[56:59], s61 offen offset:3072 lds
  s_waitcnt vmcnt(5) lgkmcnt(12)
  v_mfma_f32_16x16x32_bf16 v[8:11], a[104:107], a[208:211], v[8:11]
  ds_read_b64_tr_b16 a[136:137], v213
  s_add_u32 m0, s60, 0xa000
  v_mfma_f32_16x16x32_bf16 v[12:15], a[104:107], a[212:215], v[12:15]
  buffer_load_dwordx4 v244, s[56:59], s61 offen lds
  v_mov_b32 v2, 0xbfb8aa3b
  v_mfma_f32_16x16x32_bf16 v[16:19], a[104:107], a[216:219], v[16:19]
  ds_read_b64_tr_b16 a[138:139], v213 offset:4608
  v_mfma_f32_16x16x32_bf16 v[20:23], a[104:107], a[220:223], v[20:23]
  buffer_load_dwordx4 v245, s[56:59], s61 offen offset:1024 lds
  v_mov_b32 v3, 0xbfb8aa3b
  v_mfma_f32_16x16x32_bf16 v[8:11], a[108:111], a[224:227], v[8:11]
  ds_read_b64_tr_b16 a[140:141], v213 offset:9216
  v_mfma_f32_16x16x32_bf16 v[12:15], a[108:111], a[228:231], v[12:15]
  buffer_load_dwordx4 v246, s[56:59], s61 offen offset:2048 lds
  v_mov_b32 v4, 1.0
  v_mfma_f32_16x16x32_bf16 v[16:19], a[108:111], a[232:235], v[16:19]
  ds_read_b64_tr_b16 a[142:143], v213 offset:13824
  v_mfma_f32_16x16x32_bf16 v[20:23], a[108:111], a[236:239], v[20:23]
  buffer_load_dwordx4 v247, s[56:59], s61 offen offset:3072 lds
  v_mov_b32 v5, 1.0
  s_waitcnt lgkmcnt(12)
  v_mfma_f32_16x16x32_bf16 v[24:27], a[112:115], a[176:179], v[24:27]
  ds_read_b64_tr_b16 a[96:97], v219 offset:18432
  s_add_u32 m0, s60, 0xb000
  v_mfma_f32_16x16x32_bf16 v[28:31], a[112:115], a[180:183], v[28:31]
  buffer_load_dwordx4 v248, s[56:59], s61 offen lds
  v_mfma_f32_16x16x32_bf16 v[32:35], a[112:115], a[184:187], v[32:35]
  ds_read_b64_tr_b16 a[98:99], v219 offset:23040
  s_add_u32 s61, s61, 0x24000
  v_mfma_f32_16x16x32_bf16 v[36:39], a[112:115], a[188:191], v[36:39]
  v_mfma_f32_16x16x32_bf16 v[24:27], a[116:119], a[192:195], v[24:27]
  ds_read_b64_tr_b16 a[100:101], v219 offset:27648
  v_mfma_f32_16x16x32_bf16 v[28:31], a[116:119], a[196:199], v[28:31]
  v_mfma_f32_16x16x32_bf16 v[32:35], a[116:119], a[200:203], v[32:35]
  ds_read_b64_tr_b16 a[102:103], v219 offset:32256
  v_mfma_f32_16x16x32_bf16 v[36:39], a[116:119], a[204:207], v[36:39]
  s_waitcnt lgkmcnt(12)
  v_mfma_f32_16x16x32_bf16 v[24:27], a[120:123], a[208:211], v[24:27]
  ds_read_b64_tr_b16 a[104:105], v213 offset:18432
  v_mfma_f32_16x16x32_bf16 v[28:31], a[120:123], a[212:215], v[28:31]
  v_mfma_f32_16x16x32_bf16 v[32:35], a[120:123], a[216:219], v[32:35]
  ds_read_b64_tr_b16 a[106:107], v213 offset:23040
  v_mfma_f32_16x16x32_bf16 v[36:39], a[120:123], a[220:223], v[36:39]
  v_mfma_f32_16x16x32_bf16 v[24:27], a[124:127], a[224:227], v[24:27]
  ds_read_b64_tr_b16 a[108:109], v213 offset:27648
  v_mfma_f32_16x16x32_bf16 v[28:31], a[124:127], a[228:231], v[28:31]
  v_mfma_f32_16x16x32_bf16 v[32:35], a[124:127], a[232:235], v[32:35]
  ds_read_b64_tr_b16 a[110:111], v213 offset:32256
  v_mfma_f32_16x16x32_bf16 v[36:39], a[124:127], a[236:239], v[36:39]
  s_waitcnt lgkmcnt(12)
  v_mfma_f32_16x16x32_bf16 v[40:43], a[128:131], a[176:179], v[40:43]
  ds_read_b64_tr_b16 a[112:113], v219 offset:32
  s_barrier
  s_add_u32 m0, s60, 0x12000
  v_mfma_f32_16x16x32_bf16 v[44:47], a[128:131], a[180:183], v[44:47]
  buffer_load_dwordx4 v240, s[56:59], s61 offen lds
  v_mfma_f32_16x16x32_bf16 v[48:51], a[128:131], a[184:187], v[48:51]
  ds_read_b64_tr_b16 a[114:115], v219 offset:4640
  v_mfma_f32_16x16x32_bf16 v[52:55], a[128:131], a[188:191], v[52:55]
  buffer_load_dwordx4 v241, s[56:59], s61 offen offset:1024 lds
  v_mfma_f32_16x16x32_bf16 v[40:43], a[132:135], a[192:195], v[40:43]
  ds_read_b64_tr_b16 a[116:117], v219 offset:9248
  v_mfma_f32_16x16x32_bf16 v[44:47], a[132:135], a[196:199], v[44:47]
  buffer_load_dwordx4 v242, s[56:59], s61 offen offset:2048 lds
  v_mfma_f32_16x16x32_bf16 v[48:51], a[132:135], a[200:203], v[48:51]
  ds_read_b64_tr_b16 a[118:119], v219 offset:13856
  v_mfma_f32_16x16x32_bf16 v[52:55], a[132:135], a[204:207], v[52:55]
  buffer_load_dwordx4 v243, s[56:59], s61 offen offset:3072 lds
  s_waitcnt lgkmcnt(12)
  v_mfma_f32_16x16x32_bf16 v[40:43], a[136:139], a[208:211], v[40:43]
  ds_read_b64_tr_b16 a[120:121], v213 offset:32
  s_add_u32 m0, s60, 0x13000
  v_mfma_f32_16x16x32_bf16 v[44:47], a[136:139], a[212:215], v[44:47]
  buffer_load_dwordx4 v244, s[56:59], s61 offen lds
  v_mfma_f32_16x16x32_bf16 v[48:51], a[136:139], a[216:219], v[48:51]
  ds_read_b64_tr_b16 a[122:123], v213 offset:4640
  v_mfma_f32_16x16x32_bf16 v[52:55], a[136:139], a[220:223], v[52:55]
  buffer_load_dwordx4 v245, s[56:59], s61 offen offset:1024 lds
  v_mfma_f32_16x16x32_bf16 v[40:43], a[140:143], a[224:227], v[40:43]
  ds_read_b64_tr_b16 a[124:125], v213 offset:9248
  v_mfma_f32_16x16x32_bf16 v[44:47], a[140:143], a[228:231], v[44:47]
  buffer_load_dwordx4 v246, s[56:59], s61 offen offset:2048 lds
  v_mfma_f32_16x16x32_bf16 v[48:51], a[140:143], a[232:235], v[48:51]
  ds_read_b64_tr_b16 a[126:127], v213 offset:13856
  v_mfma_f32_16x16x32_bf16 v[52:55], a[140:143], a[236:239], v[52:55]
  buffer_load_dwordx4 v247, s[56:59], s61 offen offset:3072 lds
  v_pk_mul_f32 v[24:25], v[24:25], v[8:9]
  v_pk_mul_f32 v[26:27], v[26:27], v[10:11]
  v_pk_mul_f32 v[28:29], v[28:29], v[12:13]
  v_pk_mul_f32 v[30:31], v[30:31], v[14:15]
  v_pk_mul_f32 v[32:33], v[32:33], v[16:17]
  v_pk_mul_f32 v[34:35], v[34:35], v[18:19]
  v_pk_mul_f32 v[36:37], v[36:37], v[20:21]
  v_pk_mul_f32 v[38:39], v[38:39], v[22:23]
  v_pk_mul_f32 v[8:9], v[8:9], v[2:3]
  v_pk_mul_f32 v[10:11], v[10:11], v[2:3]
  v_pk_mul_f32 v[12:13], v[12:13], v[2:3]
  v_pk_mul_f32 v[14:15], v[14:15], v[2:3]
  v_pk_mul_f32 v[16:17], v[16:17], v[2:3]
  v_pk_mul_f32 v[18:19], v[18:19], v[2:3]
  v_pk_mul_f32 v[20:21], v[20:21], v[2:3]
  v_pk_mul_f32 v[22:23], v[22:23], v[2:3]
  s_waitcnt lgkmcnt(12)
  v_mfma_f32_16x16x32_bf16 v[56:59], a[96:99], a[176:179], v[56:59]
  ds_read_b64_tr_b16 a[128:129], v219 offset:18464
  v_exp_f32 v8, v8
  s_add_u32 m0, s60, 0x14000
  v_mfma_f32_16x16x32_bf16 v[60:63], a[96:99], a[180:183], v[60:63]
  buffer_load_dwordx4 v248, s[56:59], s61 offen lds
  v_exp_f32 v9, v9
  v_mfma_f32_16x16x32_bf16 v[64:67], a[96:99], a[184:187], v[64:67]
  ds_read_b64_tr_b16 a[130:131], v219 offset:23072
  v_exp_f32 v10, v10
  s_add_u32 s61, s61, 0x24000
  v_mfma_f32_16x16x32_bf16 v[68:71], a[96:99], a[188:191], v[68:71]
  v_exp_f32 v11, v11
  v_mfma_f32_16x16x32_bf16 v[56:59], a[100:103], a[192:195], v[56:59]
  ds_read_b64_tr_b16 a[132:133], v219 offset:27680
  v_exp_f32 v12, v12
  v_mfma_f32_16x16x32_bf16 v[60:63], a[100:103], a[196:199], v[60:63]
  v_exp_f32 v13, v13
  v_mfma_f32_16x16x32_bf16 v[64:67], a[100:103], a[200:203], v[64:67]
  ds_read_b64_tr_b16 a[134:135], v219 offset:32288
  v_exp_f32 v14, v14
  v_mfma_f32_16x16x32_bf16 v[68:71], a[100:103], a[204:207], v[68:71]
  v_exp_f32 v15, v15
  s_waitcnt lgkmcnt(12)
  v_mfma_f32_16x16x32_bf16 v[56:59], a[104:107], a[208:211], v[56:59]
  ds_read_b64_tr_b16 a[136:137], v213 offset:18464
  v_exp_f32 v16, v16
  v_mfma_f32_16x16x32_bf16 v[60:63], a[104:107], a[212:215], v[60:63]
  v_exp_f32 v17, v17
  v_mfma_f32_16x16x32_bf16 v[64:67], a[104:107], a[216:219], v[64:67]
  ds_read_b64_tr_b16 a[138:139], v213 offset:23072
  v_exp_f32 v18, v18
  v_mfma_f32_16x16x32_bf16 v[68:71], a[104:107], a[220:223], v[68:71]
  v_exp_f32 v19, v19
  v_mfma_f32_16x16x32_bf16 v[56:59], a[108:111], a[224:227], v[56:59]
  ds_read_b64_tr_b16 a[140:141], v213 offset:27680
  v_exp_f32 v20, v20
  v_mfma_f32_16x16x32_bf16 v[60:63], a[108:111], a[228:231], v[60:63]
  v_exp_f32 v21, v21
  v_mfma_f32_16x16x32_bf16 v[64:67], a[108:111], a[232:235], v[64:67]
  ds_read_b64_tr_b16 a[142:143], v213 offset:32288
  v_exp_f32 v22, v22
  v_mfma_f32_16x16x32_bf16 v[68:71], a[108:111], a[236:239], v[68:71]
  v_exp_f32 v23, v23
  v_pk_add_f32 v[8:9], v[8:9], v[4:5]
  v_pk_add_f32 v[10:11], v[10:11], v[4:5]
  v_pk_add_f32 v[12:13], v[12:13], v[4:5]
  v_pk_add_f32 v[14:15], v[14:15], v[4:5]
  v_pk_add_f32 v[16:17], v[16:17], v[4:5]
  v_pk_add_f32 v[18:19], v[18:19], v[4:5]
  v_pk_add_f32 v[20:21], v[20:21], v[4:5]
  v_pk_add_f32 v[22:23], v[22:23], v[4:5]
  s_waitcnt lgkmcnt(12)
  v_mfma_f32_16x16x32_bf16 v[72:75], a[112:115], a[176:179], v[72:75]
  ds_read_b64_tr_b16 a[96:97], v219 offset:64
  v_rcp_f32 v8, v8
  v_mfma_f32_16x16x32_bf16 v[76:79], a[112:115], a[180:183], v[76:79]
  v_rcp_f32 v9, v9
  v_mfma_f32_16x16x32_bf16 v[80:83], a[112:115], a[184:187], v[80:83]
  ds_read_b64_tr_b16 a[98:99], v219 offset:4672
  v_rcp_f32 v10, v10
  v_mfma_f32_16x16x32_bf16 v[84:87], a[112:115], a[188:191], v[84:87]
  v_rcp_f32 v11, v11
  v_mfma_f32_16x16x32_bf16 v[72:75], a[116:119], a[192:195], v[72:75]
  ds_read_b64_tr_b16 a[100:101], v219 offset:9280
  v_rcp_f32 v12, v12
  v_mfma_f32_16x16x32_bf16 v[76:79], a[116:119], a[196:199], v[76:79]
  v_rcp_f32 v13, v13
  v_mfma_f32_16x16x32_bf16 v[80:83], a[116:119], a[200:203], v[80:83]
  ds_read_b64_tr_b16 a[102:103], v219 offset:13888
  v_rcp_f32 v14, v14
  v_mfma_f32_16x16x32_bf16 v[84:87], a[116:119], a[204:207], v[84:87]
  v_rcp_f32 v15, v15
  s_waitcnt lgkmcnt(12)
  v_mfma_f32_16x16x32_bf16 v[72:75], a[120:123], a[208:211], v[72:75]
  ds_read_b64_tr_b16 a[104:105], v213 offset:64
  v_rcp_f32 v16, v16
  v_mfma_f32_16x16x32_bf16 v[76:79], a[120:123], a[212:215], v[76:79]
  v_rcp_f32 v17, v17
  v_mfma_f32_16x16x32_bf16 v[80:83], a[120:123], a[216:219], v[80:83]
  ds_read_b64_tr_b16 a[106:107], v213 offset:4672
  v_rcp_f32 v18, v18
  v_mfma_f32_16x16x32_bf16 v[84:87], a[120:123], a[220:223], v[84:87]
  v_rcp_f32 v19, v19
  v_mfma_f32_16x16x32_bf16 v[72:75], a[124:127], a[224:227], v[72:75]
  ds_read_b64_tr_b16 a[108:109], v213 offset:9280
  v_rcp_f32 v20, v20
  v_mfma_f32_16x16x32_bf16 v[76:79], a[124:127], a[228:231], v[76:79]
  v_rcp_f32 v21, v21
  v_mfma_f32_16x16x32_bf16 v[80:83], a[124:127], a[232:235], v[80:83]
  ds_read_b64_tr_b16 a[110:111], v213 offset:13888
  v_rcp_f32 v22, v22
  v_mfma_f32_16x16x32_bf16 v[84:87], a[124:127], a[236:239], v[84:87]
  v_rcp_f32 v23, v23
  v_pk_mul_f32 v[24:25], v[24:25], v[8:9]
  v_pk_mul_f32 v[26:27], v[26:27], v[10:11]
  v_cvt_pk_bf16_f32 v8, v24, v25
  v_cvt_pk_bf16_f32 v9, v26, v27
  buffer_store_dwordx2 v[8:9], v239, s[24:27], s48 offen sc1
  v_pk_mul_f32 v[28:29], v[28:29], v[12:13]
  v_pk_mul_f32 v[30:31], v[30:31], v[14:15]
  v_cvt_pk_bf16_f32 v12, v28, v29
  v_cvt_pk_bf16_f32 v13, v30, v31
  buffer_store_dwordx2 v[12:13], v239, s[24:27], s49 offen sc1
  v_pk_mul_f32 v[32:33], v[32:33], v[16:17]
  v_pk_mul_f32 v[34:35], v[34:35], v[18:19]
  v_cvt_pk_bf16_f32 v16, v32, v33
  v_cvt_pk_bf16_f32 v17, v34, v35
  buffer_store_dwordx2 v[16:17], v239, s[24:27], s50 offen sc1
  v_pk_mul_f32 v[36:37], v[36:37], v[20:21]
  v_pk_mul_f32 v[38:39], v[38:39], v[22:23]
  v_cvt_pk_bf16_f32 v20, v36, v37
  v_cvt_pk_bf16_f32 v21, v38, v39
  buffer_store_dwordx2 v[20:21], v239, s[24:27], s51 offen sc1
  v_pk_mul_f32 v[56:57], v[56:57], v[40:41]
  v_pk_mul_f32 v[58:59], v[58:59], v[42:43]
  v_pk_mul_f32 v[60:61], v[60:61], v[44:45]
  v_pk_mul_f32 v[62:63], v[62:63], v[46:47]
  v_pk_mul_f32 v[64:65], v[64:65], v[48:49]
  v_pk_mul_f32 v[66:67], v[66:67], v[50:51]
  v_pk_mul_f32 v[68:69], v[68:69], v[52:53]
  v_pk_mul_f32 v[70:71], v[70:71], v[54:55]
  v_pk_mul_f32 v[40:41], v[40:41], v[2:3]
  v_pk_mul_f32 v[42:43], v[42:43], v[2:3]
  v_pk_mul_f32 v[44:45], v[44:45], v[2:3]
  v_pk_mul_f32 v[46:47], v[46:47], v[2:3]
  v_pk_mul_f32 v[48:49], v[48:49], v[2:3]
  v_pk_mul_f32 v[50:51], v[50:51], v[2:3]
  v_pk_mul_f32 v[52:53], v[52:53], v[2:3]
  v_pk_mul_f32 v[54:55], v[54:55], v[2:3]
  s_waitcnt lgkmcnt(12)
  v_mfma_f32_16x16x32_bf16 v[88:91], a[128:131], a[176:179], v[88:91]
  ds_read_b64_tr_b16 a[112:113], v219 offset:18496
  v_exp_f32 v40, v40
  v_mfma_f32_16x16x32_bf16 v[92:95], a[128:131], a[180:183], v[92:95]
  v_exp_f32 v41, v41
  v_mfma_f32_16x16x32_bf16 v[96:99], a[128:131], a[184:187], v[96:99]
  ds_read_b64_tr_b16 a[114:115], v219 offset:23104
  v_exp_f32 v42, v42
  v_mfma_f32_16x16x32_bf16 v[100:103], a[128:131], a[188:191], v[100:103]
  v_exp_f32 v43, v43
  v_mfma_f32_16x16x32_bf16 v[88:91], a[132:135], a[192:195], v[88:91]
  ds_read_b64_tr_b16 a[116:117], v219 offset:27712
  v_exp_f32 v44, v44
  v_mfma_f32_16x16x32_bf16 v[92:95], a[132:135], a[196:199], v[92:95]
  v_exp_f32 v45, v45
  v_mfma_f32_16x16x32_bf16 v[96:99], a[132:135], a[200:203], v[96:99]
  ds_read_b64_tr_b16 a[118:119], v219 offset:32320
  v_exp_f32 v46, v46
  v_mfma_f32_16x16x32_bf16 v[100:103], a[132:135], a[204:207], v[100:103]
  v_exp_f32 v47, v47
  s_waitcnt lgkmcnt(12)
  v_mfma_f32_16x16x32_bf16 v[88:91], a[136:139], a[208:211], v[88:91]
  ds_read_b64_tr_b16 a[120:121], v213 offset:18496
  v_exp_f32 v48, v48
  v_mfma_f32_16x16x32_bf16 v[92:95], a[136:139], a[212:215], v[92:95]
  v_exp_f32 v49, v49
  v_mfma_f32_16x16x32_bf16 v[96:99], a[136:139], a[216:219], v[96:99]
  ds_read_b64_tr_b16 a[122:123], v213 offset:23104
  v_exp_f32 v50, v50
  v_mfma_f32_16x16x32_bf16 v[100:103], a[136:139], a[220:223], v[100:103]
  v_exp_f32 v51, v51
  v_mfma_f32_16x16x32_bf16 v[88:91], a[140:143], a[224:227], v[88:91]
  ds_read_b64_tr_b16 a[124:125], v213 offset:27712
  v_exp_f32 v52, v52
  v_mfma_f32_16x16x32_bf16 v[92:95], a[140:143], a[228:231], v[92:95]
  v_exp_f32 v53, v53
  v_mfma_f32_16x16x32_bf16 v[96:99], a[140:143], a[232:235], v[96:99]
  ds_read_b64_tr_b16 a[126:127], v213 offset:32320
  v_exp_f32 v54, v54
  v_mfma_f32_16x16x32_bf16 v[100:103], a[140:143], a[236:239], v[100:103]
  v_exp_f32 v55, v55
  v_pk_add_f32 v[40:41], v[40:41], v[4:5]
  v_pk_add_f32 v[42:43], v[42:43], v[4:5]
  v_pk_add_f32 v[44:45], v[44:45], v[4:5]
  v_pk_add_f32 v[46:47], v[46:47], v[4:5]
  v_pk_add_f32 v[48:49], v[48:49], v[4:5]
  v_pk_add_f32 v[50:51], v[50:51], v[4:5]
  v_pk_add_f32 v[52:53], v[52:53], v[4:5]
  v_pk_add_f32 v[54:55], v[54:55], v[4:5]
  s_waitcnt lgkmcnt(12)
  v_mfma_f32_16x16x32_bf16 v[104:107], a[96:99], a[176:179], v[104:107]
  ds_read_b64_tr_b16 a[128:129], v219 offset:96
  v_rcp_f32 v40, v40
  v_mfma_f32_16x16x32_bf16 v[108:111], a[96:99], a[180:183], v[108:111]
  v_rcp_f32 v41, v41
  v_mfma_f32_16x16x32_bf16 v[112:115], a[96:99], a[184:187], v[112:115]
  ds_read_b64_tr_b16 a[130:131], v219 offset:4704
  v_rcp_f32 v42, v42
  v_mfma_f32_16x16x32_bf16 v[116:119], a[96:99], a[188:191], v[116:119]
  v_rcp_f32 v43, v43
  v_mfma_f32_16x16x32_bf16 v[104:107], a[100:103], a[192:195], v[104:107]
  ds_read_b64_tr_b16 a[132:133], v219 offset:9312
  v_rcp_f32 v44, v44
  v_mfma_f32_16x16x32_bf16 v[108:111], a[100:103], a[196:199], v[108:111]
  v_rcp_f32 v45, v45
  v_mfma_f32_16x16x32_bf16 v[112:115], a[100:103], a[200:203], v[112:115]
  ds_read_b64_tr_b16 a[134:135], v219 offset:13920
  v_rcp_f32 v46, v46
  v_mfma_f32_16x16x32_bf16 v[116:119], a[100:103], a[204:207], v[116:119]
  v_rcp_f32 v47, v47
  s_waitcnt lgkmcnt(12)
  v_mfma_f32_16x16x32_bf16 v[104:107], a[104:107], a[208:211], v[104:107]
  ds_read_b64_tr_b16 a[136:137], v213 offset:96
  v_rcp_f32 v48, v48
  v_mfma_f32_16x16x32_bf16 v[108:111], a[104:107], a[212:215], v[108:111]
  v_rcp_f32 v49, v49
  v_mfma_f32_16x16x32_bf16 v[112:115], a[104:107], a[216:219], v[112:115]
  ds_read_b64_tr_b16 a[138:139], v213 offset:4704
  v_rcp_f32 v50, v50
  v_mfma_f32_16x16x32_bf16 v[116:119], a[104:107], a[220:223], v[116:119]
  v_rcp_f32 v51, v51
  v_mfma_f32_16x16x32_bf16 v[104:107], a[108:111], a[224:227], v[104:107]
  ds_read_b64_tr_b16 a[140:141], v213 offset:9312
  v_rcp_f32 v52, v52
  v_mfma_f32_16x16x32_bf16 v[108:111], a[108:111], a[228:231], v[108:111]
  v_rcp_f32 v53, v53
  v_mfma_f32_16x16x32_bf16 v[112:115], a[108:111], a[232:235], v[112:115]
  ds_read_b64_tr_b16 a[142:143], v213 offset:13920
  v_rcp_f32 v54, v54
  v_mfma_f32_16x16x32_bf16 v[116:119], a[108:111], a[236:239], v[116:119]
  v_rcp_f32 v55, v55
  v_pk_mul_f32 v[56:57], v[56:57], v[40:41]
  v_pk_mul_f32 v[58:59], v[58:59], v[42:43]
  v_cvt_pk_bf16_f32 v40, v56, v57
  v_cvt_pk_bf16_f32 v41, v58, v59
  v_pk_mul_f32 v[60:61], v[60:61], v[44:45]
  v_pk_mul_f32 v[62:63], v[62:63], v[46:47]
  v_cvt_pk_bf16_f32 v44, v60, v61
  v_cvt_pk_bf16_f32 v45, v62, v63
  v_pk_mul_f32 v[64:65], v[64:65], v[48:49]
  v_pk_mul_f32 v[66:67], v[66:67], v[50:51]
  v_cvt_pk_bf16_f32 v48, v64, v65
  v_cvt_pk_bf16_f32 v49, v66, v67
  v_pk_mul_f32 v[68:69], v[68:69], v[52:53]
  v_pk_mul_f32 v[70:71], v[70:71], v[54:55]
  v_cvt_pk_bf16_f32 v52, v68, v69
  v_cvt_pk_bf16_f32 v53, v70, v71
  v_pk_mul_f32 v[88:89], v[88:89], v[72:73]
  v_pk_mul_f32 v[90:91], v[90:91], v[74:75]
  v_pk_mul_f32 v[92:93], v[92:93], v[76:77]
  v_pk_mul_f32 v[94:95], v[94:95], v[78:79]
  v_pk_mul_f32 v[96:97], v[96:97], v[80:81]
  v_pk_mul_f32 v[98:99], v[98:99], v[82:83]
  v_pk_mul_f32 v[100:101], v[100:101], v[84:85]
  v_pk_mul_f32 v[102:103], v[102:103], v[86:87]
  v_pk_mul_f32 v[72:73], v[72:73], v[2:3]
  v_pk_mul_f32 v[74:75], v[74:75], v[2:3]
  v_pk_mul_f32 v[76:77], v[76:77], v[2:3]
  v_pk_mul_f32 v[78:79], v[78:79], v[2:3]
  v_pk_mul_f32 v[80:81], v[80:81], v[2:3]
  v_pk_mul_f32 v[82:83], v[82:83], v[2:3]
  v_pk_mul_f32 v[84:85], v[84:85], v[2:3]
  v_pk_mul_f32 v[86:87], v[86:87], v[2:3]
  s_waitcnt lgkmcnt(12)
  v_mfma_f32_16x16x32_bf16 v[120:123], a[112:115], a[176:179], v[120:123]
  ds_read_b64_tr_b16 a[96:97], v219 offset:18528
  v_exp_f32 v72, v72
  v_mfma_f32_16x16x32_bf16 v[124:127], a[112:115], a[180:183], v[124:127]
  v_exp_f32 v73, v73
  v_mfma_f32_16x16x32_bf16 v[128:131], a[112:115], a[184:187], v[128:131]
  ds_read_b64_tr_b16 a[98:99], v219 offset:23136
  v_exp_f32 v74, v74
  v_mfma_f32_16x16x32_bf16 v[132:135], a[112:115], a[188:191], v[132:135]
  v_exp_f32 v75, v75
  v_mfma_f32_16x16x32_bf16 v[120:123], a[116:119], a[192:195], v[120:123]
  ds_read_b64_tr_b16 a[100:101], v219 offset:27744
  v_exp_f32 v76, v76
  v_mfma_f32_16x16x32_bf16 v[124:127], a[116:119], a[196:199], v[124:127]
  v_exp_f32 v77, v77
  v_mfma_f32_16x16x32_bf16 v[128:131], a[116:119], a[200:203], v[128:131]
  ds_read_b64_tr_b16 a[102:103], v219 offset:32352
  v_exp_f32 v78, v78
  v_mfma_f32_16x16x32_bf16 v[132:135], a[116:119], a[204:207], v[132:135]
  v_exp_f32 v79, v79
  s_waitcnt lgkmcnt(12)
  v_mfma_f32_16x16x32_bf16 v[120:123], a[120:123], a[208:211], v[120:123]
  ds_read_b64_tr_b16 a[104:105], v213 offset:18528
  v_exp_f32 v80, v80
  v_mfma_f32_16x16x32_bf16 v[124:127], a[120:123], a[212:215], v[124:127]
  v_exp_f32 v81, v81
  v_mfma_f32_16x16x32_bf16 v[128:131], a[120:123], a[216:219], v[128:131]
  ds_read_b64_tr_b16 a[106:107], v213 offset:23136
  v_exp_f32 v82, v82
  v_mfma_f32_16x16x32_bf16 v[132:135], a[120:123], a[220:223], v[132:135]
  v_exp_f32 v83, v83
  v_mfma_f32_16x16x32_bf16 v[120:123], a[124:127], a[224:227], v[120:123]
  ds_read_b64_tr_b16 a[108:109], v213 offset:27744
  v_exp_f32 v84, v84
  v_mfma_f32_16x16x32_bf16 v[124:127], a[124:127], a[228:231], v[124:127]
  v_exp_f32 v85, v85
  v_mfma_f32_16x16x32_bf16 v[128:131], a[124:127], a[232:235], v[128:131]
  ds_read_b64_tr_b16 a[110:111], v213 offset:32352
  v_exp_f32 v86, v86
  v_mfma_f32_16x16x32_bf16 v[132:135], a[124:127], a[236:239], v[132:135]
  v_exp_f32 v87, v87
  v_pk_add_f32 v[72:73], v[72:73], v[4:5]
  v_pk_add_f32 v[74:75], v[74:75], v[4:5]
  v_pk_add_f32 v[76:77], v[76:77], v[4:5]
  v_pk_add_f32 v[78:79], v[78:79], v[4:5]
  v_pk_add_f32 v[80:81], v[80:81], v[4:5]
  v_pk_add_f32 v[82:83], v[82:83], v[4:5]
  v_pk_add_f32 v[84:85], v[84:85], v[4:5]
  v_pk_add_f32 v[86:87], v[86:87], v[4:5]
  s_waitcnt lgkmcnt(12)
  v_mfma_f32_16x16x32_bf16 v[136:139], a[128:131], a[176:179], v[136:139]
  ds_read_b64_tr_b16 a[112:113], v219 offset:128
  v_rcp_f32 v72, v72
  v_mfma_f32_16x16x32_bf16 v[140:143], a[128:131], a[180:183], v[140:143]
  v_rcp_f32 v73, v73
  v_mfma_f32_16x16x32_bf16 v[144:147], a[128:131], a[184:187], v[144:147]
  ds_read_b64_tr_b16 a[114:115], v219 offset:4736
  v_rcp_f32 v74, v74
  v_mfma_f32_16x16x32_bf16 v[148:151], a[128:131], a[188:191], v[148:151]
  v_rcp_f32 v75, v75
  v_mfma_f32_16x16x32_bf16 v[136:139], a[132:135], a[192:195], v[136:139]
  ds_read_b64_tr_b16 a[116:117], v219 offset:9344
  v_rcp_f32 v76, v76
  v_mfma_f32_16x16x32_bf16 v[140:143], a[132:135], a[196:199], v[140:143]
  v_rcp_f32 v77, v77
  v_mfma_f32_16x16x32_bf16 v[144:147], a[132:135], a[200:203], v[144:147]
  ds_read_b64_tr_b16 a[118:119], v219 offset:13952
  v_rcp_f32 v78, v78
  v_mfma_f32_16x16x32_bf16 v[148:151], a[132:135], a[204:207], v[148:151]
  v_rcp_f32 v79, v79
  s_waitcnt lgkmcnt(12)
  v_mfma_f32_16x16x32_bf16 v[136:139], a[136:139], a[208:211], v[136:139]
  ds_read_b64_tr_b16 a[120:121], v213 offset:128
  v_rcp_f32 v80, v80
  v_mfma_f32_16x16x32_bf16 v[140:143], a[136:139], a[212:215], v[140:143]
  v_rcp_f32 v81, v81
  v_mfma_f32_16x16x32_bf16 v[144:147], a[136:139], a[216:219], v[144:147]
  ds_read_b64_tr_b16 a[122:123], v213 offset:4736
  v_rcp_f32 v82, v82
  v_mfma_f32_16x16x32_bf16 v[148:151], a[136:139], a[220:223], v[148:151]
  v_rcp_f32 v83, v83
  v_mfma_f32_16x16x32_bf16 v[136:139], a[140:143], a[224:227], v[136:139]
  ds_read_b64_tr_b16 a[124:125], v213 offset:9344
  v_rcp_f32 v84, v84
  v_mfma_f32_16x16x32_bf16 v[140:143], a[140:143], a[228:231], v[140:143]
  v_rcp_f32 v85, v85
  v_mfma_f32_16x16x32_bf16 v[144:147], a[140:143], a[232:235], v[144:147]
  ds_read_b64_tr_b16 a[126:127], v213 offset:13952
  v_rcp_f32 v86, v86
  v_mfma_f32_16x16x32_bf16 v[148:151], a[140:143], a[236:239], v[148:151]
  v_rcp_f32 v87, v87
  v_pk_mul_f32 v[88:89], v[88:89], v[72:73]
  v_pk_mul_f32 v[90:91], v[90:91], v[74:75]
  v_cvt_pk_bf16_f32 v42, v88, v89
  v_cvt_pk_bf16_f32 v43, v90, v91
  buffer_store_dwordx4 v[40:43], v238, s[24:27], s48 offen sc1
  v_pk_mul_f32 v[92:93], v[92:93], v[76:77]
  v_pk_mul_f32 v[94:95], v[94:95], v[78:79]
  v_cvt_pk_bf16_f32 v46, v92, v93
  v_cvt_pk_bf16_f32 v47, v94, v95
  buffer_store_dwordx4 v[44:47], v238, s[24:27], s49 offen sc1
  v_pk_mul_f32 v[96:97], v[96:97], v[80:81]
  v_pk_mul_f32 v[98:99], v[98:99], v[82:83]
  v_cvt_pk_bf16_f32 v50, v96, v97
  v_cvt_pk_bf16_f32 v51, v98, v99
  buffer_store_dwordx4 v[48:51], v238, s[24:27], s50 offen sc1
  v_pk_mul_f32 v[100:101], v[100:101], v[84:85]
  v_pk_mul_f32 v[102:103], v[102:103], v[86:87]
  v_cvt_pk_bf16_f32 v54, v100, v101
  v_cvt_pk_bf16_f32 v55, v102, v103
  buffer_store_dwordx4 v[52:55], v238, s[24:27], s51 offen sc1
  v_pk_mul_f32 v[120:121], v[120:121], v[104:105]
  v_pk_mul_f32 v[122:123], v[122:123], v[106:107]
  v_pk_mul_f32 v[124:125], v[124:125], v[108:109]
  v_pk_mul_f32 v[126:127], v[126:127], v[110:111]
  v_pk_mul_f32 v[128:129], v[128:129], v[112:113]
  v_pk_mul_f32 v[130:131], v[130:131], v[114:115]
  v_pk_mul_f32 v[132:133], v[132:133], v[116:117]
  v_pk_mul_f32 v[134:135], v[134:135], v[118:119]
  v_pk_mul_f32 v[104:105], v[104:105], v[2:3]
  v_pk_mul_f32 v[106:107], v[106:107], v[2:3]
  v_pk_mul_f32 v[108:109], v[108:109], v[2:3]
  v_pk_mul_f32 v[110:111], v[110:111], v[2:3]
  v_pk_mul_f32 v[112:113], v[112:113], v[2:3]
  v_pk_mul_f32 v[114:115], v[114:115], v[2:3]
  v_pk_mul_f32 v[116:117], v[116:117], v[2:3]
  v_pk_mul_f32 v[118:119], v[118:119], v[2:3]
  s_waitcnt lgkmcnt(12)
  v_mfma_f32_16x16x32_bf16 v[152:155], a[96:99], a[176:179], v[152:155]
  ds_read_b64_tr_b16 a[128:129], v219 offset:18560
  v_exp_f32 v104, v104
  v_mfma_f32_16x16x32_bf16 v[156:159], a[96:99], a[180:183], v[156:159]
  v_exp_f32 v105, v105
  v_mfma_f32_16x16x32_bf16 v[160:163], a[96:99], a[184:187], v[160:163]
  ds_read_b64_tr_b16 a[130:131], v219 offset:23168
  v_exp_f32 v106, v106
  v_mfma_f32_16x16x32_bf16 v[164:167], a[96:99], a[188:191], v[164:167]
  v_exp_f32 v107, v107
  v_mfma_f32_16x16x32_bf16 v[152:155], a[100:103], a[192:195], v[152:155]
  ds_read_b64_tr_b16 a[132:133], v219 offset:27776
  v_exp_f32 v108, v108
  v_mfma_f32_16x16x32_bf16 v[156:159], a[100:103], a[196:199], v[156:159]
  v_exp_f32 v109, v109
  v_mfma_f32_16x16x32_bf16 v[160:163], a[100:103], a[200:203], v[160:163]
  ds_read_b64_tr_b16 a[134:135], v219 offset:32384
  v_exp_f32 v110, v110
  v_mfma_f32_16x16x32_bf16 v[164:167], a[100:103], a[204:207], v[164:167]
  v_exp_f32 v111, v111
  s_waitcnt lgkmcnt(12)
  v_mfma_f32_16x16x32_bf16 v[152:155], a[104:107], a[208:211], v[152:155]
  ds_read_b64_tr_b16 a[136:137], v213 offset:18560
  v_exp_f32 v112, v112
  v_mfma_f32_16x16x32_bf16 v[156:159], a[104:107], a[212:215], v[156:159]
  v_exp_f32 v113, v113
  v_mfma_f32_16x16x32_bf16 v[160:163], a[104:107], a[216:219], v[160:163]
  ds_read_b64_tr_b16 a[138:139], v213 offset:23168
  v_exp_f32 v114, v114
  v_mfma_f32_16x16x32_bf16 v[164:167], a[104:107], a[220:223], v[164:167]
  v_exp_f32 v115, v115
  v_mfma_f32_16x16x32_bf16 v[152:155], a[108:111], a[224:227], v[152:155]
  ds_read_b64_tr_b16 a[140:141], v213 offset:27776
  v_exp_f32 v116, v116
  v_mfma_f32_16x16x32_bf16 v[156:159], a[108:111], a[228:231], v[156:159]
  v_exp_f32 v117, v117
  v_mfma_f32_16x16x32_bf16 v[160:163], a[108:111], a[232:235], v[160:163]
  ds_read_b64_tr_b16 a[142:143], v213 offset:32384
  v_exp_f32 v118, v118
  v_mfma_f32_16x16x32_bf16 v[164:167], a[108:111], a[236:239], v[164:167]
  v_exp_f32 v119, v119
  v_pk_add_f32 v[104:105], v[104:105], v[4:5]
  v_pk_add_f32 v[106:107], v[106:107], v[4:5]
  v_pk_add_f32 v[108:109], v[108:109], v[4:5]
  v_pk_add_f32 v[110:111], v[110:111], v[4:5]
  v_pk_add_f32 v[112:113], v[112:113], v[4:5]
  v_pk_add_f32 v[114:115], v[114:115], v[4:5]
  v_pk_add_f32 v[116:117], v[116:117], v[4:5]
  v_pk_add_f32 v[118:119], v[118:119], v[4:5]
  s_waitcnt lgkmcnt(12)
  v_mfma_f32_16x16x32_bf16 v[168:171], a[112:115], a[176:179], v[168:171]
  ds_read_b64_tr_b16 a[96:97], v219 offset:160
  v_rcp_f32 v104, v104
  v_mfma_f32_16x16x32_bf16 v[172:175], a[112:115], a[180:183], v[172:175]
  v_rcp_f32 v105, v105
  v_mfma_f32_16x16x32_bf16 v[176:179], a[112:115], a[184:187], v[176:179]
  ds_read_b64_tr_b16 a[98:99], v219 offset:4768
  v_rcp_f32 v106, v106
  v_mfma_f32_16x16x32_bf16 v[180:183], a[112:115], a[188:191], v[180:183]
  v_rcp_f32 v107, v107
  v_mfma_f32_16x16x32_bf16 v[168:171], a[116:119], a[192:195], v[168:171]
  ds_read_b64_tr_b16 a[100:101], v219 offset:9376
  v_rcp_f32 v108, v108
  v_mfma_f32_16x16x32_bf16 v[172:175], a[116:119], a[196:199], v[172:175]
  v_rcp_f32 v109, v109
  v_mfma_f32_16x16x32_bf16 v[176:179], a[116:119], a[200:203], v[176:179]
  ds_read_b64_tr_b16 a[102:103], v219 offset:13984
  v_rcp_f32 v110, v110
  v_mfma_f32_16x16x32_bf16 v[180:183], a[116:119], a[204:207], v[180:183]
  v_rcp_f32 v111, v111
  s_waitcnt lgkmcnt(12)
  v_mfma_f32_16x16x32_bf16 v[168:171], a[120:123], a[208:211], v[168:171]
  ds_read_b64_tr_b16 a[104:105], v213 offset:160
  v_rcp_f32 v112, v112
  v_mfma_f32_16x16x32_bf16 v[172:175], a[120:123], a[212:215], v[172:175]
  v_rcp_f32 v113, v113
  v_mfma_f32_16x16x32_bf16 v[176:179], a[120:123], a[216:219], v[176:179]
  ds_read_b64_tr_b16 a[106:107], v213 offset:4768
  v_rcp_f32 v114, v114
  v_mfma_f32_16x16x32_bf16 v[180:183], a[120:123], a[220:223], v[180:183]
  v_rcp_f32 v115, v115
  v_mfma_f32_16x16x32_bf16 v[168:171], a[124:127], a[224:227], v[168:171]
  ds_read_b64_tr_b16 a[108:109], v213 offset:9376
  v_rcp_f32 v116, v116
  v_mfma_f32_16x16x32_bf16 v[172:175], a[124:127], a[228:231], v[172:175]
  v_rcp_f32 v117, v117
  v_mfma_f32_16x16x32_bf16 v[176:179], a[124:127], a[232:235], v[176:179]
  ds_read_b64_tr_b16 a[110:111], v213 offset:13984
  v_rcp_f32 v118, v118
  v_mfma_f32_16x16x32_bf16 v[180:183], a[124:127], a[236:239], v[180:183]
  v_rcp_f32 v119, v119
  v_pk_mul_f32 v[120:121], v[120:121], v[104:105]
  v_pk_mul_f32 v[122:123], v[122:123], v[106:107]
  v_cvt_pk_bf16_f32 v104, v120, v121
  v_cvt_pk_bf16_f32 v105, v122, v123
  v_pk_mul_f32 v[124:125], v[124:125], v[108:109]
  v_pk_mul_f32 v[126:127], v[126:127], v[110:111]
  v_cvt_pk_bf16_f32 v108, v124, v125
  v_cvt_pk_bf16_f32 v109, v126, v127
  v_pk_mul_f32 v[128:129], v[128:129], v[112:113]
  v_pk_mul_f32 v[130:131], v[130:131], v[114:115]
  v_cvt_pk_bf16_f32 v112, v128, v129
  v_cvt_pk_bf16_f32 v113, v130, v131
  v_pk_mul_f32 v[132:133], v[132:133], v[116:117]
  v_pk_mul_f32 v[134:135], v[134:135], v[118:119]
  v_cvt_pk_bf16_f32 v116, v132, v133
  v_cvt_pk_bf16_f32 v117, v134, v135
  v_pk_mul_f32 v[152:153], v[152:153], v[136:137]
  v_pk_mul_f32 v[154:155], v[154:155], v[138:139]
  v_pk_mul_f32 v[156:157], v[156:157], v[140:141]
  v_pk_mul_f32 v[158:159], v[158:159], v[142:143]
  v_pk_mul_f32 v[160:161], v[160:161], v[144:145]
  v_pk_mul_f32 v[162:163], v[162:163], v[146:147]
  v_pk_mul_f32 v[164:165], v[164:165], v[148:149]
  v_pk_mul_f32 v[166:167], v[166:167], v[150:151]
  v_pk_mul_f32 v[136:137], v[136:137], v[2:3]
  v_pk_mul_f32 v[138:139], v[138:139], v[2:3]
  v_pk_mul_f32 v[140:141], v[140:141], v[2:3]
  v_pk_mul_f32 v[142:143], v[142:143], v[2:3]
  v_pk_mul_f32 v[144:145], v[144:145], v[2:3]
  v_pk_mul_f32 v[146:147], v[146:147], v[2:3]
  v_pk_mul_f32 v[148:149], v[148:149], v[2:3]
  v_pk_mul_f32 v[150:151], v[150:151], v[2:3]
  s_waitcnt lgkmcnt(12)
  v_mfma_f32_16x16x32_bf16 v[184:187], a[128:131], a[176:179], v[184:187]
  ds_read_b64_tr_b16 a[112:113], v219 offset:18592
  v_exp_f32 v136, v136
  v_mfma_f32_16x16x32_bf16 v[188:191], a[128:131], a[180:183], v[188:191]
  v_exp_f32 v137, v137
  v_mfma_f32_16x16x32_bf16 v[192:195], a[128:131], a[184:187], v[192:195]
  ds_read_b64_tr_b16 a[114:115], v219 offset:23200
  v_exp_f32 v138, v138
  v_mfma_f32_16x16x32_bf16 v[196:199], a[128:131], a[188:191], v[196:199]
  v_exp_f32 v139, v139
  v_mfma_f32_16x16x32_bf16 v[184:187], a[132:135], a[192:195], v[184:187]
  ds_read_b64_tr_b16 a[116:117], v219 offset:27808
  v_exp_f32 v140, v140
  v_mfma_f32_16x16x32_bf16 v[188:191], a[132:135], a[196:199], v[188:191]
  v_exp_f32 v141, v141
  v_mfma_f32_16x16x32_bf16 v[192:195], a[132:135], a[200:203], v[192:195]
  ds_read_b64_tr_b16 a[118:119], v219 offset:32416
  v_exp_f32 v142, v142
  v_mfma_f32_16x16x32_bf16 v[196:199], a[132:135], a[204:207], v[196:199]
  v_exp_f32 v143, v143
  s_waitcnt lgkmcnt(12)
  v_mfma_f32_16x16x32_bf16 v[184:187], a[136:139], a[208:211], v[184:187]
  ds_read_b64_tr_b16 a[120:121], v213 offset:18592
  v_exp_f32 v144, v144
  v_mfma_f32_16x16x32_bf16 v[188:191], a[136:139], a[212:215], v[188:191]
  v_exp_f32 v145, v145
  v_mfma_f32_16x16x32_bf16 v[192:195], a[136:139], a[216:219], v[192:195]
  ds_read_b64_tr_b16 a[122:123], v213 offset:23200
  v_exp_f32 v146, v146
  v_mfma_f32_16x16x32_bf16 v[196:199], a[136:139], a[220:223], v[196:199]
  v_exp_f32 v147, v147
  v_mfma_f32_16x16x32_bf16 v[184:187], a[140:143], a[224:227], v[184:187]
  ds_read_b64_tr_b16 a[124:125], v213 offset:27808
  v_exp_f32 v148, v148
  v_mfma_f32_16x16x32_bf16 v[188:191], a[140:143], a[228:231], v[188:191]
  v_exp_f32 v149, v149
  v_mfma_f32_16x16x32_bf16 v[192:195], a[140:143], a[232:235], v[192:195]
  ds_read_b64_tr_b16 a[126:127], v213 offset:32416
  v_exp_f32 v150, v150
  v_mfma_f32_16x16x32_bf16 v[196:199], a[140:143], a[236:239], v[196:199]
  v_exp_f32 v151, v151
  v_pk_add_f32 v[136:137], v[136:137], v[4:5]
  v_pk_add_f32 v[138:139], v[138:139], v[4:5]
  v_pk_add_f32 v[140:141], v[140:141], v[4:5]
  v_pk_add_f32 v[142:143], v[142:143], v[4:5]
  v_pk_add_f32 v[144:145], v[144:145], v[4:5]
  v_pk_add_f32 v[146:147], v[146:147], v[4:5]
  v_pk_add_f32 v[148:149], v[148:149], v[4:5]
  v_pk_add_f32 v[150:151], v[150:151], v[4:5]
  s_waitcnt lgkmcnt(12)
  v_mfma_f32_16x16x32_bf16 a[0:3], a[96:99], a[176:179], a[0:3]
  ds_read_b64_tr_b16 a[128:129], v219 offset:192
  v_rcp_f32 v136, v136
  v_mfma_f32_16x16x32_bf16 a[4:7], a[96:99], a[180:183], a[4:7]
  v_rcp_f32 v137, v137
  v_mfma_f32_16x16x32_bf16 a[8:11], a[96:99], a[184:187], a[8:11]
  ds_read_b64_tr_b16 a[130:131], v219 offset:4800
  v_rcp_f32 v138, v138
  v_mfma_f32_16x16x32_bf16 a[12:15], a[96:99], a[188:191], a[12:15]
  v_rcp_f32 v139, v139
  v_mfma_f32_16x16x32_bf16 a[0:3], a[100:103], a[192:195], a[0:3]
  ds_read_b64_tr_b16 a[132:133], v219 offset:9408
  v_rcp_f32 v140, v140
  v_mfma_f32_16x16x32_bf16 a[4:7], a[100:103], a[196:199], a[4:7]
  v_rcp_f32 v141, v141
  v_mfma_f32_16x16x32_bf16 a[8:11], a[100:103], a[200:203], a[8:11]
  ds_read_b64_tr_b16 a[134:135], v219 offset:14016
  v_rcp_f32 v142, v142
  v_mfma_f32_16x16x32_bf16 a[12:15], a[100:103], a[204:207], a[12:15]
  v_rcp_f32 v143, v143
  s_waitcnt lgkmcnt(12)
  v_mfma_f32_16x16x32_bf16 a[0:3], a[104:107], a[208:211], a[0:3]
  ds_read_b64_tr_b16 a[136:137], v213 offset:192
  v_rcp_f32 v144, v144
  v_mfma_f32_16x16x32_bf16 a[4:7], a[104:107], a[212:215], a[4:7]
  v_rcp_f32 v145, v145
  v_mfma_f32_16x16x32_bf16 a[8:11], a[104:107], a[216:219], a[8:11]
  ds_read_b64_tr_b16 a[138:139], v213 offset:4800
  v_rcp_f32 v146, v146
  v_mfma_f32_16x16x32_bf16 a[12:15], a[104:107], a[220:223], a[12:15]
  v_rcp_f32 v147, v147
  v_mfma_f32_16x16x32_bf16 a[0:3], a[108:111], a[224:227], a[0:3]
  ds_read_b64_tr_b16 a[140:141], v213 offset:9408
  v_rcp_f32 v148, v148
  v_mfma_f32_16x16x32_bf16 a[4:7], a[108:111], a[228:231], a[4:7]
  v_rcp_f32 v149, v149
  v_mfma_f32_16x16x32_bf16 a[8:11], a[108:111], a[232:235], a[8:11]
  ds_read_b64_tr_b16 a[142:143], v213 offset:14016
  v_rcp_f32 v150, v150
  v_mfma_f32_16x16x32_bf16 a[12:15], a[108:111], a[236:239], a[12:15]
  v_rcp_f32 v151, v151
  v_pk_mul_f32 v[152:153], v[152:153], v[136:137]
  v_pk_mul_f32 v[154:155], v[154:155], v[138:139]
  v_cvt_pk_bf16_f32 v106, v152, v153
  v_cvt_pk_bf16_f32 v107, v154, v155
  buffer_store_dwordx4 v[104:107], v238, s[24:27], s48 offen offset:1024 sc1
  v_pk_mul_f32 v[156:157], v[156:157], v[140:141]
  v_pk_mul_f32 v[158:159], v[158:159], v[142:143]
  v_cvt_pk_bf16_f32 v110, v156, v157
  v_cvt_pk_bf16_f32 v111, v158, v159
  buffer_store_dwordx4 v[108:111], v238, s[24:27], s49 offen offset:1024 sc1
  v_pk_mul_f32 v[160:161], v[160:161], v[144:145]
  v_pk_mul_f32 v[162:163], v[162:163], v[146:147]
  v_cvt_pk_bf16_f32 v114, v160, v161
  v_cvt_pk_bf16_f32 v115, v162, v163
  buffer_store_dwordx4 v[112:115], v238, s[24:27], s50 offen offset:1024 sc1
  v_pk_mul_f32 v[164:165], v[164:165], v[148:149]
  v_pk_mul_f32 v[166:167], v[166:167], v[150:151]
  v_cvt_pk_bf16_f32 v118, v164, v165
  v_cvt_pk_bf16_f32 v119, v166, v167
  buffer_store_dwordx4 v[116:119], v238, s[24:27], s51 offen offset:1024 sc1
  v_pk_mul_f32 v[184:185], v[184:185], v[168:169]
  v_pk_mul_f32 v[186:187], v[186:187], v[170:171]
  v_pk_mul_f32 v[188:189], v[188:189], v[172:173]
  v_pk_mul_f32 v[190:191], v[190:191], v[174:175]
  v_pk_mul_f32 v[192:193], v[192:193], v[176:177]
  v_pk_mul_f32 v[194:195], v[194:195], v[178:179]
  v_pk_mul_f32 v[196:197], v[196:197], v[180:181]
  v_pk_mul_f32 v[198:199], v[198:199], v[182:183]
  v_pk_mul_f32 v[168:169], v[168:169], v[2:3]
  v_pk_mul_f32 v[170:171], v[170:171], v[2:3]
  v_pk_mul_f32 v[172:173], v[172:173], v[2:3]
  v_pk_mul_f32 v[174:175], v[174:175], v[2:3]
  v_pk_mul_f32 v[176:177], v[176:177], v[2:3]
  v_pk_mul_f32 v[178:179], v[178:179], v[2:3]
  v_pk_mul_f32 v[180:181], v[180:181], v[2:3]
  v_pk_mul_f32 v[182:183], v[182:183], v[2:3]
  s_waitcnt lgkmcnt(12)
  v_mfma_f32_16x16x32_bf16 a[16:19], a[112:115], a[176:179], a[16:19]
  ds_read_b64_tr_b16 a[96:97], v219 offset:18624
  v_exp_f32 v168, v168
  v_mfma_f32_16x16x32_bf16 a[20:23], a[112:115], a[180:183], a[20:23]
  v_exp_f32 v169, v169
  v_mfma_f32_16x16x32_bf16 a[24:27], a[112:115], a[184:187], a[24:27]
  ds_read_b64_tr_b16 a[98:99], v219 offset:23232
  v_exp_f32 v170, v170
  v_mfma_f32_16x16x32_bf16 a[28:31], a[112:115], a[188:191], a[28:31]
  v_exp_f32 v171, v171
  v_mfma_f32_16x16x32_bf16 a[16:19], a[116:119], a[192:195], a[16:19]
  ds_read_b64_tr_b16 a[100:101], v219 offset:27840
  v_exp_f32 v172, v172
  v_mfma_f32_16x16x32_bf16 a[20:23], a[116:119], a[196:199], a[20:23]
  v_exp_f32 v173, v173
  v_mfma_f32_16x16x32_bf16 a[24:27], a[116:119], a[200:203], a[24:27]
  ds_read_b64_tr_b16 a[102:103], v219 offset:32448
  v_exp_f32 v174, v174
  v_mfma_f32_16x16x32_bf16 a[28:31], a[116:119], a[204:207], a[28:31]
  v_exp_f32 v175, v175
  s_waitcnt lgkmcnt(12)
  v_mfma_f32_16x16x32_bf16 a[16:19], a[120:123], a[208:211], a[16:19]
  ds_read_b64_tr_b16 a[104:105], v213 offset:18624
  v_exp_f32 v176, v176
  v_mfma_f32_16x16x32_bf16 a[20:23], a[120:123], a[212:215], a[20:23]
  v_exp_f32 v177, v177
  v_mfma_f32_16x16x32_bf16 a[24:27], a[120:123], a[216:219], a[24:27]
  ds_read_b64_tr_b16 a[106:107], v213 offset:23232
  v_exp_f32 v178, v178
  v_mfma_f32_16x16x32_bf16 a[28:31], a[120:123], a[220:223], a[28:31]
  v_exp_f32 v179, v179
  v_mfma_f32_16x16x32_bf16 a[16:19], a[124:127], a[224:227], a[16:19]
  ds_read_b64_tr_b16 a[108:109], v213 offset:27840
  v_exp_f32 v180, v180
  v_mfma_f32_16x16x32_bf16 a[20:23], a[124:127], a[228:231], a[20:23]
  v_exp_f32 v181, v181
  v_mfma_f32_16x16x32_bf16 a[24:27], a[124:127], a[232:235], a[24:27]
  ds_read_b64_tr_b16 a[110:111], v213 offset:32448
  v_exp_f32 v182, v182
  v_mfma_f32_16x16x32_bf16 a[28:31], a[124:127], a[236:239], a[28:31]
  v_exp_f32 v183, v183
  v_pk_add_f32 v[168:169], v[168:169], v[4:5]
  v_pk_add_f32 v[170:171], v[170:171], v[4:5]
  v_pk_add_f32 v[172:173], v[172:173], v[4:5]
  v_pk_add_f32 v[174:175], v[174:175], v[4:5]
  v_pk_add_f32 v[176:177], v[176:177], v[4:5]
  v_pk_add_f32 v[178:179], v[178:179], v[4:5]
  v_pk_add_f32 v[180:181], v[180:181], v[4:5]
  v_pk_add_f32 v[182:183], v[182:183], v[4:5]
  s_waitcnt lgkmcnt(12)
  v_mfma_f32_16x16x32_bf16 a[32:35], a[128:131], a[176:179], a[32:35]
  ds_read_b64_tr_b16 a[112:113], v219 offset:224
  v_rcp_f32 v168, v168
  v_mfma_f32_16x16x32_bf16 a[36:39], a[128:131], a[180:183], a[36:39]
  v_rcp_f32 v169, v169
  v_mfma_f32_16x16x32_bf16 a[40:43], a[128:131], a[184:187], a[40:43]
  ds_read_b64_tr_b16 a[114:115], v219 offset:4832
  v_rcp_f32 v170, v170
  v_mfma_f32_16x16x32_bf16 a[44:47], a[128:131], a[188:191], a[44:47]
  v_rcp_f32 v171, v171
  v_mfma_f32_16x16x32_bf16 a[32:35], a[132:135], a[192:195], a[32:35]
  ds_read_b64_tr_b16 a[116:117], v219 offset:9440
  v_rcp_f32 v172, v172
  v_mfma_f32_16x16x32_bf16 a[36:39], a[132:135], a[196:199], a[36:39]
  v_rcp_f32 v173, v173
  v_mfma_f32_16x16x32_bf16 a[40:43], a[132:135], a[200:203], a[40:43]
  ds_read_b64_tr_b16 a[118:119], v219 offset:14048
  v_rcp_f32 v174, v174
  v_mfma_f32_16x16x32_bf16 a[44:47], a[132:135], a[204:207], a[44:47]
  v_rcp_f32 v175, v175
  s_waitcnt lgkmcnt(12)
  v_mfma_f32_16x16x32_bf16 a[32:35], a[136:139], a[208:211], a[32:35]
  ds_read_b64_tr_b16 a[120:121], v213 offset:224
  v_rcp_f32 v176, v176
  v_mfma_f32_16x16x32_bf16 a[36:39], a[136:139], a[212:215], a[36:39]
  v_rcp_f32 v177, v177
  v_mfma_f32_16x16x32_bf16 a[40:43], a[136:139], a[216:219], a[40:43]
  ds_read_b64_tr_b16 a[122:123], v213 offset:4832
  v_rcp_f32 v178, v178
  v_mfma_f32_16x16x32_bf16 a[44:47], a[136:139], a[220:223], a[44:47]
  v_rcp_f32 v179, v179
  v_mfma_f32_16x16x32_bf16 a[32:35], a[140:143], a[224:227], a[32:35]
  ds_read_b64_tr_b16 a[124:125], v213 offset:9440
  v_rcp_f32 v180, v180
  v_mfma_f32_16x16x32_bf16 a[36:39], a[140:143], a[228:231], a[36:39]
  v_rcp_f32 v181, v181
  v_mfma_f32_16x16x32_bf16 a[40:43], a[140:143], a[232:235], a[40:43]
  ds_read_b64_tr_b16 a[126:127], v213 offset:14048
  v_rcp_f32 v182, v182
  v_mfma_f32_16x16x32_bf16 a[44:47], a[140:143], a[236:239], a[44:47]
  v_rcp_f32 v183, v183
  v_pk_mul_f32 v[184:185], v[184:185], v[168:169]
  v_pk_mul_f32 v[186:187], v[186:187], v[170:171]
  v_cvt_pk_bf16_f32 v168, v184, v185
  v_cvt_pk_bf16_f32 v169, v186, v187
  v_pk_mul_f32 v[188:189], v[188:189], v[172:173]
  v_pk_mul_f32 v[190:191], v[190:191], v[174:175]
  v_cvt_pk_bf16_f32 v172, v188, v189
  v_cvt_pk_bf16_f32 v173, v190, v191
  v_pk_mul_f32 v[192:193], v[192:193], v[176:177]
  v_pk_mul_f32 v[194:195], v[194:195], v[178:179]
  v_cvt_pk_bf16_f32 v176, v192, v193
  v_cvt_pk_bf16_f32 v177, v194, v195
  v_pk_mul_f32 v[196:197], v[196:197], v[180:181]
  v_pk_mul_f32 v[198:199], v[198:199], v[182:183]
  v_cvt_pk_bf16_f32 v180, v196, v197
  v_cvt_pk_bf16_f32 v181, v198, v199
  v_accvgpr_read_b32 v8, a0
  v_accvgpr_read_b32 v9, a1
  v_accvgpr_read_b32 v10, a2
  v_accvgpr_read_b32 v11, a3
  v_accvgpr_read_b32 v24, a16
  v_accvgpr_read_b32 v25, a17
  v_accvgpr_read_b32 v26, a18
  v_accvgpr_read_b32 v27, a19
  v_accvgpr_read_b32 v12, a4
  v_accvgpr_read_b32 v13, a5
  v_accvgpr_read_b32 v14, a6
  v_accvgpr_read_b32 v15, a7
  v_accvgpr_read_b32 v28, a20
  v_accvgpr_read_b32 v29, a21
  v_accvgpr_read_b32 v30, a22
  v_accvgpr_read_b32 v31, a23
  v_accvgpr_read_b32 v16, a8
  v_accvgpr_read_b32 v17, a9
  v_accvgpr_read_b32 v18, a10
  v_accvgpr_read_b32 v19, a11
  v_accvgpr_read_b32 v32, a24
  v_accvgpr_read_b32 v33, a25
  v_accvgpr_read_b32 v34, a26
  v_accvgpr_read_b32 v35, a27
  v_accvgpr_read_b32 v20, a12
  v_accvgpr_read_b32 v21, a13
  v_accvgpr_read_b32 v22, a14
  v_accvgpr_read_b32 v23, a15
  v_accvgpr_read_b32 v36, a28
  v_accvgpr_read_b32 v37, a29
  v_accvgpr_read_b32 v38, a30
  v_accvgpr_read_b32 v39, a31
  v_pk_mul_f32 v[24:25], v[24:25], v[8:9]
  v_pk_mul_f32 v[26:27], v[26:27], v[10:11]
  v_pk_mul_f32 v[28:29], v[28:29], v[12:13]
  v_pk_mul_f32 v[30:31], v[30:31], v[14:15]
  v_pk_mul_f32 v[32:33], v[32:33], v[16:17]
  v_pk_mul_f32 v[34:35], v[34:35], v[18:19]
  v_pk_mul_f32 v[36:37], v[36:37], v[20:21]
  v_pk_mul_f32 v[38:39], v[38:39], v[22:23]
  v_pk_mul_f32 v[8:9], v[8:9], v[2:3]
  v_pk_mul_f32 v[10:11], v[10:11], v[2:3]
  v_pk_mul_f32 v[12:13], v[12:13], v[2:3]
  v_pk_mul_f32 v[14:15], v[14:15], v[2:3]
  v_pk_mul_f32 v[16:17], v[16:17], v[2:3]
  v_pk_mul_f32 v[18:19], v[18:19], v[2:3]
  v_pk_mul_f32 v[20:21], v[20:21], v[2:3]
  v_pk_mul_f32 v[22:23], v[22:23], v[2:3]
  s_waitcnt lgkmcnt(12)
  v_mfma_f32_16x16x32_bf16 a[48:51], a[96:99], a[176:179], a[48:51]
  ds_read_b64_tr_b16 a[128:129], v219 offset:18656
  v_exp_f32 v8, v8
  v_mfma_f32_16x16x32_bf16 a[52:55], a[96:99], a[180:183], a[52:55]
  v_exp_f32 v9, v9
  v_mfma_f32_16x16x32_bf16 a[56:59], a[96:99], a[184:187], a[56:59]
  ds_read_b64_tr_b16 a[130:131], v219 offset:23264
  v_exp_f32 v10, v10
  v_mfma_f32_16x16x32_bf16 a[60:63], a[96:99], a[188:191], a[60:63]
  v_exp_f32 v11, v11
  v_mfma_f32_16x16x32_bf16 a[48:51], a[100:103], a[192:195], a[48:51]
  ds_read_b64_tr_b16 a[132:133], v219 offset:27872
  v_exp_f32 v12, v12
  v_mfma_f32_16x16x32_bf16 a[52:55], a[100:103], a[196:199], a[52:55]
  v_exp_f32 v13, v13
  v_mfma_f32_16x16x32_bf16 a[56:59], a[100:103], a[200:203], a[56:59]
  ds_read_b64_tr_b16 a[134:135], v219 offset:32480
  v_exp_f32 v14, v14
  v_mfma_f32_16x16x32_bf16 a[60:63], a[100:103], a[204:207], a[60:63]
  v_exp_f32 v15, v15
  s_waitcnt lgkmcnt(12)
  v_mfma_f32_16x16x32_bf16 a[48:51], a[104:107], a[208:211], a[48:51]
  ds_read_b64_tr_b16 a[136:137], v213 offset:18656
  v_exp_f32 v16, v16
  v_mfma_f32_16x16x32_bf16 a[52:55], a[104:107], a[212:215], a[52:55]
  v_exp_f32 v17, v17
  v_mfma_f32_16x16x32_bf16 a[56:59], a[104:107], a[216:219], a[56:59]
  ds_read_b64_tr_b16 a[138:139], v213 offset:23264
  v_exp_f32 v18, v18
  v_mfma_f32_16x16x32_bf16 a[60:63], a[104:107], a[220:223], a[60:63]
  v_exp_f32 v19, v19
  v_mfma_f32_16x16x32_bf16 a[48:51], a[108:111], a[224:227], a[48:51]
  ds_read_b64_tr_b16 a[140:141], v213 offset:27872
  v_exp_f32 v20, v20
  v_mfma_f32_16x16x32_bf16 a[52:55], a[108:111], a[228:231], a[52:55]
  v_exp_f32 v21, v21
  v_mfma_f32_16x16x32_bf16 a[56:59], a[108:111], a[232:235], a[56:59]
  ds_read_b64_tr_b16 a[142:143], v213 offset:32480
  v_exp_f32 v22, v22
  v_mfma_f32_16x16x32_bf16 a[60:63], a[108:111], a[236:239], a[60:63]
  v_exp_f32 v23, v23
  v_pk_add_f32 v[8:9], v[8:9], v[4:5]
  v_pk_add_f32 v[10:11], v[10:11], v[4:5]
  v_pk_add_f32 v[12:13], v[12:13], v[4:5]
  v_pk_add_f32 v[14:15], v[14:15], v[4:5]
  v_pk_add_f32 v[16:17], v[16:17], v[4:5]
  v_pk_add_f32 v[18:19], v[18:19], v[4:5]
  v_pk_add_f32 v[20:21], v[20:21], v[4:5]
  v_pk_add_f32 v[22:23], v[22:23], v[4:5]
  s_waitcnt lgkmcnt(12)
  v_mfma_f32_16x16x32_bf16 a[64:67], a[112:115], a[176:179], a[64:67]
  v_rcp_f32 v8, v8
  v_mfma_f32_16x16x32_bf16 a[68:71], a[112:115], a[180:183], a[68:71]
  v_rcp_f32 v9, v9
  v_mfma_f32_16x16x32_bf16 a[72:75], a[112:115], a[184:187], a[72:75]
  v_rcp_f32 v10, v10
  v_mfma_f32_16x16x32_bf16 a[76:79], a[112:115], a[188:191], a[76:79]
  v_rcp_f32 v11, v11
  v_mfma_f32_16x16x32_bf16 a[64:67], a[116:119], a[192:195], a[64:67]
  v_rcp_f32 v12, v12
  v_mfma_f32_16x16x32_bf16 a[68:71], a[116:119], a[196:199], a[68:71]
  v_rcp_f32 v13, v13
  v_mfma_f32_16x16x32_bf16 a[72:75], a[116:119], a[200:203], a[72:75]
  v_rcp_f32 v14, v14
  v_mfma_f32_16x16x32_bf16 a[76:79], a[116:119], a[204:207], a[76:79]
  v_rcp_f32 v15, v15
  s_waitcnt lgkmcnt(8)
  v_mfma_f32_16x16x32_bf16 a[64:67], a[120:123], a[208:211], a[64:67]
  v_rcp_f32 v16, v16
  v_mfma_f32_16x16x32_bf16 a[68:71], a[120:123], a[212:215], a[68:71]
  v_rcp_f32 v17, v17
  v_mfma_f32_16x16x32_bf16 a[72:75], a[120:123], a[216:219], a[72:75]
  v_rcp_f32 v18, v18
  v_mfma_f32_16x16x32_bf16 a[76:79], a[120:123], a[220:223], a[76:79]
  v_rcp_f32 v19, v19
  v_mfma_f32_16x16x32_bf16 a[64:67], a[124:127], a[224:227], a[64:67]
  v_rcp_f32 v20, v20
  v_mfma_f32_16x16x32_bf16 a[68:71], a[124:127], a[228:231], a[68:71]
  v_rcp_f32 v21, v21
  v_mfma_f32_16x16x32_bf16 a[72:75], a[124:127], a[232:235], a[72:75]
  v_rcp_f32 v22, v22
  v_mfma_f32_16x16x32_bf16 a[76:79], a[124:127], a[236:239], a[76:79]
  v_rcp_f32 v23, v23
  v_pk_mul_f32 v[24:25], v[24:25], v[8:9]
  v_pk_mul_f32 v[26:27], v[26:27], v[10:11]
  v_cvt_pk_bf16_f32 v170, v24, v25
  v_cvt_pk_bf16_f32 v171, v26, v27
  buffer_store_dwordx4 v[168:171], v238, s[24:27], s48 offen offset:2048 sc1
  v_pk_mul_f32 v[28:29], v[28:29], v[12:13]
  v_pk_mul_f32 v[30:31], v[30:31], v[14:15]
  v_cvt_pk_bf16_f32 v174, v28, v29
  v_cvt_pk_bf16_f32 v175, v30, v31
  buffer_store_dwordx4 v[172:175], v238, s[24:27], s49 offen offset:2048 sc1
  v_pk_mul_f32 v[32:33], v[32:33], v[16:17]
  v_pk_mul_f32 v[34:35], v[34:35], v[18:19]
  v_cvt_pk_bf16_f32 v178, v32, v33
  v_cvt_pk_bf16_f32 v179, v34, v35
  buffer_store_dwordx4 v[176:179], v238, s[24:27], s50 offen offset:2048 sc1
  v_pk_mul_f32 v[36:37], v[36:37], v[20:21]
  v_pk_mul_f32 v[38:39], v[38:39], v[22:23]
  v_cvt_pk_bf16_f32 v182, v36, v37
  v_cvt_pk_bf16_f32 v183, v38, v39
  buffer_store_dwordx4 v[180:183], v238, s[24:27], s51 offen offset:2048 sc1
  v_accvgpr_read_b32 v40, a32
  v_accvgpr_read_b32 v41, a33
  v_accvgpr_read_b32 v42, a34
  v_accvgpr_read_b32 v43, a35
  v_accvgpr_read_b32 v56, a48
  v_accvgpr_read_b32 v57, a49
  v_accvgpr_read_b32 v58, a50
  v_accvgpr_read_b32 v59, a51
  v_accvgpr_read_b32 v44, a36
  v_accvgpr_read_b32 v45, a37
  v_accvgpr_read_b32 v46, a38
  v_accvgpr_read_b32 v47, a39
  v_accvgpr_read_b32 v60, a52
  v_accvgpr_read_b32 v61, a53
  v_accvgpr_read_b32 v62, a54
  v_accvgpr_read_b32 v63, a55
  v_accvgpr_read_b32 v48, a40
  v_accvgpr_read_b32 v49, a41
  v_accvgpr_read_b32 v50, a42
  v_accvgpr_read_b32 v51, a43
  v_accvgpr_read_b32 v64, a56
  v_accvgpr_read_b32 v65, a57
  v_accvgpr_read_b32 v66, a58
  v_accvgpr_read_b32 v67, a59
  v_accvgpr_read_b32 v52, a44
  v_accvgpr_read_b32 v53, a45
  v_accvgpr_read_b32 v54, a46
  v_accvgpr_read_b32 v55, a47
  v_accvgpr_read_b32 v68, a60
  v_accvgpr_read_b32 v69, a61
  v_accvgpr_read_b32 v70, a62
  v_accvgpr_read_b32 v71, a63
  v_pk_mul_f32 v[56:57], v[56:57], v[40:41]
  v_pk_mul_f32 v[58:59], v[58:59], v[42:43]
  v_pk_mul_f32 v[60:61], v[60:61], v[44:45]
  v_pk_mul_f32 v[62:63], v[62:63], v[46:47]
  v_pk_mul_f32 v[64:65], v[64:65], v[48:49]
  v_pk_mul_f32 v[66:67], v[66:67], v[50:51]
  v_pk_mul_f32 v[68:69], v[68:69], v[52:53]
  v_pk_mul_f32 v[70:71], v[70:71], v[54:55]
  v_pk_mul_f32 v[40:41], v[40:41], v[2:3]
  v_pk_mul_f32 v[42:43], v[42:43], v[2:3]
  v_pk_mul_f32 v[44:45], v[44:45], v[2:3]
  v_pk_mul_f32 v[46:47], v[46:47], v[2:3]
  v_pk_mul_f32 v[48:49], v[48:49], v[2:3]
  v_pk_mul_f32 v[50:51], v[50:51], v[2:3]
  v_pk_mul_f32 v[52:53], v[52:53], v[2:3]
  v_pk_mul_f32 v[54:55], v[54:55], v[2:3]
  s_waitcnt lgkmcnt(4)
  v_mfma_f32_16x16x32_bf16 a[80:83], a[128:131], a[176:179], a[80:83]
  v_exp_f32 v40, v40
  v_mfma_f32_16x16x32_bf16 a[84:87], a[128:131], a[180:183], a[84:87]
  v_exp_f32 v41, v41
  v_mfma_f32_16x16x32_bf16 a[88:91], a[128:131], a[184:187], a[88:91]
  v_exp_f32 v42, v42
  v_mfma_f32_16x16x32_bf16 a[92:95], a[128:131], a[188:191], a[92:95]
  v_exp_f32 v43, v43
  v_mfma_f32_16x16x32_bf16 a[80:83], a[132:135], a[192:195], a[80:83]
  v_exp_f32 v44, v44
  v_mfma_f32_16x16x32_bf16 a[84:87], a[132:135], a[196:199], a[84:87]
  v_exp_f32 v45, v45
  v_mfma_f32_16x16x32_bf16 a[88:91], a[132:135], a[200:203], a[88:91]
  v_exp_f32 v46, v46
  v_mfma_f32_16x16x32_bf16 a[92:95], a[132:135], a[204:207], a[92:95]
  v_exp_f32 v47, v47
  s_waitcnt lgkmcnt(0)
  v_mfma_f32_16x16x32_bf16 a[80:83], a[136:139], a[208:211], a[80:83]
  v_exp_f32 v48, v48
  v_mfma_f32_16x16x32_bf16 a[84:87], a[136:139], a[212:215], a[84:87]
  v_exp_f32 v49, v49
  v_mfma_f32_16x16x32_bf16 a[88:91], a[136:139], a[216:219], a[88:91]
  v_exp_f32 v50, v50
  v_mfma_f32_16x16x32_bf16 a[92:95], a[136:139], a[220:223], a[92:95]
  v_exp_f32 v51, v51
  v_mfma_f32_16x16x32_bf16 a[80:83], a[140:143], a[224:227], a[80:83]
  v_exp_f32 v52, v52
  v_mfma_f32_16x16x32_bf16 a[84:87], a[140:143], a[228:231], a[84:87]
  v_exp_f32 v53, v53
  v_mfma_f32_16x16x32_bf16 a[88:91], a[140:143], a[232:235], a[88:91]
  v_exp_f32 v54, v54
  v_mfma_f32_16x16x32_bf16 a[92:95], a[140:143], a[236:239], a[92:95]
  v_exp_f32 v55, v55
  v_pk_add_f32 v[40:41], v[40:41], v[4:5]
  v_pk_add_f32 v[42:43], v[42:43], v[4:5]
  v_pk_add_f32 v[44:45], v[44:45], v[4:5]
  v_pk_add_f32 v[46:47], v[46:47], v[4:5]
  v_pk_add_f32 v[48:49], v[48:49], v[4:5]
  v_pk_add_f32 v[50:51], v[50:51], v[4:5]
  v_pk_add_f32 v[52:53], v[52:53], v[4:5]
  v_pk_add_f32 v[54:55], v[54:55], v[4:5]
  s_nop 0
  v_rcp_f32 v40, v40
  v_rcp_f32 v41, v41
  v_rcp_f32 v42, v42
  v_rcp_f32 v43, v43
  v_rcp_f32 v44, v44
  v_rcp_f32 v45, v45
  v_rcp_f32 v46, v46
  v_rcp_f32 v47, v47
  v_rcp_f32 v48, v48
  v_rcp_f32 v49, v49
  v_rcp_f32 v50, v50
  v_rcp_f32 v51, v51
  v_rcp_f32 v52, v52
  v_rcp_f32 v53, v53
  v_rcp_f32 v54, v54
  v_rcp_f32 v55, v55
  v_pk_mul_f32 v[56:57], v[56:57], v[40:41]
  v_pk_mul_f32 v[58:59], v[58:59], v[42:43]
  v_cvt_pk_bf16_f32 v40, v56, v57
  v_cvt_pk_bf16_f32 v41, v58, v59
  v_pk_mul_f32 v[60:61], v[60:61], v[44:45]
  v_pk_mul_f32 v[62:63], v[62:63], v[46:47]
  v_cvt_pk_bf16_f32 v44, v60, v61
  v_cvt_pk_bf16_f32 v45, v62, v63
  v_pk_mul_f32 v[64:65], v[64:65], v[48:49]
  v_pk_mul_f32 v[66:67], v[66:67], v[50:51]
  v_cvt_pk_bf16_f32 v48, v64, v65
  v_cvt_pk_bf16_f32 v49, v66, v67
  v_pk_mul_f32 v[68:69], v[68:69], v[52:53]
  v_pk_mul_f32 v[70:71], v[70:71], v[54:55]
  v_cvt_pk_bf16_f32 v52, v68, v69
  v_cvt_pk_bf16_f32 v53, v70, v71
  v_accvgpr_read_b32 v72, a64
  v_accvgpr_read_b32 v73, a65
  v_accvgpr_read_b32 v74, a66
  v_accvgpr_read_b32 v75, a67
  v_accvgpr_read_b32 v88, a80
  v_accvgpr_read_b32 v89, a81
  v_accvgpr_read_b32 v90, a82
  v_accvgpr_read_b32 v91, a83
  v_accvgpr_read_b32 v76, a68
  v_accvgpr_read_b32 v77, a69
  v_accvgpr_read_b32 v78, a70
  v_accvgpr_read_b32 v79, a71
  v_accvgpr_read_b32 v92, a84
  v_accvgpr_read_b32 v93, a85
  v_accvgpr_read_b32 v94, a86
  v_accvgpr_read_b32 v95, a87
  v_accvgpr_read_b32 v80, a72
  v_accvgpr_read_b32 v81, a73
  v_accvgpr_read_b32 v82, a74
  v_accvgpr_read_b32 v83, a75
  v_accvgpr_read_b32 v96, a88
  v_accvgpr_read_b32 v97, a89
  v_accvgpr_read_b32 v98, a90
  v_accvgpr_read_b32 v99, a91
  v_accvgpr_read_b32 v84, a76
  v_accvgpr_read_b32 v85, a77
  v_accvgpr_read_b32 v86, a78
  v_accvgpr_read_b32 v87, a79
  v_accvgpr_read_b32 v100, a92
  v_accvgpr_read_b32 v101, a93
  v_accvgpr_read_b32 v102, a94
  v_accvgpr_read_b32 v103, a95
  v_pk_mul_f32 v[88:89], v[88:89], v[72:73]
  v_pk_mul_f32 v[90:91], v[90:91], v[74:75]
  v_pk_mul_f32 v[92:93], v[92:93], v[76:77]
  v_pk_mul_f32 v[94:95], v[94:95], v[78:79]
  v_pk_mul_f32 v[96:97], v[96:97], v[80:81]
  v_pk_mul_f32 v[98:99], v[98:99], v[82:83]
  v_pk_mul_f32 v[100:101], v[100:101], v[84:85]
  v_pk_mul_f32 v[102:103], v[102:103], v[86:87]
  v_pk_mul_f32 v[72:73], v[72:73], v[2:3]
  v_pk_mul_f32 v[74:75], v[74:75], v[2:3]
  v_pk_mul_f32 v[76:77], v[76:77], v[2:3]
  v_pk_mul_f32 v[78:79], v[78:79], v[2:3]
  v_pk_mul_f32 v[80:81], v[80:81], v[2:3]
  v_pk_mul_f32 v[82:83], v[82:83], v[2:3]
  v_pk_mul_f32 v[84:85], v[84:85], v[2:3]
  v_pk_mul_f32 v[86:87], v[86:87], v[2:3]
  v_exp_f32 v72, v72
  v_exp_f32 v73, v73
  v_exp_f32 v74, v74
  v_exp_f32 v75, v75
  v_exp_f32 v76, v76
  v_exp_f32 v77, v77
  v_exp_f32 v78, v78
  v_exp_f32 v79, v79
  v_exp_f32 v80, v80
  v_exp_f32 v81, v81
  v_exp_f32 v82, v82
  v_exp_f32 v83, v83
  v_exp_f32 v84, v84
  v_exp_f32 v85, v85
  v_exp_f32 v86, v86
  v_exp_f32 v87, v87
  v_pk_add_f32 v[72:73], v[72:73], v[4:5]
  v_pk_add_f32 v[74:75], v[74:75], v[4:5]
  v_pk_add_f32 v[76:77], v[76:77], v[4:5]
  v_pk_add_f32 v[78:79], v[78:79], v[4:5]
  v_pk_add_f32 v[80:81], v[80:81], v[4:5]
  v_pk_add_f32 v[82:83], v[82:83], v[4:5]
  v_pk_add_f32 v[84:85], v[84:85], v[4:5]
  v_pk_add_f32 v[86:87], v[86:87], v[4:5]
  v_rcp_f32 v72, v72
  v_rcp_f32 v73, v73
  v_rcp_f32 v74, v74
  v_rcp_f32 v75, v75
  v_rcp_f32 v76, v76
  v_rcp_f32 v77, v77
  v_rcp_f32 v78, v78
  v_rcp_f32 v79, v79
  v_rcp_f32 v80, v80
  v_rcp_f32 v81, v81
  v_rcp_f32 v82, v82
  v_rcp_f32 v83, v83
  v_rcp_f32 v84, v84
  v_rcp_f32 v85, v85
  v_rcp_f32 v86, v86
  v_rcp_f32 v87, v87
  v_pk_mul_f32 v[88:89], v[88:89], v[72:73]
  v_pk_mul_f32 v[90:91], v[90:91], v[74:75]
  v_cvt_pk_bf16_f32 v42, v88, v89
  v_cvt_pk_bf16_f32 v43, v90, v91
  buffer_store_dwordx4 v[40:43], v238, s[24:27], s48 offen offset:3072 sc1
  v_pk_mul_f32 v[92:93], v[92:93], v[76:77]
  v_pk_mul_f32 v[94:95], v[94:95], v[78:79]
  v_cvt_pk_bf16_f32 v46, v92, v93
  v_cvt_pk_bf16_f32 v47, v94, v95
  buffer_store_dwordx4 v[44:47], v238, s[24:27], s49 offen offset:3072 sc1
  v_pk_mul_f32 v[96:97], v[96:97], v[80:81]
  v_pk_mul_f32 v[98:99], v[98:99], v[82:83]
  v_cvt_pk_bf16_f32 v50, v96, v97
  v_cvt_pk_bf16_f32 v51, v98, v99
  buffer_store_dwordx4 v[48:51], v238, s[24:27], s50 offen offset:3072 sc1
  v_pk_mul_f32 v[100:101], v[100:101], v[84:85]
  v_pk_mul_f32 v[102:103], v[102:103], v[86:87]
  v_cvt_pk_bf16_f32 v54, v100, v101
  v_cvt_pk_bf16_f32 v55, v102, v103
  buffer_store_dwordx4 v[52:55], v238, s[24:27], s51 offen offset:3072 sc1
  s_lshr_b32 s86, s2, 5
  s_lshl_b32 s86, s86, 12
  s_lshl_b32 s36, s32, 7
  s_add_u32 s86, s86, s36
  s_add_u32 s86, s86, 0x10000
  s_barrier
glu_kernel_codeend:
down_kernel:
  v_and_b32 v1, 63, v0
  s_and_b32 s39, s2, 1
  s_lshl_b32 s39, s39, 3
  s_lshr_b32 s34, s2, 5
  s_add_u32 s39, s39, s34
  s_lshl_b32 s33, s39, 3
  s_lshl_b32 s34, s101, 1
  s_add_u32 s33, s33, s34
  s_and_b32 s36, s62, 1
  s_mul_i32 s30, s63, 0x9000
  s_mul_i32 s34, s33, 0x24000
  v_lshlrev_b32 v6, 4, v1
  v_add_u32 v161, s34, v6
  v_add_u32 v162, 0x24000, v161
  s_add_u32 s8, s4, 0x2000000
  s_addc_u32 s9, s5, 0
  s_mov_b32 s10, 0x1200000
  s_mov_b32 s11, 0x20000
  s_add_u32 s20, s4, 0x40000
  s_addc_u32 s21, s5, 0
  s_mov_b32 s22, 0x30000
  s_mov_b32 s23, 0x20000
  s_add_u32 s16, s4, 0x4800000
  s_addc_u32 s17, s5, 0
  s_mov_b32 s18, 0x900000
  s_mov_b32 s19, 0x20000
  v_lshrrev_b32 v3, 2, v1
  v_mul_u32_u24 v3, 0x120, v3
  v_and_b32 v4, 3, v1
  v_lshl_add_u32 v3, v4, 3, v3
  s_lshl_b32 s34, s36, 5
  s_xor_b32 s35, s36, 1
  s_lshl_b32 s35, s35, 8
  v_add_u32 v165, s34, v3
  v_add_u32 v166, s35, v3
  v_add_u32 v167, 0x9000, v165
  v_add_u32 v168, 0x9000, v166
  v_add_u32 v169, 0x12000, v165
  v_add_u32 v170, 0x12000, v166
  v_add_u32 v171, 0x1b000, v165
  v_add_u32 v172, 0x1b000, v166
  s_mul_i32 s34, s62, 9
  s_add_u32 s34, s34, 1
  s_lshr_b32 s34, s34, 1
  s_lshl_b32 s34, s34, 10
  s_mul_i32 s35, s33, 0x4800
  s_add_u32 s34, s34, s35
  s_mul_i32 s35, s63, 0x240000
  s_add_u32 s34, s34, s35
  v_add_u32 v173, s34, v6
  s_mul_i32 s35, s36, 0xffffec08
  s_add_u32 s35, s35, 0x1000
  v_add_u32 v174, s35, v173
  s_mov_b32 s48, 0
  s_mov_b32 s49, 0x4800
  s_lshl_b32 s38, s39, 11
  s_lshl_b32 s34, s63, 9
  s_add_u32 s38, s38, s34
  s_lshl_b32 s34, s62, 7
  s_add_u32 s38, s38, s34
  s_add_u32 s38, s38, 0x18000
  s_lshr_b32 s34, s39, 1
  s_lshl_b32 s34, s34, 12
  s_lshl_b32 s35, s63, 10
  s_add_u32 s34, s34, s35
  s_add_u32 s34, s34, 0x10000
  v_and_b32 v3, 7, v1
  v_lshl_add_u32 v3, v3, 7, s34
  s_waitcnt vmcnt(0)
  s_barrier
  s_cmp_lg_u32 s101, 0
  s_cbranch_scc1 pg2_pubin
  s_mov_b64 exec, 1
  v_mov_b32 v4, s100
  buffer_store_dword v4, off, s[20:23], s86 sc1
  s_mov_b64 exec, -1
pg2_pubin:
  s_add_u32 m0, s60, 0x1b000
  s_nop 0
  buffer_load_dwordx4 v240, s[56:59], s61 offen lds
  buffer_load_dwordx4 v241, s[56:59], s61 offen offset:1024 lds
  buffer_load_dwordx4 v242, s[56:59], s61 offen offset:2048 lds
  buffer_load_dwordx4 v243, s[56:59], s61 offen offset:3072 lds
  s_add_u32 m0, s60, 0x1c000
  s_nop 0
  buffer_load_dwordx4 v244, s[56:59], s61 offen lds
  buffer_load_dwordx4 v245, s[56:59], s61 offen offset:1024 lds
  buffer_load_dwordx4 v246, s[56:59], s61 offen offset:2048 lds
  buffer_load_dwordx4 v247, s[56:59], s61 offen offset:3072 lds
  s_add_u32 m0, s60, 0x1d000
  s_nop 0
  buffer_load_dwordx4 v248, s[56:59], s61 offen lds
  s_add_u32 s61, s61, 0x24000
  s_mov_b32 s34, 0x40000
pg2_poll:
  buffer_load_dword v4, v3, s[20:23], 0 offen sc1
  s_waitcnt vmcnt(0)
  v_cmp_ne_u32 vcc, s100, v4
  s_nop 1
  s_cbranch_vccz pg2_poll_ok
  s_sleep 1
  s_sub_u32 s34, s34, 1
  s_cbranch_scc0 pg2_poll
pg2_poll_ok:
  buffer_load_dwordx4 a[48:51], v161, s[8:11], s30 offen sc1
  buffer_load_dwordx4 a[52:55], v162, s[8:11], s30 offen sc1
  buffer_load_dwordx4 a[56:59], v161, s[8:11], s30 offen offset:1024 sc1
  buffer_load_dwordx4 a[60:63], v162, s[8:11], s30 offen offset:1024 sc1
  buffer_load_dwordx4 a[64:67], v161, s[8:11], s30 offen offset:2048 sc1
  buffer_load_dwordx4 a[68:71], v162, s[8:11], s30 offen offset:2048 sc1
  buffer_load_dwordx4 a[72:75], v161, s[8:11], s30 offen offset:3072 sc1
  buffer_load_dwordx4 a[76:79], v162, s[8:11], s30 offen offset:3072 sc1
  s_add_u32 s30, s30, 0x1000
  buffer_load_dwordx4 a[80:83], v161, s[8:11], s30 offen sc1
  buffer_load_dwordx4 a[84:87], v162, s[8:11], s30 offen sc1
  buffer_load_dwordx4 a[88:91], v161, s[8:11], s30 offen offset:1024 sc1
  buffer_load_dwordx4 a[92:95], v162, s[8:11], s30 offen offset:1024 sc1
  buffer_load_dwordx4 a[96:99], v161, s[8:11], s30 offen offset:2048 sc1
  buffer_load_dwordx4 a[100:103], v162, s[8:11], s30 offen offset:2048 sc1
  buffer_load_dwordx4 a[104:107], v161, s[8:11], s30 offen offset:3072 sc1
  buffer_load_dwordx4 a[108:111], v162, s[8:11], s30 offen offset:3072 sc1
  s_add_u32 s30, s30, 0x1000
  ds_read_b64_tr_b16 a[0:1], v168
  ds_read_b64_tr_b16 a[2:3], v168 offset:4608
  ds_read_b64_tr_b16 a[4:5], v167
  ds_read_b64_tr_b16 a[6:7], v167 offset:4608
  ds_read_b64_tr_b16 a[8:9], v167 offset:32
  ds_read_b64_tr_b16 a[10:11], v167 offset:4640
  ds_read_b64_tr_b16 a[12:13], v167 offset:64
  ds_read_b64_tr_b16 a[14:15], v167 offset:4672
  ds_read_b64_tr_b16 a[16:17], v167 offset:96
  ds_read_b64_tr_b16 a[18:19], v167 offset:4704
  ds_read_b64_tr_b16 a[20:21], v167 offset:128
  ds_read_b64_tr_b16 a[22:23], v167 offset:4736
  ds_read_b64_tr_b16 a[24:25], v167 offset:160
  ds_read_b64_tr_b16 a[26:27], v167 offset:4768
  ds_read_b64_tr_b16 a[28:29], v167 offset:192
  ds_read_b64_tr_b16 a[30:31], v167 offset:4800
  s_waitcnt vmcnt(14) lgkmcnt(8)
  v_mfma_f32_16x16x32_bf16 v[8:11], a[0:3], a[48:51], 0
  ds_read_b64_tr_b16 a[32:33], v167 offset:224
  v_mfma_f32_16x16x32_bf16 v[12:15], a[0:3], a[52:55], 0
  ds_read_b64_tr_b16 a[34:35], v167 offset:4832
  v_mfma_f32_16x16x32_bf16 v[16:19], a[4:7], a[48:51], 0
  ds_read_b64_tr_b16 a[36:37], v168 offset:9216
  s_add_u32 m0, s60, 0
  s_nop 0
  buffer_load_dwordx4 v240, s[56:59], s61 offen lds
  v_mfma_f32_16x16x32_bf16 v[20:23], a[4:7], a[52:55], 0
  ds_read_b64_tr_b16 a[38:39], v168 offset:13824
  v_mfma_f32_16x16x32_bf16 v[24:27], a[8:11], a[48:51], 0
  ds_read_b64_tr_b16 a[40:41], v167 offset:9216
  buffer_load_dwordx4 v241, s[56:59], s61 offen offset:1024 lds
  v_mfma_f32_16x16x32_bf16 v[28:31], a[8:11], a[52:55], 0
  ds_read_b64_tr_b16 a[42:43], v167 offset:13824
  v_mfma_f32_16x16x32_bf16 v[32:35], a[12:15], a[48:51], 0
  ds_read_b64_tr_b16 a[44:45], v167 offset:9248
  buffer_load_dwordx4 v242, s[56:59], s61 offen offset:2048 lds
  v_mfma_f32_16x16x32_bf16 v[36:39], a[12:15], a[52:55], 0
  ds_read_b64_tr_b16 a[46:47], v167 offset:13856
  s_waitcnt lgkmcnt(8)
  v_mfma_f32_16x16x32_bf16 v[40:43], a[16:19], a[48:51], 0
  ds_read_b64_tr_b16 a[0:1], v167 offset:9280
  buffer_load_dwordx4 v243, s[56:59], s61 offen offset:3072 lds
  v_mfma_f32_16x16x32_bf16 v[44:47], a[16:19], a[52:55], 0
  ds_read_b64_tr_b16 a[2:3], v167 offset:13888
  s_add_u32 m0, s60, 0x1000
  v_mfma_f32_16x16x32_bf16 v[48:51], a[20:23], a[48:51], 0
  ds_read_b64_tr_b16 a[4:5], v167 offset:9312
  buffer_load_dwordx4 v244, s[56:59], s61 offen lds
  v_mfma_f32_16x16x32_bf16 v[52:55], a[20:23], a[52:55], 0
  ds_read_b64_tr_b16 a[6:7], v167 offset:13920
  v_mfma_f32_16x16x32_bf16 v[56:59], a[24:27], a[48:51], 0
  ds_read_b64_tr_b16 a[8:9], v167 offset:9344
  buffer_load_dwordx4 v245, s[56:59], s61 offen offset:1024 lds
  v_mfma_f32_16x16x32_bf16 v[60:63], a[24:27], a[52:55], 0
  ds_read_b64_tr_b16 a[10:11], v167 offset:13952
  v_mfma_f32_16x16x32_bf16 v[64:67], a[28:31], a[48:51], 0
  ds_read_b64_tr_b16 a[12:13], v167 offset:9376
  buffer_load_dwordx4 v246, s[56:59], s61 offen offset:2048 lds
  v_mfma_f32_16x16x32_bf16 v[68:71], a[28:31], a[52:55], 0
  ds_read_b64_tr_b16 a[14:15], v167 offset:13984
  s_waitcnt vmcnt(19) lgkmcnt(8)
  v_mfma_f32_16x16x32_bf16 v[72:75], a[32:35], a[48:51], 0
  ds_read_b64_tr_b16 a[16:17], v167 offset:9408
  buffer_load_dwordx4 v247, s[56:59], s61 offen offset:3072 lds
  v_mfma_f32_16x16x32_bf16 v[76:79], a[32:35], a[52:55], 0
  ds_read_b64_tr_b16 a[18:19], v167 offset:14016
  s_add_u32 m0, s60, 0x2000
  v_mfma_f32_16x16x32_bf16 v[8:11], a[36:39], a[56:59], v[8:11]
  ds_read_b64_tr_b16 a[20:21], v167 offset:9440
  buffer_load_dwordx4 v248, s[56:59], s61 offen lds
  v_mfma_f32_16x16x32_bf16 v[12:15], a[36:39], a[60:63], v[12:15]
  ds_read_b64_tr_b16 a[22:23], v167 offset:14048
  s_add_u32 s61, s61, 0x24000
  v_mfma_f32_16x16x32_bf16 v[16:19], a[40:43], a[56:59], v[16:19]
  ds_read_b64_tr_b16 a[24:25], v168 offset:18432
  buffer_load_dwordx4 a[112:115], v161, s[8:11], s30 offen sc1
  v_mfma_f32_16x16x32_bf16 v[20:23], a[40:43], a[60:63], v[20:23]
  ds_read_b64_tr_b16 a[26:27], v168 offset:23040
  v_mfma_f32_16x16x32_bf16 v[24:27], a[44:47], a[56:59], v[24:27]
  ds_read_b64_tr_b16 a[28:29], v167 offset:18432
  buffer_load_dwordx4 a[116:119], v162, s[8:11], s30 offen sc1
  v_mfma_f32_16x16x32_bf16 v[28:31], a[44:47], a[60:63], v[28:31]
  ds_read_b64_tr_b16 a[30:31], v167 offset:23040
  s_waitcnt lgkmcnt(8)
  v_mfma_f32_16x16x32_bf16 v[32:35], a[0:3], a[56:59], v[32:35]
  ds_read_b64_tr_b16 a[32:33], v167 offset:18464
  buffer_load_dwordx4 a[120:123], v161, s[8:11], s30 offen offset:1024 sc1
  v_mfma_f32_16x16x32_bf16 v[36:39], a[0:3], a[60:63], v[36:39]
  ds_read_b64_tr_b16 a[34:35], v167 offset:23072
  v_mfma_f32_16x16x32_bf16 v[40:43], a[4:7], a[56:59], v[40:43]
  ds_read_b64_tr_b16 a[36:37], v167 offset:18496
  buffer_load_dwordx4 a[124:127], v162, s[8:11], s30 offen offset:1024 sc1
  v_mfma_f32_16x16x32_bf16 v[44:47], a[4:7], a[60:63], v[44:47]
  ds_read_b64_tr_b16 a[38:39], v167 offset:23104
  v_mfma_f32_16x16x32_bf16 v[48:51], a[8:11], a[56:59], v[48:51]
  ds_read_b64_tr_b16 a[40:41], v167 offset:18528
  buffer_load_dwordx4 a[128:131], v161, s[8:11], s30 offen offset:2048 sc1
  v_mfma_f32_16x16x32_bf16 v[52:55], a[8:11], a[60:63], v[52:55]
  ds_read_b64_tr_b16 a[42:43], v167 offset:23136
  v_mfma_f32_16x16x32_bf16 v[56:59], a[12:15], a[56:59], v[56:59]
  ds_read_b64_tr_b16 a[44:45], v167 offset:18560
  buffer_load_dwordx4 a[132:135], v162, s[8:11], s30 offen offset:2048 sc1
  v_mfma_f32_16x16x32_bf16 v[60:63], a[12:15], a[60:63], v[60:63]
  ds_read_b64_tr_b16 a[46:47], v167 offset:23168
  s_waitcnt vmcnt(25) lgkmcnt(8)
  v_mfma_f32_16x16x32_bf16 v[64:67], a[16:19], a[56:59], v[64:67]
  ds_read_b64_tr_b16 a[0:1], v167 offset:18592
  buffer_load_dwordx4 a[136:139], v161, s[8:11], s30 offen offset:3072 sc1
  v_mfma_f32_16x16x32_bf16 v[68:71], a[16:19], a[60:63], v[68:71]
  ds_read_b64_tr_b16 a[2:3], v167 offset:23200
  v_mfma_f32_16x16x32_bf16 v[72:75], a[20:23], a[56:59], v[72:75]
  ds_read_b64_tr_b16 a[4:5], v167 offset:18624
  buffer_load_dwordx4 a[140:143], v162, s[8:11], s30 offen offset:3072 sc1
  v_mfma_f32_16x16x32_bf16 v[76:79], a[20:23], a[60:63], v[76:79]
  ds_read_b64_tr_b16 a[6:7], v167 offset:23232
  s_add_u32 s30, s30, 0x1000
  v_mfma_f32_16x16x32_bf16 v[8:11], a[24:27], a[64:67], v[8:11]
  ds_read_b64_tr_b16 a[8:9], v167 offset:18656
  buffer_load_dwordx4 a[144:147], v161, s[8:11], s30 offen sc1
  v_mfma_f32_16x16x32_bf16 v[12:15], a[24:27], a[68:71], v[12:15]
  ds_read_b64_tr_b16 a[10:11], v167 offset:23264
  v_mfma_f32_16x16x32_bf16 v[16:19], a[28:31], a[64:67], v[16:19]
  ds_read_b64_tr_b16 a[12:13], v168 offset:27648
  buffer_load_dwordx4 a[148:151], v162, s[8:11], s30 offen sc1
  v_mfma_f32_16x16x32_bf16 v[20:23], a[28:31], a[68:71], v[20:23]
  ds_read_b64_tr_b16 a[14:15], v168 offset:32256
  s_waitcnt lgkmcnt(8)
  v_mfma_f32_16x16x32_bf16 v[24:27], a[32:35], a[64:67], v[24:27]
  ds_read_b64_tr_b16 a[16:17], v167 offset:27648
  buffer_load_dwordx4 a[152:155], v161, s[8:11], s30 offen offset:1024 sc1
  v_mfma_f32_16x16x32_bf16 v[28:31], a[32:35], a[68:71], v[28:31]
  ds_read_b64_tr_b16 a[18:19], v167 offset:32256
  v_mfma_f32_16x16x32_bf16 v[32:35], a[36:39], a[64:67], v[32:35]
  ds_read_b64_tr_b16 a[20:21], v167 offset:27680
  buffer_load_dwordx4 a[156:159], v162, s[8:11], s30 offen offset:1024 sc1
  v_mfma_f32_16x16x32_bf16 v[36:39], a[36:39], a[68:71], v[36:39]
  ds_read_b64_tr_b16 a[22:23], v167 offset:32288
  v_mfma_f32_16x16x32_bf16 v[40:43], a[40:43], a[64:67], v[40:43]
  ds_read_b64_tr_b16 a[24:25], v167 offset:27712
  buffer_load_dwordx4 a[160:163], v161, s[8:11], s30 offen offset:2048 sc1
  v_mfma_f32_16x16x32_bf16 v[44:47], a[40:43], a[68:71], v[44:47]
  ds_read_b64_tr_b16 a[26:27], v167 offset:32320
  v_mfma_f32_16x16x32_bf16 v[48:51], a[44:47], a[64:67], v[48:51]
  ds_read_b64_tr_b16 a[28:29], v167 offset:27744
  buffer_load_dwordx4 a[164:167], v162, s[8:11], s30 offen offset:2048 sc1
  v_mfma_f32_16x16x32_bf16 v[52:55], a[44:47], a[68:71], v[52:55]
  ds_read_b64_tr_b16 a[30:31], v167 offset:32352
  s_waitcnt vmcnt(32) lgkmcnt(8)
  v_mfma_f32_16x16x32_bf16 v[56:59], a[0:3], a[64:67], v[56:59]
  ds_read_b64_tr_b16 a[32:33], v167 offset:27776
  buffer_load_dwordx4 a[168:171], v161, s[8:11], s30 offen offset:3072 sc1
  v_mfma_f32_16x16x32_bf16 v[60:63], a[0:3], a[68:71], v[60:63]
  ds_read_b64_tr_b16 a[34:35], v167 offset:32384
  v_mfma_f32_16x16x32_bf16 v[64:67], a[4:7], a[64:67], v[64:67]
  ds_read_b64_tr_b16 a[36:37], v167 offset:27808
  buffer_load_dwordx4 a[172:175], v162, s[8:11], s30 offen offset:3072 sc1
  v_mfma_f32_16x16x32_bf16 v[68:71], a[4:7], a[68:71], v[68:71]
  ds_read_b64_tr_b16 a[38:39], v167 offset:32416
  s_add_u32 s30, s30, 0x1000
  v_mfma_f32_16x16x32_bf16 v[72:75], a[8:11], a[64:67], v[72:75]
  ds_read_b64_tr_b16 a[40:41], v167 offset:27840
  v_mfma_f32_16x16x32_bf16 v[76:79], a[8:11], a[68:71], v[76:79]
  ds_read_b64_tr_b16 a[42:43], v167 offset:32448
  v_mfma_f32_16x16x32_bf16 v[8:11], a[12:15], a[72:75], v[8:11]
  ds_read_b64_tr_b16 a[44:45], v167 offset:27872
  s_waitcnt vmcnt(33)
  s_barrier
  v_mfma_f32_16x16x32_bf16 v[12:15], a[12:15], a[76:79], v[12:15]
  ds_read_b64_tr_b16 a[46:47], v167 offset:32480
  s_waitcnt lgkmcnt(8)
  v_mfma_f32_16x16x32_bf16 v[16:19], a[16:19], a[72:75], v[16:19]
  ds_read_b64_tr_b16 a[0:1], v170
  v_mfma_f32_16x16x32_bf16 v[20:23], a[16:19], a[76:79], v[20:23]
  ds_read_b64_tr_b16 a[2:3], v170 offset:4608
  v_mfma_f32_16x16x32_bf16 v[24:27], a[20:23], a[72:75], v[24:27]
  ds_read_b64_tr_b16 a[4:5], v169
  v_mfma_f32_16x16x32_bf16 v[28:31], a[20:23], a[76:79], v[28:31]
  ds_read_b64_tr_b16 a[6:7], v169 offset:4608
  v_mfma_f32_16x16x32_bf16 v[32:35], a[24:27], a[72:75], v[32:35]
  ds_read_b64_tr_b16 a[8:9], v169 offset:32
  v_mfma_f32_16x16x32_bf16 v[36:39], a[24:27], a[76:79], v[36:39]
  ds_read_b64_tr_b16 a[10:11], v169 offset:4640
  v_mfma_f32_16x16x32_bf16 v[40:43], a[28:31], a[72:75], v[40:43]
  ds_read_b64_tr_b16 a[12:13], v169 offset:64
  v_mfma_f32_16x16x32_bf16 v[44:47], a[28:31], a[76:79], v[44:47]
  ds_read_b64_tr_b16 a[14:15], v169 offset:4672
  s_waitcnt lgkmcnt(8)
  v_mfma_f32_16x16x32_bf16 v[48:51], a[32:35], a[72:75], v[48:51]
  ds_read_b64_tr_b16 a[16:17], v169 offset:96
  v_mfma_f32_16x16x32_bf16 v[52:55], a[32:35], a[76:79], v[52:55]
  ds_read_b64_tr_b16 a[18:19], v169 offset:4704
  v_mfma_f32_16x16x32_bf16 v[56:59], a[36:39], a[72:75], v[56:59]
  ds_read_b64_tr_b16 a[20:21], v169 offset:128
  v_mfma_f32_16x16x32_bf16 v[60:63], a[36:39], a[76:79], v[60:63]
  ds_read_b64_tr_b16 a[22:23], v169 offset:4736
  v_mfma_f32_16x16x32_bf16 v[64:67], a[40:43], a[72:75], v[64:67]
  ds_read_b64_tr_b16 a[24:25], v169 offset:160
  v_mfma_f32_16x16x32_bf16 v[68:71], a[40:43], a[76:79], v[68:71]
  ds_read_b64_tr_b16 a[26:27], v169 offset:4768
  v_mfma_f32_16x16x32_bf16 v[72:75], a[44:47], a[72:75], v[72:75]
  ds_read_b64_tr_b16 a[28:29], v169 offset:192
  v_mfma_f32_16x16x32_bf16 v[76:79], a[44:47], a[76:79], v[76:79]
  ds_read_b64_tr_b16 a[30:31], v169 offset:4800
  s_waitcnt vmcnt(31) lgkmcnt(14)
  v_mfma_f32_16x16x32_bf16 v[8:11], a[0:3], a[80:83], v[8:11]
  ds_read_b64_tr_b16 a[32:33], v169 offset:224
  v_mfma_f32_16x16x32_bf16 v[12:15], a[0:3], a[84:87], v[12:15]
  ds_read_b64_tr_b16 a[34:35], v169 offset:4832
  s_waitcnt vmcnt(42) lgkmcnt(10)
  s_barrier
  v_mfma_f32_16x16x32_bf16 v[16:19], a[4:7], a[80:83], v[16:19]
  ds_read_b64_tr_b16 a[36:37], v170 offset:9216
  s_add_u32 m0, s60, 0x9000
  s_nop 0
  buffer_load_dwordx4 v240, s[56:59], s61 offen lds
  v_mfma_f32_16x16x32_bf16 v[20:23], a[4:7], a[84:87], v[20:23]
  ds_read_b64_tr_b16 a[38:39], v170 offset:13824
  v_mfma_f32_16x16x32_bf16 v[24:27], a[8:11], a[80:83], v[24:27]
  ds_read_b64_tr_b16 a[40:41], v169 offset:9216
  buffer_load_dwordx4 v241, s[56:59], s61 offen offset:1024 lds
  v_mfma_f32_16x16x32_bf16 v[28:31], a[8:11], a[84:87], v[28:31]
  ds_read_b64_tr_b16 a[42:43], v169 offset:13824
  v_mfma_f32_16x16x32_bf16 v[32:35], a[12:15], a[80:83], v[32:35]
  ds_read_b64_tr_b16 a[44:45], v169 offset:9248
  v_mfma_f32_16x16x32_bf16 v[36:39], a[12:15], a[84:87], v[36:39]
  ds_read_b64_tr_b16 a[46:47], v169 offset:13856
  buffer_load_dwordx4 v242, s[56:59], s61 offen offset:2048 lds
  s_waitcnt lgkmcnt(8)
  v_mfma_f32_16x16x32_bf16 v[40:43], a[16:19], a[80:83], v[40:43]
  ds_read_b64_tr_b16 a[0:1], v169 offset:9280
  v_mfma_f32_16x16x32_bf16 v[44:47], a[16:19], a[84:87], v[44:47]
  ds_read_b64_tr_b16 a[2:3], v169 offset:13888
  buffer_load_dwordx4 v243, s[56:59], s61 offen offset:3072 lds
  v_mfma_f32_16x16x32_bf16 v[48:51], a[20:23], a[80:83], v[48:51]
  ds_read_b64_tr_b16 a[4:5], v169 offset:9312
  s_add_u32 m0, s60, 0xa000
  v_mfma_f32_16x16x32_bf16 v[52:55], a[20:23], a[84:87], v[52:55]
  ds_read_b64_tr_b16 a[6:7], v169 offset:13920
  v_mfma_f32_16x16x32_bf16 v[56:59], a[24:27], a[80:83], v[56:59]
  ds_read_b64_tr_b16 a[8:9], v169 offset:9344
  buffer_load_dwordx4 v244, s[56:59], s61 offen lds
  v_mfma_f32_16x16x32_bf16 v[60:63], a[24:27], a[84:87], v[60:63]
  ds_read_b64_tr_b16 a[10:11], v169 offset:13952
  v_mfma_f32_16x16x32_bf16 v[64:67], a[28:31], a[80:83], v[64:67]
  ds_read_b64_tr_b16 a[12:13], v169 offset:9376
  v_mfma_f32_16x16x32_bf16 v[68:71], a[28:31], a[84:87], v[68:71]
  ds_read_b64_tr_b16 a[14:15], v169 offset:13984
  buffer_load_dwordx4 v245, s[56:59], s61 offen offset:1024 lds
  s_waitcnt vmcnt(35) lgkmcnt(8)
  v_mfma_f32_16x16x32_bf16 v[72:75], a[32:35], a[80:83], v[72:75]
  ds_read_b64_tr_b16 a[16:17], v169 offset:9408
  v_mfma_f32_16x16x32_bf16 v[76:79], a[32:35], a[84:87], v[76:79]
  ds_read_b64_tr_b16 a[18:19], v169 offset:14016
  buffer_load_dwordx4 v246, s[56:59], s61 offen offset:2048 lds
  v_mfma_f32_16x16x32_bf16 v[8:11], a[36:39], a[88:91], v[8:11]
  ds_read_b64_tr_b16 a[20:21], v169 offset:9440
  v_mfma_f32_16x16x32_bf16 v[12:15], a[36:39], a[92:95], v[12:15]
  ds_read_b64_tr_b16 a[22:23], v169 offset:14048
  v_mfma_f32_16x16x32_bf16 v[16:19], a[40:43], a[88:91], v[16:19]
  ds_read_b64_tr_b16 a[24:25], v170 offset:18432
  buffer_load_dwordx4 v247, s[56:59], s61 offen offset:3072 lds
  v_mfma_f32_16x16x32_bf16 v[20:23], a[40:43], a[92:95], v[20:23]
  ds_read_b64_tr_b16 a[26:27], v170 offset:23040
  s_add_u32 m0, s60, 0xb000
  v_mfma_f32_16x16x32_bf16 v[24:27], a[44:47], a[88:91], v[24:27]
  ds_read_b64_tr_b16 a[28:29], v169 offset:18432
  v_mfma_f32_16x16x32_bf16 v[28:31], a[44:47], a[92:95], v[28:31]
  ds_read_b64_tr_b16 a[30:31], v169 offset:23040
  buffer_load_dwordx4 v248, s[56:59], s61 offen lds
  s_waitcnt lgkmcnt(8)
  v_mfma_f32_16x16x32_bf16 v[32:35], a[0:3], a[88:91], v[32:35]
  ds_read_b64_tr_b16 a[32:33], v169 offset:18464
  s_add_u32 s61, s61, 0x24000
  v_mfma_f32_16x16x32_bf16 v[36:39], a[0:3], a[92:95], v[36:39]
  ds_read_b64_tr_b16 a[34:35], v169 offset:23072
  buffer_load_dwordx4 a[176:179], v161, s[8:11], s30 offen sc1
  v_mfma_f32_16x16x32_bf16 v[40:43], a[4:7], a[88:91], v[40:43]
  ds_read_b64_tr_b16 a[36:37], v169 offset:18496
  v_mfma_f32_16x16x32_bf16 v[44:47], a[4:7], a[92:95], v[44:47]
  ds_read_b64_tr_b16 a[38:39], v169 offset:23104
  v_mfma_f32_16x16x32_bf16 v[48:51], a[8:11], a[88:91], v[48:51]
  ds_read_b64_tr_b16 a[40:41], v169 offset:18528
  buffer_load_dwordx4 a[180:183], v162, s[8:11], s30 offen sc1
  v_mfma_f32_16x16x32_bf16 v[52:55], a[8:11], a[92:95], v[52:55]
  ds_read_b64_tr_b16 a[42:43], v169 offset:23136
  v_mfma_f32_16x16x32_bf16 v[56:59], a[12:15], a[88:91], v[56:59]
  ds_read_b64_tr_b16 a[44:45], v169 offset:18560
  v_mfma_f32_16x16x32_bf16 v[60:63], a[12:15], a[92:95], v[60:63]
  ds_read_b64_tr_b16 a[46:47], v169 offset:23168
  buffer_load_dwordx4 a[184:187], v161, s[8:11], s30 offen offset:1024 sc1
  s_waitcnt vmcnt(39) lgkmcnt(8)
  v_mfma_f32_16x16x32_bf16 v[64:67], a[16:19], a[88:91], v[64:67]
  ds_read_b64_tr_b16 a[0:1], v169 offset:18592
  v_mfma_f32_16x16x32_bf16 v[68:71], a[16:19], a[92:95], v[68:71]
  ds_read_b64_tr_b16 a[2:3], v169 offset:23200
  buffer_load_dwordx4 a[188:191], v162, s[8:11], s30 offen offset:1024 sc1
  v_mfma_f32_16x16x32_bf16 v[72:75], a[20:23], a[88:91], v[72:75]
  ds_read_b64_tr_b16 a[4:5], v169 offset:18624
  v_mfma_f32_16x16x32_bf16 v[76:79], a[20:23], a[92:95], v[76:79]
  ds_read_b64_tr_b16 a[6:7], v169 offset:23232
  v_mfma_f32_16x16x32_bf16 v[8:11], a[24:27], a[96:99], v[8:11]
  ds_read_b64_tr_b16 a[8:9], v169 offset:18656
  buffer_load_dwordx4 a[192:195], v161, s[8:11], s30 offen offset:2048 sc1
  v_mfma_f32_16x16x32_bf16 v[12:15], a[24:27], a[100:103], v[12:15]
  ds_read_b64_tr_b16 a[10:11], v169 offset:23264
  v_mfma_f32_16x16x32_bf16 v[16:19], a[28:31], a[96:99], v[16:19]
  ds_read_b64_tr_b16 a[12:13], v170 offset:27648
  buffer_load_dwordx4 a[196:199], v162, s[8:11], s30 offen offset:2048 sc1
  v_mfma_f32_16x16x32_bf16 v[20:23], a[28:31], a[100:103], v[20:23]
  ds_read_b64_tr_b16 a[14:15], v170 offset:32256
  s_waitcnt lgkmcnt(8)
  v_mfma_f32_16x16x32_bf16 v[24:27], a[32:35], a[96:99], v[24:27]
  ds_read_b64_tr_b16 a[16:17], v169 offset:27648
  v_mfma_f32_16x16x32_bf16 v[28:31], a[32:35], a[100:103], v[28:31]
  ds_read_b64_tr_b16 a[18:19], v169 offset:32256
  buffer_load_dwordx4 a[200:203], v161, s[8:11], s30 offen offset:3072 sc1
  v_mfma_f32_16x16x32_bf16 v[32:35], a[36:39], a[96:99], v[32:35]
  ds_read_b64_tr_b16 a[20:21], v169 offset:27680
  v_mfma_f32_16x16x32_bf16 v[36:39], a[36:39], a[100:103], v[36:39]
  ds_read_b64_tr_b16 a[22:23], v169 offset:32288
  v_mfma_f32_16x16x32_bf16 v[40:43], a[40:43], a[96:99], v[40:43]
  ds_read_b64_tr_b16 a[24:25], v169 offset:27712
  buffer_load_dwordx4 a[204:207], v162, s[8:11], s30 offen offset:3072 sc1
  v_mfma_f32_16x16x32_bf16 v[44:47], a[40:43], a[100:103], v[44:47]
  ds_read_b64_tr_b16 a[26:27], v169 offset:32320
  s_add_u32 s30, s30, 0x1000
  v_mfma_f32_16x16x32_bf16 v[48:51], a[44:47], a[96:99], v[48:51]
  ds_read_b64_tr_b16 a[28:29], v169 offset:27744
  buffer_load_dwordx4 a[208:211], v161, s[8:11], s30 offen sc1
  v_mfma_f32_16x16x32_bf16 v[52:55], a[44:47], a[100:103], v[52:55]
  ds_read_b64_tr_b16 a[30:31], v169 offset:32352
  s_waitcnt vmcnt(43) lgkmcnt(8)
  v_mfma_f32_16x16x32_bf16 v[56:59], a[0:3], a[96:99], v[56:59]
  ds_read_b64_tr_b16 a[32:33], v169 offset:27776
  v_mfma_f32_16x16x32_bf16 v[60:63], a[0:3], a[100:103], v[60:63]
  ds_read_b64_tr_b16 a[34:35], v169 offset:32384
  buffer_load_dwordx4 a[212:215], v162, s[8:11], s30 offen sc1
  v_mfma_f32_16x16x32_bf16 v[64:67], a[4:7], a[96:99], v[64:67]
  ds_read_b64_tr_b16 a[36:37], v169 offset:27808
  v_mfma_f32_16x16x32_bf16 v[68:71], a[4:7], a[100:103], v[68:71]
  ds_read_b64_tr_b16 a[38:39], v169 offset:32416
  v_mfma_f32_16x16x32_bf16 v[72:75], a[8:11], a[96:99], v[72:75]
  ds_read_b64_tr_b16 a[40:41], v169 offset:27840
  buffer_load_dwordx4 a[216:219], v161, s[8:11], s30 offen offset:1024 sc1
  v_mfma_f32_16x16x32_bf16 v[76:79], a[8:11], a[100:103], v[76:79]
  ds_read_b64_tr_b16 a[42:43], v169 offset:32448
  v_mfma_f32_16x16x32_bf16 v[8:11], a[12:15], a[104:107], v[8:11]
  ds_read_b64_tr_b16 a[44:45], v169 offset:27872
  buffer_load_dwordx4 a[220:223], v162, s[8:11], s30 offen offset:1024 sc1
  v_mfma_f32_16x16x32_bf16 v[12:15], a[12:15], a[108:111], v[12:15]
  ds_read_b64_tr_b16 a[46:47], v169 offset:32480
  s_waitcnt lgkmcnt(8)
  v_mfma_f32_16x16x32_bf16 v[16:19], a[16:19], a[104:107], v[16:19]
  ds_read_b64_tr_b16 a[0:1], v172
  v_mfma_f32_16x16x32_bf16 v[20:23], a[16:19], a[108:111], v[20:23]
  ds_read_b64_tr_b16 a[2:3], v172 offset:4608
  buffer_load_dwordx4 a[224:227], v161, s[8:11], s30 offen offset:2048 sc1
  v_mfma_f32_16x16x32_bf16 v[24:27], a[20:23], a[104:107], v[24:27]
  ds_read_b64_tr_b16 a[4:5], v171
  v_mfma_f32_16x16x32_bf16 v[28:31], a[20:23], a[108:111], v[28:31]
  ds_read_b64_tr_b16 a[6:7], v171 offset:4608
  v_mfma_f32_16x16x32_bf16 v[32:35], a[24:27], a[104:107], v[32:35]
  ds_read_b64_tr_b16 a[8:9], v171 offset:32
  buffer_load_dwordx4 a[228:231], v162, s[8:11], s30 offen offset:2048 sc1
  v_mfma_f32_16x16x32_bf16 v[36:39], a[24:27], a[108:111], v[36:39]
  ds_read_b64_tr_b16 a[10:11], v171 offset:4640
  v_mfma_f32_16x16x32_bf16 v[40:43], a[28:31], a[104:107], v[40:43]
  ds_read_b64_tr_b16 a[12:13], v171 offset:64
  buffer_load_dwordx4 a[232:235], v161, s[8:11], s30 offen offset:3072 sc1
  v_mfma_f32_16x16x32_bf16 v[44:47], a[28:31], a[108:111], v[44:47]
  ds_read_b64_tr_b16 a[14:15], v171 offset:4672
  s_waitcnt lgkmcnt(8)
  v_mfma_f32_16x16x32_bf16 v[48:51], a[32:35], a[104:107], v[48:51]
  ds_read_b64_tr_b16 a[16:17], v171 offset:96
  v_mfma_f32_16x16x32_bf16 v[52:55], a[32:35], a[108:111], v[52:55]
  ds_read_b64_tr_b16 a[18:19], v171 offset:4704
  buffer_load_dwordx4 a[236:239], v162, s[8:11], s30 offen offset:3072 sc1
  v_mfma_f32_16x16x32_bf16 v[56:59], a[36:39], a[104:107], v[56:59]
  ds_read_b64_tr_b16 a[20:21], v171 offset:128
  s_add_u32 s30, s30, 0x1000
  v_mfma_f32_16x16x32_bf16 v[60:63], a[36:39], a[108:111], v[60:63]
  ds_read_b64_tr_b16 a[22:23], v171 offset:4736
  v_mfma_f32_16x16x32_bf16 v[64:67], a[40:43], a[104:107], v[64:67]
  ds_read_b64_tr_b16 a[24:25], v171 offset:160
  v_mfma_f32_16x16x32_bf16 v[68:71], a[40:43], a[108:111], v[68:71]
  ds_read_b64_tr_b16 a[26:27], v171 offset:4768
  v_mfma_f32_16x16x32_bf16 v[72:75], a[44:47], a[104:107], v[72:75]
  ds_read_b64_tr_b16 a[28:29], v171 offset:192
  v_mfma_f32_16x16x32_bf16 v[76:79], a[44:47], a[108:111], v[76:79]
  ds_read_b64_tr_b16 a[30:31], v171 offset:4800
  s_waitcnt vmcnt(39) lgkmcnt(14)
  v_mfma_f32_16x16x32_bf16 v[8:11], a[0:3], a[112:115], v[8:11]
  ds_read_b64_tr_b16 a[32:33], v171 offset:224
  v_mfma_f32_16x16x32_bf16 v[12:15], a[0:3], a[116:119], v[12:15]
  ds_read_b64_tr_b16 a[34:35], v171 offset:4832
  s_waitcnt vmcnt(41) lgkmcnt(10)
  s_barrier
  v_mfma_f32_16x16x32_bf16 v[16:19], a[4:7], a[112:115], v[16:19]
  ds_read_b64_tr_b16 a[36:37], v172 offset:9216
  s_add_u32 m0, s60, 0x12000
  s_nop 0
  buffer_load_dwordx4 v240, s[56:59], s61 offen lds
  v_mfma_f32_16x16x32_bf16 v[20:23], a[4:7], a[116:119], v[20:23]
  ds_read_b64_tr_b16 a[38:39], v172 offset:13824
  v_mfma_f32_16x16x32_bf16 v[24:27], a[8:11], a[112:115], v[24:27]
  ds_read_b64_tr_b16 a[40:41], v171 offset:9216
  buffer_load_dwordx4 v241, s[56:59], s61 offen offset:1024 lds
  v_mfma_f32_16x16x32_bf16 v[28:31], a[8:11], a[116:119], v[28:31]
  ds_read_b64_tr_b16 a[42:43], v171 offset:13824
  v_mfma_f32_16x16x32_bf16 v[32:35], a[12:15], a[112:115], v[32:35]
  ds_read_b64_tr_b16 a[44:45], v171 offset:9248
  v_mfma_f32_16x16x32_bf16 v[36:39], a[12:15], a[116:119], v[36:39]
  ds_read_b64_tr_b16 a[46:47], v171 offset:13856
  buffer_load_dwordx4 v242, s[56:59], s61 offen offset:2048 lds
  s_waitcnt lgkmcnt(8)
  v_mfma_f32_16x16x32_bf16 v[40:43], a[16:19], a[112:115], v[40:43]
  ds_read_b64_tr_b16 a[0:1], v171 offset:9280
  v_mfma_f32_16x16x32_bf16 v[44:47], a[16:19], a[116:119], v[44:47]
  ds_read_b64_tr_b16 a[2:3], v171 offset:13888
  buffer_load_dwordx4 v243, s[56:59], s61 offen offset:3072 lds
  v_mfma_f32_16x16x32_bf16 v[48:51], a[20:23], a[112:115], v[48:51]
  ds_read_b64_tr_b16 a[4:5], v171 offset:9312
  s_add_u32 m0, s60, 0x13000
  v_mfma_f32_16x16x32_bf16 v[52:55], a[20:23], a[116:119], v[52:55]
  ds_read_b64_tr_b16 a[6:7], v171 offset:13920
  v_mfma_f32_16x16x32_bf16 v[56:59], a[24:27], a[112:115], v[56:59]
  ds_read_b64_tr_b16 a[8:9], v171 offset:9344
  buffer_load_dwordx4 v244, s[56:59], s61 offen lds
  v_mfma_f32_16x16x32_bf16 v[60:63], a[24:27], a[116:119], v[60:63]
  ds_read_b64_tr_b16 a[10:11], v171 offset:13952
  v_mfma_f32_16x16x32_bf16 v[64:67], a[28:31], a[112:115], v[64:67]
  ds_read_b64_tr_b16 a[12:13], v171 offset:9376
  v_mfma_f32_16x16x32_bf16 v[68:71], a[28:31], a[116:119], v[68:71]
  ds_read_b64_tr_b16 a[14:15], v171 offset:13984
  buffer_load_dwordx4 v245, s[56:59], s61 offen offset:1024 lds
  s_waitcnt vmcnt(43) lgkmcnt(8)
  v_mfma_f32_16x16x32_bf16 v[72:75], a[32:35], a[112:115], v[72:75]
  ds_read_b64_tr_b16 a[16:17], v171 offset:9408
  v_mfma_f32_16x16x32_bf16 v[76:79], a[32:35], a[116:119], v[76:79]
  ds_read_b64_tr_b16 a[18:19], v171 offset:14016
  buffer_load_dwordx4 v246, s[56:59], s61 offen offset:2048 lds
  v_mfma_f32_16x16x32_bf16 v[8:11], a[36:39], a[120:123], v[8:11]
  ds_read_b64_tr_b16 a[20:21], v171 offset:9440
  v_mfma_f32_16x16x32_bf16 v[12:15], a[36:39], a[124:127], v[12:15]
  ds_read_b64_tr_b16 a[22:23], v171 offset:14048
  v_mfma_f32_16x16x32_bf16 v[16:19], a[40:43], a[120:123], v[16:19]
  ds_read_b64_tr_b16 a[24:25], v172 offset:18432
  buffer_load_dwordx4 v247, s[56:59], s61 offen offset:3072 lds
  v_mfma_f32_16x16x32_bf16 v[20:23], a[40:43], a[124:127], v[20:23]
  ds_read_b64_tr_b16 a[26:27], v172 offset:23040
  s_add_u32 m0, s60, 0x14000
  v_mfma_f32_16x16x32_bf16 v[24:27], a[44:47], a[120:123], v[24:27]
  ds_read_b64_tr_b16 a[28:29], v171 offset:18432
  v_mfma_f32_16x16x32_bf16 v[28:31], a[44:47], a[124:127], v[28:31]
  ds_read_b64_tr_b16 a[30:31], v171 offset:23040
  buffer_load_dwordx4 v248, s[56:59], s61 offen lds
  s_waitcnt lgkmcnt(8)
  v_mfma_f32_16x16x32_bf16 v[32:35], a[0:3], a[120:123], v[32:35]
  ds_read_b64_tr_b16 a[32:33], v171 offset:18464
  s_add_u32 s61, s61, 0x24000
  v_mfma_f32_16x16x32_bf16 v[36:39], a[0:3], a[124:127], v[36:39]
  ds_read_b64_tr_b16 a[34:35], v171 offset:23072
  buffer_load_dwordx4 a[48:51], v161, s[8:11], s30 offen sc1
  v_mfma_f32_16x16x32_bf16 v[40:43], a[4:7], a[120:123], v[40:43]
  ds_read_b64_tr_b16 a[36:37], v171 offset:18496
  v_mfma_f32_16x16x32_bf16 v[44:47], a[4:7], a[124:127], v[44:47]
  ds_read_b64_tr_b16 a[38:39], v171 offset:23104
  v_mfma_f32_16x16x32_bf16 v[48:51], a[8:11], a[120:123], v[48:51]
  ds_read_b64_tr_b16 a[40:41], v171 offset:18528
  buffer_load_dwordx4 a[52:55], v162, s[8:11], s30 offen sc1
  v_mfma_f32_16x16x32_bf16 v[52:55], a[8:11], a[124:127], v[52:55]
  ds_read_b64_tr_b16 a[42:43], v171 offset:23136
  v_mfma_f32_16x16x32_bf16 v[56:59], a[12:15], a[120:123], v[56:59]
  ds_read_b64_tr_b16 a[44:45], v171 offset:18560
  v_mfma_f32_16x16x32_bf16 v[60:63], a[12:15], a[124:127], v[60:63]
  ds_read_b64_tr_b16 a[46:47], v171 offset:23168
  buffer_load_dwordx4 a[56:59], v161, s[8:11], s30 offen offset:1024 sc1
  s_waitcnt vmcnt(47) lgkmcnt(8)
  v_mfma_f32_16x16x32_bf16 v[64:67], a[16:19], a[120:123], v[64:67]
  ds_read_b64_tr_b16 a[0:1], v171 offset:18592
  v_mfma_f32_16x16x32_bf16 v[68:71], a[16:19], a[124:127], v[68:71]
  ds_read_b64_tr_b16 a[2:3], v171 offset:23200
  buffer_load_dwordx4 a[60:63], v162, s[8:11], s30 offen offset:1024 sc1
  v_mfma_f32_16x16x32_bf16 v[72:75], a[20:23], a[120:123], v[72:75]
  ds_read_b64_tr_b16 a[4:5], v171 offset:18624
  v_mfma_f32_16x16x32_bf16 v[76:79], a[20:23], a[124:127], v[76:79]
  ds_read_b64_tr_b16 a[6:7], v171 offset:23232
  v_mfma_f32_16x16x32_bf16 v[8:11], a[24:27], a[128:131], v[8:11]
  ds_read_b64_tr_b16 a[8:9], v171 offset:18656
  buffer_load_dwordx4 a[64:67], v161, s[8:11], s30 offen offset:2048 sc1
  v_mfma_f32_16x16x32_bf16 v[12:15], a[24:27], a[132:135], v[12:15]
  ds_read_b64_tr_b16 a[10:11], v171 offset:23264
  v_mfma_f32_16x16x32_bf16 v[16:19], a[28:31], a[128:131], v[16:19]
  ds_read_b64_tr_b16 a[12:13], v172 offset:27648
  buffer_load_dwordx4 a[68:71], v162, s[8:11], s30 offen offset:2048 sc1
  v_mfma_f32_16x16x32_bf16 v[20:23], a[28:31], a[132:135], v[20:23]
  ds_read_b64_tr_b16 a[14:15], v172 offset:32256
  s_waitcnt lgkmcnt(8)
  v_mfma_f32_16x16x32_bf16 v[24:27], a[32:35], a[128:131], v[24:27]
  ds_read_b64_tr_b16 a[16:17], v171 offset:27648
  v_mfma_f32_16x16x32_bf16 v[28:31], a[32:35], a[132:135], v[28:31]
  ds_read_b64_tr_b16 a[18:19], v171 offset:32256
  buffer_load_dwordx4 a[72:75], v161, s[8:11], s30 offen offset:3072 sc1
  v_mfma_f32_16x16x32_bf16 v[32:35], a[36:39], a[128:131], v[32:35]
  ds_read_b64_tr_b16 a[20:21], v171 offset:27680
  v_mfma_f32_16x16x32_bf16 v[36:39], a[36:39], a[132:135], v[36:39]
  ds_read_b64_tr_b16 a[22:23], v171 offset:32288
  v_mfma_f32_16x16x32_bf16 v[40:43], a[40:43], a[128:131], v[40:43]
  ds_read_b64_tr_b16 a[24:25], v171 offset:27712
  buffer_load_dwordx4 a[76:79], v162, s[8:11], s30 offen offset:3072 sc1
  v_mfma_f32_16x16x32_bf16 v[44:47], a[40:43], a[132:135], v[44:47]
  ds_read_b64_tr_b16 a[26:27], v171 offset:32320
  s_add_u32 s30, s30, 0x1000
  v_mfma_f32_16x16x32_bf16 v[48:51], a[44:47], a[128:131], v[48:51]
  ds_read_b64_tr_b16 a[28:29], v171 offset:27744
  buffer_load_dwordx4 a[80:83], v161, s[8:11], s30 offen sc1
  v_mfma_f32_16x16x32_bf16 v[52:55], a[44:47], a[132:135], v[52:55]
  ds_read_b64_tr_b16 a[30:31], v171 offset:32352
  s_waitcnt vmcnt(51) lgkmcnt(8)
  v_mfma_f32_16x16x32_bf16 v[56:59], a[0:3], a[128:131], v[56:59]
  ds_read_b64_tr_b16 a[32:33], v171 offset:27776
  v_mfma_f32_16x16x32_bf16 v[60:63], a[0:3], a[132:135], v[60:63]
  ds_read_b64_tr_b16 a[34:35], v171 offset:32384
  buffer_load_dwordx4 a[84:87], v162, s[8:11], s30 offen sc1
  v_mfma_f32_16x16x32_bf16 v[64:67], a[4:7], a[128:131], v[64:67]
  ds_read_b64_tr_b16 a[36:37], v171 offset:27808
  v_mfma_f32_16x16x32_bf16 v[68:71], a[4:7], a[132:135], v[68:71]
  ds_read_b64_tr_b16 a[38:39], v171 offset:32416
  v_mfma_f32_16x16x32_bf16 v[72:75], a[8:11], a[128:131], v[72:75]
  ds_read_b64_tr_b16 a[40:41], v171 offset:27840
  buffer_load_dwordx4 a[88:91], v161, s[8:11], s30 offen offset:1024 sc1
  v_mfma_f32_16x16x32_bf16 v[76:79], a[8:11], a[132:135], v[76:79]
  ds_read_b64_tr_b16 a[42:43], v171 offset:32448
  v_mfma_f32_16x16x32_bf16 v[8:11], a[12:15], a[136:139], v[8:11]
  ds_read_b64_tr_b16 a[44:45], v171 offset:27872
  buffer_load_dwordx4 a[92:95], v162, s[8:11], s30 offen offset:1024 sc1
  v_mfma_f32_16x16x32_bf16 v[12:15], a[12:15], a[140:143], v[12:15]
  ds_read_b64_tr_b16 a[46:47], v171 offset:32480
  s_waitcnt lgkmcnt(8)
  v_mfma_f32_16x16x32_bf16 v[16:19], a[16:19], a[136:139], v[16:19]
  ds_read_b64_tr_b16 a[0:1], v166
  v_mfma_f32_16x16x32_bf16 v[20:23], a[16:19], a[140:143], v[20:23]
  ds_read_b64_tr_b16 a[2:3], v166 offset:4608
  buffer_load_dwordx4 a[96:99], v161, s[8:11], s30 offen offset:2048 sc1
  v_mfma_f32_16x16x32_bf16 v[24:27], a[20:23], a[136:139], v[24:27]
  ds_read_b64_tr_b16 a[4:5], v165
  v_mfma_f32_16x16x32_bf16 v[28:31], a[20:23], a[140:143], v[28:31]
  ds_read_b64_tr_b16 a[6:7], v165 offset:4608
  v_mfma_f32_16x16x32_bf16 v[32:35], a[24:27], a[136:139], v[32:35]
  ds_read_b64_tr_b16 a[8:9], v165 offset:32
  buffer_load_dwordx4 a[100:103], v162, s[8:11], s30 offen offset:2048 sc1
  v_mfma_f32_16x16x32_bf16 v[36:39], a[24:27], a[140:143], v[36:39]
  ds_read_b64_tr_b16 a[10:11], v165 offset:4640
  v_mfma_f32_16x16x32_bf16 v[40:43], a[28:31], a[136:139], v[40:43]
  ds_read_b64_tr_b16 a[12:13], v165 offset:64
  buffer_load_dwordx4 a[104:107], v161, s[8:11], s30 offen offset:3072 sc1
  v_mfma_f32_16x16x32_bf16 v[44:47], a[28:31], a[140:143], v[44:47]
  ds_read_b64_tr_b16 a[14:15], v165 offset:4672
  s_waitcnt lgkmcnt(8)
  v_mfma_f32_16x16x32_bf16 v[48:51], a[32:35], a[136:139], v[48:51]
  ds_read_b64_tr_b16 a[16:17], v165 offset:96
  v_mfma_f32_16x16x32_bf16 v[52:55], a[32:35], a[140:143], v[52:55]
  ds_read_b64_tr_b16 a[18:19], v165 offset:4704
  buffer_load_dwordx4 a[108:111], v162, s[8:11], s30 offen offset:3072 sc1
  v_mfma_f32_16x16x32_bf16 v[56:59], a[36:39], a[136:139], v[56:59]
  ds_read_b64_tr_b16 a[20:21], v165 offset:128
  s_add_u32 s30, s30, 0x1000
  v_mfma_f32_16x16x32_bf16 v[60:63], a[36:39], a[140:143], v[60:63]
  ds_read_b64_tr_b16 a[22:23], v165 offset:4736
  v_mfma_f32_16x16x32_bf16 v[64:67], a[40:43], a[136:139], v[64:67]
  ds_read_b64_tr_b16 a[24:25], v165 offset:160
  v_mfma_f32_16x16x32_bf16 v[68:71], a[40:43], a[140:143], v[68:71]
  ds_read_b64_tr_b16 a[26:27], v165 offset:4768
  v_mfma_f32_16x16x32_bf16 v[72:75], a[44:47], a[136:139], v[72:75]
  ds_read_b64_tr_b16 a[28:29], v165 offset:192
  v_mfma_f32_16x16x32_bf16 v[76:79], a[44:47], a[140:143], v[76:79]
  ds_read_b64_tr_b16 a[30:31], v165 offset:4800
  s_waitcnt vmcnt(56) lgkmcnt(14)
  v_mfma_f32_16x16x32_bf16 v[8:11], a[0:3], a[144:147], v[8:11]
  ds_read_b64_tr_b16 a[32:33], v165 offset:224
  v_mfma_f32_16x16x32_bf16 v[12:15], a[0:3], a[148:151], v[12:15]
  ds_read_b64_tr_b16 a[34:35], v165 offset:4832
  s_waitcnt vmcnt(41) lgkmcnt(10)
  s_barrier
  v_mfma_f32_16x16x32_bf16 v[16:19], a[4:7], a[144:147], v[16:19]
  ds_read_b64_tr_b16 a[36:37], v166 offset:9216
  s_add_u32 m0, s60, 0x1b000
  s_nop 0
  buffer_load_dwordx4 v240, s[56:59], s61 offen lds
  v_mfma_f32_16x16x32_bf16 v[20:23], a[4:7], a[148:151], v[20:23]
  ds_read_b64_tr_b16 a[38:39], v166 offset:13824
  v_mfma_f32_16x16x32_bf16 v[24:27], a[8:11], a[144:147], v[24:27]
  ds_read_b64_tr_b16 a[40:41], v165 offset:9216
  v_mfma_f32_16x16x32_bf16 v[28:31], a[8:11], a[148:151], v[28:31]
  ds_read_b64_tr_b16 a[42:43], v165 offset:13824
  buffer_load_dwordx4 v241, s[56:59], s61 offen offset:1024 lds
  v_mfma_f32_16x16x32_bf16 v[32:35], a[12:15], a[144:147], v[32:35]
  ds_read_b64_tr_b16 a[44:45], v165 offset:9248
  v_mfma_f32_16x16x32_bf16 v[36:39], a[12:15], a[148:151], v[36:39]
  ds_read_b64_tr_b16 a[46:47], v165 offset:13856
  s_waitcnt lgkmcnt(8)
  v_mfma_f32_16x16x32_bf16 v[40:43], a[16:19], a[144:147], v[40:43]
  ds_read_b64_tr_b16 a[0:1], v165 offset:9280
  v_mfma_f32_16x16x32_bf16 v[44:47], a[16:19], a[148:151], v[44:47]
  ds_read_b64_tr_b16 a[2:3], v165 offset:13888
  buffer_load_dwordx4 v242, s[56:59], s61 offen offset:2048 lds
  v_mfma_f32_16x16x32_bf16 v[48:51], a[20:23], a[144:147], v[48:51]
  ds_read_b64_tr_b16 a[4:5], v165 offset:9312
  v_mfma_f32_16x16x32_bf16 v[52:55], a[20:23], a[148:151], v[52:55]
  ds_read_b64_tr_b16 a[6:7], v165 offset:13920
  v_mfma_f32_16x16x32_bf16 v[56:59], a[24:27], a[144:147], v[56:59]
  ds_read_b64_tr_b16 a[8:9], v165 offset:9344
  v_mfma_f32_16x16x32_bf16 v[60:63], a[24:27], a[148:151], v[60:63]
  ds_read_b64_tr_b16 a[10:11], v165 offset:13952
  buffer_load_dwordx4 v243, s[56:59], s61 offen offset:3072 lds
  v_mfma_f32_16x16x32_bf16 v[64:67], a[28:31], a[144:147], v[64:67]
  ds_read_b64_tr_b16 a[12:13], v165 offset:9376
  s_add_u32 m0, s60, 0x1c000
  v_mfma_f32_16x16x32_bf16 v[68:71], a[28:31], a[148:151], v[68:71]
  ds_read_b64_tr_b16 a[14:15], v165 offset:13984
  s_waitcnt lgkmcnt(8)
  v_mfma_f32_16x16x32_bf16 v[72:75], a[32:35], a[144:147], v[72:75]
  ds_read_b64_tr_b16 a[16:17], v165 offset:9408
  v_mfma_f32_16x16x32_bf16 v[76:79], a[32:35], a[148:151], v[76:79]
  ds_read_b64_tr_b16 a[18:19], v165 offset:14016
  buffer_load_dwordx4 v244, s[56:59], s61 offen lds
  v_mfma_f32_16x16x32_bf16 v[8:11], a[36:39], a[152:155], v[8:11]
  ds_read_b64_tr_b16 a[20:21], v165 offset:9440
  v_mfma_f32_16x16x32_bf16 v[12:15], a[36:39], a[156:159], v[12:15]
  ds_read_b64_tr_b16 a[22:23], v165 offset:14048
  v_mfma_f32_16x16x32_bf16 v[16:19], a[40:43], a[152:155], v[16:19]
  ds_read_b64_tr_b16 a[24:25], v166 offset:18432
  v_mfma_f32_16x16x32_bf16 v[20:23], a[40:43], a[156:159], v[20:23]
  ds_read_b64_tr_b16 a[26:27], v166 offset:23040
  buffer_load_dwordx4 v245, s[56:59], s61 offen offset:1024 lds
  v_mfma_f32_16x16x32_bf16 v[24:27], a[44:47], a[152:155], v[24:27]
  ds_read_b64_tr_b16 a[28:29], v165 offset:18432
  v_mfma_f32_16x16x32_bf16 v[28:31], a[44:47], a[156:159], v[28:31]
  ds_read_b64_tr_b16 a[30:31], v165 offset:23040
  s_waitcnt lgkmcnt(8)
  v_mfma_f32_16x16x32_bf16 v[32:35], a[0:3], a[152:155], v[32:35]
  ds_read_b64_tr_b16 a[32:33], v165 offset:18464
  v_mfma_f32_16x16x32_bf16 v[36:39], a[0:3], a[156:159], v[36:39]
  ds_read_b64_tr_b16 a[34:35], v165 offset:23072
  buffer_load_dwordx4 v246, s[56:59], s61 offen offset:2048 lds
  v_mfma_f32_16x16x32_bf16 v[40:43], a[4:7], a[152:155], v[40:43]
  ds_read_b64_tr_b16 a[36:37], v165 offset:18496
  v_mfma_f32_16x16x32_bf16 v[44:47], a[4:7], a[156:159], v[44:47]
  ds_read_b64_tr_b16 a[38:39], v165 offset:23104
  v_mfma_f32_16x16x32_bf16 v[48:51], a[8:11], a[152:155], v[48:51]
  ds_read_b64_tr_b16 a[40:41], v165 offset:18528
  v_mfma_f32_16x16x32_bf16 v[52:55], a[8:11], a[156:159], v[52:55]
  ds_read_b64_tr_b16 a[42:43], v165 offset:23136
  buffer_load_dwordx4 v247, s[56:59], s61 offen offset:3072 lds
  v_mfma_f32_16x16x32_bf16 v[56:59], a[12:15], a[152:155], v[56:59]
  ds_read_b64_tr_b16 a[44:45], v165 offset:18560
  s_add_u32 m0, s60, 0x1d000
  v_mfma_f32_16x16x32_bf16 v[60:63], a[12:15], a[156:159], v[60:63]
  ds_read_b64_tr_b16 a[46:47], v165 offset:23168
  s_waitcnt lgkmcnt(8)
  v_mfma_f32_16x16x32_bf16 v[64:67], a[16:19], a[152:155], v[64:67]
  ds_read_b64_tr_b16 a[0:1], v165 offset:18592
  v_mfma_f32_16x16x32_bf16 v[68:71], a[16:19], a[156:159], v[68:71]
  ds_read_b64_tr_b16 a[2:3], v165 offset:23200
  buffer_load_dwordx4 v248, s[56:59], s61 offen lds
  v_mfma_f32_16x16x32_bf16 v[72:75], a[20:23], a[152:155], v[72:75]
  ds_read_b64_tr_b16 a[4:5], v165 offset:18624
  s_add_u32 s61, s61, 0x24000
  v_mfma_f32_16x16x32_bf16 v[76:79], a[20:23], a[156:159], v[76:79]
  ds_read_b64_tr_b16 a[6:7], v165 offset:23232
  v_mfma_f32_16x16x32_bf16 v[8:11], a[24:27], a[160:163], v[8:11]
  ds_read_b64_tr_b16 a[8:9], v165 offset:18656
  buffer_load_dwordx4 a[112:115], v161, s[8:11], s30 offen sc1
  v_mfma_f32_16x16x32_bf16 v[12:15], a[24:27], a[164:167], v[12:15]
  ds_read_b64_tr_b16 a[10:11], v165 offset:23264
  v_mfma_f32_16x16x32_bf16 v[16:19], a[28:31], a[160:163], v[16:19]
  ds_read_b64_tr_b16 a[12:13], v166 offset:27648
  v_mfma_f32_16x16x32_bf16 v[20:23], a[28:31], a[164:167], v[20:23]
  ds_read_b64_tr_b16 a[14:15], v166 offset:32256
  s_waitcnt lgkmcnt(8)
  v_mfma_f32_16x16x32_bf16 v[24:27], a[32:35], a[160:163], v[24:27]
  ds_read_b64_tr_b16 a[16:17], v165 offset:27648
  buffer_load_dwordx4 a[116:119], v162, s[8:11], s30 offen sc1
  v_mfma_f32_16x16x32_bf16 v[28:31], a[32:35], a[164:167], v[28:31]
  ds_read_b64_tr_b16 a[18:19], v165 offset:32256
  v_mfma_f32_16x16x32_bf16 v[32:35], a[36:39], a[160:163], v[32:35]
  ds_read_b64_tr_b16 a[20:21], v165 offset:27680
  v_mfma_f32_16x16x32_bf16 v[36:39], a[36:39], a[164:167], v[36:39]
  ds_read_b64_tr_b16 a[22:23], v165 offset:32288
  v_mfma_f32_16x16x32_bf16 v[40:43], a[40:43], a[160:163], v[40:43]
  ds_read_b64_tr_b16 a[24:25], v165 offset:27712
  buffer_load_dwordx4 a[120:123], v161, s[8:11], s30 offen offset:1024 sc1
  v_mfma_f32_16x16x32_bf16 v[44:47], a[40:43], a[164:167], v[44:47]
  ds_read_b64_tr_b16 a[26:27], v165 offset:32320
  v_mfma_f32_16x16x32_bf16 v[48:51], a[44:47], a[160:163], v[48:51]
  ds_read_b64_tr_b16 a[28:29], v165 offset:27744
  v_mfma_f32_16x16x32_bf16 v[52:55], a[44:47], a[164:167], v[52:55]
  ds_read_b64_tr_b16 a[30:31], v165 offset:32352
  s_waitcnt lgkmcnt(8)
  v_mfma_f32_16x16x32_bf16 v[56:59], a[0:3], a[160:163], v[56:59]
  ds_read_b64_tr_b16 a[32:33], v165 offset:27776
  buffer_load_dwordx4 a[124:127], v162, s[8:11], s30 offen offset:1024 sc1
  v_mfma_f32_16x16x32_bf16 v[60:63], a[0:3], a[164:167], v[60:63]
  ds_read_b64_tr_b16 a[34:35], v165 offset:32384
  v_mfma_f32_16x16x32_bf16 v[64:67], a[4:7], a[160:163], v[64:67]
  ds_read_b64_tr_b16 a[36:37], v165 offset:27808
  v_mfma_f32_16x16x32_bf16 v[68:71], a[4:7], a[164:167], v[68:71]
  ds_read_b64_tr_b16 a[38:39], v165 offset:32416
  v_mfma_f32_16x16x32_bf16 v[72:75], a[8:11], a[160:163], v[72:75]
  ds_read_b64_tr_b16 a[40:41], v165 offset:27840
  buffer_load_dwordx4 a[128:131], v161, s[8:11], s30 offen offset:2048 sc1
  v_mfma_f32_16x16x32_bf16 v[76:79], a[8:11], a[164:167], v[76:79]
  ds_read_b64_tr_b16 a[42:43], v165 offset:32448
  v_mfma_f32_16x16x32_bf16 v[8:11], a[12:15], a[168:171], v[8:11]
  ds_read_b64_tr_b16 a[44:45], v165 offset:27872
  v_mfma_f32_16x16x32_bf16 v[12:15], a[12:15], a[172:175], v[12:15]
  ds_read_b64_tr_b16 a[46:47], v165 offset:32480
  s_waitcnt lgkmcnt(8)
  v_mfma_f32_16x16x32_bf16 v[16:19], a[16:19], a[168:171], v[16:19]
  ds_read_b64_tr_b16 a[0:1], v168
  buffer_load_dwordx4 a[132:135], v162, s[8:11], s30 offen offset:2048 sc1
  v_mfma_f32_16x16x32_bf16 v[20:23], a[16:19], a[172:175], v[20:23]
  ds_read_b64_tr_b16 a[2:3], v168 offset:4608
  v_mfma_f32_16x16x32_bf16 v[24:27], a[20:23], a[168:171], v[24:27]
  ds_read_b64_tr_b16 a[4:5], v167
  v_mfma_f32_16x16x32_bf16 v[28:31], a[20:23], a[172:175], v[28:31]
  ds_read_b64_tr_b16 a[6:7], v167 offset:4608
  v_mfma_f32_16x16x32_bf16 v[32:35], a[24:27], a[168:171], v[32:35]
  ds_read_b64_tr_b16 a[8:9], v167 offset:32
  buffer_load_dwordx4 a[136:139], v161, s[8:11], s30 offen offset:3072 sc1
  v_mfma_f32_16x16x32_bf16 v[36:39], a[24:27], a[172:175], v[36:39]
  ds_read_b64_tr_b16 a[10:11], v167 offset:4640
  v_mfma_f32_16x16x32_bf16 v[40:43], a[28:31], a[168:171], v[40:43]
  ds_read_b64_tr_b16 a[12:13], v167 offset:64
  v_mfma_f32_16x16x32_bf16 v[44:47], a[28:31], a[172:175], v[44:47]
  ds_read_b64_tr_b16 a[14:15], v167 offset:4672
  s_waitcnt lgkmcnt(8)
  v_mfma_f32_16x16x32_bf16 v[48:51], a[32:35], a[168:171], v[48:51]
  ds_read_b64_tr_b16 a[16:17], v167 offset:96
  buffer_load_dwordx4 a[140:143], v162, s[8:11], s30 offen offset:3072 sc1
  v_mfma_f32_16x16x32_bf16 v[52:55], a[32:35], a[172:175], v[52:55]
  ds_read_b64_tr_b16 a[18:19], v167 offset:4704
  s_add_u32 s30, s30, 0x1000
  v_mfma_f32_16x16x32_bf16 v[56:59], a[36:39], a[168:171], v[56:59]
  ds_read_b64_tr_b16 a[20:21], v167 offset:128
  v_mfma_f32_16x16x32_bf16 v[60:63], a[36:39], a[172:175], v[60:63]
  ds_read_b64_tr_b16 a[22:23], v167 offset:4736
  v_mfma_f32_16x16x32_bf16 v[64:67], a[40:43], a[168:171], v[64:67]
  ds_read_b64_tr_b16 a[24:25], v167 offset:160
  v_mfma_f32_16x16x32_bf16 v[68:71], a[40:43], a[172:175], v[68:71]
  ds_read_b64_tr_b16 a[26:27], v167 offset:4768
  v_mfma_f32_16x16x32_bf16 v[72:75], a[44:47], a[168:171], v[72:75]
  ds_read_b64_tr_b16 a[28:29], v167 offset:192
  v_mfma_f32_16x16x32_bf16 v[76:79], a[44:47], a[172:175], v[76:79]
  ds_read_b64_tr_b16 a[30:31], v167 offset:4800
  s_waitcnt vmcnt(56) lgkmcnt(14)
  v_mfma_f32_16x16x32_bf16 v[8:11], a[0:3], a[176:179], v[8:11]
  ds_read_b64_tr_b16 a[32:33], v167 offset:224
  v_mfma_f32_16x16x32_bf16 v[12:15], a[0:3], a[180:183], v[12:15]
  ds_read_b64_tr_b16 a[34:35], v167 offset:4832
  s_waitcnt vmcnt(33) lgkmcnt(10)
  s_barrier
  v_mfma_f32_16x16x32_bf16 v[16:19], a[4:7], a[176:179], v[16:19]
  ds_read_b64_tr_b16 a[36:37], v168 offset:9216
  s_add_u32 m0, s60, 0
  s_nop 0
  buffer_load_dwordx4 v240, s[56:59], s61 offen lds
  v_mfma_f32_16x16x32_bf16 v[20:23], a[4:7], a[180:183], v[20:23]
  ds_read_b64_tr_b16 a[38:39], v168 offset:13824
  v_mfma_f32_16x16x32_bf16 v[24:27], a[8:11], a[176:179], v[24:27]
  ds_read_b64_tr_b16 a[40:41], v167 offset:9216
  v_mfma_f32_16x16x32_bf16 v[28:31], a[8:11], a[180:183], v[28:31]
  ds_read_b64_tr_b16 a[42:43], v167 offset:13824
  v_mfma_f32_16x16x32_bf16 v[32:35], a[12:15], a[176:179], v[32:35]
  ds_read_b64_tr_b16 a[44:45], v167 offset:9248
  v_mfma_f32_16x16x32_bf16 v[36:39], a[12:15], a[180:183], v[36:39]
  ds_read_b64_tr_b16 a[46:47], v167 offset:13856
  s_waitcnt lgkmcnt(8)
  v_mfma_f32_16x16x32_bf16 v[40:43], a[16:19], a[176:179], v[40:43]
  ds_read_b64_tr_b16 a[0:1], v167 offset:9280
  v_mfma_f32_16x16x32_bf16 v[44:47], a[16:19], a[180:183], v[44:47]
  ds_read_b64_tr_b16 a[2:3], v167 offset:13888
  buffer_load_dwordx4 v241, s[56:59], s61 offen offset:1024 lds
  v_mfma_f32_16x16x32_bf16 v[48:51], a[20:23], a[176:179], v[48:51]
  ds_read_b64_tr_b16 a[4:5], v167 offset:9312
  v_mfma_f32_16x16x32_bf16 v[52:55], a[20:23], a[180:183], v[52:55]
  ds_read_b64_tr_b16 a[6:7], v167 offset:13920
  v_mfma_f32_16x16x32_bf16 v[56:59], a[24:27], a[176:179], v[56:59]
  ds_read_b64_tr_b16 a[8:9], v167 offset:9344
  v_mfma_f32_16x16x32_bf16 v[60:63], a[24:27], a[180:183], v[60:63]
  ds_read_b64_tr_b16 a[10:11], v167 offset:13952
  v_mfma_f32_16x16x32_bf16 v[64:67], a[28:31], a[176:179], v[64:67]
  ds_read_b64_tr_b16 a[12:13], v167 offset:9376
  v_mfma_f32_16x16x32_bf16 v[68:71], a[28:31], a[180:183], v[68:71]
  ds_read_b64_tr_b16 a[14:15], v167 offset:13984
  s_waitcnt lgkmcnt(8)
  v_mfma_f32_16x16x32_bf16 v[72:75], a[32:35], a[176:179], v[72:75]
  ds_read_b64_tr_b16 a[16:17], v167 offset:9408
  buffer_load_dwordx4 v242, s[56:59], s61 offen offset:2048 lds
  v_mfma_f32_16x16x32_bf16 v[76:79], a[32:35], a[180:183], v[76:79]
  ds_read_b64_tr_b16 a[18:19], v167 offset:14016
  v_mfma_f32_16x16x32_bf16 v[8:11], a[36:39], a[184:187], v[8:11]
  ds_read_b64_tr_b16 a[20:21], v167 offset:9440
  v_mfma_f32_16x16x32_bf16 v[12:15], a[36:39], a[188:191], v[12:15]
  ds_read_b64_tr_b16 a[22:23], v167 offset:14048
  v_mfma_f32_16x16x32_bf16 v[16:19], a[40:43], a[184:187], v[16:19]
  ds_read_b64_tr_b16 a[24:25], v168 offset:18432
  v_mfma_f32_16x16x32_bf16 v[20:23], a[40:43], a[188:191], v[20:23]
  ds_read_b64_tr_b16 a[26:27], v168 offset:23040
  v_mfma_f32_16x16x32_bf16 v[24:27], a[44:47], a[184:187], v[24:27]
  ds_read_b64_tr_b16 a[28:29], v167 offset:18432
  v_mfma_f32_16x16x32_bf16 v[28:31], a[44:47], a[188:191], v[28:31]
  ds_read_b64_tr_b16 a[30:31], v167 offset:23040
  s_waitcnt lgkmcnt(8)
  v_mfma_f32_16x16x32_bf16 v[32:35], a[0:3], a[184:187], v[32:35]
  ds_read_b64_tr_b16 a[32:33], v167 offset:18464
  buffer_load_dwordx4 v243, s[56:59], s61 offen offset:3072 lds
  v_mfma_f32_16x16x32_bf16 v[36:39], a[0:3], a[188:191], v[36:39]
  ds_read_b64_tr_b16 a[34:35], v167 offset:23072
  s_add_u32 m0, s60, 0x1000
  v_mfma_f32_16x16x32_bf16 v[40:43], a[4:7], a[184:187], v[40:43]
  ds_read_b64_tr_b16 a[36:37], v167 offset:18496
  v_mfma_f32_16x16x32_bf16 v[44:47], a[4:7], a[188:191], v[44:47]
  ds_read_b64_tr_b16 a[38:39], v167 offset:23104
  v_mfma_f32_16x16x32_bf16 v[48:51], a[8:11], a[184:187], v[48:51]
  ds_read_b64_tr_b16 a[40:41], v167 offset:18528
  v_mfma_f32_16x16x32_bf16 v[52:55], a[8:11], a[188:191], v[52:55]
  ds_read_b64_tr_b16 a[42:43], v167 offset:23136
  v_mfma_f32_16x16x32_bf16 v[56:59], a[12:15], a[184:187], v[56:59]
  ds_read_b64_tr_b16 a[44:45], v167 offset:18560
  v_mfma_f32_16x16x32_bf16 v[60:63], a[12:15], a[188:191], v[60:63]
  ds_read_b64_tr_b16 a[46:47], v167 offset:23168
  buffer_load_dwordx4 v244, s[56:59], s61 offen lds
  s_waitcnt lgkmcnt(8)
  v_mfma_f32_16x16x32_bf16 v[64:67], a[16:19], a[184:187], v[64:67]
  ds_read_b64_tr_b16 a[0:1], v167 offset:18592
  v_mfma_f32_16x16x32_bf16 v[68:71], a[16:19], a[188:191], v[68:71]
  ds_read_b64_tr_b16 a[2:3], v167 offset:23200
  v_mfma_f32_16x16x32_bf16 v[72:75], a[20:23], a[184:187], v[72:75]
  ds_read_b64_tr_b16 a[4:5], v167 offset:18624
  v_mfma_f32_16x16x32_bf16 v[76:79], a[20:23], a[188:191], v[76:79]
  ds_read_b64_tr_b16 a[6:7], v167 offset:23232
  v_mfma_f32_16x16x32_bf16 v[8:11], a[24:27], a[192:195], v[8:11]
  ds_read_b64_tr_b16 a[8:9], v167 offset:18656
  v_mfma_f32_16x16x32_bf16 v[12:15], a[24:27], a[196:199], v[12:15]
  ds_read_b64_tr_b16 a[10:11], v167 offset:23264
  v_mfma_f32_16x16x32_bf16 v[16:19], a[28:31], a[192:195], v[16:19]
  ds_read_b64_tr_b16 a[12:13], v168 offset:27648
  buffer_load_dwordx4 v245, s[56:59], s61 offen offset:1024 lds
  v_mfma_f32_16x16x32_bf16 v[20:23], a[28:31], a[196:199], v[20:23]
  ds_read_b64_tr_b16 a[14:15], v168 offset:32256
  s_waitcnt lgkmcnt(8)
  v_mfma_f32_16x16x32_bf16 v[24:27], a[32:35], a[192:195], v[24:27]
  ds_read_b64_tr_b16 a[16:17], v167 offset:27648
  v_mfma_f32_16x16x32_bf16 v[28:31], a[32:35], a[196:199], v[28:31]
  ds_read_b64_tr_b16 a[18:19], v167 offset:32256
  v_mfma_f32_16x16x32_bf16 v[32:35], a[36:39], a[192:195], v[32:35]
  ds_read_b64_tr_b16 a[20:21], v167 offset:27680
  v_mfma_f32_16x16x32_bf16 v[36:39], a[36:39], a[196:199], v[36:39]
  ds_read_b64_tr_b16 a[22:23], v167 offset:32288
  v_mfma_f32_16x16x32_bf16 v[40:43], a[40:43], a[192:195], v[40:43]
  ds_read_b64_tr_b16 a[24:25], v167 offset:27712
  v_mfma_f32_16x16x32_bf16 v[44:47], a[40:43], a[196:199], v[44:47]
  ds_read_b64_tr_b16 a[26:27], v167 offset:32320
  v_mfma_f32_16x16x32_bf16 v[48:51], a[44:47], a[192:195], v[48:51]
  ds_read_b64_tr_b16 a[28:29], v167 offset:27744
  buffer_load_dwordx4 v246, s[56:59], s61 offen offset:2048 lds
  v_mfma_f32_16x16x32_bf16 v[52:55], a[44:47], a[196:199], v[52:55]
  ds_read_b64_tr_b16 a[30:31], v167 offset:32352
  s_waitcnt lgkmcnt(8)
  v_mfma_f32_16x16x32_bf16 v[56:59], a[0:3], a[192:195], v[56:59]
  ds_read_b64_tr_b16 a[32:33], v167 offset:27776
  v_mfma_f32_16x16x32_bf16 v[60:63], a[0:3], a[196:199], v[60:63]
  ds_read_b64_tr_b16 a[34:35], v167 offset:32384
  v_mfma_f32_16x16x32_bf16 v[64:67], a[4:7], a[192:195], v[64:67]
  ds_read_b64_tr_b16 a[36:37], v167 offset:27808
  v_mfma_f32_16x16x32_bf16 v[68:71], a[4:7], a[196:199], v[68:71]
  ds_read_b64_tr_b16 a[38:39], v167 offset:32416
  v_mfma_f32_16x16x32_bf16 v[72:75], a[8:11], a[192:195], v[72:75]
  ds_read_b64_tr_b16 a[40:41], v167 offset:27840
  v_mfma_f32_16x16x32_bf16 v[76:79], a[8:11], a[196:199], v[76:79]
  ds_read_b64_tr_b16 a[42:43], v167 offset:32448
  buffer_load_dwordx4 v247, s[56:59], s61 offen offset:3072 lds
  v_mfma_f32_16x16x32_bf16 v[8:11], a[12:15], a[200:203], v[8:11]
  ds_read_b64_tr_b16 a[44:45], v167 offset:27872
  s_add_u32 m0, s60, 0x2000
  v_mfma_f32_16x16x32_bf16 v[12:15], a[12:15], a[204:207], v[12:15]
  ds_read_b64_tr_b16 a[46:47], v167 offset:32480
  s_waitcnt lgkmcnt(8)
  v_mfma_f32_16x16x32_bf16 v[16:19], a[16:19], a[200:203], v[16:19]
  ds_read_b64_tr_b16 a[0:1], v170
  v_mfma_f32_16x16x32_bf16 v[20:23], a[16:19], a[204:207], v[20:23]
  ds_read_b64_tr_b16 a[2:3], v170 offset:4608
  v_mfma_f32_16x16x32_bf16 v[24:27], a[20:23], a[200:203], v[24:27]
  ds_read_b64_tr_b16 a[4:5], v169
  v_mfma_f32_16x16x32_bf16 v[28:31], a[20:23], a[204:207], v[28:31]
  ds_read_b64_tr_b16 a[6:7], v169 offset:4608
  v_mfma_f32_16x16x32_bf16 v[32:35], a[24:27], a[200:203], v[32:35]
  ds_read_b64_tr_b16 a[8:9], v169 offset:32
  buffer_load_dwordx4 v248, s[56:59], s61 offen lds
  v_mfma_f32_16x16x32_bf16 v[36:39], a[24:27], a[204:207], v[36:39]
  ds_read_b64_tr_b16 a[10:11], v169 offset:4640
  s_add_u32 s61, s61, 0x24000
  v_mfma_f32_16x16x32_bf16 v[40:43], a[28:31], a[200:203], v[40:43]
  ds_read_b64_tr_b16 a[12:13], v169 offset:64
  v_mfma_f32_16x16x32_bf16 v[44:47], a[28:31], a[204:207], v[44:47]
  ds_read_b64_tr_b16 a[14:15], v169 offset:4672
  s_waitcnt lgkmcnt(8)
  v_mfma_f32_16x16x32_bf16 v[48:51], a[32:35], a[200:203], v[48:51]
  ds_read_b64_tr_b16 a[16:17], v169 offset:96
  v_mfma_f32_16x16x32_bf16 v[52:55], a[32:35], a[204:207], v[52:55]
  ds_read_b64_tr_b16 a[18:19], v169 offset:4704
  v_mfma_f32_16x16x32_bf16 v[56:59], a[36:39], a[200:203], v[56:59]
  ds_read_b64_tr_b16 a[20:21], v169 offset:128
  v_mfma_f32_16x16x32_bf16 v[60:63], a[36:39], a[204:207], v[60:63]
  ds_read_b64_tr_b16 a[22:23], v169 offset:4736
  v_mfma_f32_16x16x32_bf16 v[64:67], a[40:43], a[200:203], v[64:67]
  ds_read_b64_tr_b16 a[24:25], v169 offset:160
  v_mfma_f32_16x16x32_bf16 v[68:71], a[40:43], a[204:207], v[68:71]
  ds_read_b64_tr_b16 a[26:27], v169 offset:4768
  v_mfma_f32_16x16x32_bf16 v[72:75], a[44:47], a[200:203], v[72:75]
  ds_read_b64_tr_b16 a[28:29], v169 offset:192
  v_mfma_f32_16x16x32_bf16 v[76:79], a[44:47], a[204:207], v[76:79]
  ds_read_b64_tr_b16 a[30:31], v169 offset:4800
  s_waitcnt lgkmcnt(14)
  v_mfma_f32_16x16x32_bf16 v[8:11], a[0:3], a[208:211], v[8:11]
  ds_read_b64_tr_b16 a[32:33], v169 offset:224
  v_mfma_f32_16x16x32_bf16 v[12:15], a[0:3], a[212:215], v[12:15]
  ds_read_b64_tr_b16 a[34:35], v169 offset:4832
  s_waitcnt vmcnt(17) lgkmcnt(10)
  s_barrier
  v_mfma_f32_16x16x32_bf16 v[16:19], a[4:7], a[208:211], v[16:19]
  ds_read_b64_tr_b16 a[36:37], v170 offset:9216
  s_add_u32 m0, s60, 0x9000
  s_nop 0
  buffer_load_dwordx4 v240, s[56:59], s61 offen lds
  v_mfma_f32_16x16x32_bf16 v[20:23], a[4:7], a[212:215], v[20:23]
  ds_read_b64_tr_b16 a[38:39], v170 offset:13824
  v_mfma_f32_16x16x32_bf16 v[24:27], a[8:11], a[208:211], v[24:27]
  ds_read_b64_tr_b16 a[40:41], v169 offset:9216
  v_mfma_f32_16x16x32_bf16 v[28:31], a[8:11], a[212:215], v[28:31]
  ds_read_b64_tr_b16 a[42:43], v169 offset:13824
  v_mfma_f32_16x16x32_bf16 v[32:35], a[12:15], a[208:211], v[32:35]
  ds_read_b64_tr_b16 a[44:45], v169 offset:9248
  v_mfma_f32_16x16x32_bf16 v[36:39], a[12:15], a[212:215], v[36:39]
  ds_read_b64_tr_b16 a[46:47], v169 offset:13856
  buffer_load_dwordx4 v241, s[56:59], s61 offen offset:1024 lds
  s_waitcnt lgkmcnt(8)
  v_mfma_f32_16x16x32_bf16 v[40:43], a[16:19], a[208:211], v[40:43]
  ds_read_b64_tr_b16 a[0:1], v169 offset:9280
  v_mfma_f32_16x16x32_bf16 v[44:47], a[16:19], a[212:215], v[44:47]
  ds_read_b64_tr_b16 a[2:3], v169 offset:13888
  v_mfma_f32_16x16x32_bf16 v[48:51], a[20:23], a[208:211], v[48:51]
  ds_read_b64_tr_b16 a[4:5], v169 offset:9312
  v_mfma_f32_16x16x32_bf16 v[52:55], a[20:23], a[212:215], v[52:55]
  ds_read_b64_tr_b16 a[6:7], v169 offset:13920
  v_mfma_f32_16x16x32_bf16 v[56:59], a[24:27], a[208:211], v[56:59]
  ds_read_b64_tr_b16 a[8:9], v169 offset:9344
  v_mfma_f32_16x16x32_bf16 v[60:63], a[24:27], a[212:215], v[60:63]
  ds_read_b64_tr_b16 a[10:11], v169 offset:13952
  buffer_load_dwordx4 v242, s[56:59], s61 offen offset:2048 lds
  v_mfma_f32_16x16x32_bf16 v[64:67], a[28:31], a[208:211], v[64:67]
  ds_read_b64_tr_b16 a[12:13], v169 offset:9376
  v_mfma_f32_16x16x32_bf16 v[68:71], a[28:31], a[212:215], v[68:71]
  ds_read_b64_tr_b16 a[14:15], v169 offset:13984
  s_waitcnt lgkmcnt(8)
  v_mfma_f32_16x16x32_bf16 v[72:75], a[32:35], a[208:211], v[72:75]
  ds_read_b64_tr_b16 a[16:17], v169 offset:9408
  v_mfma_f32_16x16x32_bf16 v[76:79], a[32:35], a[212:215], v[76:79]
  ds_read_b64_tr_b16 a[18:19], v169 offset:14016
  v_mfma_f32_16x16x32_bf16 v[8:11], a[36:39], a[216:219], v[8:11]
  ds_read_b64_tr_b16 a[20:21], v169 offset:9440
  buffer_load_dwordx4 v243, s[56:59], s61 offen offset:3072 lds
  v_mfma_f32_16x16x32_bf16 v[12:15], a[36:39], a[220:223], v[12:15]
  ds_read_b64_tr_b16 a[22:23], v169 offset:14048
  s_add_u32 m0, s60, 0xa000
  v_mfma_f32_16x16x32_bf16 v[16:19], a[40:43], a[216:219], v[16:19]
  ds_read_b64_tr_b16 a[24:25], v170 offset:18432
  v_mfma_f32_16x16x32_bf16 v[20:23], a[40:43], a[220:223], v[20:23]
  ds_read_b64_tr_b16 a[26:27], v170 offset:23040
  v_mfma_f32_16x16x32_bf16 v[24:27], a[44:47], a[216:219], v[24:27]
  ds_read_b64_tr_b16 a[28:29], v169 offset:18432
  v_mfma_f32_16x16x32_bf16 v[28:31], a[44:47], a[220:223], v[28:31]
  ds_read_b64_tr_b16 a[30:31], v169 offset:23040
  s_waitcnt lgkmcnt(8)
  v_mfma_f32_16x16x32_bf16 v[32:35], a[0:3], a[216:219], v[32:35]
  ds_read_b64_tr_b16 a[32:33], v169 offset:18464
  buffer_load_dwordx4 v244, s[56:59], s61 offen lds
  v_mfma_f32_16x16x32_bf16 v[36:39], a[0:3], a[220:223], v[36:39]
  ds_read_b64_tr_b16 a[34:35], v169 offset:23072
  v_mfma_f32_16x16x32_bf16 v[40:43], a[4:7], a[216:219], v[40:43]
  ds_read_b64_tr_b16 a[36:37], v169 offset:18496
  v_mfma_f32_16x16x32_bf16 v[44:47], a[4:7], a[220:223], v[44:47]
  ds_read_b64_tr_b16 a[38:39], v169 offset:23104
  v_mfma_f32_16x16x32_bf16 v[48:51], a[8:11], a[216:219], v[48:51]
  ds_read_b64_tr_b16 a[40:41], v169 offset:18528
  v_mfma_f32_16x16x32_bf16 v[52:55], a[8:11], a[220:223], v[52:55]
  ds_read_b64_tr_b16 a[42:43], v169 offset:23136
  buffer_load_dwordx4 v245, s[56:59], s61 offen offset:1024 lds
  v_mfma_f32_16x16x32_bf16 v[56:59], a[12:15], a[216:219], v[56:59]
  ds_read_b64_tr_b16 a[44:45], v169 offset:18560
  v_mfma_f32_16x16x32_bf16 v[60:63], a[12:15], a[220:223], v[60:63]
  ds_read_b64_tr_b16 a[46:47], v169 offset:23168
  s_waitcnt lgkmcnt(8)
  v_mfma_f32_16x16x32_bf16 v[64:67], a[16:19], a[216:219], v[64:67]
  ds_read_b64_tr_b16 a[0:1], v169 offset:18592
  v_mfma_f32_16x16x32_bf16 v[68:71], a[16:19], a[220:223], v[68:71]
  ds_read_b64_tr_b16 a[2:3], v169 offset:23200
  v_mfma_f32_16x16x32_bf16 v[72:75], a[20:23], a[216:219], v[72:75]
  ds_read_b64_tr_b16 a[4:5], v169 offset:18624
  v_mfma_f32_16x16x32_bf16 v[76:79], a[20:23], a[220:223], v[76:79]
  ds_read_b64_tr_b16 a[6:7], v169 offset:23232
  buffer_load_dwordx4 v246, s[56:59], s61 offen offset:2048 lds
  v_mfma_f32_16x16x32_bf16 v[8:11], a[24:27], a[224:227], v[8:11]
  ds_read_b64_tr_b16 a[8:9], v169 offset:18656
  v_mfma_f32_16x16x32_bf16 v[12:15], a[24:27], a[228:231], v[12:15]
  ds_read_b64_tr_b16 a[10:11], v169 offset:23264
  v_mfma_f32_16x16x32_bf16 v[16:19], a[28:31], a[224:227], v[16:19]
  ds_read_b64_tr_b16 a[12:13], v170 offset:27648
  v_mfma_f32_16x16x32_bf16 v[20:23], a[28:31], a[228:231], v[20:23]
  ds_read_b64_tr_b16 a[14:15], v170 offset:32256
  s_waitcnt lgkmcnt(8)
  v_mfma_f32_16x16x32_bf16 v[24:27], a[32:35], a[224:227], v[24:27]
  ds_read_b64_tr_b16 a[16:17], v169 offset:27648
  buffer_load_dwordx4 v247, s[56:59], s61 offen offset:3072 lds
  v_mfma_f32_16x16x32_bf16 v[28:31], a[32:35], a[228:231], v[28:31]
  ds_read_b64_tr_b16 a[18:19], v169 offset:32256
  s_add_u32 m0, s60, 0xb000
  v_mfma_f32_16x16x32_bf16 v[32:35], a[36:39], a[224:227], v[32:35]
  ds_read_b64_tr_b16 a[20:21], v169 offset:27680
  v_mfma_f32_16x16x32_bf16 v[36:39], a[36:39], a[228:231], v[36:39]
  ds_read_b64_tr_b16 a[22:23], v169 offset:32288
  v_mfma_f32_16x16x32_bf16 v[40:43], a[40:43], a[224:227], v[40:43]
  ds_read_b64_tr_b16 a[24:25], v169 offset:27712
  v_mfma_f32_16x16x32_bf16 v[44:47], a[40:43], a[228:231], v[44:47]
  ds_read_b64_tr_b16 a[26:27], v169 offset:32320
  v_mfma_f32_16x16x32_bf16 v[48:51], a[44:47], a[224:227], v[48:51]
  ds_read_b64_tr_b16 a[28:29], v169 offset:27744
  buffer_load_dwordx4 v248, s[56:59], s61 offen lds
  v_mfma_f32_16x16x32_bf16 v[52:55], a[44:47], a[228:231], v[52:55]
  ds_read_b64_tr_b16 a[30:31], v169 offset:32352
  s_add_u32 s61, s61, 0x24000
  s_waitcnt lgkmcnt(8)
  v_mfma_f32_16x16x32_bf16 v[56:59], a[0:3], a[224:227], v[56:59]
  ds_read_b64_tr_b16 a[32:33], v169 offset:27776
  v_mfma_f32_16x16x32_bf16 v[60:63], a[0:3], a[228:231], v[60:63]
  ds_read_b64_tr_b16 a[34:35], v169 offset:32384
  v_mfma_f32_16x16x32_bf16 v[64:67], a[4:7], a[224:227], v[64:67]
  ds_read_b64_tr_b16 a[36:37], v169 offset:27808
  v_mfma_f32_16x16x32_bf16 v[68:71], a[4:7], a[228:231], v[68:71]
  ds_read_b64_tr_b16 a[38:39], v169 offset:32416
  v_mfma_f32_16x16x32_bf16 v[72:75], a[8:11], a[224:227], v[72:75]
  ds_read_b64_tr_b16 a[40:41], v169 offset:27840
  v_mfma_f32_16x16x32_bf16 v[76:79], a[8:11], a[228:231], v[76:79]
  ds_read_b64_tr_b16 a[42:43], v169 offset:32448
  v_mfma_f32_16x16x32_bf16 v[8:11], a[12:15], a[232:235], v[8:11]
  ds_read_b64_tr_b16 a[44:45], v169 offset:27872
  s_waitcnt vmcnt(9)
  s_barrier
  v_mfma_f32_16x16x32_bf16 v[12:15], a[12:15], a[236:239], v[12:15]
  ds_read_b64_tr_b16 a[46:47], v169 offset:32480
  s_waitcnt lgkmcnt(8)
  v_mfma_f32_16x16x32_bf16 v[16:19], a[16:19], a[232:235], v[16:19]
  ds_read_b64_tr_b16 a[0:1], v172
  v_mfma_f32_16x16x32_bf16 v[20:23], a[16:19], a[236:239], v[20:23]
  ds_read_b64_tr_b16 a[2:3], v172 offset:4608
  v_mfma_f32_16x16x32_bf16 v[24:27], a[20:23], a[232:235], v[24:27]
  ds_read_b64_tr_b16 a[4:5], v172 offset:9216
  v_mfma_f32_16x16x32_bf16 v[28:31], a[20:23], a[236:239], v[28:31]
  ds_read_b64_tr_b16 a[6:7], v172 offset:13824
  v_mfma_f32_16x16x32_bf16 v[32:35], a[24:27], a[232:235], v[32:35]
  ds_read_b64_tr_b16 a[8:9], v172 offset:18432
  v_mfma_f32_16x16x32_bf16 v[36:39], a[24:27], a[236:239], v[36:39]
  ds_read_b64_tr_b16 a[10:11], v172 offset:23040
  v_mfma_f32_16x16x32_bf16 v[40:43], a[28:31], a[232:235], v[40:43]
  ds_read_b64_tr_b16 a[12:13], v172 offset:27648
  v_mfma_f32_16x16x32_bf16 v[44:47], a[28:31], a[236:239], v[44:47]
  ds_read_b64_tr_b16 a[14:15], v172 offset:32256
  s_waitcnt lgkmcnt(8)
  v_mfma_f32_16x16x32_bf16 v[48:51], a[32:35], a[232:235], v[48:51]
  ds_read_b64_tr_b16 a[16:17], v166
  v_mfma_f32_16x16x32_bf16 v[52:55], a[32:35], a[236:239], v[52:55]
  ds_read_b64_tr_b16 a[18:19], v166 offset:4608
  v_mfma_f32_16x16x32_bf16 v[56:59], a[36:39], a[232:235], v[56:59]
  ds_read_b64_tr_b16 a[20:21], v166 offset:9216
  v_mfma_f32_16x16x32_bf16 v[60:63], a[36:39], a[236:239], v[60:63]
  ds_read_b64_tr_b16 a[22:23], v166 offset:13824
  v_mfma_f32_16x16x32_bf16 v[64:67], a[40:43], a[232:235], v[64:67]
  ds_read_b64_tr_b16 a[24:25], v166 offset:18432
  v_mfma_f32_16x16x32_bf16 v[68:71], a[40:43], a[236:239], v[68:71]
  ds_read_b64_tr_b16 a[26:27], v166 offset:23040
  v_mfma_f32_16x16x32_bf16 v[72:75], a[44:47], a[232:235], v[72:75]
  ds_read_b64_tr_b16 a[28:29], v166 offset:27648
  v_mfma_f32_16x16x32_bf16 v[76:79], a[44:47], a[236:239], v[76:79]
  ds_read_b64_tr_b16 a[30:31], v166 offset:32256
  s_nop 0
  s_waitcnt vmcnt(0) lgkmcnt(8)
  s_barrier
  v_mfma_f32_16x16x32_bf16 v[8:11], a[0:3], a[48:51], v[8:11]
  ds_read_b64_tr_b16 a[32:33], v168
  v_lshrrev_b32 v4, 3, v0
  v_mfma_f32_16x16x32_bf16 v[12:15], a[0:3], a[52:55], v[12:15]
  ds_read_b64_tr_b16 a[34:35], v168 offset:4608
  v_and_b32 v5, 7, v0
  v_mfma_f32_16x16x32_bf16 v[8:11], a[4:7], a[56:59], v[8:11]
  ds_read_b64_tr_b16 a[36:37], v168 offset:9216
  v_lshlrev_b32 v1, 8, v4
  v_mfma_f32_16x16x32_bf16 v[12:15], a[4:7], a[60:63], v[12:15]
  ds_read_b64_tr_b16 a[38:39], v168 offset:13824
  v_lshl_add_u32 v1, v5, 4, v1
  v_mfma_f32_16x16x32_bf16 v[8:11], a[8:11], a[64:67], v[8:11]
  ds_read_b64_tr_b16 a[40:41], v168 offset:18432
  s_lshr_b32 s34, s2, 1
  v_mfma_f32_16x16x32_bf16 v[12:15], a[8:11], a[68:71], v[12:15]
  ds_read_b64_tr_b16 a[42:43], v168 offset:23040
  s_mul_i32 s34, s34, 0x4800
  v_mfma_f32_16x16x32_bf16 v[8:11], a[12:15], a[72:75], v[8:11]
  ds_read_b64_tr_b16 a[44:45], v168 offset:27648
  s_and_b32 s35, s2, 1
  v_mfma_f32_16x16x32_bf16 v[12:15], a[12:15], a[76:79], v[12:15]
  ds_read_b64_tr_b16 a[46:47], v168 offset:32256
  s_waitcnt lgkmcnt(8)
  v_mfma_f32_16x16x32_bf16 v[8:11], a[16:19], a[80:83], v[8:11]
  ds_read_b64_tr_b16 a[0:1], v171
  s_lshl_b32 s35, s35, 7
  v_mfma_f32_16x16x32_bf16 v[12:15], a[16:19], a[84:87], v[12:15]
  ds_read_b64_tr_b16 a[2:3], v171 offset:4608
  s_add_u32 s34, s34, s35
  v_mfma_f32_16x16x32_bf16 v[8:11], a[20:23], a[88:91], v[8:11]
  ds_read_b64_tr_b16 a[4:5], v171 offset:9216
  v_add_u32 v1, s34, v1
  v_mfma_f32_16x16x32_bf16 v[12:15], a[20:23], a[92:95], v[12:15]
  ds_read_b64_tr_b16 a[6:7], v171 offset:13824
  v_cmp_gt_u32 vcc, 64, v0
  v_mfma_f32_16x16x32_bf16 v[8:11], a[24:27], a[96:99], v[8:11]
  ds_read_b64_tr_b16 a[8:9], v171 offset:18432
  v_mov_b32 v6, 0x40000000
  v_mfma_f32_16x16x32_bf16 v[12:15], a[24:27], a[100:103], v[12:15]
  ds_read_b64_tr_b16 a[10:11], v171 offset:23040
  s_mov_b64 s[54:55], vcc
  v_mfma_f32_16x16x32_bf16 v[8:11], a[28:31], a[104:107], v[8:11]
  ds_read_b64_tr_b16 a[12:13], v171 offset:27648
  v_add_u32 v7, 0x4000, v1
  v_mfma_f32_16x16x32_bf16 v[12:15], a[28:31], a[108:111], v[12:15]
  ds_read_b64_tr_b16 a[14:15], v171 offset:32256
  s_waitcnt lgkmcnt(8)
  v_mfma_f32_16x16x32_bf16 v[8:11], a[32:35], a[112:115], v[8:11]
  ds_read_b64_tr_b16 a[16:17], v165
  v_cndmask_b32 v7, v6, v7, vcc
  v_mfma_f32_16x16x32_bf16 v[12:15], a[32:35], a[116:119], v[12:15]
  ds_read_b64_tr_b16 a[18:19], v165 offset:4608
  v_lshrrev_b32 v3, 2, v4
  v_mfma_f32_16x16x32_bf16 v[8:11], a[36:39], a[120:123], v[8:11]
  ds_read_b64_tr_b16 a[20:21], v165 offset:9216
  v_lshlrev_b32 v3, 6, v3
  v_mfma_f32_16x16x32_bf16 v[12:15], a[36:39], a[124:127], v[12:15]
  ds_read_b64_tr_b16 a[22:23], v165 offset:13824
  v_and_b32 v6, 3, v4
  v_mfma_f32_16x16x32_bf16 v[8:11], a[40:43], a[128:131], v[8:11]
  ds_read_b64_tr_b16 a[24:25], v165 offset:18432
  v_lshl_add_u32 v3, v6, 3, v3
  v_mfma_f32_16x16x32_bf16 v[12:15], a[40:43], a[132:135], v[12:15]
  ds_read_b64_tr_b16 a[26:27], v165 offset:23040
  s_lshl_b32 s34, s2, 3
  v_mfma_f32_16x16x32_bf16 v[8:11], a[44:47], a[136:139], v[8:11]
  ds_read_b64_tr_b16 a[28:29], v165 offset:27648
  v_add_u32 v2, s34, v5
  v_mfma_f32_16x16x32_bf16 v[12:15], a[44:47], a[140:143], v[12:15]
  ds_read_b64_tr_b16 a[30:31], v165 offset:32256
  s_waitcnt lgkmcnt(8)
  v_mfma_f32_16x16x32_bf16 v[16:19], a[0:3], a[48:51], v[16:19]
  ds_read_b64_tr_b16 a[32:33], v167
  v_mul_u32_u24 v2, 0x480, v2
  v_mfma_f32_16x16x32_bf16 v[20:23], a[0:3], a[52:55], v[20:23]
  ds_read_b64_tr_b16 a[34:35], v167 offset:4608
  v_add_u32 v2, v2, v3
  v_mfma_f32_16x16x32_bf16 v[16:19], a[4:7], a[56:59], v[16:19]
  ds_read_b64_tr_b16 a[36:37], v167 offset:9216
  v_lshlrev_b32 v3, 1, v3
  v_mfma_f32_16x16x32_bf16 v[20:23], a[4:7], a[60:63], v[20:23]
  ds_read_b64_tr_b16 a[38:39], v167 offset:13824
  s_add_u32 s8, s4, 0x4800000
  v_mfma_f32_16x16x32_bf16 v[16:19], a[8:11], a[64:67], v[16:19]
  ds_read_b64_tr_b16 a[40:41], v167 offset:18432
  s_addc_u32 s9, s5, 0
  v_mfma_f32_16x16x32_bf16 v[20:23], a[8:11], a[68:71], v[20:23]
  ds_read_b64_tr_b16 a[42:43], v167 offset:23040
  s_mov_b32 s10, 0x900000
  v_mfma_f32_16x16x32_bf16 v[16:19], a[12:15], a[72:75], v[16:19]
  ds_read_b64_tr_b16 a[44:45], v167 offset:27648
  v_cvt_pk_bf16_f32 v8, v8, v9
  v_mfma_f32_16x16x32_bf16 v[20:23], a[12:15], a[76:79], v[20:23]
  ds_read_b64_tr_b16 a[46:47], v167 offset:32256
  s_waitcnt lgkmcnt(8)
  v_mfma_f32_16x16x32_bf16 v[16:19], a[16:19], a[80:83], v[16:19]
  ds_read_b64_tr_b16 a[0:1], v171 offset:32
  v_cvt_pk_bf16_f32 v9, v10, v11
  v_mfma_f32_16x16x32_bf16 v[20:23], a[16:19], a[84:87], v[20:23]
  ds_read_b64_tr_b16 a[2:3], v171 offset:4640
  s_mov_b32 s11, 0x20000
  v_mfma_f32_16x16x32_bf16 v[16:19], a[20:23], a[88:91], v[16:19]
  ds_read_b64_tr_b16 a[4:5], v171 offset:9248
  v_cvt_pk_bf16_f32 v12, v12, v13
  v_mfma_f32_16x16x32_bf16 v[20:23], a[20:23], a[92:95], v[20:23]
  ds_read_b64_tr_b16 a[6:7], v171 offset:13856
  s_add_u32 s24, s4, 0x1900000
  v_mfma_f32_16x16x32_bf16 v[16:19], a[24:27], a[96:99], v[16:19]
  ds_read_b64_tr_b16 a[8:9], v171 offset:18464
  v_cvt_pk_bf16_f32 v13, v14, v15
  v_mfma_f32_16x16x32_bf16 v[20:23], a[24:27], a[100:103], v[20:23]
  ds_read_b64_tr_b16 a[10:11], v171 offset:23072
  s_addc_u32 s25, s5, 0
  v_mfma_f32_16x16x32_bf16 v[16:19], a[28:31], a[104:107], v[16:19]
  ds_read_b64_tr_b16 a[12:13], v171 offset:27680
  buffer_store_dwordx2 v[8:9], v174, s[16:19], s48 offen sc1
  v_mfma_f32_16x16x32_bf16 v[20:23], a[28:31], a[108:111], v[20:23]
  ds_read_b64_tr_b16 a[14:15], v171 offset:32288
  s_waitcnt lgkmcnt(8)
  v_mfma_f32_16x16x32_bf16 v[16:19], a[32:35], a[112:115], v[16:19]
  ds_read_b64_tr_b16 a[16:17], v165 offset:32
  buffer_store_dwordx2 v[12:13], v174, s[16:19], s49 offen sc1
  v_mfma_f32_16x16x32_bf16 v[20:23], a[32:35], a[116:119], v[20:23]
  ds_read_b64_tr_b16 a[18:19], v165 offset:4640
  s_mov_b32 s26, 0x240000
  v_mfma_f32_16x16x32_bf16 v[16:19], a[36:39], a[120:123], v[16:19]
  ds_read_b64_tr_b16 a[20:21], v165 offset:9248
  s_mov_b32 s27, 0x20000
  v_mfma_f32_16x16x32_bf16 v[20:23], a[36:39], a[124:127], v[20:23]
  ds_read_b64_tr_b16 a[22:23], v165 offset:13856
  s_mov_b32 s79, 0x2000
  v_mfma_f32_16x16x32_bf16 v[16:19], a[40:43], a[128:131], v[16:19]
  ds_read_b64_tr_b16 a[24:25], v165 offset:18464
  v_add_u32 v3, 0x24100, v3
  v_mfma_f32_16x16x32_bf16 v[20:23], a[40:43], a[132:135], v[20:23]
  ds_read_b64_tr_b16 a[26:27], v165 offset:23072
  s_mov_b32 s40, s46
  v_mfma_f32_16x16x32_bf16 v[16:19], a[44:47], a[136:139], v[16:19]
  ds_read_b64_tr_b16 a[28:29], v165 offset:27680
  s_mov_b32 s41, s47
  v_mfma_f32_16x16x32_bf16 v[20:23], a[44:47], a[140:143], v[20:23]
  ds_read_b64_tr_b16 a[30:31], v165 offset:32288
  s_waitcnt lgkmcnt(8)
  v_mfma_f32_16x16x32_bf16 v[24:27], a[0:3], a[48:51], v[24:27]
  ds_read_b64_tr_b16 a[32:33], v167 offset:32
  s_mov_b32 s42, 0x240000
  v_mfma_f32_16x16x32_bf16 v[28:31], a[0:3], a[52:55], v[28:31]
  ds_read_b64_tr_b16 a[34:35], v167 offset:4640
  s_mov_b32 s43, 0x20000
  v_mfma_f32_16x16x32_bf16 v[24:27], a[4:7], a[56:59], v[24:27]
  ds_read_b64_tr_b16 a[36:37], v167 offset:9248
  buffer_load_dwordx4 v[176:179], v1, s[24:27], 0 offen sc1
  v_mfma_f32_16x16x32_bf16 v[28:31], a[4:7], a[60:63], v[28:31]
  ds_read_b64_tr_b16 a[38:39], v167 offset:13856
  buffer_load_dwordx4 v[180:183], v1, s[24:27], s79 offen sc1
  v_mfma_f32_16x16x32_bf16 v[24:27], a[8:11], a[64:67], v[24:27]
  ds_read_b64_tr_b16 a[40:41], v167 offset:18464
  buffer_load_dwordx4 v[184:187], v7, s[24:27], 0 offen sc1
  v_mfma_f32_16x16x32_bf16 v[28:31], a[8:11], a[68:71], v[28:31]
  ds_read_b64_tr_b16 a[42:43], v167 offset:23072
  s_mov_b32 s56, 0
  v_mfma_f32_16x16x32_bf16 v[24:27], a[12:15], a[72:75], v[24:27]
  ds_read_b64_tr_b16 a[44:45], v167 offset:27680
  v_cvt_pk_bf16_f32 v16, v16, v17
  v_mfma_f32_16x16x32_bf16 v[28:31], a[12:15], a[76:79], v[28:31]
  ds_read_b64_tr_b16 a[46:47], v167 offset:32288
  s_waitcnt lgkmcnt(8)
  v_mfma_f32_16x16x32_bf16 v[24:27], a[16:19], a[80:83], v[24:27]
  ds_read_b64_tr_b16 a[0:1], v171 offset:64
  v_cvt_pk_bf16_f32 v17, v18, v19
  v_mfma_f32_16x16x32_bf16 v[28:31], a[16:19], a[84:87], v[28:31]
  ds_read_b64_tr_b16 a[2:3], v171 offset:4672
  s_mov_b32 s60, 0x2000
  v_mfma_f32_16x16x32_bf16 v[24:27], a[20:23], a[88:91], v[24:27]
  ds_read_b64_tr_b16 a[4:5], v171 offset:9280
  v_cvt_pk_bf16_f32 v20, v20, v21
  v_mfma_f32_16x16x32_bf16 v[28:31], a[20:23], a[92:95], v[28:31]
  ds_read_b64_tr_b16 a[6:7], v171 offset:13888
  s_mov_b32 s57, 0x240000
  v_mfma_f32_16x16x32_bf16 v[24:27], a[24:27], a[96:99], v[24:27]
  ds_read_b64_tr_b16 a[8:9], v171 offset:18496
  v_cvt_pk_bf16_f32 v21, v22, v23
  v_mfma_f32_16x16x32_bf16 v[28:31], a[24:27], a[100:103], v[28:31]
  ds_read_b64_tr_b16 a[10:11], v171 offset:23104
  s_mov_b32 s61, 0x242000
  v_mfma_f32_16x16x32_bf16 v[24:27], a[28:31], a[104:107], v[24:27]
  ds_read_b64_tr_b16 a[12:13], v171 offset:27712
  s_mov_b32 s58, 0x480000
  v_mfma_f32_16x16x32_bf16 v[28:31], a[28:31], a[108:111], v[28:31]
  ds_read_b64_tr_b16 a[14:15], v171 offset:32320
  s_waitcnt lgkmcnt(8)
  v_mfma_f32_16x16x32_bf16 v[24:27], a[32:35], a[112:115], v[24:27]
  ds_read_b64_tr_b16 a[16:17], v165 offset:64
  s_mov_b32 s62, 0x482000
  v_mfma_f32_16x16x32_bf16 v[28:31], a[32:35], a[116:119], v[28:31]
  ds_read_b64_tr_b16 a[18:19], v165 offset:4672
  s_mov_b32 s59, 0x6c0000
  v_mfma_f32_16x16x32_bf16 v[24:27], a[36:39], a[120:123], v[24:27]
  ds_read_b64_tr_b16 a[20:21], v165 offset:9280
  s_mov_b32 s63, 0x6c2000
  v_mfma_f32_16x16x32_bf16 v[28:31], a[36:39], a[124:127], v[28:31]
  ds_read_b64_tr_b16 a[22:23], v165 offset:13888
  s_lshr_b32 s34, s2, 4
  v_mfma_f32_16x16x32_bf16 v[24:27], a[40:43], a[128:131], v[24:27]
  ds_read_b64_tr_b16 a[24:25], v165 offset:18496
  s_lshl_b32 s34, s34, 11
  v_mfma_f32_16x16x32_bf16 v[28:31], a[40:43], a[132:135], v[28:31]
  ds_read_b64_tr_b16 a[26:27], v165 offset:23104
  s_add_u32 s34, s34, 0x18000
  v_mfma_f32_16x16x32_bf16 v[24:27], a[44:47], a[136:139], v[24:27]
  ds_read_b64_tr_b16 a[28:29], v165 offset:27712
  v_and_b32 v4, 15, v0
  v_mfma_f32_16x16x32_bf16 v[28:31], a[44:47], a[140:143], v[28:31]
  ds_read_b64_tr_b16 a[30:31], v165 offset:32320
  s_waitcnt lgkmcnt(8)
  v_mfma_f32_16x16x32_bf16 v[32:35], a[0:3], a[48:51], v[32:35]
  ds_read_b64_tr_b16 a[32:33], v167 offset:64
  v_lshl_add_u32 v4, v4, 7, s34
  v_mfma_f32_16x16x32_bf16 v[36:39], a[0:3], a[52:55], v[36:39]
  ds_read_b64_tr_b16 a[34:35], v167 offset:4672
  v_mfma_f32_16x16x32_bf16 v[32:35], a[4:7], a[56:59], v[32:35]
  ds_read_b64_tr_b16 a[36:37], v167 offset:9280
  v_mfma_f32_16x16x32_bf16 v[36:39], a[4:7], a[60:63], v[36:39]
  ds_read_b64_tr_b16 a[38:39], v167 offset:13888
  v_mfma_f32_16x16x32_bf16 v[32:35], a[8:11], a[64:67], v[32:35]
  ds_read_b64_tr_b16 a[40:41], v167 offset:18496
  v_mfma_f32_16x16x32_bf16 v[36:39], a[8:11], a[68:71], v[36:39]
  ds_read_b64_tr_b16 a[42:43], v167 offset:23104
  v_mfma_f32_16x16x32_bf16 v[32:35], a[12:15], a[72:75], v[32:35]
  ds_read_b64_tr_b16 a[44:45], v167 offset:27712
  v_cvt_pk_bf16_f32 v18, v24, v25
  v_mfma_f32_16x16x32_bf16 v[36:39], a[12:15], a[76:79], v[36:39]
  ds_read_b64_tr_b16 a[46:47], v167 offset:32320
  s_waitcnt lgkmcnt(8)
  v_mfma_f32_16x16x32_bf16 v[32:35], a[16:19], a[80:83], v[32:35]
  ds_read_b64_tr_b16 a[0:1], v171 offset:96
  v_cvt_pk_bf16_f32 v19, v26, v27
  v_mfma_f32_16x16x32_bf16 v[36:39], a[16:19], a[84:87], v[36:39]
  ds_read_b64_tr_b16 a[2:3], v171 offset:4704
  v_mfma_f32_16x16x32_bf16 v[32:35], a[20:23], a[88:91], v[32:35]
  ds_read_b64_tr_b16 a[4:5], v171 offset:9312
  v_cvt_pk_bf16_f32 v22, v28, v29
  v_mfma_f32_16x16x32_bf16 v[36:39], a[20:23], a[92:95], v[36:39]
  ds_read_b64_tr_b16 a[6:7], v171 offset:13920
  v_mfma_f32_16x16x32_bf16 v[32:35], a[24:27], a[96:99], v[32:35]
  ds_read_b64_tr_b16 a[8:9], v171 offset:18528
  v_cvt_pk_bf16_f32 v23, v30, v31
  v_mfma_f32_16x16x32_bf16 v[36:39], a[24:27], a[100:103], v[36:39]
  ds_read_b64_tr_b16 a[10:11], v171 offset:23136
  v_mfma_f32_16x16x32_bf16 v[32:35], a[28:31], a[104:107], v[32:35]
  ds_read_b64_tr_b16 a[12:13], v171 offset:27744
  buffer_store_dwordx4 v[16:19], v173, s[16:19], s48 offen sc1
  v_mfma_f32_16x16x32_bf16 v[36:39], a[28:31], a[108:111], v[36:39]
  ds_read_b64_tr_b16 a[14:15], v171 offset:32352
  s_waitcnt lgkmcnt(8)
  v_mfma_f32_16x16x32_bf16 v[32:35], a[32:35], a[112:115], v[32:35]
  ds_read_b64_tr_b16 a[16:17], v165 offset:96
  buffer_store_dwordx4 v[20:23], v173, s[16:19], s49 offen sc1
  v_mfma_f32_16x16x32_bf16 v[36:39], a[32:35], a[116:119], v[36:39]
  ds_read_b64_tr_b16 a[18:19], v165 offset:4704
  v_mfma_f32_16x16x32_bf16 v[32:35], a[36:39], a[120:123], v[32:35]
  ds_read_b64_tr_b16 a[20:21], v165 offset:9312
  v_mfma_f32_16x16x32_bf16 v[36:39], a[36:39], a[124:127], v[36:39]
  ds_read_b64_tr_b16 a[22:23], v165 offset:13920
  v_mfma_f32_16x16x32_bf16 v[32:35], a[40:43], a[128:131], v[32:35]
  ds_read_b64_tr_b16 a[24:25], v165 offset:18528
  v_mfma_f32_16x16x32_bf16 v[36:39], a[40:43], a[132:135], v[36:39]
  ds_read_b64_tr_b16 a[26:27], v165 offset:23136
  v_mfma_f32_16x16x32_bf16 v[32:35], a[44:47], a[136:139], v[32:35]
  ds_read_b64_tr_b16 a[28:29], v165 offset:27744
  v_mfma_f32_16x16x32_bf16 v[36:39], a[44:47], a[140:143], v[36:39]
  ds_read_b64_tr_b16 a[30:31], v165 offset:32352
  s_waitcnt lgkmcnt(8)
  v_mfma_f32_16x16x32_bf16 v[40:43], a[0:3], a[48:51], v[40:43]
  ds_read_b64_tr_b16 a[32:33], v167 offset:96
  v_mfma_f32_16x16x32_bf16 v[44:47], a[0:3], a[52:55], v[44:47]
  ds_read_b64_tr_b16 a[34:35], v167 offset:4704
  v_mfma_f32_16x16x32_bf16 v[40:43], a[4:7], a[56:59], v[40:43]
  ds_read_b64_tr_b16 a[36:37], v167 offset:9312
  v_mfma_f32_16x16x32_bf16 v[44:47], a[4:7], a[60:63], v[44:47]
  ds_read_b64_tr_b16 a[38:39], v167 offset:13920
  v_mfma_f32_16x16x32_bf16 v[40:43], a[8:11], a[64:67], v[40:43]
  ds_read_b64_tr_b16 a[40:41], v167 offset:18528
  v_mfma_f32_16x16x32_bf16 v[44:47], a[8:11], a[68:71], v[44:47]
  ds_read_b64_tr_b16 a[42:43], v167 offset:23136
  v_mfma_f32_16x16x32_bf16 v[40:43], a[12:15], a[72:75], v[40:43]
  ds_read_b64_tr_b16 a[44:45], v167 offset:27744
  v_cvt_pk_bf16_f32 v32, v32, v33
  v_mfma_f32_16x16x32_bf16 v[44:47], a[12:15], a[76:79], v[44:47]
  ds_read_b64_tr_b16 a[46:47], v167 offset:32352
  s_waitcnt lgkmcnt(8)
  v_mfma_f32_16x16x32_bf16 v[40:43], a[16:19], a[80:83], v[40:43]
  ds_read_b64_tr_b16 a[0:1], v171 offset:128
  v_cvt_pk_bf16_f32 v33, v34, v35
  v_mfma_f32_16x16x32_bf16 v[44:47], a[16:19], a[84:87], v[44:47]
  ds_read_b64_tr_b16 a[2:3], v171 offset:4736
  v_mfma_f32_16x16x32_bf16 v[40:43], a[20:23], a[88:91], v[40:43]
  ds_read_b64_tr_b16 a[4:5], v171 offset:9344
  v_cvt_pk_bf16_f32 v36, v36, v37
  v_mfma_f32_16x16x32_bf16 v[44:47], a[20:23], a[92:95], v[44:47]
  ds_read_b64_tr_b16 a[6:7], v171 offset:13952
  v_mfma_f32_16x16x32_bf16 v[40:43], a[24:27], a[96:99], v[40:43]
  ds_read_b64_tr_b16 a[8:9], v171 offset:18560
  v_cvt_pk_bf16_f32 v37, v38, v39
  v_mfma_f32_16x16x32_bf16 v[44:47], a[24:27], a[100:103], v[44:47]
  ds_read_b64_tr_b16 a[10:11], v171 offset:23168
  v_mfma_f32_16x16x32_bf16 v[40:43], a[28:31], a[104:107], v[40:43]
  ds_read_b64_tr_b16 a[12:13], v171 offset:27776
  v_mfma_f32_16x16x32_bf16 v[44:47], a[28:31], a[108:111], v[44:47]
  ds_read_b64_tr_b16 a[14:15], v171 offset:32384
  s_waitcnt lgkmcnt(8)
  v_mfma_f32_16x16x32_bf16 v[40:43], a[32:35], a[112:115], v[40:43]
  ds_read_b64_tr_b16 a[16:17], v165 offset:128
  v_mfma_f32_16x16x32_bf16 v[44:47], a[32:35], a[116:119], v[44:47]
  ds_read_b64_tr_b16 a[18:19], v165 offset:4736
  v_mfma_f32_16x16x32_bf16 v[40:43], a[36:39], a[120:123], v[40:43]
  ds_read_b64_tr_b16 a[20:21], v165 offset:9344
  v_mfma_f32_16x16x32_bf16 v[44:47], a[36:39], a[124:127], v[44:47]
  ds_read_b64_tr_b16 a[22:23], v165 offset:13952
  v_mfma_f32_16x16x32_bf16 v[40:43], a[40:43], a[128:131], v[40:43]
  ds_read_b64_tr_b16 a[24:25], v165 offset:18560
  v_mfma_f32_16x16x32_bf16 v[44:47], a[40:43], a[132:135], v[44:47]
  ds_read_b64_tr_b16 a[26:27], v165 offset:23168
  v_mfma_f32_16x16x32_bf16 v[40:43], a[44:47], a[136:139], v[40:43]
  ds_read_b64_tr_b16 a[28:29], v165 offset:27776
  v_mfma_f32_16x16x32_bf16 v[44:47], a[44:47], a[140:143], v[44:47]
  ds_read_b64_tr_b16 a[30:31], v165 offset:32384
  s_waitcnt lgkmcnt(8)
  v_mfma_f32_16x16x32_bf16 v[48:51], a[0:3], a[48:51], v[48:51]
  ds_read_b64_tr_b16 a[32:33], v167 offset:128
  v_mfma_f32_16x16x32_bf16 v[52:55], a[0:3], a[52:55], v[52:55]
  ds_read_b64_tr_b16 a[34:35], v167 offset:4736
  v_mfma_f32_16x16x32_bf16 v[48:51], a[4:7], a[56:59], v[48:51]
  ds_read_b64_tr_b16 a[36:37], v167 offset:9344
  v_mfma_f32_16x16x32_bf16 v[52:55], a[4:7], a[60:63], v[52:55]
  ds_read_b64_tr_b16 a[38:39], v167 offset:13952
  v_mfma_f32_16x16x32_bf16 v[48:51], a[8:11], a[64:67], v[48:51]
  ds_read_b64_tr_b16 a[40:41], v167 offset:18560
  v_mfma_f32_16x16x32_bf16 v[52:55], a[8:11], a[68:71], v[52:55]
  ds_read_b64_tr_b16 a[42:43], v167 offset:23168
  v_mfma_f32_16x16x32_bf16 v[48:51], a[12:15], a[72:75], v[48:51]
  ds_read_b64_tr_b16 a[44:45], v167 offset:27776
  v_cvt_pk_bf16_f32 v34, v40, v41
  v_mfma_f32_16x16x32_bf16 v[52:55], a[12:15], a[76:79], v[52:55]
  ds_read_b64_tr_b16 a[46:47], v167 offset:32384
  s_waitcnt lgkmcnt(8)
  v_mfma_f32_16x16x32_bf16 v[48:51], a[16:19], a[80:83], v[48:51]
  ds_read_b64_tr_b16 a[0:1], v171 offset:160
  v_cvt_pk_bf16_f32 v35, v42, v43
  v_mfma_f32_16x16x32_bf16 v[52:55], a[16:19], a[84:87], v[52:55]
  ds_read_b64_tr_b16 a[2:3], v171 offset:4768
  v_mfma_f32_16x16x32_bf16 v[48:51], a[20:23], a[88:91], v[48:51]
  ds_read_b64_tr_b16 a[4:5], v171 offset:9376
  v_cvt_pk_bf16_f32 v38, v44, v45
  v_mfma_f32_16x16x32_bf16 v[52:55], a[20:23], a[92:95], v[52:55]
  ds_read_b64_tr_b16 a[6:7], v171 offset:13984
  v_mfma_f32_16x16x32_bf16 v[48:51], a[24:27], a[96:99], v[48:51]
  ds_read_b64_tr_b16 a[8:9], v171 offset:18592
  v_cvt_pk_bf16_f32 v39, v46, v47
  v_mfma_f32_16x16x32_bf16 v[52:55], a[24:27], a[100:103], v[52:55]
  ds_read_b64_tr_b16 a[10:11], v171 offset:23200
  v_mfma_f32_16x16x32_bf16 v[48:51], a[28:31], a[104:107], v[48:51]
  ds_read_b64_tr_b16 a[12:13], v171 offset:27808
  buffer_store_dwordx4 v[32:35], v173, s[16:19], s48 offen offset:1024 sc1
  v_mfma_f32_16x16x32_bf16 v[52:55], a[28:31], a[108:111], v[52:55]
  ds_read_b64_tr_b16 a[14:15], v171 offset:32416
  s_waitcnt lgkmcnt(8)
  v_mfma_f32_16x16x32_bf16 v[48:51], a[32:35], a[112:115], v[48:51]
  ds_read_b64_tr_b16 a[16:17], v165 offset:160
  buffer_store_dwordx4 v[36:39], v173, s[16:19], s49 offen offset:1024 sc1
  v_mfma_f32_16x16x32_bf16 v[52:55], a[32:35], a[116:119], v[52:55]
  ds_read_b64_tr_b16 a[18:19], v165 offset:4768
  v_mfma_f32_16x16x32_bf16 v[48:51], a[36:39], a[120:123], v[48:51]
  ds_read_b64_tr_b16 a[20:21], v165 offset:9376
  v_mfma_f32_16x16x32_bf16 v[52:55], a[36:39], a[124:127], v[52:55]
  ds_read_b64_tr_b16 a[22:23], v165 offset:13984
  v_mfma_f32_16x16x32_bf16 v[48:51], a[40:43], a[128:131], v[48:51]
  ds_read_b64_tr_b16 a[24:25], v165 offset:18592
  v_mfma_f32_16x16x32_bf16 v[52:55], a[40:43], a[132:135], v[52:55]
  ds_read_b64_tr_b16 a[26:27], v165 offset:23200
  v_mfma_f32_16x16x32_bf16 v[48:51], a[44:47], a[136:139], v[48:51]
  ds_read_b64_tr_b16 a[28:29], v165 offset:27808
  v_mfma_f32_16x16x32_bf16 v[52:55], a[44:47], a[140:143], v[52:55]
  ds_read_b64_tr_b16 a[30:31], v165 offset:32416
  s_waitcnt lgkmcnt(8)
  v_mfma_f32_16x16x32_bf16 v[56:59], a[0:3], a[48:51], v[56:59]
  ds_read_b64_tr_b16 a[32:33], v167 offset:160
  v_mfma_f32_16x16x32_bf16 v[60:63], a[0:3], a[52:55], v[60:63]
  ds_read_b64_tr_b16 a[34:35], v167 offset:4768
  v_mfma_f32_16x16x32_bf16 v[56:59], a[4:7], a[56:59], v[56:59]
  ds_read_b64_tr_b16 a[36:37], v167 offset:9376
  v_mfma_f32_16x16x32_bf16 v[60:63], a[4:7], a[60:63], v[60:63]
  ds_read_b64_tr_b16 a[38:39], v167 offset:13984
  v_mfma_f32_16x16x32_bf16 v[56:59], a[8:11], a[64:67], v[56:59]
  ds_read_b64_tr_b16 a[40:41], v167 offset:18592
  v_mfma_f32_16x16x32_bf16 v[60:63], a[8:11], a[68:71], v[60:63]
  ds_read_b64_tr_b16 a[42:43], v167 offset:23200
  v_mfma_f32_16x16x32_bf16 v[56:59], a[12:15], a[72:75], v[56:59]
  ds_read_b64_tr_b16 a[44:45], v167 offset:27808
  v_cvt_pk_bf16_f32 v48, v48, v49
  v_mfma_f32_16x16x32_bf16 v[60:63], a[12:15], a[76:79], v[60:63]
  ds_read_b64_tr_b16 a[46:47], v167 offset:32416
  s_waitcnt lgkmcnt(8)
  v_mfma_f32_16x16x32_bf16 v[56:59], a[16:19], a[80:83], v[56:59]
  ds_read_b64_tr_b16 a[0:1], v171 offset:192
  v_cvt_pk_bf16_f32 v49, v50, v51
  v_mfma_f32_16x16x32_bf16 v[60:63], a[16:19], a[84:87], v[60:63]
  ds_read_b64_tr_b16 a[2:3], v171 offset:4800
  v_mfma_f32_16x16x32_bf16 v[56:59], a[20:23], a[88:91], v[56:59]
  ds_read_b64_tr_b16 a[4:5], v171 offset:9408
  v_cvt_pk_bf16_f32 v52, v52, v53
  v_mfma_f32_16x16x32_bf16 v[60:63], a[20:23], a[92:95], v[60:63]
  ds_read_b64_tr_b16 a[6:7], v171 offset:14016
  v_mfma_f32_16x16x32_bf16 v[56:59], a[24:27], a[96:99], v[56:59]
  ds_read_b64_tr_b16 a[8:9], v171 offset:18624
  v_cvt_pk_bf16_f32 v53, v54, v55
  v_mfma_f32_16x16x32_bf16 v[60:63], a[24:27], a[100:103], v[60:63]
  ds_read_b64_tr_b16 a[10:11], v171 offset:23232
  v_mfma_f32_16x16x32_bf16 v[56:59], a[28:31], a[104:107], v[56:59]
  ds_read_b64_tr_b16 a[12:13], v171 offset:27840
  v_mfma_f32_16x16x32_bf16 v[60:63], a[28:31], a[108:111], v[60:63]
  ds_read_b64_tr_b16 a[14:15], v171 offset:32448
  s_waitcnt lgkmcnt(8)
  v_mfma_f32_16x16x32_bf16 v[56:59], a[32:35], a[112:115], v[56:59]
  ds_read_b64_tr_b16 a[16:17], v165 offset:192
  v_mfma_f32_16x16x32_bf16 v[60:63], a[32:35], a[116:119], v[60:63]
  ds_read_b64_tr_b16 a[18:19], v165 offset:4800
  v_mfma_f32_16x16x32_bf16 v[56:59], a[36:39], a[120:123], v[56:59]
  ds_read_b64_tr_b16 a[20:21], v165 offset:9408
  v_mfma_f32_16x16x32_bf16 v[60:63], a[36:39], a[124:127], v[60:63]
  ds_read_b64_tr_b16 a[22:23], v165 offset:14016
  v_mfma_f32_16x16x32_bf16 v[56:59], a[40:43], a[128:131], v[56:59]
  ds_read_b64_tr_b16 a[24:25], v165 offset:18624
  v_mfma_f32_16x16x32_bf16 v[60:63], a[40:43], a[132:135], v[60:63]
  ds_read_b64_tr_b16 a[26:27], v165 offset:23232
  v_mfma_f32_16x16x32_bf16 v[56:59], a[44:47], a[136:139], v[56:59]
  ds_read_b64_tr_b16 a[28:29], v165 offset:27840
  v_mfma_f32_16x16x32_bf16 v[60:63], a[44:47], a[140:143], v[60:63]
  ds_read_b64_tr_b16 a[30:31], v165 offset:32448
  s_waitcnt lgkmcnt(8)
  v_mfma_f32_16x16x32_bf16 v[64:67], a[0:3], a[48:51], v[64:67]
  ds_read_b64_tr_b16 a[32:33], v167 offset:192
  v_mfma_f32_16x16x32_bf16 v[68:71], a[0:3], a[52:55], v[68:71]
  ds_read_b64_tr_b16 a[34:35], v167 offset:4800
  v_mfma_f32_16x16x32_bf16 v[64:67], a[4:7], a[56:59], v[64:67]
  ds_read_b64_tr_b16 a[36:37], v167 offset:9408
  v_mfma_f32_16x16x32_bf16 v[68:71], a[4:7], a[60:63], v[68:71]
  ds_read_b64_tr_b16 a[38:39], v167 offset:14016
  v_mfma_f32_16x16x32_bf16 v[64:67], a[8:11], a[64:67], v[64:67]
  ds_read_b64_tr_b16 a[40:41], v167 offset:18624
  v_mfma_f32_16x16x32_bf16 v[68:71], a[8:11], a[68:71], v[68:71]
  ds_read_b64_tr_b16 a[42:43], v167 offset:23232
  v_mfma_f32_16x16x32_bf16 v[64:67], a[12:15], a[72:75], v[64:67]
  ds_read_b64_tr_b16 a[44:45], v167 offset:27840
  v_cvt_pk_bf16_f32 v50, v56, v57
  v_mfma_f32_16x16x32_bf16 v[68:71], a[12:15], a[76:79], v[68:71]
  ds_read_b64_tr_b16 a[46:47], v167 offset:32448
  s_waitcnt lgkmcnt(8)
  v_mfma_f32_16x16x32_bf16 v[64:67], a[16:19], a[80:83], v[64:67]
  ds_read_b64_tr_b16 a[0:1], v171 offset:224
  v_cvt_pk_bf16_f32 v51, v58, v59
  v_mfma_f32_16x16x32_bf16 v[68:71], a[16:19], a[84:87], v[68:71]
  ds_read_b64_tr_b16 a[2:3], v171 offset:4832
  v_mfma_f32_16x16x32_bf16 v[64:67], a[20:23], a[88:91], v[64:67]
  ds_read_b64_tr_b16 a[4:5], v171 offset:9440
  v_cvt_pk_bf16_f32 v54, v60, v61
  v_mfma_f32_16x16x32_bf16 v[68:71], a[20:23], a[92:95], v[68:71]
  ds_read_b64_tr_b16 a[6:7], v171 offset:14048
  v_mfma_f32_16x16x32_bf16 v[64:67], a[24:27], a[96:99], v[64:67]
  ds_read_b64_tr_b16 a[8:9], v171 offset:18656
  v_cvt_pk_bf16_f32 v55, v62, v63
  v_mfma_f32_16x16x32_bf16 v[68:71], a[24:27], a[100:103], v[68:71]
  ds_read_b64_tr_b16 a[10:11], v171 offset:23264
  v_mfma_f32_16x16x32_bf16 v[64:67], a[28:31], a[104:107], v[64:67]
  ds_read_b64_tr_b16 a[12:13], v171 offset:27872
  buffer_store_dwordx4 v[48:51], v173, s[16:19], s48 offen offset:2048 sc1
  v_mfma_f32_16x16x32_bf16 v[68:71], a[28:31], a[108:111], v[68:71]
  ds_read_b64_tr_b16 a[14:15], v171 offset:32480
  s_waitcnt lgkmcnt(8)
  v_mfma_f32_16x16x32_bf16 v[64:67], a[32:35], a[112:115], v[64:67]
  ds_read_b64_tr_b16 a[16:17], v165 offset:224
  buffer_store_dwordx4 v[52:55], v173, s[16:19], s49 offen offset:2048 sc1
  v_mfma_f32_16x16x32_bf16 v[68:71], a[32:35], a[116:119], v[68:71]
  ds_read_b64_tr_b16 a[18:19], v165 offset:4832
  v_mfma_f32_16x16x32_bf16 v[64:67], a[36:39], a[120:123], v[64:67]
  ds_read_b64_tr_b16 a[20:21], v165 offset:9440
  v_mfma_f32_16x16x32_bf16 v[68:71], a[36:39], a[124:127], v[68:71]
  ds_read_b64_tr_b16 a[22:23], v165 offset:14048
  v_mfma_f32_16x16x32_bf16 v[64:67], a[40:43], a[128:131], v[64:67]
  ds_read_b64_tr_b16 a[24:25], v165 offset:18656
  v_mfma_f32_16x16x32_bf16 v[68:71], a[40:43], a[132:135], v[68:71]
  ds_read_b64_tr_b16 a[26:27], v165 offset:23264
  v_mfma_f32_16x16x32_bf16 v[64:67], a[44:47], a[136:139], v[64:67]
  ds_read_b64_tr_b16 a[28:29], v165 offset:27872
  v_mfma_f32_16x16x32_bf16 v[68:71], a[44:47], a[140:143], v[68:71]
  ds_read_b64_tr_b16 a[30:31], v165 offset:32480
  s_waitcnt lgkmcnt(8)
  v_mfma_f32_16x16x32_bf16 v[72:75], a[0:3], a[48:51], v[72:75]
  ds_read_b64_tr_b16 a[32:33], v167 offset:224
  v_mfma_f32_16x16x32_bf16 v[76:79], a[0:3], a[52:55], v[76:79]
  ds_read_b64_tr_b16 a[34:35], v167 offset:4832
  v_mfma_f32_16x16x32_bf16 v[72:75], a[4:7], a[56:59], v[72:75]
  ds_read_b64_tr_b16 a[36:37], v167 offset:9440
  v_mfma_f32_16x16x32_bf16 v[76:79], a[4:7], a[60:63], v[76:79]
  ds_read_b64_tr_b16 a[38:39], v167 offset:14048
  v_mfma_f32_16x16x32_bf16 v[72:75], a[8:11], a[64:67], v[72:75]
  ds_read_b64_tr_b16 a[40:41], v167 offset:18656
  v_mfma_f32_16x16x32_bf16 v[76:79], a[8:11], a[68:71], v[76:79]
  ds_read_b64_tr_b16 a[42:43], v167 offset:23264
  v_mfma_f32_16x16x32_bf16 v[72:75], a[12:15], a[72:75], v[72:75]
  ds_read_b64_tr_b16 a[44:45], v167 offset:27872
  v_cvt_pk_bf16_f32 v64, v64, v65
  v_mfma_f32_16x16x32_bf16 v[76:79], a[12:15], a[76:79], v[76:79]
  ds_read_b64_tr_b16 a[46:47], v167 offset:32480
  s_waitcnt lgkmcnt(8)
  v_mfma_f32_16x16x32_bf16 v[72:75], a[16:19], a[80:83], v[72:75]
  v_cvt_pk_bf16_f32 v65, v66, v67
  v_mfma_f32_16x16x32_bf16 v[76:79], a[16:19], a[84:87], v[76:79]
  v_mfma_f32_16x16x32_bf16 v[72:75], a[20:23], a[88:91], v[72:75]
  v_cvt_pk_bf16_f32 v68, v68, v69
  v_mfma_f32_16x16x32_bf16 v[76:79], a[20:23], a[92:95], v[76:79]
  v_mfma_f32_16x16x32_bf16 v[72:75], a[24:27], a[96:99], v[72:75]
  v_cvt_pk_bf16_f32 v69, v70, v71
  v_mfma_f32_16x16x32_bf16 v[76:79], a[24:27], a[100:103], v[76:79]
  v_mfma_f32_16x16x32_bf16 v[72:75], a[28:31], a[104:107], v[72:75]
  v_mfma_f32_16x16x32_bf16 v[76:79], a[28:31], a[108:111], v[76:79]
  s_waitcnt lgkmcnt(0)
  v_mfma_f32_16x16x32_bf16 v[72:75], a[32:35], a[112:115], v[72:75]
  v_mfma_f32_16x16x32_bf16 v[76:79], a[32:35], a[116:119], v[76:79]
  v_mfma_f32_16x16x32_bf16 v[72:75], a[36:39], a[120:123], v[72:75]
  v_mfma_f32_16x16x32_bf16 v[76:79], a[36:39], a[124:127], v[76:79]
  v_mfma_f32_16x16x32_bf16 v[72:75], a[40:43], a[128:131], v[72:75]
  v_mfma_f32_16x16x32_bf16 v[76:79], a[40:43], a[132:135], v[76:79]
  v_mfma_f32_16x16x32_bf16 v[72:75], a[44:47], a[136:139], v[72:75]
  v_mfma_f32_16x16x32_bf16 v[76:79], a[44:47], a[140:143], v[76:79]
  s_nop 0
  s_nop 5
  v_cvt_pk_bf16_f32 v66, v72, v73
  v_cvt_pk_bf16_f32 v67, v74, v75
  v_cvt_pk_bf16_f32 v70, v76, v77
  v_cvt_pk_bf16_f32 v71, v78, v79
  buffer_store_dwordx4 v[64:67], v173, s[16:19], s48 offen offset:3072 sc1
  buffer_store_dwordx4 v[68:71], v173, s[16:19], s49 offen offset:3072 sc1
  s_waitcnt vmcnt(0)
  s_barrier
  s_cmp_lg_u32 s101, 0
  s_cbranch_scc1 rd2_pub
  s_mov_b64 exec, 1
  v_mov_b32 v6, s100
  buffer_store_dword v6, off, s[20:23], s38 sc1
  s_mov_b64 exec, -1
rd2_pub:
  ds_read_b128 v[88:91], v3 offset:6912
  ds_read_b128 v[92:95], v3 offset:6976
  ds_read_b128 v[96:99], v3 offset:7936
  ds_read_b128 v[100:103], v3 offset:8000
  ds_read_b128 v[104:107], v3 offset:8960
  ds_read_b128 v[108:111], v3 offset:9024
  s_cmp_lg_u32 s101, 0
  s_cbranch_scc1 rd2_poll_ok
  s_mov_b32 s34, 0x40000
rd2_poll:
  buffer_load_dword v5, v4, s[20:23], 0 offen sc1
  s_waitcnt vmcnt(0)
  v_cmp_ne_u32 vcc, s100, v5
  s_nop 1
  s_cbranch_vccz rd2_poll_ok
  s_sleep 1
  s_sub_u32 s34, s34, 1
  s_cbranch_scc0 rd2_poll
rd2_poll_ok:
  s_barrier
  buffer_load_dwordx4 v[8:11], v1, s[8:11], s56 offen sc1
  buffer_load_dwordx4 v[12:15], v1, s[8:11], s60 offen sc1
  buffer_load_dwordx4 v[16:19], v7, s[8:11], s56 offen sc1
  buffer_load_dwordx4 v[20:23], v1, s[8:11], s57 offen sc1
  buffer_load_dwordx4 v[24:27], v1, s[8:11], s61 offen sc1
  buffer_load_dwordx4 v[28:31], v7, s[8:11], s57 offen sc1
  buffer_load_dwordx4 v[32:35], v1, s[8:11], s58 offen sc1
  buffer_load_dwordx4 v[36:39], v1, s[8:11], s62 offen sc1
  buffer_load_dwordx4 v[40:43], v7, s[8:11], s58 offen sc1
  buffer_load_dwordx4 v[44:47], v1, s[8:11], s59 offen sc1
  buffer_load_dwordx4 v[48:51], v1, s[8:11], s63 offen sc1
  buffer_load_dwordx4 v[52:55], v7, s[8:11], s59 offen sc1
  s_waitcnt vmcnt(11)
  v_lshlrev_b32 v188, 16, v8
  v_and_b32 v189, 0xffff0000, v8
  v_lshlrev_b32 v190, 16, v9
  v_and_b32 v191, 0xffff0000, v9
  v_lshlrev_b32 v192, 16, v10
  v_and_b32 v193, 0xffff0000, v10
  v_lshlrev_b32 v194, 16, v11
  v_and_b32 v195, 0xffff0000, v11
  s_waitcnt vmcnt(10)
  v_lshlrev_b32 v196, 16, v12
  v_and_b32 v197, 0xffff0000, v12
  v_lshlrev_b32 v198, 16, v13
  v_and_b32 v199, 0xffff0000, v13
  v_lshlrev_b32 v200, 16, v14
  v_and_b32 v201, 0xffff0000, v14
  v_lshlrev_b32 v202, 16, v15
  v_and_b32 v203, 0xffff0000, v15
  s_waitcnt vmcnt(9)
  v_lshlrev_b32 v204, 16, v16
  v_and_b32 v205, 0xffff0000, v16
  v_lshlrev_b32 v206, 16, v17
  v_and_b32 v207, 0xffff0000, v17
  v_lshlrev_b32 v208, 16, v18
  v_and_b32 v209, 0xffff0000, v18
  v_lshlrev_b32 v210, 16, v19
  v_and_b32 v211, 0xffff0000, v19
  s_waitcnt vmcnt(8)
  v_lshlrev_b32 v212, 16, v20
  v_and_b32 v213, 0xffff0000, v20
  v_lshlrev_b32 v214, 16, v21
  v_and_b32 v215, 0xffff0000, v21
  v_lshlrev_b32 v216, 16, v22
  v_and_b32 v217, 0xffff0000, v22
  v_lshlrev_b32 v218, 16, v23
  v_and_b32 v219, 0xffff0000, v23
  v_pk_add_f32 v[188:189], v[188:189], v[212:213]
  v_pk_add_f32 v[190:191], v[190:191], v[214:215]
  v_pk_add_f32 v[192:193], v[192:193], v[216:217]
  v_pk_add_f32 v[194:195], v[194:195], v[218:219]
  s_waitcnt vmcnt(7)
  v_lshlrev_b32 v212, 16, v24
  v_and_b32 v213, 0xffff0000, v24
  v_lshlrev_b32 v214, 16, v25
  v_and_b32 v215, 0xffff0000, v25
  v_lshlrev_b32 v216, 16, v26
  v_and_b32 v217, 0xffff0000, v26
  v_lshlrev_b32 v218, 16, v27
  v_and_b32 v219, 0xffff0000, v27
  v_pk_add_f32 v[196:197], v[196:197], v[212:213]
  v_pk_add_f32 v[198:199], v[198:199], v[214:215]
  v_pk_add_f32 v[200:201], v[200:201], v[216:217]
  v_pk_add_f32 v[202:203], v[202:203], v[218:219]
  s_waitcnt vmcnt(6)
  v_lshlrev_b32 v212, 16, v28
  v_and_b32 v213, 0xffff0000, v28
  v_lshlrev_b32 v214, 16, v29
  v_and_b32 v215, 0xffff0000, v29
  v_lshlrev_b32 v216, 16, v30
  v_and_b32 v217, 0xffff0000, v30
  v_lshlrev_b32 v218, 16, v31
  v_and_b32 v219, 0xffff0000, v31
  v_pk_add_f32 v[204:205], v[204:205], v[212:213]
  v_pk_add_f32 v[206:207], v[206:207], v[214:215]
  v_pk_add_f32 v[208:209], v[208:209], v[216:217]
  v_pk_add_f32 v[210:211], v[210:211], v[218:219]
  s_waitcnt vmcnt(5)
  v_lshlrev_b32 v212, 16, v32
  v_and_b32 v213, 0xffff0000, v32
  v_lshlrev_b32 v214, 16, v33
  v_and_b32 v215, 0xffff0000, v33
  v_lshlrev_b32 v216, 16, v34
  v_and_b32 v217, 0xffff0000, v34
  v_lshlrev_b32 v218, 16, v35
  v_and_b32 v219, 0xffff0000, v35
  v_pk_add_f32 v[188:189], v[188:189], v[212:213]
  v_pk_add_f32 v[190:191], v[190:191], v[214:215]
  v_pk_add_f32 v[192:193], v[192:193], v[216:217]
  v_pk_add_f32 v[194:195], v[194:195], v[218:219]
  s_waitcnt vmcnt(4)
  v_lshlrev_b32 v212, 16, v36
  v_and_b32 v213, 0xffff0000, v36
  v_lshlrev_b32 v214, 16, v37
  v_and_b32 v215, 0xffff0000, v37
  v_lshlrev_b32 v216, 16, v38
  v_and_b32 v217, 0xffff0000, v38
  v_lshlrev_b32 v218, 16, v39
  v_and_b32 v219, 0xffff0000, v39
  v_pk_add_f32 v[196:197], v[196:197], v[212:213]
  v_pk_add_f32 v[198:199], v[198:199], v[214:215]
  v_pk_add_f32 v[200:201], v[200:201], v[216:217]
  v_pk_add_f32 v[202:203], v[202:203], v[218:219]
  s_waitcnt vmcnt(3)
  v_lshlrev_b32 v212, 16, v40
  v_and_b32 v213, 0xffff0000, v40
  v_lshlrev_b32 v214, 16, v41
  v_and_b32 v215, 0xffff0000, v41
  v_lshlrev_b32 v216, 16, v42
  v_and_b32 v217, 0xffff0000, v42
  v_lshlrev_b32 v218, 16, v43
  v_and_b32 v219, 0xffff0000, v43
  v_pk_add_f32 v[204:205], v[204:205], v[212:213]
  v_pk_add_f32 v[206:207], v[206:207], v[214:215]
  v_pk_add_f32 v[208:209], v[208:209], v[216:217]
  v_pk_add_f32 v[210:211], v[210:211], v[218:219]
  s_waitcnt vmcnt(2)
  v_lshlrev_b32 v212, 16, v44
  v_and_b32 v213, 0xffff0000, v44
  v_lshlrev_b32 v214, 16, v45
  v_and_b32 v215, 0xffff0000, v45
  v_lshlrev_b32 v216, 16, v46
  v_and_b32 v217, 0xffff0000, v46
  v_lshlrev_b32 v218, 16, v47
  v_and_b32 v219, 0xffff0000, v47
  v_pk_add_f32 v[188:189], v[188:189], v[212:213]
  v_pk_add_f32 v[190:191], v[190:191], v[214:215]
  v_pk_add_f32 v[192:193], v[192:193], v[216:217]
  v_pk_add_f32 v[194:195], v[194:195], v[218:219]
  s_waitcnt vmcnt(1)
  v_lshlrev_b32 v212, 16, v48
  v_and_b32 v213, 0xffff0000, v48
  v_lshlrev_b32 v214, 16, v49
  v_and_b32 v215, 0xffff0000, v49
  v_lshlrev_b32 v216, 16, v50
  v_and_b32 v217, 0xffff0000, v50
  v_lshlrev_b32 v218, 16, v51
  v_and_b32 v219, 0xffff0000, v51
  v_pk_add_f32 v[196:197], v[196:197], v[212:213]
  v_pk_add_f32 v[198:199], v[198:199], v[214:215]
  v_pk_add_f32 v[200:201], v[200:201], v[216:217]
  v_pk_add_f32 v[202:203], v[202:203], v[218:219]
  s_waitcnt vmcnt(0)
  v_lshlrev_b32 v212, 16, v52
  v_and_b32 v213, 0xffff0000, v52
  v_lshlrev_b32 v214, 16, v53
  v_and_b32 v215, 0xffff0000, v53
  v_lshlrev_b32 v216, 16, v54
  v_and_b32 v217, 0xffff0000, v54
  v_lshlrev_b32 v218, 16, v55
  v_and_b32 v219, 0xffff0000, v55
  v_pk_add_f32 v[204:205], v[204:205], v[212:213]
  v_pk_add_f32 v[206:207], v[206:207], v[214:215]
  v_pk_add_f32 v[208:209], v[208:209], v[216:217]
  v_pk_add_f32 v[210:211], v[210:211], v[218:219]
  v_lshlrev_b32 v212, 16, v176
  v_and_b32 v213, 0xffff0000, v176
  v_lshlrev_b32 v214, 16, v177
  v_and_b32 v215, 0xffff0000, v177
  v_lshlrev_b32 v216, 16, v178
  v_and_b32 v217, 0xffff0000, v178
  v_lshlrev_b32 v218, 16, v179
  v_and_b32 v219, 0xffff0000, v179
  s_waitcnt lgkmcnt(5)
  v_pk_fma_f32 v[188:189], v[88:89], v[188:189], v[212:213]
  v_pk_fma_f32 v[190:191], v[90:91], v[190:191], v[214:215]
  s_waitcnt lgkmcnt(4)
  v_pk_fma_f32 v[192:193], v[92:93], v[192:193], v[216:217]
  v_pk_fma_f32 v[194:195], v[94:95], v[194:195], v[218:219]
  v_cvt_pk_bf16_f32 v176, v188, v189
  v_cvt_pk_bf16_f32 v177, v190, v191
  v_cvt_pk_bf16_f32 v178, v192, v193
  v_cvt_pk_bf16_f32 v179, v194, v195
  v_lshlrev_b32 v212, 16, v180
  v_and_b32 v213, 0xffff0000, v180
  v_lshlrev_b32 v214, 16, v181
  v_and_b32 v215, 0xffff0000, v181
  v_lshlrev_b32 v216, 16, v182
  v_and_b32 v217, 0xffff0000, v182
  v_lshlrev_b32 v218, 16, v183
  v_and_b32 v219, 0xffff0000, v183
  s_waitcnt lgkmcnt(3)
  v_pk_fma_f32 v[196:197], v[96:97], v[196:197], v[212:213]
  v_pk_fma_f32 v[198:199], v[98:99], v[198:199], v[214:215]
  s_waitcnt lgkmcnt(2)
  v_pk_fma_f32 v[200:201], v[100:101], v[200:201], v[216:217]
  v_pk_fma_f32 v[202:203], v[102:103], v[202:203], v[218:219]
  v_cvt_pk_bf16_f32 v180, v196, v197
  v_cvt_pk_bf16_f32 v181, v198, v199
  v_cvt_pk_bf16_f32 v182, v200, v201
  v_cvt_pk_bf16_f32 v183, v202, v203
  v_lshlrev_b32 v212, 16, v184
  v_and_b32 v213, 0xffff0000, v184
  v_lshlrev_b32 v214, 16, v185
  v_and_b32 v215, 0xffff0000, v185
  v_lshlrev_b32 v216, 16, v186
  v_and_b32 v217, 0xffff0000, v186
  v_lshlrev_b32 v218, 16, v187
  v_and_b32 v219, 0xffff0000, v187
  s_waitcnt lgkmcnt(1)
  v_pk_fma_f32 v[204:205], v[104:105], v[204:205], v[212:213]
  v_pk_fma_f32 v[206:207], v[106:107], v[206:207], v[214:215]
  s_waitcnt lgkmcnt(0)
  v_pk_fma_f32 v[208:209], v[108:109], v[208:209], v[216:217]
  v_pk_fma_f32 v[210:211], v[110:111], v[210:211], v[218:219]
  v_cvt_pk_bf16_f32 v184, v204, v205
  v_cvt_pk_bf16_f32 v185, v206, v207
  v_cvt_pk_bf16_f32 v186, v208, v209
  v_cvt_pk_bf16_f32 v187, v210, v211
  buffer_store_dwordx2 v[176:177], v2, s[40:43], 0 offen
  buffer_store_dwordx2 v[178:179], v2, s[40:43], 0 offen offset:32
  buffer_store_dwordx2 v[180:181], v2, s[40:43], 0 offen offset:512
  buffer_store_dwordx2 v[182:183], v2, s[40:43], 0 offen offset:544
  s_mov_b64 exec, s[54:55]
  buffer_store_dwordx2 v[184:185], v2, s[40:43], 0 offen offset:1024
  buffer_store_dwordx2 v[186:187], v2, s[40:43], 0 offen offset:1056
  s_mov_b64 exec, -1
tail_end:
  s_endpgm
down_kernel_codeend:
wo_kernel_codeend:
.section .rodata,"a"
.p2align 6
.amdhsa_kernel wo_kernel
  .amdhsa_next_free_vgpr 496
  .amdhsa_next_free_sgpr 102
  .amdhsa_accum_offset 256
  .amdhsa_group_segment_fixed_size 0
  .amdhsa_kernarg_size 112
  .amdhsa_user_sgpr_count 2
  .amdhsa_user_sgpr_kernarg_segment_ptr 1
  .amdhsa_system_sgpr_workgroup_id_x 1
.end_amdhsa_kernel
.text
prep_kernel:
prep_kernel_codeend:
  s_endpgm
```
